```python
import torch

def _softmax(x, axis=-1):
    return torch.softmax(x, dim=axis)
def _gelu(x):
    return torch.nn.functional.gelu(x, approximate="tanh")
def _silu(x):
    return torch.nn.functional.silu(x)
def _sigmoid(x):
    return torch.sigmoid(x)
def _layernorm(x, axis=-1, eps=1e-5):
    m = x.mean(dim=axis, keepdim=True)
    v = x.var(dim=axis, keepdim=True, unbiased=False)
    return (x - m) / torch.sqrt(v + eps)
def _scatter_add(tgt, idx, src, axis=0):
    return tgt.clone().index_add_(axis, idx, src)
def _segment_sum(src, seg, n):
    out = torch.zeros((n,) + src.shape[1:], dtype=src.dtype)
    return out.index_add_(0, seg, src)
def _pad(x, pw):
    flat = tuple(v for pair in reversed(pw) for v in pair)
    return torch.nn.functional.pad(x, flat)

kernel_name = 'recurrent_scan__compressed_kv_cla__dense_activation_relu__prompt'

def setup_inputs():

    _w = (lambda a: (lambda t: t.to(torch.bfloat16) if t.is_floating_point() else t)(torch.as_tensor(a)))
    def _A_setup():
        B, H, Sq, Sk, D, M = 1, 32, 2048, 2048, 128, 512
        Dc = 4 * D
        return {
            "x": _w((lambda *s: torch.randn(*s, dtype=torch.bfloat16) * 0.05)(B, Sq, M)),
            "c_kv": _w((lambda *s: torch.randn(*s, dtype=torch.bfloat16) * 0.2)(B, Sk, Dc)),
            "w_q": _w((lambda *s: torch.randn(*s, dtype=torch.bfloat16) * 3.2)(M, H, D) * (M ** -0.5)),
            "w_uk": _w((lambda *s: torch.randn(*s, dtype=torch.bfloat16) * 3.2)(Dc, H, D) * (Dc ** -0.5)),
            "w_uv": _w((lambda *s: torch.randn(*s, dtype=torch.bfloat16) * 0.2)(Dc, H, D) * (Dc ** -0.5)),
            "w_o": _w((lambda *s: torch.randn(*s, dtype=torch.bfloat16) * 0.2)(H, D, M) * ((H * D) ** -0.5)),
        }
    _A_in = _A_setup()

    def _B_setup():
        B, S, D, Dff = 1, 2048, 512, 1376
        return {
            "x": _w((lambda *s: torch.randn(*s, dtype=torch.bfloat16) * 0.05)(B, S, D)),
            "w1": _w((lambda *s: torch.randn(*s, dtype=torch.bfloat16) * 0.1)(D, Dff)),
            "w2": _w((lambda *s: torch.randn(*s, dtype=torch.bfloat16) * 0.1)(Dff, D)),
        }
    _B_in = _B_setup()

    return {
        "A_x": _A_in["x"],
        "A_c_kv": _A_in["c_kv"],
        "A_w_q": _A_in["w_q"],
        "A_w_uk": _A_in["w_uk"],
        "A_w_uv": _A_in["w_uv"],
        "A_w_o": _A_in["w_o"],
        "B_x": _B_in["x"],
        "B_w1": _B_in["w1"],
        "B_w2": _B_in["w2"],
    }

def reference(A_x, A_c_kv, A_w_q, A_w_uk, A_w_uv, A_w_o, B_x, B_w1, B_w2):
    def _A_ref(x, c_kv, w_q, w_uk, w_uv, w_o):
        B, Sq, M = x.shape[0], x.shape[1], x.shape[2]
        Sk = c_kv.shape[1]
        H, D = w_q.shape[1], w_q.shape[2]
        q = torch.einsum("bqm,mhd->bhqd", x, w_q)
        k = torch.einsum("bkc,chd->bhkd", c_kv, w_uk)
        v = torch.einsum("bkc,chd->bhkd", c_kv, w_uv)
        scores = torch.einsum("bhqd,bhkd->bhqk", q, k) * (D ** -0.5)
        off = Sk - Sq
        qi = torch.arange(Sq)[:, None]
        kj = torch.arange(Sk)[None, :]
        cmask = kj <= (qi + off)
        scores = torch.where(cmask[None, None], scores, -1e9)
        p = _softmax(scores, axis=-1)
        ctx = torch.einsum("bhqk,bhkd->bhqd", p, v)
        return torch.einsum("bhqd,hdm->bqm", ctx, w_o)

    def _B_ref(x, w1, w2):
        h = torch.einsum("bsd,df->bsf", x, w1)
        zero = torch.zeros_like(h)
        h = torch.maximum(h, zero)
        return torch.einsum("bsf,fd->bsd", h, w2)

    x = A_x
    xn = _layernorm(x, axis=-1)
    s = _A_ref(xn, A_c_kv, A_w_q, A_w_uk, A_w_uv, A_w_o)
    g = _silu(_B_ref(xn, B_w1, B_w2))
    return x + s * g
```

```asm
; @launch kernel=qa_kernel grid=(256,1,1) block=(512,1,1) lds=163840
.amdgcn_target "amdgcn-amd-amdhsa--gfx950"
.text
.globl qa_kernel
.p2align 8
.type qa_kernel,@function
qa_kernel:
  s_cmp_ge_u32 s2, 256
  s_cbranch_scc1 L_attn_done
  s_load_dwordx2 s[96:97], s[0:1], 0
  s_load_dwordx2 s[80:81], s[0:1], 8
  s_load_dwordx2 s[52:53], s[0:1], 24
  s_load_dwordx2 s[54:55], s[0:1], 32
  s_load_dwordx2 s[60:61], s[0:1], 88
  s_load_dwordx2 s[24:25], s[0:1], 16
  s_load_dwordx2 s[20:21], s[0:1], 56
  s_load_dwordx2 s[76:77], s[0:1], 40
  s_load_dwordx2 s[78:79], s[0:1], 64
  s_load_dwordx2 s[28:29], s[0:1], 80
  v_and_b32 v1, 63, v0
  v_lshrrev_b32 v2, 6, v0
  v_lshlrev_b32 v11, 4, v1
  v_readfirstlane_b32 s93, v2
  s_and_b32 s62, s2, 7
  s_lshr_b32 s63, s2, 3
  s_and_b32 s44, s63, 7
  s_lshr_b32 s63, s63, 3
  s_lshl_b32 s62, s62, 1
  s_and_b32 s40, s63, 1
  s_add_u32 s62, s62, s40
  s_lshr_b32 s92, s63, 1
  s_lshl_b32 s34, s62, 9
  s_and_b32 s73, s44, 3
  s_lshl_b32 s47, s62, 8
  s_lshl_b32 s44, s44, 3
  s_add_u32 s44, s44, s93
  s_lshl_b32 s36, s62, 7
  s_add_u32 s36, s36, s44
  s_lshl_b32 s36, s36, 13
  s_mov_b32 s40, 0x2000000
  s_cmp_eq_u32 s92, 1
  s_cselect_b32 s40, 0x3000000, s40
  s_add_u32 s36, s36, s40
  s_lshl_b32 s32, s93, 11
  s_lshl_b32 s84, s2, 3
  s_add_u32 s84, s84, s93
  s_lshl_b32 s85, s84, 10
  s_lshl_b32 s86, s44, 15
  s_add_u32 s87, s86, 8192
  s_add_u32 s88, s86, 16384
  s_add_u32 s89, s86, 24576
  v_lshrrev_b32 v2, 3, v1
  v_and_b32 v3, 7, v1
  v_lshrrev_b32 v4, 4, v1
  v_xor_b32 v3, v3, v4
  v_lshlrev_b32 v3, 4, v3
  v_lshl_add_u32 v9, v2, 10, v3
  v_xor_b32 v10, 64, v9
  s_mov_b32 s98, 0x200000
  s_mov_b32 s99, 0x00020000
  s_mov_b32 s82, 0x200000
  s_mov_b32 s83, 0x00020000
  s_mov_b32 s18, 0x400000
  s_mov_b32 s19, 0x00020000
  s_waitcnt lgkmcnt(0)
  s_cmp_eq_u32 s92, 1
  s_cselect_b32 s16, s54, s52
  s_cselect_b32 s17, s55, s53
  buffer_load_dwordx4 v[180:183], v11, s[96:99], s85 offen
  s_add_u32 s40, s73, 0
  s_and_b32 s40, s40, 3
  s_lshl_b32 s40, s40, 8
  s_lshl_b32 s86, s44, 15
  s_add_u32 s86, s86, s40
  s_add_u32 s87, s86, 8192
  s_add_u32 s88, s86, 16384
  s_add_u32 s89, s86, 24576
  s_lshl2_add_u32 m0, s32, 98304
  s_nop 0
  buffer_load_dwordx4 v9, s[80:83], s86 offen offset:0 lds
  s_lshl2_add_u32 m0, s32, 99328
  s_nop 0
  buffer_load_dwordx4 v10, s[80:83], s87 offen offset:0 lds
  s_lshl2_add_u32 m0, s32, 100352
  s_nop 0
  buffer_load_dwordx4 v9, s[80:83], s88 offen offset:0 lds
  s_lshl2_add_u32 m0, s32, 101376
  s_nop 0
  buffer_load_dwordx4 v10, s[80:83], s89 offen offset:0 lds
  s_lshl2_add_u32 m0, s32, 102272
  s_nop 0
  buffer_load_dwordx4 v9, s[80:83], s86 offen offset:128 lds
  s_lshl2_add_u32 m0, s32, 103296
  s_nop 0
  buffer_load_dwordx4 v10, s[80:83], s87 offen offset:128 lds
  s_lshl2_add_u32 m0, s32, 104320
  s_nop 0
  buffer_load_dwordx4 v9, s[80:83], s88 offen offset:128 lds
  s_lshl2_add_u32 m0, s32, 105344
  s_nop 0
  buffer_load_dwordx4 v10, s[80:83], s89 offen offset:128 lds
  v_lshrrev_b32 v2, 3, v1
  s_lshl_b32 s40, s93, 4
  v_add_u32 v2, s40, v2
  v_and_b32 v3, 7, v1
  v_lshrrev_b32 v4, 2, v1
  v_and_b32 v4, 4, v4
  v_xor_b32 v3, v3, v4
  v_lshlrev_b32 v3, 4, v3
  v_lshl_add_u32 v7, v2, 13, v3
  v_xor_b32 v0, 32, v7
  s_add_u32 s40, s73, 0
  s_and_b32 s40, s40, 3
  s_lshl_b32 s40, s40, 20
  s_add_u32 s40, s40, s34
  s_add_u32 m0, s32, 0
  s_add_u32 s41, s40, 65536
  buffer_load_dwordx4 v7, s[16:19], s40 offen lds
  s_add_u32 m0, s32, 1024
  s_nop 0
  buffer_load_dwordx4 v0, s[16:19], s41 offen lds
  s_barrier
  s_add_u32 s40, s73, 0
  s_and_b32 s40, s40, 3
  s_lshl_b32 s40, s40, 20
  s_add_u32 s40, s40, s34
  s_add_u32 s40, s40, 128
  s_add_u32 m0, s32, 16384
  s_add_u32 s41, s40, 65536
  buffer_load_dwordx4 v7, s[16:19], s40 offen lds
  s_add_u32 m0, s32, 17408
  s_nop 0
  buffer_load_dwordx4 v0, s[16:19], s41 offen lds
  s_add_u32 s40, s73, 0
  s_and_b32 s40, s40, 3
  s_lshl_b32 s40, s40, 20
  s_add_u32 s40, s40, s34
  s_add_u32 s40, s40, 256
  s_add_u32 m0, s32, 32768
  s_add_u32 s41, s40, 65536
  buffer_load_dwordx4 v7, s[16:19], s40 offen lds
  s_add_u32 m0, s32, 33792
  s_nop 0
  buffer_load_dwordx4 v0, s[16:19], s41 offen lds
  s_add_u32 s40, s73, 0
  s_and_b32 s40, s40, 3
  s_lshl_b32 s40, s40, 20
  s_add_u32 s40, s40, s34
  s_add_u32 s40, s40, 384
  s_add_u32 m0, s32, 49152
  s_add_u32 s41, s40, 65536
  buffer_load_dwordx4 v7, s[16:19], s40 offen lds
  s_add_u32 m0, s32, 50176
  s_nop 0
  buffer_load_dwordx4 v0, s[16:19], s41 offen lds
  s_lshr_b32 s62, s2, 3
  s_lshl_b32 s62, s62, 3
  s_add_u32 s84, s62, s93
  s_and_b32 s62, s2, 7
  s_lshr_b32 s63, s2, 3
  s_lshl_b32 s70, s62, 2
  s_lshr_b32 s101, s63, 3
  s_add_u32 s70, s70, s101
  s_and_b32 s75, s63, 7
  s_sub_u32 s40, 15, s75
  s_lshl_b32 s65, s40, 2
  s_lshl_b32 s66, s75, 2
  s_cmp_lt_u32 s93, 4
  s_cselect_b32 s40, s40, s75
  s_lshl_b32 s40, s40, 2
  s_and_b32 s41, s93, 3
  s_sub_u32 s45, 3, s41
  s_cmp_lt_u32 s93, 4
  s_cselect_b32 s41, s41, s45
  s_add_u32 s45, s40, s41
  s_lshl_b32 s33, s70, 8
  s_lshr_b32 s64, s70, 1
  s_lshl_b32 s64, s64, 8
  s_lshr_b32 s43, s2, 4
  s_lshl_b32 s43, s43, 2
  s_mov_b32 s90, 0xc080400
  s_mov_b32 s91, 0x1a16130f
  s_cmp_eq_u32 s101, 1
  s_cselect_b32 s90, 0xd090501, s90
  s_cselect_b32 s91, 0x1b171410, s91
  s_cmp_eq_u32 s101, 2
  s_cselect_b32 s90, 0xe0a0602, s90
  s_cselect_b32 s91, 0x1c181511, s91
  s_cmp_eq_u32 s101, 3
  s_cselect_b32 s90, 0x1d0b0703, s90
  s_cselect_b32 s91, 0x1d191d12, s91
  s_lshl_b32 s63, s62, 3
  s_lshr_b64 s[90:91], s[90:91], s63
  s_and_b32 s90, s90, 0xff
  s_sub_u32 s91, s90, 32
  s_max_i32 s91, s91, 0
  s_lshl_b32 s91, s91, 3
  s_add_u32 s91, s91, s75
  s_mul_i32 s91, s91, 5
  s_add_u32 s91, s91, 256
  s_cmp_lt_u32 s90, 32
  s_cselect_b32 s46, 1, 0
  s_mul_i32 s35, s90, 96
  s_cmp_eq_u32 s90, 29
  s_cselect_b32 s35, 0x70000000, s35
  s_lshl_b32 s39, s70, 6
  s_add_u32 s39, s39, s45
  s_lshl_b32 s39, s39, 13
  s_add_u32 s39, s39, 0x1000000
  s_cmp_lt_u32 s93, 4
  s_cselect_b32 s39, 0x7fffdff0, s39
  s_mul_i32 s37, s45, 86
  s_mul_i32 s40, s90, 3
  s_add_u32 s37, s37, s40
  s_lshl_b32 s37, s37, 10
  s_add_u32 s37, s37, 0x4000000
  s_add_u32 s38, s37, 2048
  s_cmp_ge_u32 s90, 28
  s_cselect_b32 s38, 0x7ffffff0, s38
  s_cmp_ge_u32 s90, 29
  s_cselect_b32 s37, 0x7ffffff0, s37
  s_mov_b32 s26, 0x400000
  s_mov_b32 s27, 0x00020000
  s_mov_b32 s22, 0x158000
  s_mov_b32 s23, 0x00020000
  s_mov_b32 s30, 256
  s_mov_b32 s31, 0x00020000
  s_lshl_b32 s48, s45, 15
  s_add_u32 s49, s48, 4096
  s_add_u32 s50, s48, 8192
  s_add_u32 s51, s48, 12288
  s_add_u32 s56, s48, 16384
  s_add_u32 s57, s48, 20480
  s_add_u32 s58, s48, 24576
  s_add_u32 s59, s48, 28672
  s_lshr_b32 s62, s2, 1
  s_and_b32 s63, s2, 1
  s_lshl_b32 s91, s62, 14
  s_lshl_b32 s67, s63, 9
  s_add_u32 s91, s91, s67
  s_add_u32 s91, s91, s32
  s_lshl_b32 s63, s63, 2
  s_lshr_b32 s67, s93, 1
  s_add_u32 s67, s67, s63
  s_mul_i32 s67, s67, 342
  s_add_u32 s67, s67, s62
  s_lshl_b32 s67, s67, 1
  s_and_b32 s63, s93, 1
  s_add_u32 s67, s67, s63
  s_lshl_b32 s67, s67, 10
  s_add_u32 s67, s67, 0x6000000
  s_lshl_b32 s62, s2, 3
  s_add_u32 s62, s62, s93
  s_lshl_b32 s62, s62, 10
  s_add_u32 s62, s62, 0x6800000
  s_add_u32 s69, s67, 524288
  s_sub_u32 s68, s91, 1409024
  s_cmp_lt_u32 s2, 172
  s_cselect_b32 s68, s91, s68
  s_cselect_b32 s69, s69, s62
  s_mov_b32 s41, 128
  s_cmp_eq_u32 s46, 1
  s_cselect_b32 s40, 2752, s41
  v_mul_lo_u32 v8, v2, s40
  v_add_u32 v8, v8, v3
  s_mov_b32 s8, s60
  s_mov_b32 s9, s61
  s_mov_b32 s10, 0x200000
  s_mov_b32 s11, 0x00020000
  s_mov_b32 s12, s60
  s_mov_b32 s13, s61
  s_mov_b32 s14, 0x8000000
  s_mov_b32 s15, 0x00020000
  v_lshrrev_b32 v2, 4, v1
  v_lshlrev_b32 v2, 3, v2
  v_bfe_u32 v3, v1, 2, 2
  v_add_u32 v2, v2, v3
  v_lshlrev_b32 v5, 7, v2
  v_bfe_u32 v2, v1, 3, 1
  v_lshl_add_u32 v5, v2, 6, v5
  v_bfe_u32 v2, v1, 4, 1
  v_lshl_add_u32 v5, v2, 5, v5
  v_and_b32 v2, 3, v1
  v_lshl_add_u32 v5, v2, 3, v5
  v_xor_b32 v6, 32, v5
  v_xor_b32 v2, 64, v5
  v_xor_b32 v3, 96, v5
  s_lshr_b32 s85, s2, 2
  s_lshl_b32 s85, s85, 15
  s_and_b32 s63, s2, 1
  s_lshl_b32 s63, s63, 7
  s_add_u32 s85, s85, s63
  s_and_b32 s63, s2, 2
  s_lshl_b32 s63, s63, 9
  s_add_u32 s85, s85, s63
  s_lshl_b32 s63, s93, 12
  s_add_u32 s85, s85, s63
  s_lshl_b32 s63, s93, 13
  s_add_u32 s63, s63, 98304
  v_bfe_u32 v172, v1, 1, 3
  v_lshrrev_b32 v173, 4, v1
  v_xor_b32 v172, v172, v173
  v_lshlrev_b32 v172, 4, v172
  v_and_b32 v173, 15, v1
  v_lshl_add_u32 v172, v173, 7, v172
  v_add_u32 v188, s63, v172
  v_xor_b32 v189, 64, v188
  v_xor_b32 v172, s93, v1
  s_lshl_b32 s62, s93, 10
  s_add_u32 s62, s62, 81920
  v_lshl_add_u32 v186, v172, 4, s62
  v_lshrrev_b32 v172, 3, v1
  v_and_b32 v173, 7, v1
  v_and_b32 v4, 3, v172
  v_lshlrev_b32 v4, 8, v4
  v_lshrrev_b32 v187, 5, v1
  v_lshl_add_u32 v4, v187, 11, v4
  v_lshl_add_u32 v4, v173, 4, v4
  v_xor_b32 v172, v172, v173
  v_lshlrev_b32 v172, 4, v172
  v_lshl_add_u32 v172, v173, 10, v172
  s_lshl_b32 s62, s93, 7
  s_add_u32 s62, s62, 81920
  v_add_u32 v187, s62, v172
  s_waitcnt vmcnt(16)
  v_lshlrev_b32 v172, 16, v180
  v_and_b32 v173, 0xffff0000, v180
  v_lshlrev_b32 v174, 16, v181
  v_and_b32 v175, 0xffff0000, v181
  v_lshlrev_b32 v176, 16, v182
  v_and_b32 v177, 0xffff0000, v182
  v_lshlrev_b32 v178, 16, v183
  v_and_b32 v179, 0xffff0000, v183
  v_add_f32 v180, v172, v173
  v_add_f32 v182, v174, v175
  v_add_f32 v181, v176, v177
  v_add_f32 v183, v178, v179
  v_add_f32 v180, v180, v182
  v_add_f32 v181, v181, v183
  v_add_f32 v180, v180, v181
  s_nop 1
  v_add_f32_dpp v180, v180, v180 quad_perm:[1,0,3,2] row_mask:0xf bank_mask:0xf
  s_nop 1
  v_add_f32_dpp v180, v180, v180 quad_perm:[2,3,0,1] row_mask:0xf bank_mask:0xf
  s_nop 1
  v_add_f32_dpp v180, v180, v180 row_half_mirror row_mask:0xf bank_mask:0xf
  s_nop 1
  v_add_f32_dpp v180, v180, v180 row_mirror row_mask:0xf bank_mask:0xf
  v_mov_b32 v182, v180
  s_nop 1
  v_permlane16_swap_b32 v182, v180
  v_add_f32 v180, v180, v182
  v_mov_b32 v182, v180
  s_nop 1
  v_permlane32_swap_b32 v182, v180
  v_add_f32 v180, v180, v182
  v_mul_f32 v180, 0x3b000000, v180
  v_mov_b32 v181, 0
  v_sub_f32 v183, v172, v180
  v_fmac_f32 v181, v183, v183
  v_sub_f32 v183, v173, v180
  v_fmac_f32 v181, v183, v183
  v_sub_f32 v183, v174, v180
  v_fmac_f32 v181, v183, v183
  v_sub_f32 v183, v175, v180
  v_fmac_f32 v181, v183, v183
  v_sub_f32 v183, v176, v180
  v_fmac_f32 v181, v183, v183
  v_sub_f32 v183, v177, v180
  v_fmac_f32 v181, v183, v183
  v_sub_f32 v183, v178, v180
  v_fmac_f32 v181, v183, v183
  v_sub_f32 v183, v179, v180
  v_fmac_f32 v181, v183, v183
  s_nop 1
  v_add_f32_dpp v181, v181, v181 quad_perm:[1,0,3,2] row_mask:0xf bank_mask:0xf
  s_nop 1
  v_add_f32_dpp v181, v181, v181 quad_perm:[2,3,0,1] row_mask:0xf bank_mask:0xf
  s_nop 1
  v_add_f32_dpp v181, v181, v181 row_half_mirror row_mask:0xf bank_mask:0xf
  s_nop 1
  v_add_f32_dpp v181, v181, v181 row_mirror row_mask:0xf bank_mask:0xf
  v_mov_b32 v182, v181
  s_nop 1
  v_permlane16_swap_b32 v182, v181
  v_add_f32 v181, v181, v182
  v_mov_b32 v182, v181
  s_nop 1
  v_permlane32_swap_b32 v182, v181
  v_add_f32 v181, v181, v182
  v_mul_f32 v181, 0x3b000000, v181
  v_cvt_pk_bf16_f32 v180, v180, v180
  v_and_b32 v180, 0xffff0000, v180
  v_cvt_pk_bf16_f32 v181, v181, v181
  v_and_b32 v181, 0xffff0000, v181
  v_add_f32 v181, 0x3727c5ac, v181
  v_cvt_pk_bf16_f32 v181, v181, v181
  v_and_b32 v181, 0xffff0000, v181
  v_sqrt_f32 v181, v181
  s_nop 0
  v_cvt_pk_bf16_f32 v181, v181, v181
  v_and_b32 v181, 0xffff0000, v181
  v_rcp_f32 v183, v181
  v_sub_f32 v172, v172, v180
  v_sub_f32 v173, v173, v180
  v_sub_f32 v174, v174, v180
  v_sub_f32 v175, v175, v180
  v_sub_f32 v176, v176, v180
  v_sub_f32 v177, v177, v180
  v_sub_f32 v178, v178, v180
  v_sub_f32 v179, v179, v180
  v_cvt_pk_bf16_f32 v184, v172, v173
  v_lshlrev_b32 v172, 16, v184
  v_and_b32 v173, 0xffff0000, v184
  v_cvt_pk_bf16_f32 v185, v174, v175
  v_lshlrev_b32 v174, 16, v185
  v_and_b32 v175, 0xffff0000, v185
  v_cvt_pk_bf16_f32 v184, v176, v177
  v_lshlrev_b32 v176, 16, v184
  v_and_b32 v177, 0xffff0000, v184
  v_cvt_pk_bf16_f32 v185, v178, v179
  v_lshlrev_b32 v178, 16, v185
  v_and_b32 v179, 0xffff0000, v185
  v_mul_f32 v184, v172, v183
  v_fma_f32 v185, -v184, v181, v172
  v_fma_f32 v172, v185, v183, v184
  v_mul_f32 v184, v173, v183
  v_fma_f32 v185, -v184, v181, v173
  v_fma_f32 v173, v185, v183, v184
  v_mul_f32 v184, v174, v183
  v_fma_f32 v185, -v184, v181, v174
  v_fma_f32 v174, v185, v183, v184
  v_mul_f32 v184, v175, v183
  v_fma_f32 v185, -v184, v181, v175
  v_fma_f32 v175, v185, v183, v184
  v_mul_f32 v184, v176, v183
  v_fma_f32 v185, -v184, v181, v176
  v_fma_f32 v176, v185, v183, v184
  v_mul_f32 v184, v177, v183
  v_fma_f32 v185, -v184, v181, v177
  v_fma_f32 v177, v185, v183, v184
  v_mul_f32 v184, v178, v183
  v_fma_f32 v185, -v184, v181, v178
  v_fma_f32 v178, v185, v183, v184
  v_mul_f32 v184, v179, v183
  v_fma_f32 v185, -v184, v181, v179
  v_fma_f32 v179, v185, v183, v184
  v_cvt_pk_bf16_f32 v180, v172, v173
  v_cvt_pk_bf16_f32 v181, v174, v175
  v_cvt_pk_bf16_f32 v182, v176, v177
  v_cvt_pk_bf16_f32 v183, v178, v179
  ds_write_b128 v186, v[180:183]
  s_cmp_eq_u32 s92, 1
  s_cbranch_scc1 L_kv_V
  s_waitcnt vmcnt(12)
  ds_read_b128 a[0:3], v188 offset:0
  ds_read_b128 a[4:7], v188 offset:2048
  ds_read_b128 a[8:11], v189 offset:0
  ds_read_b128 a[12:15], v189 offset:2048
  s_waitcnt vmcnt(8)
  ds_read_b128 a[16:19], v188 offset:4096
  ds_read_b128 a[20:23], v188 offset:6144
  ds_read_b128 a[24:27], v189 offset:4096
  ds_read_b128 a[28:31], v189 offset:6144
  s_waitcnt lgkmcnt(4)
  s_add_u32 s40, s73, 1
  s_and_b32 s40, s40, 3
  s_lshl_b32 s40, s40, 8
  s_lshl_b32 s86, s44, 15
  s_add_u32 s86, s86, s40
  s_add_u32 s87, s86, 8192
  s_add_u32 s88, s86, 16384
  s_add_u32 s89, s86, 24576
  s_lshl2_add_u32 m0, s32, 98304
  s_nop 0
  buffer_load_dwordx4 v9, s[80:83], s86 offen offset:0 lds
  s_lshl2_add_u32 m0, s32, 99328
  s_nop 0
  buffer_load_dwordx4 v10, s[80:83], s87 offen offset:0 lds
  s_lshl2_add_u32 m0, s32, 100352
  s_nop 0
  buffer_load_dwordx4 v9, s[80:83], s88 offen offset:0 lds
  s_lshl2_add_u32 m0, s32, 101376
  s_nop 0
  buffer_load_dwordx4 v10, s[80:83], s89 offen offset:0 lds
  s_waitcnt lgkmcnt(0)
  s_lshl2_add_u32 m0, s32, 102272
  s_nop 0
  buffer_load_dwordx4 v9, s[80:83], s86 offen offset:128 lds
  s_lshl2_add_u32 m0, s32, 103296
  s_nop 0
  buffer_load_dwordx4 v10, s[80:83], s87 offen offset:128 lds
  s_lshl2_add_u32 m0, s32, 104320
  s_nop 0
  buffer_load_dwordx4 v9, s[80:83], s88 offen offset:128 lds
  s_lshl2_add_u32 m0, s32, 105344
  s_nop 0
  buffer_load_dwordx4 v10, s[80:83], s89 offen offset:128 lds
  s_waitcnt vmcnt(14)
  s_barrier
  ds_read_b128 v[180:183], v187
  ds_read_b64_tr_b16 v[140:141], v5 offset:0
  ds_read_b64_tr_b16 v[142:143], v5 offset:512
  ds_read_b64_tr_b16 v[144:145], v6 offset:0
  ds_read_b64_tr_b16 v[146:147], v6 offset:512
  ds_read_b64_tr_b16 v[148:149], v2 offset:0
  ds_read_b64_tr_b16 v[150:151], v2 offset:512
  ds_read_b64_tr_b16 v[152:153], v3 offset:0
  ds_read_b64_tr_b16 v[154:155], v3 offset:512
  ds_read_b64_tr_b16 v[156:157], v5 offset:4096
  ds_read_b64_tr_b16 v[158:159], v5 offset:4608
  s_waitcnt lgkmcnt(8)
  v_mfma_f32_16x16x32_bf16 v[12:15], v[140:143], a[0:3], 0
  ds_read_b64_tr_b16 v[160:161], v6 offset:4096
  ds_read_b64_tr_b16 v[162:163], v6 offset:4608
  v_mfma_f32_16x16x32_bf16 v[20:23], v[140:143], a[4:7], 0
  s_getreg_b32 s62, hwreg(HW_REG_XCC_ID, 0, 4)
  s_mul_i32 s63, s62, 6
  s_mov_b64 s[100:101], 1
  s_lshl_b64 s[100:101], s[100:101], s63
  s_cmp_gt_u32 s62, 7
  s_cselect_b32 s100, 0, s100
  s_cselect_b32 s101, 0, s101
  v_mov_b32 v176, s100
  v_mov_b32 v177, s101
  s_lshl_b32 s62, s93, 12
  v_lshl_add_u32 v178, v1, 12, s62
  s_and_b32 s62, s2, 7
  s_lshl_b32 s62, s62, 3
  s_add_u32 s62, s62, 128
  buffer_atomic_add_x2 v[176:177], v178, s[28:31], s62 offen
  s_waitcnt lgkmcnt(8)
  v_mfma_f32_16x16x32_bf16 v[24:27], v[144:147], a[4:7], 0
  ds_read_b64_tr_b16 v[164:165], v2 offset:4096
  ds_read_b64_tr_b16 v[166:167], v2 offset:4608
  v_mfma_f32_16x16x32_bf16 v[16:19], v[144:147], a[0:3], 0
  buffer_store_dwordx4 v[180:183], v4, s[8:11], s85 offen sc1
  s_lshl_b32 s62, s93, 6
  v_add_u32 v172, s62, v1
  v_cmp_eq_u32 vcc, 0, v172
  v_mov_b32 v173, 0
  v_mov_b32 v172, 0x7ffffff0
  v_cndmask_b32 v172, v172, v173, vcc
  s_lshl_b32 s62, s2, 8
  s_add_u32 s62, s62, 0x7000000
  s_cmp_lt_u32 s2, 160
  s_cselect_b32 s62, s62, 0x7ffffff0
  buffer_store_dword v173, v172, s[12:15], s62 offen sc1
  v_xor_b32 v4, 32, v8
  s_mov_b32 exec_lo, 0xc0cc0c0
  s_mov_b32 exec_hi, 0xc0cc0c0
  v_mov_b32 v8, 0x4000000
  s_mov_b32 exec_lo, 0x3033030
  s_mov_b32 exec_hi, 0x3033030
  v_mov_b32 v4, 0x4000000
  s_mov_b64 exec, -1
  s_waitcnt lgkmcnt(8)
  v_mfma_f32_16x16x32_bf16 v[28:31], v[148:151], a[0:3], 0
  ds_read_b64_tr_b16 v[168:169], v3 offset:4096
  ds_read_b64_tr_b16 v[170:171], v3 offset:4608
  v_mfma_f32_16x16x32_bf16 v[36:39], v[148:151], a[4:7], 0
  s_waitcnt lgkmcnt(8)
  v_mfma_f32_16x16x32_bf16 v[40:43], v[152:155], a[4:7], 0
  ds_read_b64_tr_b16 v[140:141], v5 offset:8192
  ds_read_b64_tr_b16 v[142:143], v5 offset:8704
  v_mfma_f32_16x16x32_bf16 v[32:35], v[152:155], a[0:3], 0
  s_add_u32 s40, s73, 1
  s_and_b32 s40, s40, 3
  s_lshl_b32 s40, s40, 20
  s_add_u32 s40, s40, s34
  s_add_u32 m0, s32, 65536
  s_add_u32 s41, s40, 65536
  buffer_load_dwordx4 v7, s[16:19], s40 offen lds
  s_add_u32 m0, s32, 66560
  s_nop 0
  buffer_load_dwordx4 v0, s[16:19], s41 offen lds
  s_waitcnt lgkmcnt(8)
  v_mfma_f32_16x16x32_bf16 v[12:15], v[156:159], a[8:11], v[12:15]
  ds_read_b64_tr_b16 v[144:145], v6 offset:8192
  ds_read_b64_tr_b16 v[146:147], v6 offset:8704
  v_mfma_f32_16x16x32_bf16 v[20:23], v[156:159], a[12:15], v[20:23]
  s_waitcnt lgkmcnt(8)
  v_mfma_f32_16x16x32_bf16 v[24:27], v[160:163], a[12:15], v[24:27]
  ds_read_b64_tr_b16 v[148:149], v2 offset:8192
  ds_read_b64_tr_b16 v[150:151], v2 offset:8704
  v_mfma_f32_16x16x32_bf16 v[16:19], v[160:163], a[8:11], v[16:19]
  s_waitcnt lgkmcnt(8)
  v_mfma_f32_16x16x32_bf16 v[28:31], v[164:167], a[8:11], v[28:31]
  ds_read_b64_tr_b16 v[152:153], v3 offset:8192
  ds_read_b64_tr_b16 v[154:155], v3 offset:8704
  v_mfma_f32_16x16x32_bf16 v[36:39], v[164:167], a[12:15], v[36:39]
  s_waitcnt lgkmcnt(8)
  v_mfma_f32_16x16x32_bf16 v[40:43], v[168:171], a[12:15], v[40:43]
  ds_read_b64_tr_b16 v[156:157], v5 offset:12288
  ds_read_b64_tr_b16 v[158:159], v5 offset:12800
  v_mfma_f32_16x16x32_bf16 v[32:35], v[168:171], a[8:11], v[32:35]
  s_waitcnt vmcnt(15)
  s_barrier
  s_waitcnt lgkmcnt(8)
  v_mfma_f32_16x16x32_bf16 v[12:15], v[140:143], a[16:19], v[12:15]
  ds_read_b64_tr_b16 v[160:161], v6 offset:12288
  ds_read_b64_tr_b16 v[162:163], v6 offset:12800
  v_mfma_f32_16x16x32_bf16 v[20:23], v[140:143], a[20:23], v[20:23]
  s_waitcnt lgkmcnt(8)
  v_mfma_f32_16x16x32_bf16 v[24:27], v[144:147], a[20:23], v[24:27]
  ds_read_b64_tr_b16 v[164:165], v2 offset:12288
  ds_read_b64_tr_b16 v[166:167], v2 offset:12800
  v_mfma_f32_16x16x32_bf16 v[16:19], v[144:147], a[16:19], v[16:19]
  s_add_u32 s40, s73, 1
  s_and_b32 s40, s40, 3
  s_lshl_b32 s40, s40, 20
  s_add_u32 s40, s40, s34
  s_add_u32 s40, s40, 128
  s_add_u32 m0, s32, 81920
  s_add_u32 s41, s40, 65536
  buffer_load_dwordx4 v7, s[16:19], s40 offen lds
  s_add_u32 m0, s32, 82944
  s_nop 0
  buffer_load_dwordx4 v0, s[16:19], s41 offen lds
  s_waitcnt lgkmcnt(8)
  v_mfma_f32_16x16x32_bf16 v[28:31], v[148:151], a[16:19], v[28:31]
  ds_read_b64_tr_b16 v[168:169], v3 offset:12288
  ds_read_b64_tr_b16 v[170:171], v3 offset:12800
  v_mfma_f32_16x16x32_bf16 v[36:39], v[148:151], a[20:23], v[36:39]
  s_waitcnt lgkmcnt(8)
  v_mfma_f32_16x16x32_bf16 v[40:43], v[152:155], a[20:23], v[40:43]
  ds_read_b64_tr_b16 v[140:141], v5 offset:16384
  ds_read_b64_tr_b16 v[142:143], v5 offset:16896
  v_mfma_f32_16x16x32_bf16 v[32:35], v[152:155], a[16:19], v[32:35]
  s_waitcnt lgkmcnt(8)
  v_mfma_f32_16x16x32_bf16 v[12:15], v[156:159], a[24:27], v[12:15]
  ds_read_b64_tr_b16 v[144:145], v6 offset:16384
  ds_read_b64_tr_b16 v[146:147], v6 offset:16896
  v_mfma_f32_16x16x32_bf16 v[20:23], v[156:159], a[28:31], v[20:23]
  s_waitcnt lgkmcnt(8)
  v_mfma_f32_16x16x32_bf16 v[24:27], v[160:163], a[28:31], v[24:27]
  ds_read_b64_tr_b16 v[148:149], v2 offset:16384
  ds_read_b64_tr_b16 v[150:151], v2 offset:16896
  v_mfma_f32_16x16x32_bf16 v[16:19], v[160:163], a[24:27], v[16:19]
  s_waitcnt lgkmcnt(8)
  v_mfma_f32_16x16x32_bf16 v[28:31], v[164:167], a[24:27], v[28:31]
  ds_read_b64_tr_b16 v[152:153], v3 offset:16384
  ds_read_b64_tr_b16 v[154:155], v3 offset:16896
  v_mfma_f32_16x16x32_bf16 v[36:39], v[164:167], a[28:31], v[36:39]
  s_waitcnt lgkmcnt(8)
  v_mfma_f32_16x16x32_bf16 v[40:43], v[168:171], a[28:31], v[40:43]
  ds_read_b64_tr_b16 v[156:157], v5 offset:20480
  ds_read_b64_tr_b16 v[158:159], v5 offset:20992
  v_mfma_f32_16x16x32_bf16 v[32:35], v[168:171], a[24:27], v[32:35]
  s_waitcnt lgkmcnt(8)
  v_mfma_f32_16x16x32_bf16 v[44:47], v[140:143], a[0:3], 0
  ds_read_b64_tr_b16 v[160:161], v6 offset:20480
  ds_read_b64_tr_b16 v[162:163], v6 offset:20992
  v_mfma_f32_16x16x32_bf16 v[52:55], v[140:143], a[4:7], 0
  s_waitcnt lgkmcnt(8)
  v_mfma_f32_16x16x32_bf16 v[56:59], v[144:147], a[4:7], 0
  ds_read_b64_tr_b16 v[164:165], v2 offset:20480
  ds_read_b64_tr_b16 v[166:167], v2 offset:20992
  v_mfma_f32_16x16x32_bf16 v[48:51], v[144:147], a[0:3], 0
  s_waitcnt lgkmcnt(8)
  v_mfma_f32_16x16x32_bf16 v[60:63], v[148:151], a[0:3], 0
  ds_read_b64_tr_b16 v[168:169], v3 offset:20480
  ds_read_b64_tr_b16 v[170:171], v3 offset:20992
  v_mfma_f32_16x16x32_bf16 v[68:71], v[148:151], a[4:7], 0
  s_waitcnt lgkmcnt(8)
  v_mfma_f32_16x16x32_bf16 v[72:75], v[152:155], a[4:7], 0
  ds_read_b64_tr_b16 v[140:141], v5 offset:24576
  ds_read_b64_tr_b16 v[142:143], v5 offset:25088
  v_mfma_f32_16x16x32_bf16 v[64:67], v[152:155], a[0:3], 0
  s_waitcnt lgkmcnt(8)
  v_mfma_f32_16x16x32_bf16 v[44:47], v[156:159], a[8:11], v[44:47]
  ds_read_b64_tr_b16 v[144:145], v6 offset:24576
  ds_read_b64_tr_b16 v[146:147], v6 offset:25088
  v_mfma_f32_16x16x32_bf16 v[52:55], v[156:159], a[12:15], v[52:55]
  s_waitcnt lgkmcnt(8)
  v_mfma_f32_16x16x32_bf16 v[56:59], v[160:163], a[12:15], v[56:59]
  ds_read_b64_tr_b16 v[148:149], v2 offset:24576
  ds_read_b64_tr_b16 v[150:151], v2 offset:25088
  v_mfma_f32_16x16x32_bf16 v[48:51], v[160:163], a[8:11], v[48:51]
  s_waitcnt lgkmcnt(8)
  v_mfma_f32_16x16x32_bf16 v[60:63], v[164:167], a[8:11], v[60:63]
  ds_read_b64_tr_b16 v[152:153], v3 offset:24576
  ds_read_b64_tr_b16 v[154:155], v3 offset:25088
  v_mfma_f32_16x16x32_bf16 v[68:71], v[164:167], a[12:15], v[68:71]
  s_waitcnt lgkmcnt(8)
  v_mfma_f32_16x16x32_bf16 v[72:75], v[168:171], a[12:15], v[72:75]
  ds_read_b64_tr_b16 v[156:157], v5 offset:28672
  ds_read_b64_tr_b16 v[158:159], v5 offset:29184
  v_mfma_f32_16x16x32_bf16 v[64:67], v[168:171], a[8:11], v[64:67]
  s_waitcnt vmcnt(4)
  s_barrier
  s_lshl_b32 s62, s93, 12
  v_lshl_add_u32 v186, v1, 12, s62
  v_mov_b32 v187, 1
  buffer_atomic_add v187, v186, s[28:31], s43 offen
  s_waitcnt lgkmcnt(8)
  v_mfma_f32_16x16x32_bf16 v[44:47], v[140:143], a[16:19], v[44:47]
  ds_read_b64_tr_b16 v[160:161], v6 offset:28672
  ds_read_b64_tr_b16 v[162:163], v6 offset:29184
  v_mfma_f32_16x16x32_bf16 v[52:55], v[140:143], a[20:23], v[52:55]
  s_waitcnt lgkmcnt(8)
  v_mfma_f32_16x16x32_bf16 v[56:59], v[144:147], a[20:23], v[56:59]
  ds_read_b64_tr_b16 v[164:165], v2 offset:28672
  ds_read_b64_tr_b16 v[166:167], v2 offset:29184
  v_mfma_f32_16x16x32_bf16 v[48:51], v[144:147], a[16:19], v[48:51]
  s_waitcnt lgkmcnt(8)
  v_mfma_f32_16x16x32_bf16 v[60:63], v[148:151], a[16:19], v[60:63]
  ds_read_b64_tr_b16 v[168:169], v3 offset:28672
  ds_read_b64_tr_b16 v[170:171], v3 offset:29184
  v_mfma_f32_16x16x32_bf16 v[68:71], v[148:151], a[20:23], v[68:71]
  s_waitcnt lgkmcnt(8)
  v_mfma_f32_16x16x32_bf16 v[72:75], v[152:155], a[20:23], v[72:75]
  ds_read_b64_tr_b16 v[140:141], v5 offset:32768
  ds_read_b64_tr_b16 v[142:143], v5 offset:33280
  v_mfma_f32_16x16x32_bf16 v[64:67], v[152:155], a[16:19], v[64:67]
  s_add_u32 s40, s73, 1
  s_and_b32 s40, s40, 3
  s_lshl_b32 s40, s40, 20
  s_add_u32 s40, s40, s34
  s_add_u32 s40, s40, 256
  s_add_u32 m0, s32, 0
  s_add_u32 s41, s40, 65536
  buffer_load_dwordx4 v7, s[16:19], s40 offen lds
  s_add_u32 m0, s32, 1024
  s_nop 0
  buffer_load_dwordx4 v0, s[16:19], s41 offen lds
  s_waitcnt lgkmcnt(8)
  v_mfma_f32_16x16x32_bf16 v[44:47], v[156:159], a[24:27], v[44:47]
  ds_read_b64_tr_b16 v[144:145], v6 offset:32768
  ds_read_b64_tr_b16 v[146:147], v6 offset:33280
  v_mfma_f32_16x16x32_bf16 v[52:55], v[156:159], a[28:31], v[52:55]
  s_waitcnt lgkmcnt(8)
  v_mfma_f32_16x16x32_bf16 v[56:59], v[160:163], a[28:31], v[56:59]
  ds_read_b64_tr_b16 v[148:149], v2 offset:32768
  ds_read_b64_tr_b16 v[150:151], v2 offset:33280
  v_mfma_f32_16x16x32_bf16 v[48:51], v[160:163], a[24:27], v[48:51]
  s_waitcnt lgkmcnt(8)
  v_mfma_f32_16x16x32_bf16 v[60:63], v[164:167], a[24:27], v[60:63]
  ds_read_b64_tr_b16 v[152:153], v3 offset:32768
  ds_read_b64_tr_b16 v[154:155], v3 offset:33280
  v_mfma_f32_16x16x32_bf16 v[68:71], v[164:167], a[28:31], v[68:71]
  s_waitcnt lgkmcnt(8)
  v_mfma_f32_16x16x32_bf16 v[72:75], v[168:171], a[28:31], v[72:75]
  ds_read_b64_tr_b16 v[156:157], v5 offset:36864
  ds_read_b64_tr_b16 v[158:159], v5 offset:37376
  v_mfma_f32_16x16x32_bf16 v[64:67], v[168:171], a[24:27], v[64:67]
  s_waitcnt lgkmcnt(8)
  v_mfma_f32_16x16x32_bf16 v[76:79], v[140:143], a[0:3], 0
  ds_read_b64_tr_b16 v[160:161], v6 offset:36864
  ds_read_b64_tr_b16 v[162:163], v6 offset:37376
  v_mfma_f32_16x16x32_bf16 v[84:87], v[140:143], a[4:7], 0
  ds_read_b128 a[32:35], v188 offset:0
  ds_read_b128 a[36:39], v188 offset:2048
  s_waitcnt lgkmcnt(10)
  v_mfma_f32_16x16x32_bf16 v[88:91], v[144:147], a[4:7], 0
  ds_read_b64_tr_b16 v[164:165], v2 offset:36864
  ds_read_b64_tr_b16 v[166:167], v2 offset:37376
  v_mfma_f32_16x16x32_bf16 v[80:83], v[144:147], a[0:3], 0
  ds_read_b128 a[40:43], v189 offset:0
  ds_read_b128 a[44:47], v189 offset:2048
  s_waitcnt lgkmcnt(12)
  v_mfma_f32_16x16x32_bf16 v[92:95], v[148:151], a[0:3], 0
  ds_read_b64_tr_b16 v[168:169], v3 offset:36864
  ds_read_b64_tr_b16 v[170:171], v3 offset:37376
  v_mfma_f32_16x16x32_bf16 v[100:103], v[148:151], a[4:7], 0
  s_waitcnt lgkmcnt(12)
  v_mfma_f32_16x16x32_bf16 v[104:107], v[152:155], a[4:7], 0
  ds_read_b64_tr_b16 v[140:141], v5 offset:40960
  ds_read_b64_tr_b16 v[142:143], v5 offset:41472
  v_mfma_f32_16x16x32_bf16 v[96:99], v[152:155], a[0:3], 0
  s_waitcnt lgkmcnt(12)
  v_mfma_f32_16x16x32_bf16 v[76:79], v[156:159], a[8:11], v[76:79]
  ds_read_b64_tr_b16 v[144:145], v6 offset:40960
  ds_read_b64_tr_b16 v[146:147], v6 offset:41472
  v_mfma_f32_16x16x32_bf16 v[84:87], v[156:159], a[12:15], v[84:87]
  s_waitcnt lgkmcnt(6)
  s_add_u32 s40, s73, 2
  s_and_b32 s40, s40, 3
  s_lshl_b32 s40, s40, 8
  s_lshl_b32 s86, s44, 15
  s_add_u32 s86, s86, s40
  s_add_u32 s87, s86, 8192
  s_add_u32 s88, s86, 16384
  s_add_u32 s89, s86, 24576
  s_lshl2_add_u32 m0, s32, 98304
  s_nop 0
  buffer_load_dwordx4 v9, s[80:83], s86 offen offset:0 lds
  v_mfma_f32_16x16x32_bf16 v[88:91], v[160:163], a[12:15], v[88:91]
  ds_read_b64_tr_b16 v[148:149], v2 offset:40960
  ds_read_b64_tr_b16 v[150:151], v2 offset:41472
  v_mfma_f32_16x16x32_bf16 v[80:83], v[160:163], a[8:11], v[80:83]
  v_mfma_f32_16x16x32_bf16 v[92:95], v[164:167], a[8:11], v[92:95]
  ds_read_b64_tr_b16 v[152:153], v3 offset:40960
  ds_read_b64_tr_b16 v[154:155], v3 offset:41472
  v_mfma_f32_16x16x32_bf16 v[100:103], v[164:167], a[12:15], v[100:103]
  s_lshl2_add_u32 m0, s32, 99328
  s_nop 0
  buffer_load_dwordx4 v10, s[80:83], s87 offen offset:0 lds
  s_waitcnt lgkmcnt(8)
  v_mfma_f32_16x16x32_bf16 v[104:107], v[168:171], a[12:15], v[104:107]
  ds_read_b64_tr_b16 v[156:157], v5 offset:45056
  ds_read_b64_tr_b16 v[158:159], v5 offset:45568
  v_mfma_f32_16x16x32_bf16 v[96:99], v[168:171], a[8:11], v[96:99]
  s_barrier
  s_waitcnt lgkmcnt(8)
  v_mfma_f32_16x16x32_bf16 v[76:79], v[140:143], a[16:19], v[76:79]
  ds_read_b64_tr_b16 v[160:161], v6 offset:45056
  ds_read_b64_tr_b16 v[162:163], v6 offset:45568
  v_mfma_f32_16x16x32_bf16 v[84:87], v[140:143], a[20:23], v[84:87]
  ds_read_b128 a[48:51], v188 offset:4096
  ds_read_b128 a[52:55], v188 offset:6144
  s_waitcnt lgkmcnt(10)
  v_mfma_f32_16x16x32_bf16 v[88:91], v[144:147], a[20:23], v[88:91]
  ds_read_b64_tr_b16 v[164:165], v2 offset:45056
  ds_read_b64_tr_b16 v[166:167], v2 offset:45568
  v_mfma_f32_16x16x32_bf16 v[80:83], v[144:147], a[16:19], v[80:83]
  ds_read_b128 a[56:59], v189 offset:4096
  ds_read_b128 a[60:63], v189 offset:6144
  s_lshl2_add_u32 m0, s32, 100352
  s_nop 0
  buffer_load_dwordx4 v9, s[80:83], s88 offen offset:0 lds
  s_waitcnt lgkmcnt(12)
  v_mfma_f32_16x16x32_bf16 v[92:95], v[148:151], a[16:19], v[92:95]
  ds_read_b64_tr_b16 v[168:169], v3 offset:45056
  ds_read_b64_tr_b16 v[170:171], v3 offset:45568
  v_mfma_f32_16x16x32_bf16 v[100:103], v[148:151], a[20:23], v[100:103]
  s_waitcnt lgkmcnt(12)
  v_mfma_f32_16x16x32_bf16 v[104:107], v[152:155], a[20:23], v[104:107]
  ds_read_b64_tr_b16 v[140:141], v5 offset:49152
  ds_read_b64_tr_b16 v[142:143], v5 offset:49664
  v_mfma_f32_16x16x32_bf16 v[96:99], v[152:155], a[16:19], v[96:99]
  s_add_u32 s40, s73, 1
  s_and_b32 s40, s40, 3
  s_lshl_b32 s40, s40, 20
  s_add_u32 s40, s40, s34
  s_add_u32 s40, s40, 384
  s_add_u32 m0, s32, 16384
  s_add_u32 s41, s40, 65536
  buffer_load_dwordx4 v7, s[16:19], s40 offen lds
  s_add_u32 m0, s32, 17408
  s_nop 0
  buffer_load_dwordx4 v0, s[16:19], s41 offen lds
  s_waitcnt lgkmcnt(12)
  v_mfma_f32_16x16x32_bf16 v[76:79], v[156:159], a[24:27], v[76:79]
  ds_read_b64_tr_b16 v[144:145], v6 offset:49152
  ds_read_b64_tr_b16 v[146:147], v6 offset:49664
  v_mfma_f32_16x16x32_bf16 v[84:87], v[156:159], a[28:31], v[84:87]
  s_waitcnt lgkmcnt(12)
  v_mfma_f32_16x16x32_bf16 v[88:91], v[160:163], a[28:31], v[88:91]
  ds_read_b64_tr_b16 v[148:149], v2 offset:49152
  ds_read_b64_tr_b16 v[150:151], v2 offset:49664
  v_mfma_f32_16x16x32_bf16 v[80:83], v[160:163], a[24:27], v[80:83]
  s_lshl2_add_u32 m0, s32, 101376
  s_nop 0
  buffer_load_dwordx4 v10, s[80:83], s89 offen offset:0 lds
  s_waitcnt lgkmcnt(10)
  v_mfma_f32_16x16x32_bf16 v[92:95], v[164:167], a[24:27], v[92:95]
  ds_read_b64_tr_b16 v[152:153], v3 offset:49152
  ds_read_b64_tr_b16 v[154:155], v3 offset:49664
  v_mfma_f32_16x16x32_bf16 v[100:103], v[164:167], a[28:31], v[100:103]
  s_waitcnt lgkmcnt(8)
  v_mfma_f32_16x16x32_bf16 v[104:107], v[168:171], a[28:31], v[104:107]
  ds_read_b64_tr_b16 v[156:157], v5 offset:53248
  ds_read_b64_tr_b16 v[158:159], v5 offset:53760
  v_mfma_f32_16x16x32_bf16 v[96:99], v[168:171], a[24:27], v[96:99]
  s_waitcnt lgkmcnt(8)
  v_mfma_f32_16x16x32_bf16 v[108:111], v[140:143], a[0:3], 0
  ds_read_b64_tr_b16 v[160:161], v6 offset:53248
  ds_read_b64_tr_b16 v[162:163], v6 offset:53760
  v_mfma_f32_16x16x32_bf16 v[116:119], v[140:143], a[4:7], 0
  s_waitcnt lgkmcnt(8)
  v_mfma_f32_16x16x32_bf16 v[120:123], v[144:147], a[4:7], 0
  ds_read_b64_tr_b16 v[164:165], v2 offset:53248
  ds_read_b64_tr_b16 v[166:167], v2 offset:53760
  v_mfma_f32_16x16x32_bf16 v[112:115], v[144:147], a[0:3], 0
  s_lshl2_add_u32 m0, s32, 102272
  s_nop 0
  buffer_load_dwordx4 v9, s[80:83], s86 offen offset:128 lds
  s_waitcnt lgkmcnt(8)
  v_mfma_f32_16x16x32_bf16 v[124:127], v[148:151], a[0:3], 0
  ds_read_b64_tr_b16 v[168:169], v3 offset:53248
  ds_read_b64_tr_b16 v[170:171], v3 offset:53760
  v_mfma_f32_16x16x32_bf16 v[132:135], v[148:151], a[4:7], 0
  s_waitcnt lgkmcnt(8)
  v_mfma_f32_16x16x32_bf16 v[136:139], v[152:155], a[4:7], 0
  ds_read_b64_tr_b16 v[140:141], v5 offset:57344
  ds_read_b64_tr_b16 v[142:143], v5 offset:57856
  v_mfma_f32_16x16x32_bf16 v[128:131], v[152:155], a[0:3], 0
  s_waitcnt lgkmcnt(8)
  v_mfma_f32_16x16x32_bf16 v[108:111], v[156:159], a[8:11], v[108:111]
  ds_read_b64_tr_b16 v[144:145], v6 offset:57344
  ds_read_b64_tr_b16 v[146:147], v6 offset:57856
  v_mfma_f32_16x16x32_bf16 v[116:119], v[156:159], a[12:15], v[116:119]
  s_lshl2_add_u32 m0, s32, 103296
  s_nop 0
  buffer_load_dwordx4 v10, s[80:83], s87 offen offset:128 lds
  s_waitcnt lgkmcnt(8)
  v_mfma_f32_16x16x32_bf16 v[120:123], v[160:163], a[12:15], v[120:123]
  ds_read_b64_tr_b16 v[148:149], v2 offset:57344
  ds_read_b64_tr_b16 v[150:151], v2 offset:57856
  v_mfma_f32_16x16x32_bf16 v[112:115], v[160:163], a[8:11], v[112:115]
  s_waitcnt lgkmcnt(8)
  v_mfma_f32_16x16x32_bf16 v[124:127], v[164:167], a[8:11], v[124:127]
  ds_read_b64_tr_b16 v[152:153], v3 offset:57344
  ds_read_b64_tr_b16 v[154:155], v3 offset:57856
  v_mfma_f32_16x16x32_bf16 v[132:135], v[164:167], a[12:15], v[132:135]
  s_waitcnt lgkmcnt(8)
  v_mfma_f32_16x16x32_bf16 v[136:139], v[168:171], a[12:15], v[136:139]
  ds_read_b64_tr_b16 v[156:157], v5 offset:61440
  ds_read_b64_tr_b16 v[158:159], v5 offset:61952
  v_mfma_f32_16x16x32_bf16 v[128:131], v[168:171], a[8:11], v[128:131]
  s_waitcnt vmcnt(12)
  s_barrier
  s_waitcnt lgkmcnt(8)
  v_mfma_f32_16x16x32_bf16 v[108:111], v[140:143], a[16:19], v[108:111]
  ds_read_b64_tr_b16 v[160:161], v6 offset:61440
  ds_read_b64_tr_b16 v[162:163], v6 offset:61952
  v_mfma_f32_16x16x32_bf16 v[116:119], v[140:143], a[20:23], v[116:119]
  s_waitcnt lgkmcnt(8)
  v_mfma_f32_16x16x32_bf16 v[120:123], v[144:147], a[20:23], v[120:123]
  ds_read_b64_tr_b16 v[164:165], v2 offset:61440
  ds_read_b64_tr_b16 v[166:167], v2 offset:61952
  v_mfma_f32_16x16x32_bf16 v[112:115], v[144:147], a[16:19], v[112:115]
  s_lshl2_add_u32 m0, s32, 104320
  s_nop 0
  buffer_load_dwordx4 v9, s[80:83], s88 offen offset:128 lds
  s_waitcnt lgkmcnt(8)
  v_mfma_f32_16x16x32_bf16 v[124:127], v[148:151], a[16:19], v[124:127]
  ds_read_b64_tr_b16 v[168:169], v3 offset:61440
  ds_read_b64_tr_b16 v[170:171], v3 offset:61952
  v_mfma_f32_16x16x32_bf16 v[132:135], v[148:151], a[20:23], v[132:135]
  s_waitcnt lgkmcnt(8)
  v_mfma_f32_16x16x32_bf16 v[136:139], v[152:155], a[20:23], v[136:139]
  v_xor_b32 v5, 0x10000, v5
  ds_read_b64_tr_b16 v[140:141], v5 offset:0
  ds_read_b64_tr_b16 v[142:143], v5 offset:512
  v_mfma_f32_16x16x32_bf16 v[128:131], v[152:155], a[16:19], v[128:131]
  s_add_u32 s40, s73, 2
  s_and_b32 s40, s40, 3
  s_lshl_b32 s40, s40, 20
  s_add_u32 s40, s40, s34
  s_add_u32 m0, s32, 32768
  s_add_u32 s41, s40, 65536
  buffer_load_dwordx4 v7, s[16:19], s40 offen lds
  s_add_u32 m0, s32, 33792
  s_nop 0
  buffer_load_dwordx4 v0, s[16:19], s41 offen lds
  s_waitcnt lgkmcnt(8)
  v_mfma_f32_16x16x32_bf16 v[108:111], v[156:159], a[24:27], v[108:111]
  v_xor_b32 v6, 0x10000, v6
  ds_read_b64_tr_b16 v[144:145], v6 offset:0
  ds_read_b64_tr_b16 v[146:147], v6 offset:512
  v_mfma_f32_16x16x32_bf16 v[116:119], v[156:159], a[28:31], v[116:119]
  s_waitcnt lgkmcnt(8)
  v_mfma_f32_16x16x32_bf16 v[120:123], v[160:163], a[28:31], v[120:123]
  v_xor_b32 v2, 0x10000, v2
  ds_read_b64_tr_b16 v[148:149], v2 offset:0
  ds_read_b64_tr_b16 v[150:151], v2 offset:512
  v_mfma_f32_16x16x32_bf16 v[112:115], v[160:163], a[24:27], v[112:115]
  s_lshl2_add_u32 m0, s32, 105344
  s_nop 0
  buffer_load_dwordx4 v10, s[80:83], s89 offen offset:128 lds
  s_waitcnt lgkmcnt(8)
  v_mfma_f32_16x16x32_bf16 v[124:127], v[164:167], a[24:27], v[124:127]
  v_xor_b32 v3, 0x10000, v3
  ds_read_b64_tr_b16 v[152:153], v3 offset:0
  ds_read_b64_tr_b16 v[154:155], v3 offset:512
  v_mfma_f32_16x16x32_bf16 v[132:135], v[164:167], a[28:31], v[132:135]
  s_waitcnt lgkmcnt(8)
  v_mfma_f32_16x16x32_bf16 v[136:139], v[168:171], a[28:31], v[136:139]
  ds_read_b64_tr_b16 v[156:157], v5 offset:4096
  ds_read_b64_tr_b16 v[158:159], v5 offset:4608
  v_mfma_f32_16x16x32_bf16 v[128:131], v[168:171], a[24:27], v[128:131]
  s_waitcnt lgkmcnt(8)
  v_mfma_f32_16x16x32_bf16 v[12:15], v[140:143], a[32:35], v[12:15]
  ds_read_b64_tr_b16 v[160:161], v6 offset:4096
  ds_read_b64_tr_b16 v[162:163], v6 offset:4608
  v_mfma_f32_16x16x32_bf16 v[20:23], v[140:143], a[36:39], v[20:23]
  s_waitcnt lgkmcnt(8)
  v_mfma_f32_16x16x32_bf16 v[24:27], v[144:147], a[36:39], v[24:27]
  ds_read_b64_tr_b16 v[164:165], v2 offset:4096
  ds_read_b64_tr_b16 v[166:167], v2 offset:4608
  v_mfma_f32_16x16x32_bf16 v[16:19], v[144:147], a[32:35], v[16:19]
  s_waitcnt lgkmcnt(8)
  v_mfma_f32_16x16x32_bf16 v[28:31], v[148:151], a[32:35], v[28:31]
  ds_read_b64_tr_b16 v[168:169], v3 offset:4096
  ds_read_b64_tr_b16 v[170:171], v3 offset:4608
  v_mfma_f32_16x16x32_bf16 v[36:39], v[148:151], a[36:39], v[36:39]
  v_lshrrev_b32 v175, 3, v1
  v_bfe_u32 v174, v1, 2, 1
  v_lshlrev_b32 v174, 10, v174
  v_lshl_add_u32 v174, v175, 21, v174
  v_and_b32 v175, 3, v1
  v_lshl_add_u32 v174, v175, 7, v174
  v_bfe_u32 v176, v1, 4, 1
  v_and_b32 v177, 14, v1
  v_lshlrev_b32 v177, 6, v177
  v_lshl_add_u32 v176, v176, 13, v177
  s_lshl_b32 s62, s84, 14
  s_and_b32 s63, s2, 7
  s_lshl_b32 s63, s63, 10
  s_add_u32 s62, s62, s63
  buffer_load_dword v178, v176, s[24:27], s62 offen
  s_waitcnt lgkmcnt(8)
  v_mfma_f32_16x16x32_bf16 v[40:43], v[152:155], a[36:39], v[40:43]
  ds_read_b64_tr_b16 v[140:141], v5 offset:8192
  ds_read_b64_tr_b16 v[142:143], v5 offset:8704
  v_mfma_f32_16x16x32_bf16 v[32:35], v[152:155], a[32:35], v[32:35]
  s_waitcnt lgkmcnt(8)
  v_mfma_f32_16x16x32_bf16 v[12:15], v[156:159], a[40:43], v[12:15]
  ds_read_b64_tr_b16 v[144:145], v6 offset:8192
  ds_read_b64_tr_b16 v[146:147], v6 offset:8704
  v_mfma_f32_16x16x32_bf16 v[20:23], v[156:159], a[44:47], v[20:23]
  s_waitcnt lgkmcnt(8)
  v_mfma_f32_16x16x32_bf16 v[24:27], v[160:163], a[44:47], v[24:27]
  ds_read_b64_tr_b16 v[148:149], v2 offset:8192
  ds_read_b64_tr_b16 v[150:151], v2 offset:8704
  v_mfma_f32_16x16x32_bf16 v[16:19], v[160:163], a[40:43], v[16:19]
  v_bfe_u32 v179, v1, 3, 1
  v_mul_u32_u24 v179, 2752, v179
  v_and_b32 v180, 7, v1
  v_lshl_add_u32 v179, v180, 6, v179
  s_and_b32 s63, s2, 7
  s_lshl_b32 s63, s63, 3
  s_mov_b32 s100, 0xc080400
  s_mov_b32 s101, 0x1a16130f
  s_lshr_b64 s[100:101], s[100:101], s63
  s_and_b32 s62, s100, 0xff
  s_mul_i32 s62, s62, 96
  s_mul_i32 s63, s84, 5504
  s_add_u32 s62, s62, s63
  buffer_load_dword v181, v179, s[20:23], s62 offen
  s_waitcnt lgkmcnt(8)
  v_mfma_f32_16x16x32_bf16 v[28:31], v[164:167], a[40:43], v[28:31]
  ds_read_b64_tr_b16 v[152:153], v3 offset:8192
  ds_read_b64_tr_b16 v[154:155], v3 offset:8704
  v_mfma_f32_16x16x32_bf16 v[36:39], v[164:167], a[44:47], v[36:39]
  s_waitcnt lgkmcnt(8)
  v_mfma_f32_16x16x32_bf16 v[40:43], v[168:171], a[44:47], v[40:43]
  ds_read_b64_tr_b16 v[156:157], v5 offset:12288
  ds_read_b64_tr_b16 v[158:159], v5 offset:12800
  v_mfma_f32_16x16x32_bf16 v[32:35], v[168:171], a[40:43], v[32:35]
  s_waitcnt vmcnt(16)
  s_barrier
  s_waitcnt lgkmcnt(8)
  v_mfma_f32_16x16x32_bf16 v[12:15], v[140:143], a[48:51], v[12:15]
  ds_read_b64_tr_b16 v[160:161], v6 offset:12288
  ds_read_b64_tr_b16 v[162:163], v6 offset:12800
  v_mfma_f32_16x16x32_bf16 v[20:23], v[140:143], a[52:55], v[20:23]
  s_waitcnt lgkmcnt(8)
  v_mfma_f32_16x16x32_bf16 v[24:27], v[144:147], a[52:55], v[24:27]
  ds_read_b64_tr_b16 v[164:165], v2 offset:12288
  ds_read_b64_tr_b16 v[166:167], v2 offset:12800
  v_mfma_f32_16x16x32_bf16 v[16:19], v[144:147], a[48:51], v[16:19]
  s_waitcnt lgkmcnt(8)
  v_mfma_f32_16x16x32_bf16 v[28:31], v[148:151], a[48:51], v[28:31]
  ds_read_b64_tr_b16 v[168:169], v3 offset:12288
  ds_read_b64_tr_b16 v[170:171], v3 offset:12800
  v_mfma_f32_16x16x32_bf16 v[36:39], v[148:151], a[52:55], v[36:39]
  s_waitcnt lgkmcnt(8)
  v_mfma_f32_16x16x32_bf16 v[40:43], v[152:155], a[52:55], v[40:43]
  ds_read_b64_tr_b16 v[140:141], v5 offset:16384
  ds_read_b64_tr_b16 v[142:143], v5 offset:16896
  v_mfma_f32_16x16x32_bf16 v[32:35], v[152:155], a[48:51], v[32:35]
  s_add_u32 s40, s73, 2
  s_and_b32 s40, s40, 3
  s_lshl_b32 s40, s40, 20
  s_add_u32 s40, s40, s34
  s_add_u32 s40, s40, 128
  s_add_u32 m0, s32, 49152
  s_add_u32 s41, s40, 65536
  buffer_load_dwordx4 v7, s[16:19], s40 offen lds
  s_add_u32 m0, s32, 50176
  s_nop 0
  buffer_load_dwordx4 v0, s[16:19], s41 offen lds
  s_waitcnt lgkmcnt(8)
  v_mfma_f32_16x16x32_bf16 v[12:15], v[156:159], a[56:59], v[12:15]
  ds_read_b64_tr_b16 v[144:145], v6 offset:16384
  ds_read_b64_tr_b16 v[146:147], v6 offset:16896
  v_mfma_f32_16x16x32_bf16 v[20:23], v[156:159], a[60:63], v[20:23]
  s_waitcnt lgkmcnt(8)
  v_mfma_f32_16x16x32_bf16 v[24:27], v[160:163], a[60:63], v[24:27]
  ds_read_b64_tr_b16 v[148:149], v2 offset:16384
  ds_read_b64_tr_b16 v[150:151], v2 offset:16896
  v_mfma_f32_16x16x32_bf16 v[16:19], v[160:163], a[56:59], v[16:19]
  s_waitcnt lgkmcnt(8)
  v_mfma_f32_16x16x32_bf16 v[28:31], v[164:167], a[56:59], v[28:31]
  ds_read_b64_tr_b16 v[152:153], v3 offset:16384
  ds_read_b64_tr_b16 v[154:155], v3 offset:16896
  v_mfma_f32_16x16x32_bf16 v[36:39], v[164:167], a[60:63], v[36:39]
  s_waitcnt lgkmcnt(8)
  v_mfma_f32_16x16x32_bf16 v[40:43], v[168:171], a[60:63], v[40:43]
  ds_read_b64_tr_b16 v[156:157], v5 offset:20480
  ds_read_b64_tr_b16 v[158:159], v5 offset:20992
  v_mfma_f32_16x16x32_bf16 v[32:35], v[168:171], a[56:59], v[32:35]
  s_waitcnt lgkmcnt(8)
  v_mfma_f32_16x16x32_bf16 v[44:47], v[140:143], a[32:35], v[44:47]
  ds_read_b64_tr_b16 v[160:161], v6 offset:20480
  ds_read_b64_tr_b16 v[162:163], v6 offset:20992
  v_mfma_f32_16x16x32_bf16 v[52:55], v[140:143], a[36:39], v[52:55]
  s_waitcnt lgkmcnt(8)
  v_mfma_f32_16x16x32_bf16 v[56:59], v[144:147], a[36:39], v[56:59]
  ds_read_b64_tr_b16 v[164:165], v2 offset:20480
  ds_read_b64_tr_b16 v[166:167], v2 offset:20992
  v_mfma_f32_16x16x32_bf16 v[48:51], v[144:147], a[32:35], v[48:51]
  s_waitcnt lgkmcnt(8)
  v_mfma_f32_16x16x32_bf16 v[60:63], v[148:151], a[32:35], v[60:63]
  ds_read_b64_tr_b16 v[168:169], v3 offset:20480
  ds_read_b64_tr_b16 v[170:171], v3 offset:20992
  v_mfma_f32_16x16x32_bf16 v[68:71], v[148:151], a[36:39], v[68:71]
  s_waitcnt lgkmcnt(8)
  v_mfma_f32_16x16x32_bf16 v[72:75], v[152:155], a[36:39], v[72:75]
  ds_read_b64_tr_b16 v[140:141], v5 offset:24576
  ds_read_b64_tr_b16 v[142:143], v5 offset:25088
  v_mfma_f32_16x16x32_bf16 v[64:67], v[152:155], a[32:35], v[64:67]
  s_waitcnt lgkmcnt(8)
  v_mfma_f32_16x16x32_bf16 v[44:47], v[156:159], a[40:43], v[44:47]
  ds_read_b64_tr_b16 v[144:145], v6 offset:24576
  ds_read_b64_tr_b16 v[146:147], v6 offset:25088
  v_mfma_f32_16x16x32_bf16 v[52:55], v[156:159], a[44:47], v[52:55]
  s_waitcnt lgkmcnt(8)
  v_mfma_f32_16x16x32_bf16 v[56:59], v[160:163], a[44:47], v[56:59]
  ds_read_b64_tr_b16 v[148:149], v2 offset:24576
  ds_read_b64_tr_b16 v[150:151], v2 offset:25088
  v_mfma_f32_16x16x32_bf16 v[48:51], v[160:163], a[40:43], v[48:51]
  s_mov_b32 s96, s78
  s_mov_b32 s97, s79
  s_mov_b32 s98, 0x158000
  s_mov_b32 s99, 0x00020000
  s_mov_b64 exec, 0xff
  buffer_load_dword v175, v174, s[96:99], s68 offen
  s_mov_b64 exec, -1
  s_waitcnt lgkmcnt(8)
  v_mfma_f32_16x16x32_bf16 v[60:63], v[164:167], a[40:43], v[60:63]
  ds_read_b64_tr_b16 v[152:153], v3 offset:24576
  ds_read_b64_tr_b16 v[154:155], v3 offset:25088
  v_mfma_f32_16x16x32_bf16 v[68:71], v[164:167], a[44:47], v[68:71]
  s_waitcnt lgkmcnt(8)
  v_mfma_f32_16x16x32_bf16 v[72:75], v[168:171], a[44:47], v[72:75]
  ds_read_b64_tr_b16 v[156:157], v5 offset:28672
  ds_read_b64_tr_b16 v[158:159], v5 offset:29184
  v_mfma_f32_16x16x32_bf16 v[64:67], v[168:171], a[40:43], v[64:67]
  s_waitcnt vmcnt(17)
  s_barrier
  s_waitcnt lgkmcnt(8)
  v_mfma_f32_16x16x32_bf16 v[44:47], v[140:143], a[48:51], v[44:47]
  ds_read_b64_tr_b16 v[160:161], v6 offset:28672
  ds_read_b64_tr_b16 v[162:163], v6 offset:29184
  v_mfma_f32_16x16x32_bf16 v[52:55], v[140:143], a[52:55], v[52:55]
  s_waitcnt lgkmcnt(8)
  v_mfma_f32_16x16x32_bf16 v[56:59], v[144:147], a[52:55], v[56:59]
  ds_read_b64_tr_b16 v[164:165], v2 offset:28672
  ds_read_b64_tr_b16 v[166:167], v2 offset:29184
  v_mfma_f32_16x16x32_bf16 v[48:51], v[144:147], a[48:51], v[48:51]
  s_waitcnt lgkmcnt(8)
  v_mfma_f32_16x16x32_bf16 v[60:63], v[148:151], a[48:51], v[60:63]
  ds_read_b64_tr_b16 v[168:169], v3 offset:28672
  ds_read_b64_tr_b16 v[170:171], v3 offset:29184
  v_mfma_f32_16x16x32_bf16 v[68:71], v[148:151], a[52:55], v[68:71]
  s_waitcnt lgkmcnt(8)
  v_mfma_f32_16x16x32_bf16 v[72:75], v[152:155], a[52:55], v[72:75]
  v_xor_b32 v5, 0x10000, v5
  ds_read_b64_tr_b16 v[140:141], v5 offset:0
  ds_read_b64_tr_b16 v[142:143], v5 offset:512
  v_mfma_f32_16x16x32_bf16 v[64:67], v[152:155], a[48:51], v[64:67]
  s_add_u32 s40, s73, 2
  s_and_b32 s40, s40, 3
  s_lshl_b32 s40, s40, 20
  s_add_u32 s40, s40, s34
  s_add_u32 s40, s40, 256
  s_add_u32 m0, s32, 65536
  s_add_u32 s41, s40, 65536
  buffer_load_dwordx4 v7, s[16:19], s40 offen lds
  s_add_u32 m0, s32, 66560
  s_nop 0
  buffer_load_dwordx4 v0, s[16:19], s41 offen lds
  s_waitcnt lgkmcnt(8)
  v_mfma_f32_16x16x32_bf16 v[44:47], v[156:159], a[56:59], v[44:47]
  v_xor_b32 v6, 0x10000, v6
  ds_read_b64_tr_b16 v[144:145], v6 offset:0
  ds_read_b64_tr_b16 v[146:147], v6 offset:512
  v_mfma_f32_16x16x32_bf16 v[52:55], v[156:159], a[60:63], v[52:55]
  s_waitcnt lgkmcnt(8)
  v_mfma_f32_16x16x32_bf16 v[56:59], v[160:163], a[60:63], v[56:59]
  v_xor_b32 v2, 0x10000, v2
  ds_read_b64_tr_b16 v[148:149], v2 offset:0
  ds_read_b64_tr_b16 v[150:151], v2 offset:512
  v_mfma_f32_16x16x32_bf16 v[48:51], v[160:163], a[56:59], v[48:51]
  s_waitcnt lgkmcnt(8)
  v_mfma_f32_16x16x32_bf16 v[60:63], v[164:167], a[56:59], v[60:63]
  v_xor_b32 v3, 0x10000, v3
  ds_read_b64_tr_b16 v[152:153], v3 offset:0
  ds_read_b64_tr_b16 v[154:155], v3 offset:512
  v_mfma_f32_16x16x32_bf16 v[68:71], v[164:167], a[60:63], v[68:71]
  s_waitcnt lgkmcnt(8)
  v_mfma_f32_16x16x32_bf16 v[72:75], v[168:171], a[60:63], v[72:75]
  ds_read_b64_tr_b16 v[156:157], v5 offset:4096
  ds_read_b64_tr_b16 v[158:159], v5 offset:4608
  v_mfma_f32_16x16x32_bf16 v[64:67], v[168:171], a[56:59], v[64:67]
  s_waitcnt lgkmcnt(8)
  v_mfma_f32_16x16x32_bf16 v[76:79], v[140:143], a[32:35], v[76:79]
  ds_read_b64_tr_b16 v[160:161], v6 offset:4096
  ds_read_b64_tr_b16 v[162:163], v6 offset:4608
  v_mfma_f32_16x16x32_bf16 v[84:87], v[140:143], a[36:39], v[84:87]
  s_waitcnt vmcnt(13)
  ds_read_b128 a[0:3], v188 offset:0
  ds_read_b128 a[4:7], v188 offset:2048
  s_waitcnt lgkmcnt(10)
  v_mfma_f32_16x16x32_bf16 v[88:91], v[144:147], a[36:39], v[88:91]
  ds_read_b64_tr_b16 v[164:165], v2 offset:4096
  ds_read_b64_tr_b16 v[166:167], v2 offset:4608
  v_mfma_f32_16x16x32_bf16 v[80:83], v[144:147], a[32:35], v[80:83]
  ds_read_b128 a[8:11], v189 offset:0
  ds_read_b128 a[12:15], v189 offset:2048
  s_waitcnt lgkmcnt(12)
  v_mfma_f32_16x16x32_bf16 v[92:95], v[148:151], a[32:35], v[92:95]
  ds_read_b64_tr_b16 v[168:169], v3 offset:4096
  ds_read_b64_tr_b16 v[170:171], v3 offset:4608
  v_mfma_f32_16x16x32_bf16 v[100:103], v[148:151], a[36:39], v[100:103]
  s_waitcnt lgkmcnt(12)
  v_mfma_f32_16x16x32_bf16 v[104:107], v[152:155], a[36:39], v[104:107]
  ds_read_b64_tr_b16 v[140:141], v5 offset:8192
  ds_read_b64_tr_b16 v[142:143], v5 offset:8704
  v_mfma_f32_16x16x32_bf16 v[96:99], v[152:155], a[32:35], v[96:99]
  s_waitcnt lgkmcnt(12)
  v_mfma_f32_16x16x32_bf16 v[76:79], v[156:159], a[40:43], v[76:79]
  ds_read_b64_tr_b16 v[144:145], v6 offset:8192
  ds_read_b64_tr_b16 v[146:147], v6 offset:8704
  v_mfma_f32_16x16x32_bf16 v[84:87], v[156:159], a[44:47], v[84:87]
  s_waitcnt lgkmcnt(6)
  s_add_u32 s40, s73, 3
  s_and_b32 s40, s40, 3
  s_lshl_b32 s40, s40, 8
  s_lshl_b32 s86, s44, 15
  s_add_u32 s86, s86, s40
  s_add_u32 s87, s86, 8192
  s_add_u32 s88, s86, 16384
  s_add_u32 s89, s86, 24576
  s_lshl2_add_u32 m0, s32, 98304
  s_nop 0
  buffer_load_dwordx4 v9, s[80:83], s86 offen offset:0 lds
  v_mfma_f32_16x16x32_bf16 v[88:91], v[160:163], a[44:47], v[88:91]
  ds_read_b64_tr_b16 v[148:149], v2 offset:8192
  ds_read_b64_tr_b16 v[150:151], v2 offset:8704
  v_mfma_f32_16x16x32_bf16 v[80:83], v[160:163], a[40:43], v[80:83]
  v_mfma_f32_16x16x32_bf16 v[92:95], v[164:167], a[40:43], v[92:95]
  ds_read_b64_tr_b16 v[152:153], v3 offset:8192
  ds_read_b64_tr_b16 v[154:155], v3 offset:8704
  v_mfma_f32_16x16x32_bf16 v[100:103], v[164:167], a[44:47], v[100:103]
  s_lshl2_add_u32 m0, s32, 99328
  s_nop 0
  buffer_load_dwordx4 v10, s[80:83], s87 offen offset:0 lds
  s_waitcnt lgkmcnt(8)
  v_mfma_f32_16x16x32_bf16 v[104:107], v[168:171], a[44:47], v[104:107]
  ds_read_b64_tr_b16 v[156:157], v5 offset:12288
  ds_read_b64_tr_b16 v[158:159], v5 offset:12800
  v_mfma_f32_16x16x32_bf16 v[96:99], v[168:171], a[40:43], v[96:99]
  s_barrier
  s_waitcnt lgkmcnt(8)
  v_mfma_f32_16x16x32_bf16 v[76:79], v[140:143], a[48:51], v[76:79]
  ds_read_b64_tr_b16 v[160:161], v6 offset:12288
  ds_read_b64_tr_b16 v[162:163], v6 offset:12800
  v_mfma_f32_16x16x32_bf16 v[84:87], v[140:143], a[52:55], v[84:87]
  s_waitcnt vmcnt(9)
  ds_read_b128 a[16:19], v188 offset:4096
  ds_read_b128 a[20:23], v188 offset:6144
  s_waitcnt lgkmcnt(10)
  v_mfma_f32_16x16x32_bf16 v[88:91], v[144:147], a[52:55], v[88:91]
  ds_read_b64_tr_b16 v[164:165], v2 offset:12288
  ds_read_b64_tr_b16 v[166:167], v2 offset:12800
  v_mfma_f32_16x16x32_bf16 v[80:83], v[144:147], a[48:51], v[80:83]
  ds_read_b128 a[24:27], v189 offset:4096
  ds_read_b128 a[28:31], v189 offset:6144
  s_lshl2_add_u32 m0, s32, 100352
  s_nop 0
  buffer_load_dwordx4 v9, s[80:83], s88 offen offset:0 lds
  s_waitcnt lgkmcnt(12)
  v_mfma_f32_16x16x32_bf16 v[92:95], v[148:151], a[48:51], v[92:95]
  ds_read_b64_tr_b16 v[168:169], v3 offset:12288
  ds_read_b64_tr_b16 v[170:171], v3 offset:12800
  v_mfma_f32_16x16x32_bf16 v[100:103], v[148:151], a[52:55], v[100:103]
  s_waitcnt lgkmcnt(12)
  v_mfma_f32_16x16x32_bf16 v[104:107], v[152:155], a[52:55], v[104:107]
  ds_read_b64_tr_b16 v[140:141], v5 offset:16384
  ds_read_b64_tr_b16 v[142:143], v5 offset:16896
  v_mfma_f32_16x16x32_bf16 v[96:99], v[152:155], a[48:51], v[96:99]
  s_add_u32 s40, s73, 2
  s_and_b32 s40, s40, 3
  s_lshl_b32 s40, s40, 20
  s_add_u32 s40, s40, s34
  s_add_u32 s40, s40, 384
  s_add_u32 m0, s32, 81920
  s_add_u32 s41, s40, 65536
  buffer_load_dwordx4 v7, s[16:19], s40 offen lds
  s_add_u32 m0, s32, 82944
  s_nop 0
  buffer_load_dwordx4 v0, s[16:19], s41 offen lds
  s_waitcnt lgkmcnt(12)
  v_mfma_f32_16x16x32_bf16 v[76:79], v[156:159], a[56:59], v[76:79]
  ds_read_b64_tr_b16 v[144:145], v6 offset:16384
  ds_read_b64_tr_b16 v[146:147], v6 offset:16896
  v_mfma_f32_16x16x32_bf16 v[84:87], v[156:159], a[60:63], v[84:87]
  s_waitcnt lgkmcnt(12)
  v_mfma_f32_16x16x32_bf16 v[88:91], v[160:163], a[60:63], v[88:91]
  ds_read_b64_tr_b16 v[148:149], v2 offset:16384
  ds_read_b64_tr_b16 v[150:151], v2 offset:16896
  v_mfma_f32_16x16x32_bf16 v[80:83], v[160:163], a[56:59], v[80:83]
  s_lshl2_add_u32 m0, s32, 101376
  s_nop 0
  buffer_load_dwordx4 v10, s[80:83], s89 offen offset:0 lds
  v_and_b32 v173, 15, v1
  v_lshlrev_b32 v173, 2, v173
  buffer_load_dword v172, v173, s[28:31], 0 offen sc1
  s_waitcnt lgkmcnt(10)
  v_mfma_f32_16x16x32_bf16 v[92:95], v[164:167], a[56:59], v[92:95]
  ds_read_b64_tr_b16 v[152:153], v3 offset:16384
  ds_read_b64_tr_b16 v[154:155], v3 offset:16896
  v_mfma_f32_16x16x32_bf16 v[100:103], v[164:167], a[60:63], v[100:103]
  s_waitcnt lgkmcnt(8)
  v_mfma_f32_16x16x32_bf16 v[104:107], v[168:171], a[60:63], v[104:107]
  ds_read_b64_tr_b16 v[156:157], v5 offset:20480
  ds_read_b64_tr_b16 v[158:159], v5 offset:20992
  v_mfma_f32_16x16x32_bf16 v[96:99], v[168:171], a[56:59], v[96:99]
  s_waitcnt lgkmcnt(8)
  v_mfma_f32_16x16x32_bf16 v[108:111], v[140:143], a[32:35], v[108:111]
  ds_read_b64_tr_b16 v[160:161], v6 offset:20480
  ds_read_b64_tr_b16 v[162:163], v6 offset:20992
  v_mfma_f32_16x16x32_bf16 v[116:119], v[140:143], a[36:39], v[116:119]
  s_waitcnt lgkmcnt(8)
  v_mfma_f32_16x16x32_bf16 v[120:123], v[144:147], a[36:39], v[120:123]
  ds_read_b64_tr_b16 v[164:165], v2 offset:20480
  ds_read_b64_tr_b16 v[166:167], v2 offset:20992
  v_mfma_f32_16x16x32_bf16 v[112:115], v[144:147], a[32:35], v[112:115]
  s_lshl2_add_u32 m0, s32, 102272
  s_nop 0
  buffer_load_dwordx4 v9, s[80:83], s86 offen offset:128 lds
  s_waitcnt lgkmcnt(8)
  v_mfma_f32_16x16x32_bf16 v[124:127], v[148:151], a[32:35], v[124:127]
  ds_read_b64_tr_b16 v[168:169], v3 offset:20480
  ds_read_b64_tr_b16 v[170:171], v3 offset:20992
  v_mfma_f32_16x16x32_bf16 v[132:135], v[148:151], a[36:39], v[132:135]
  s_waitcnt lgkmcnt(8)
  v_mfma_f32_16x16x32_bf16 v[136:139], v[152:155], a[36:39], v[136:139]
  ds_read_b64_tr_b16 v[140:141], v5 offset:24576
  ds_read_b64_tr_b16 v[142:143], v5 offset:25088
  v_mfma_f32_16x16x32_bf16 v[128:131], v[152:155], a[32:35], v[128:131]
  s_waitcnt lgkmcnt(8)
  v_mfma_f32_16x16x32_bf16 v[108:111], v[156:159], a[40:43], v[108:111]
  ds_read_b64_tr_b16 v[144:145], v6 offset:24576
  ds_read_b64_tr_b16 v[146:147], v6 offset:25088
  v_mfma_f32_16x16x32_bf16 v[116:119], v[156:159], a[44:47], v[116:119]
  s_lshl2_add_u32 m0, s32, 103296
  s_nop 0
  buffer_load_dwordx4 v10, s[80:83], s87 offen offset:128 lds
  s_waitcnt lgkmcnt(8)
  v_mfma_f32_16x16x32_bf16 v[120:123], v[160:163], a[44:47], v[120:123]
  ds_read_b64_tr_b16 v[148:149], v2 offset:24576
  ds_read_b64_tr_b16 v[150:151], v2 offset:25088
  v_mfma_f32_16x16x32_bf16 v[112:115], v[160:163], a[40:43], v[112:115]
  s_waitcnt lgkmcnt(8)
  v_mfma_f32_16x16x32_bf16 v[124:127], v[164:167], a[40:43], v[124:127]
  ds_read_b64_tr_b16 v[152:153], v3 offset:24576
  ds_read_b64_tr_b16 v[154:155], v3 offset:25088
  v_mfma_f32_16x16x32_bf16 v[132:135], v[164:167], a[44:47], v[132:135]
  s_waitcnt lgkmcnt(8)
  v_mfma_f32_16x16x32_bf16 v[136:139], v[168:171], a[44:47], v[136:139]
  ds_read_b64_tr_b16 v[156:157], v5 offset:28672
  ds_read_b64_tr_b16 v[158:159], v5 offset:29184
  v_mfma_f32_16x16x32_bf16 v[128:131], v[168:171], a[40:43], v[128:131]
  s_barrier
  s_waitcnt lgkmcnt(8)
  v_mfma_f32_16x16x32_bf16 v[108:111], v[140:143], a[48:51], v[108:111]
  ds_read_b64_tr_b16 v[160:161], v6 offset:28672
  ds_read_b64_tr_b16 v[162:163], v6 offset:29184
  v_mfma_f32_16x16x32_bf16 v[116:119], v[140:143], a[52:55], v[116:119]
  s_waitcnt lgkmcnt(8)
  v_mfma_f32_16x16x32_bf16 v[120:123], v[144:147], a[52:55], v[120:123]
  ds_read_b64_tr_b16 v[164:165], v2 offset:28672
  ds_read_b64_tr_b16 v[166:167], v2 offset:29184
  v_mfma_f32_16x16x32_bf16 v[112:115], v[144:147], a[48:51], v[112:115]
  s_lshl2_add_u32 m0, s32, 104320
  s_nop 0
  buffer_load_dwordx4 v9, s[80:83], s88 offen offset:128 lds
  s_waitcnt lgkmcnt(8)
  v_mfma_f32_16x16x32_bf16 v[124:127], v[148:151], a[48:51], v[124:127]
  ds_read_b64_tr_b16 v[168:169], v3 offset:28672
  ds_read_b64_tr_b16 v[170:171], v3 offset:29184
  v_mfma_f32_16x16x32_bf16 v[132:135], v[148:151], a[52:55], v[132:135]
  s_waitcnt lgkmcnt(8)
  v_mfma_f32_16x16x32_bf16 v[136:139], v[152:155], a[52:55], v[136:139]
  ds_read_b64_tr_b16 v[140:141], v5 offset:32768
  ds_read_b64_tr_b16 v[142:143], v5 offset:33280
  v_mfma_f32_16x16x32_bf16 v[128:131], v[152:155], a[48:51], v[128:131]
  s_add_u32 s40, s73, 3
  s_and_b32 s40, s40, 3
  s_lshl_b32 s40, s40, 20
  s_add_u32 s40, s40, s34
  s_add_u32 m0, s32, 0
  s_add_u32 s41, s40, 65536
  buffer_load_dwordx4 v7, s[16:19], s40 offen lds
  s_add_u32 m0, s32, 1024
  s_nop 0
  buffer_load_dwordx4 v0, s[16:19], s41 offen lds
  s_waitcnt lgkmcnt(8)
  v_mfma_f32_16x16x32_bf16 v[108:111], v[156:159], a[56:59], v[108:111]
  ds_read_b64_tr_b16 v[144:145], v6 offset:32768
  ds_read_b64_tr_b16 v[146:147], v6 offset:33280
  v_mfma_f32_16x16x32_bf16 v[116:119], v[156:159], a[60:63], v[116:119]
  s_waitcnt lgkmcnt(8)
  v_mfma_f32_16x16x32_bf16 v[120:123], v[160:163], a[60:63], v[120:123]
  ds_read_b64_tr_b16 v[148:149], v2 offset:32768
  ds_read_b64_tr_b16 v[150:151], v2 offset:33280
  v_mfma_f32_16x16x32_bf16 v[112:115], v[160:163], a[56:59], v[112:115]
  s_lshl2_add_u32 m0, s32, 105344
  s_nop 0
  buffer_load_dwordx4 v10, s[80:83], s89 offen offset:128 lds
  s_waitcnt lgkmcnt(8)
  v_mfma_f32_16x16x32_bf16 v[124:127], v[164:167], a[56:59], v[124:127]
  ds_read_b64_tr_b16 v[152:153], v3 offset:32768
  ds_read_b64_tr_b16 v[154:155], v3 offset:33280
  v_mfma_f32_16x16x32_bf16 v[132:135], v[164:167], a[60:63], v[132:135]
  s_waitcnt vmcnt(6)
  s_cmp_lg_u32 s93, 0
  s_cbranch_scc1 L_attn_spun_2
  v_cmp_ne_u32 vcc, 16, v172
  s_cbranch_vccnz L_attn_spin_1
L_attn_spun_2:
  s_waitcnt lgkmcnt(8)
  v_mfma_f32_16x16x32_bf16 v[136:139], v[168:171], a[60:63], v[136:139]
  ds_read_b64_tr_b16 v[156:157], v5 offset:36864
  ds_read_b64_tr_b16 v[158:159], v5 offset:37376
  v_mfma_f32_16x16x32_bf16 v[128:131], v[168:171], a[56:59], v[128:131]
  s_and_b32 s62, s2, 7
  s_lshl_b32 s62, s62, 3
  s_add_u32 s62, s62, 128
  buffer_load_dwordx2 v[184:185], off, s[28:31], s62 sc1
  s_waitcnt lgkmcnt(8)
  v_mfma_f32_16x16x32_bf16 v[12:15], v[140:143], a[0:3], v[12:15]
  ds_read_b64_tr_b16 v[160:161], v6 offset:36864
  ds_read_b64_tr_b16 v[162:163], v6 offset:37376
  v_mfma_f32_16x16x32_bf16 v[20:23], v[140:143], a[4:7], v[20:23]
  s_waitcnt lgkmcnt(8)
  v_mfma_f32_16x16x32_bf16 v[24:27], v[144:147], a[4:7], v[24:27]
  ds_read_b64_tr_b16 v[164:165], v2 offset:36864
  ds_read_b64_tr_b16 v[166:167], v2 offset:37376
  v_mfma_f32_16x16x32_bf16 v[16:19], v[144:147], a[0:3], v[16:19]
  s_waitcnt lgkmcnt(8)
  v_mfma_f32_16x16x32_bf16 v[28:31], v[148:151], a[0:3], v[28:31]
  ds_read_b64_tr_b16 v[168:169], v3 offset:36864
  ds_read_b64_tr_b16 v[170:171], v3 offset:37376
  v_mfma_f32_16x16x32_bf16 v[36:39], v[148:151], a[4:7], v[36:39]
  s_waitcnt lgkmcnt(8)
  v_mfma_f32_16x16x32_bf16 v[40:43], v[152:155], a[4:7], v[40:43]
  ds_read_b64_tr_b16 v[140:141], v5 offset:40960
  ds_read_b64_tr_b16 v[142:143], v5 offset:41472
  v_mfma_f32_16x16x32_bf16 v[32:35], v[152:155], a[0:3], v[32:35]
  s_waitcnt lgkmcnt(8)
  v_mfma_f32_16x16x32_bf16 v[12:15], v[156:159], a[8:11], v[12:15]
  ds_read_b64_tr_b16 v[144:145], v6 offset:40960
  ds_read_b64_tr_b16 v[146:147], v6 offset:41472
  v_mfma_f32_16x16x32_bf16 v[20:23], v[156:159], a[12:15], v[20:23]
  s_waitcnt lgkmcnt(8)
  v_mfma_f32_16x16x32_bf16 v[24:27], v[160:163], a[12:15], v[24:27]
  ds_read_b64_tr_b16 v[148:149], v2 offset:40960
  ds_read_b64_tr_b16 v[150:151], v2 offset:41472
  v_mfma_f32_16x16x32_bf16 v[16:19], v[160:163], a[8:11], v[16:19]
  s_waitcnt lgkmcnt(8)
  v_mfma_f32_16x16x32_bf16 v[28:31], v[164:167], a[8:11], v[28:31]
  ds_read_b64_tr_b16 v[152:153], v3 offset:40960
  ds_read_b64_tr_b16 v[154:155], v3 offset:41472
  v_mfma_f32_16x16x32_bf16 v[36:39], v[164:167], a[12:15], v[36:39]
  s_waitcnt lgkmcnt(8)
  v_mfma_f32_16x16x32_bf16 v[40:43], v[168:171], a[12:15], v[40:43]
  ds_read_b64_tr_b16 v[156:157], v5 offset:45056
  ds_read_b64_tr_b16 v[158:159], v5 offset:45568
  v_mfma_f32_16x16x32_bf16 v[32:35], v[168:171], a[8:11], v[32:35]
  s_barrier
  s_waitcnt lgkmcnt(8)
  v_mfma_f32_16x16x32_bf16 v[12:15], v[140:143], a[16:19], v[12:15]
  ds_read_b64_tr_b16 v[160:161], v6 offset:45056
  ds_read_b64_tr_b16 v[162:163], v6 offset:45568
  v_mfma_f32_16x16x32_bf16 v[20:23], v[140:143], a[20:23], v[20:23]
  s_lshr_b32 s62, s2, 6
  s_lshl_b32 s62, s62, 3
  s_add_u32 s62, s62, s93
  s_cmp_lt_u32 s62, 16
  s_cselect_b32 s63, s65, s66
  s_and_b32 s62, s62, 15
  s_lshl_b32 s62, s62, 13
  s_lshl_b32 s63, s63, 15
  s_add_u32 s62, s62, s63
  v_lshl_add_u32 v182, v1, 7, s62
  s_add_u32 s28, s60, 0x7000000
  s_addc_u32 s29, s61, 0
  s_mov_b32 s30, 4096
  s_mov_b32 exec_lo, 0xffff
  s_mov_b32 exec_hi, 0x0
  buffer_load_dword v183, v182, s[8:11], 0 offen
  s_mov_b64 exec, -1
  s_waitcnt lgkmcnt(8)
  v_mfma_f32_16x16x32_bf16 v[24:27], v[144:147], a[20:23], v[24:27]
  ds_read_b64_tr_b16 v[164:165], v2 offset:45056
  ds_read_b64_tr_b16 v[166:167], v2 offset:45568
  v_mfma_f32_16x16x32_bf16 v[16:19], v[144:147], a[16:19], v[16:19]
  s_waitcnt lgkmcnt(8)
  v_mfma_f32_16x16x32_bf16 v[28:31], v[148:151], a[16:19], v[28:31]
  ds_read_b64_tr_b16 v[168:169], v3 offset:45056
  ds_read_b64_tr_b16 v[170:171], v3 offset:45568
  v_mfma_f32_16x16x32_bf16 v[36:39], v[148:151], a[20:23], v[36:39]
  s_waitcnt lgkmcnt(8)
  v_mfma_f32_16x16x32_bf16 v[40:43], v[152:155], a[20:23], v[40:43]
  ds_read_b64_tr_b16 v[140:141], v5 offset:49152
  ds_read_b64_tr_b16 v[142:143], v5 offset:49664
  v_mfma_f32_16x16x32_bf16 v[32:35], v[152:155], a[16:19], v[32:35]
  s_add_u32 s40, s73, 3
  s_and_b32 s40, s40, 3
  s_lshl_b32 s40, s40, 20
  s_add_u32 s40, s40, s34
  s_add_u32 s40, s40, 128
  s_add_u32 m0, s32, 16384
  s_add_u32 s41, s40, 65536
  buffer_load_dwordx4 v7, s[16:19], s40 offen lds
  s_add_u32 m0, s32, 17408
  s_nop 0
  buffer_load_dwordx4 v0, s[16:19], s41 offen lds
  s_waitcnt lgkmcnt(8)
  v_mfma_f32_16x16x32_bf16 v[12:15], v[156:159], a[24:27], v[12:15]
  ds_read_b64_tr_b16 v[144:145], v6 offset:49152
  ds_read_b64_tr_b16 v[146:147], v6 offset:49664
  v_mfma_f32_16x16x32_bf16 v[20:23], v[156:159], a[28:31], v[20:23]
  s_waitcnt lgkmcnt(8)
  v_mfma_f32_16x16x32_bf16 v[24:27], v[160:163], a[28:31], v[24:27]
  ds_read_b64_tr_b16 v[148:149], v2 offset:49152
  ds_read_b64_tr_b16 v[150:151], v2 offset:49664
  v_mfma_f32_16x16x32_bf16 v[16:19], v[160:163], a[24:27], v[16:19]
  s_waitcnt lgkmcnt(8)
  v_mfma_f32_16x16x32_bf16 v[28:31], v[164:167], a[24:27], v[28:31]
  ds_read_b64_tr_b16 v[152:153], v3 offset:49152
  ds_read_b64_tr_b16 v[154:155], v3 offset:49664
  v_mfma_f32_16x16x32_bf16 v[36:39], v[164:167], a[28:31], v[36:39]
  s_waitcnt lgkmcnt(8)
  v_mfma_f32_16x16x32_bf16 v[40:43], v[168:171], a[28:31], v[40:43]
  ds_read_b64_tr_b16 v[156:157], v5 offset:53248
  ds_read_b64_tr_b16 v[158:159], v5 offset:53760
  v_mfma_f32_16x16x32_bf16 v[32:35], v[168:171], a[24:27], v[32:35]
  s_waitcnt lgkmcnt(8)
  v_mfma_f32_16x16x32_bf16 v[44:47], v[140:143], a[0:3], v[44:47]
  ds_read_b64_tr_b16 v[160:161], v6 offset:53248
  ds_read_b64_tr_b16 v[162:163], v6 offset:53760
  v_mfma_f32_16x16x32_bf16 v[52:55], v[140:143], a[4:7], v[52:55]
  s_waitcnt lgkmcnt(8)
  v_mfma_f32_16x16x32_bf16 v[56:59], v[144:147], a[4:7], v[56:59]
  ds_read_b64_tr_b16 v[164:165], v2 offset:53248
  ds_read_b64_tr_b16 v[166:167], v2 offset:53760
  v_mfma_f32_16x16x32_bf16 v[48:51], v[144:147], a[0:3], v[48:51]
  s_waitcnt lgkmcnt(8)
  v_mfma_f32_16x16x32_bf16 v[60:63], v[148:151], a[0:3], v[60:63]
  ds_read_b64_tr_b16 v[168:169], v3 offset:53248
  ds_read_b64_tr_b16 v[170:171], v3 offset:53760
  v_mfma_f32_16x16x32_bf16 v[68:71], v[148:151], a[4:7], v[68:71]
  s_mov_b32 exec_lo, 0xffff0000
  s_mov_b32 exec_hi, 0x0
  buffer_load_dword v183, v182, s[8:11], 0 offen
  s_mov_b64 exec, -1
  s_waitcnt lgkmcnt(8)
  v_mfma_f32_16x16x32_bf16 v[72:75], v[152:155], a[4:7], v[72:75]
  ds_read_b64_tr_b16 v[140:141], v5 offset:57344
  ds_read_b64_tr_b16 v[142:143], v5 offset:57856
  v_mfma_f32_16x16x32_bf16 v[64:67], v[152:155], a[0:3], v[64:67]
  s_waitcnt lgkmcnt(8)
  v_mfma_f32_16x16x32_bf16 v[44:47], v[156:159], a[8:11], v[44:47]
  ds_read_b64_tr_b16 v[144:145], v6 offset:57344
  ds_read_b64_tr_b16 v[146:147], v6 offset:57856
  v_mfma_f32_16x16x32_bf16 v[52:55], v[156:159], a[12:15], v[52:55]
  s_waitcnt lgkmcnt(8)
  v_mfma_f32_16x16x32_bf16 v[56:59], v[160:163], a[12:15], v[56:59]
  ds_read_b64_tr_b16 v[148:149], v2 offset:57344
  ds_read_b64_tr_b16 v[150:151], v2 offset:57856
  v_mfma_f32_16x16x32_bf16 v[48:51], v[160:163], a[8:11], v[48:51]
  s_waitcnt lgkmcnt(8)
  v_mfma_f32_16x16x32_bf16 v[60:63], v[164:167], a[8:11], v[60:63]
  ds_read_b64_tr_b16 v[152:153], v3 offset:57344
  ds_read_b64_tr_b16 v[154:155], v3 offset:57856
  v_mfma_f32_16x16x32_bf16 v[68:71], v[164:167], a[12:15], v[68:71]
  s_waitcnt lgkmcnt(8)
  v_mfma_f32_16x16x32_bf16 v[72:75], v[168:171], a[12:15], v[72:75]
  ds_read_b64_tr_b16 v[156:157], v5 offset:61440
  ds_read_b64_tr_b16 v[158:159], v5 offset:61952
  v_mfma_f32_16x16x32_bf16 v[64:67], v[168:171], a[8:11], v[64:67]
  s_barrier
  s_waitcnt lgkmcnt(8)
  v_mfma_f32_16x16x32_bf16 v[44:47], v[140:143], a[16:19], v[44:47]
  ds_read_b64_tr_b16 v[160:161], v6 offset:61440
  ds_read_b64_tr_b16 v[162:163], v6 offset:61952
  v_mfma_f32_16x16x32_bf16 v[52:55], v[140:143], a[20:23], v[52:55]
  s_waitcnt lgkmcnt(8)
  v_mfma_f32_16x16x32_bf16 v[56:59], v[144:147], a[20:23], v[56:59]
  ds_read_b64_tr_b16 v[164:165], v2 offset:61440
  ds_read_b64_tr_b16 v[166:167], v2 offset:61952
  v_mfma_f32_16x16x32_bf16 v[48:51], v[144:147], a[16:19], v[48:51]
  s_mov_b32 exec_lo, 0x0
  s_mov_b32 exec_hi, 0xffff
  buffer_load_dword v183, v182, s[8:11], 0 offen
  s_mov_b64 exec, -1
  s_waitcnt lgkmcnt(8)
  v_mfma_f32_16x16x32_bf16 v[60:63], v[148:151], a[16:19], v[60:63]
  ds_read_b64_tr_b16 v[168:169], v3 offset:61440
  ds_read_b64_tr_b16 v[170:171], v3 offset:61952
  v_mfma_f32_16x16x32_bf16 v[68:71], v[148:151], a[20:23], v[68:71]
  s_waitcnt lgkmcnt(8)
  v_mfma_f32_16x16x32_bf16 v[72:75], v[152:155], a[20:23], v[72:75]
  v_xor_b32 v5, 0x10000, v5
  ds_read_b64_tr_b16 v[140:141], v5 offset:0
  ds_read_b64_tr_b16 v[142:143], v5 offset:512
  v_mfma_f32_16x16x32_bf16 v[64:67], v[152:155], a[16:19], v[64:67]
  s_add_u32 s40, s73, 3
  s_and_b32 s40, s40, 3
  s_lshl_b32 s40, s40, 20
  s_add_u32 s40, s40, s34
  s_add_u32 s40, s40, 256
  s_add_u32 m0, s32, 32768
  s_add_u32 s41, s40, 65536
  buffer_load_dwordx4 v7, s[16:19], s40 offen lds
  s_add_u32 m0, s32, 33792
  s_nop 0
  buffer_load_dwordx4 v0, s[16:19], s41 offen lds
  s_waitcnt lgkmcnt(8)
  v_mfma_f32_16x16x32_bf16 v[44:47], v[156:159], a[24:27], v[44:47]
  v_xor_b32 v6, 0x10000, v6
  ds_read_b64_tr_b16 v[144:145], v6 offset:0
  ds_read_b64_tr_b16 v[146:147], v6 offset:512
  v_mfma_f32_16x16x32_bf16 v[52:55], v[156:159], a[28:31], v[52:55]
  s_waitcnt lgkmcnt(8)
  v_mfma_f32_16x16x32_bf16 v[56:59], v[160:163], a[28:31], v[56:59]
  v_xor_b32 v2, 0x10000, v2
  ds_read_b64_tr_b16 v[148:149], v2 offset:0
  ds_read_b64_tr_b16 v[150:151], v2 offset:512
  v_mfma_f32_16x16x32_bf16 v[48:51], v[160:163], a[24:27], v[48:51]
  s_waitcnt lgkmcnt(8)
  v_mfma_f32_16x16x32_bf16 v[60:63], v[164:167], a[24:27], v[60:63]
  v_xor_b32 v3, 0x10000, v3
  ds_read_b64_tr_b16 v[152:153], v3 offset:0
  ds_read_b64_tr_b16 v[154:155], v3 offset:512
  v_mfma_f32_16x16x32_bf16 v[68:71], v[164:167], a[28:31], v[68:71]
  s_waitcnt lgkmcnt(8)
  v_mfma_f32_16x16x32_bf16 v[72:75], v[168:171], a[28:31], v[72:75]
  ds_read_b64_tr_b16 v[156:157], v5 offset:4096
  ds_read_b64_tr_b16 v[158:159], v5 offset:4608
  v_mfma_f32_16x16x32_bf16 v[64:67], v[168:171], a[24:27], v[64:67]
  s_waitcnt lgkmcnt(8)
  v_mfma_f32_16x16x32_bf16 v[76:79], v[140:143], a[0:3], v[76:79]
  ds_read_b64_tr_b16 v[160:161], v6 offset:4096
  ds_read_b64_tr_b16 v[162:163], v6 offset:4608
  v_mfma_f32_16x16x32_bf16 v[84:87], v[140:143], a[4:7], v[84:87]
  ds_read_b128 a[32:35], v188 offset:0
  ds_read_b128 a[36:39], v188 offset:2048
  s_waitcnt lgkmcnt(10)
  v_mfma_f32_16x16x32_bf16 v[88:91], v[144:147], a[4:7], v[88:91]
  ds_read_b64_tr_b16 v[164:165], v2 offset:4096
  ds_read_b64_tr_b16 v[166:167], v2 offset:4608
  v_mfma_f32_16x16x32_bf16 v[80:83], v[144:147], a[0:3], v[80:83]
  ds_read_b128 a[40:43], v189 offset:0
  ds_read_b128 a[44:47], v189 offset:2048
  s_waitcnt lgkmcnt(12)
  v_mfma_f32_16x16x32_bf16 v[92:95], v[148:151], a[0:3], v[92:95]
  ds_read_b64_tr_b16 v[168:169], v3 offset:4096
  ds_read_b64_tr_b16 v[170:171], v3 offset:4608
  v_mfma_f32_16x16x32_bf16 v[100:103], v[148:151], a[4:7], v[100:103]
  s_waitcnt lgkmcnt(12)
  v_mfma_f32_16x16x32_bf16 v[104:107], v[152:155], a[4:7], v[104:107]
  ds_read_b64_tr_b16 v[140:141], v5 offset:8192
  ds_read_b64_tr_b16 v[142:143], v5 offset:8704
  v_mfma_f32_16x16x32_bf16 v[96:99], v[152:155], a[0:3], v[96:99]
  s_waitcnt lgkmcnt(12)
  v_mfma_f32_16x16x32_bf16 v[76:79], v[156:159], a[8:11], v[76:79]
  ds_read_b64_tr_b16 v[144:145], v6 offset:8192
  ds_read_b64_tr_b16 v[146:147], v6 offset:8704
  v_mfma_f32_16x16x32_bf16 v[84:87], v[156:159], a[12:15], v[84:87]
  s_mov_b32 exec_lo, 0x0
  s_mov_b32 exec_hi, 0xffff0000
  buffer_load_dword v183, v182, s[8:11], 0 offen
  s_mov_b64 exec, -1
  s_waitcnt lgkmcnt(12)
  v_mfma_f32_16x16x32_bf16 v[88:91], v[160:163], a[12:15], v[88:91]
  ds_read_b64_tr_b16 v[148:149], v2 offset:8192
  ds_read_b64_tr_b16 v[150:151], v2 offset:8704
  v_mfma_f32_16x16x32_bf16 v[80:83], v[160:163], a[8:11], v[80:83]
  s_waitcnt vmcnt(8)
  v_readfirstlane_b32 s100, v184
  v_readfirstlane_b32 s101, v185
  s_getreg_b32 s62, hwreg(HW_REG_XCC_ID, 0, 4)
  s_mul_i32 s63, s62, 6
  s_lshr_b64 s[100:101], s[100:101], s63
  s_and_b32 s100, s100, 63
  s_cmp_eq_u32 s100, 32
  s_cselect_b32 s43, 1, 0
  s_cmp_gt_u32 s62, 7
  s_cselect_b32 s43, 0, s43
  s_waitcnt lgkmcnt(10)
  v_mfma_f32_16x16x32_bf16 v[92:95], v[164:167], a[8:11], v[92:95]
  ds_read_b64_tr_b16 v[152:153], v3 offset:8192
  ds_read_b64_tr_b16 v[154:155], v3 offset:8704
  v_mfma_f32_16x16x32_bf16 v[100:103], v[164:167], a[12:15], v[100:103]
  s_waitcnt lgkmcnt(8)
  v_mfma_f32_16x16x32_bf16 v[104:107], v[168:171], a[12:15], v[104:107]
  ds_read_b64_tr_b16 v[156:157], v5 offset:12288
  ds_read_b64_tr_b16 v[158:159], v5 offset:12800
  v_mfma_f32_16x16x32_bf16 v[96:99], v[168:171], a[8:11], v[96:99]
  s_barrier
  s_waitcnt lgkmcnt(8)
  v_mfma_f32_16x16x32_bf16 v[76:79], v[140:143], a[16:19], v[76:79]
  ds_read_b64_tr_b16 v[160:161], v6 offset:12288
  ds_read_b64_tr_b16 v[162:163], v6 offset:12800
  v_mfma_f32_16x16x32_bf16 v[84:87], v[140:143], a[20:23], v[84:87]
  ds_read_b128 a[48:51], v188 offset:4096
  ds_read_b128 a[52:55], v188 offset:6144
  s_waitcnt lgkmcnt(10)
  v_mfma_f32_16x16x32_bf16 v[88:91], v[144:147], a[20:23], v[88:91]
  ds_read_b64_tr_b16 v[164:165], v2 offset:12288
  ds_read_b64_tr_b16 v[166:167], v2 offset:12800
  v_mfma_f32_16x16x32_bf16 v[80:83], v[144:147], a[16:19], v[80:83]
  ds_read_b128 a[56:59], v189 offset:4096
  ds_read_b128 a[60:63], v189 offset:6144
  s_waitcnt lgkmcnt(12)
  v_mfma_f32_16x16x32_bf16 v[92:95], v[148:151], a[16:19], v[92:95]
  ds_read_b64_tr_b16 v[168:169], v3 offset:12288
  ds_read_b64_tr_b16 v[170:171], v3 offset:12800
  v_mfma_f32_16x16x32_bf16 v[100:103], v[148:151], a[20:23], v[100:103]
  s_waitcnt lgkmcnt(12)
  v_mfma_f32_16x16x32_bf16 v[104:107], v[152:155], a[20:23], v[104:107]
  ds_read_b64_tr_b16 v[140:141], v5 offset:16384
  ds_read_b64_tr_b16 v[142:143], v5 offset:16896
  v_mfma_f32_16x16x32_bf16 v[96:99], v[152:155], a[16:19], v[96:99]
  s_add_u32 s40, s73, 3
  s_and_b32 s40, s40, 3
  s_lshl_b32 s40, s40, 20
  s_add_u32 s40, s40, s34
  s_add_u32 s40, s40, 384
  s_add_u32 m0, s32, 49152
  s_add_u32 s41, s40, 65536
  buffer_load_dwordx4 v7, s[16:19], s40 offen lds
  s_add_u32 m0, s32, 50176
  s_nop 0
  buffer_load_dwordx4 v0, s[16:19], s41 offen lds
  s_waitcnt lgkmcnt(12)
  v_mfma_f32_16x16x32_bf16 v[76:79], v[156:159], a[24:27], v[76:79]
  ds_read_b64_tr_b16 v[144:145], v6 offset:16384
  ds_read_b64_tr_b16 v[146:147], v6 offset:16896
  v_mfma_f32_16x16x32_bf16 v[84:87], v[156:159], a[28:31], v[84:87]
  s_waitcnt lgkmcnt(12)
  v_mfma_f32_16x16x32_bf16 v[88:91], v[160:163], a[28:31], v[88:91]
  ds_read_b64_tr_b16 v[148:149], v2 offset:16384
  ds_read_b64_tr_b16 v[150:151], v2 offset:16896
  v_mfma_f32_16x16x32_bf16 v[80:83], v[160:163], a[24:27], v[80:83]
  s_waitcnt lgkmcnt(10)
  v_mfma_f32_16x16x32_bf16 v[92:95], v[164:167], a[24:27], v[92:95]
  ds_read_b64_tr_b16 v[152:153], v3 offset:16384
  ds_read_b64_tr_b16 v[154:155], v3 offset:16896
  v_mfma_f32_16x16x32_bf16 v[100:103], v[164:167], a[28:31], v[100:103]
  s_waitcnt lgkmcnt(8)
  v_mfma_f32_16x16x32_bf16 v[104:107], v[168:171], a[28:31], v[104:107]
  ds_read_b64_tr_b16 v[156:157], v5 offset:20480
  ds_read_b64_tr_b16 v[158:159], v5 offset:20992
  v_mfma_f32_16x16x32_bf16 v[96:99], v[168:171], a[24:27], v[96:99]
  s_waitcnt lgkmcnt(8)
  v_mfma_f32_16x16x32_bf16 v[108:111], v[140:143], a[0:3], v[108:111]
  ds_read_b64_tr_b16 v[160:161], v6 offset:20480
  ds_read_b64_tr_b16 v[162:163], v6 offset:20992
  v_mfma_f32_16x16x32_bf16 v[116:119], v[140:143], a[4:7], v[116:119]
  s_waitcnt lgkmcnt(8)
  v_mfma_f32_16x16x32_bf16 v[120:123], v[144:147], a[4:7], v[120:123]
  ds_read_b64_tr_b16 v[164:165], v2 offset:20480
  ds_read_b64_tr_b16 v[166:167], v2 offset:20992
  v_mfma_f32_16x16x32_bf16 v[112:115], v[144:147], a[0:3], v[112:115]
  s_waitcnt lgkmcnt(8)
  v_mfma_f32_16x16x32_bf16 v[124:127], v[148:151], a[0:3], v[124:127]
  ds_read_b64_tr_b16 v[168:169], v3 offset:20480
  ds_read_b64_tr_b16 v[170:171], v3 offset:20992
  v_mfma_f32_16x16x32_bf16 v[132:135], v[148:151], a[4:7], v[132:135]
  s_waitcnt lgkmcnt(8)
  v_mfma_f32_16x16x32_bf16 v[136:139], v[152:155], a[4:7], v[136:139]
  ds_read_b64_tr_b16 v[140:141], v5 offset:24576
  ds_read_b64_tr_b16 v[142:143], v5 offset:25088
  v_mfma_f32_16x16x32_bf16 v[128:131], v[152:155], a[0:3], v[128:131]
  s_waitcnt lgkmcnt(8)
  v_mfma_f32_16x16x32_bf16 v[108:111], v[156:159], a[8:11], v[108:111]
  ds_read_b64_tr_b16 v[144:145], v6 offset:24576
  ds_read_b64_tr_b16 v[146:147], v6 offset:25088
  v_mfma_f32_16x16x32_bf16 v[116:119], v[156:159], a[12:15], v[116:119]
  s_waitcnt lgkmcnt(8)
  v_mfma_f32_16x16x32_bf16 v[120:123], v[160:163], a[12:15], v[120:123]
  ds_read_b64_tr_b16 v[148:149], v2 offset:24576
  ds_read_b64_tr_b16 v[150:151], v2 offset:25088
  v_mfma_f32_16x16x32_bf16 v[112:115], v[160:163], a[8:11], v[112:115]
  s_waitcnt lgkmcnt(8)
  v_mfma_f32_16x16x32_bf16 v[124:127], v[164:167], a[8:11], v[124:127]
  ds_read_b64_tr_b16 v[152:153], v3 offset:24576
  ds_read_b64_tr_b16 v[154:155], v3 offset:25088
  v_mfma_f32_16x16x32_bf16 v[132:135], v[164:167], a[12:15], v[132:135]
  s_waitcnt lgkmcnt(8)
  v_mfma_f32_16x16x32_bf16 v[136:139], v[168:171], a[12:15], v[136:139]
  ds_read_b64_tr_b16 v[156:157], v5 offset:28672
  ds_read_b64_tr_b16 v[158:159], v5 offset:29184
  v_mfma_f32_16x16x32_bf16 v[128:131], v[168:171], a[8:11], v[128:131]
  s_barrier
  s_waitcnt lgkmcnt(8)
  v_mfma_f32_16x16x32_bf16 v[108:111], v[140:143], a[16:19], v[108:111]
  ds_read_b64_tr_b16 v[160:161], v6 offset:28672
  ds_read_b64_tr_b16 v[162:163], v6 offset:29184
  v_mfma_f32_16x16x32_bf16 v[116:119], v[140:143], a[20:23], v[116:119]
  s_waitcnt lgkmcnt(8)
  v_mfma_f32_16x16x32_bf16 v[120:123], v[144:147], a[20:23], v[120:123]
  ds_read_b64_tr_b16 v[164:165], v2 offset:28672
  ds_read_b64_tr_b16 v[166:167], v2 offset:29184
  v_mfma_f32_16x16x32_bf16 v[112:115], v[144:147], a[16:19], v[112:115]
  s_waitcnt lgkmcnt(8)
  v_mfma_f32_16x16x32_bf16 v[124:127], v[148:151], a[16:19], v[124:127]
  ds_read_b64_tr_b16 v[168:169], v3 offset:28672
  ds_read_b64_tr_b16 v[170:171], v3 offset:29184
  v_mfma_f32_16x16x32_bf16 v[132:135], v[148:151], a[20:23], v[132:135]
  s_waitcnt lgkmcnt(8)
  v_mfma_f32_16x16x32_bf16 v[136:139], v[152:155], a[20:23], v[136:139]
  v_xor_b32 v5, 0x10000, v5
  ds_read_b64_tr_b16 v[140:141], v5 offset:0
  ds_read_b64_tr_b16 v[142:143], v5 offset:512
  v_mfma_f32_16x16x32_bf16 v[128:131], v[152:155], a[16:19], v[128:131]
  s_add_u32 s40, s33, 0x0
  s_add_u32 m0, s32, 65536
  s_add_u32 s41, s40, 65536
  buffer_load_dwordx4 v7, s[24:27], s40 offen lds
  s_add_u32 m0, s32, 66560
  s_nop 0
  buffer_load_dwordx4 v0, s[24:27], s41 offen lds
  s_waitcnt lgkmcnt(8)
  v_mfma_f32_16x16x32_bf16 v[108:111], v[156:159], a[24:27], v[108:111]
  v_xor_b32 v6, 0x10000, v6
  ds_read_b64_tr_b16 v[144:145], v6 offset:0
  ds_read_b64_tr_b16 v[146:147], v6 offset:512
  v_mfma_f32_16x16x32_bf16 v[116:119], v[156:159], a[28:31], v[116:119]
  s_waitcnt lgkmcnt(8)
  v_mfma_f32_16x16x32_bf16 v[120:123], v[160:163], a[28:31], v[120:123]
  v_xor_b32 v2, 0x10000, v2
  ds_read_b64_tr_b16 v[148:149], v2 offset:0
  ds_read_b64_tr_b16 v[150:151], v2 offset:512
  v_mfma_f32_16x16x32_bf16 v[112:115], v[160:163], a[24:27], v[112:115]
  s_waitcnt lgkmcnt(8)
  v_mfma_f32_16x16x32_bf16 v[124:127], v[164:167], a[24:27], v[124:127]
  v_xor_b32 v3, 0x10000, v3
  ds_read_b64_tr_b16 v[152:153], v3 offset:0
  ds_read_b64_tr_b16 v[154:155], v3 offset:512
  v_mfma_f32_16x16x32_bf16 v[132:135], v[164:167], a[28:31], v[132:135]
  s_waitcnt lgkmcnt(8)
  v_mfma_f32_16x16x32_bf16 v[136:139], v[168:171], a[28:31], v[136:139]
  ds_read_b64_tr_b16 v[156:157], v5 offset:4096
  ds_read_b64_tr_b16 v[158:159], v5 offset:4608
  v_mfma_f32_16x16x32_bf16 v[128:131], v[168:171], a[24:27], v[128:131]
  s_waitcnt lgkmcnt(8)
  v_mfma_f32_16x16x32_bf16 v[12:15], v[140:143], a[32:35], v[12:15]
  ds_read_b64_tr_b16 v[160:161], v6 offset:4096
  ds_read_b64_tr_b16 v[162:163], v6 offset:4608
  v_mfma_f32_16x16x32_bf16 v[20:23], v[140:143], a[36:39], v[20:23]
  buffer_load_dwordx4 a[0:3], v11, s[8:11], s48 offen offset:0 sc1
  s_waitcnt lgkmcnt(8)
  v_mfma_f32_16x16x32_bf16 v[24:27], v[144:147], a[36:39], v[24:27]
  ds_read_b64_tr_b16 v[164:165], v2 offset:4096
  ds_read_b64_tr_b16 v[166:167], v2 offset:4608
  v_mfma_f32_16x16x32_bf16 v[16:19], v[144:147], a[32:35], v[16:19]
  s_waitcnt lgkmcnt(8)
  v_mfma_f32_16x16x32_bf16 v[28:31], v[148:151], a[32:35], v[28:31]
  ds_read_b64_tr_b16 v[168:169], v3 offset:4096
  ds_read_b64_tr_b16 v[170:171], v3 offset:4608
  v_mfma_f32_16x16x32_bf16 v[36:39], v[148:151], a[36:39], v[36:39]
  v_lshrrev_b32 v9, 5, v1
  v_and_b32 v10, 31, v1
  v_lshlrev_b32 v189, 4, v10
  s_waitcnt lgkmcnt(8)
  v_mfma_f32_16x16x32_bf16 v[40:43], v[152:155], a[36:39], v[40:43]
  ds_read_b64_tr_b16 v[140:141], v5 offset:8192
  ds_read_b64_tr_b16 v[142:143], v5 offset:8704
  v_mfma_f32_16x16x32_bf16 v[32:35], v[152:155], a[32:35], v[32:35]
  buffer_load_dwordx4 a[4:7], v11, s[8:11], s48 offen offset:1024 sc1
  v_lshl_add_u32 v189, v9, 10, v189
  v_lshlrev_b32 v9, 3, v9
  v_bfe_u32 v10, v1, 2, 2
  s_waitcnt lgkmcnt(8)
  v_mfma_f32_16x16x32_bf16 v[12:15], v[156:159], a[40:43], v[12:15]
  ds_read_b64_tr_b16 v[144:145], v6 offset:8192
  ds_read_b64_tr_b16 v[146:147], v6 offset:8704
  v_mfma_f32_16x16x32_bf16 v[20:23], v[156:159], a[44:47], v[20:23]
  v_add_u32 v9, v9, v10
  v_lshlrev_b32 v188, 9, v9
  v_bfe_u32 v9, v1, 4, 1
  s_waitcnt lgkmcnt(8)
  v_mfma_f32_16x16x32_bf16 v[24:27], v[160:163], a[44:47], v[24:27]
  ds_read_b64_tr_b16 v[148:149], v2 offset:8192
  ds_read_b64_tr_b16 v[150:151], v2 offset:8704
  v_mfma_f32_16x16x32_bf16 v[16:19], v[160:163], a[40:43], v[16:19]
  v_lshl_add_u32 v188, v9, 5, v188
  v_and_b32 v9, 3, v1
  v_lshl_add_u32 v188, v9, 3, v188
  s_waitcnt lgkmcnt(8)
  v_mfma_f32_16x16x32_bf16 v[28:31], v[164:167], a[40:43], v[28:31]
  ds_read_b64_tr_b16 v[152:153], v3 offset:8192
  ds_read_b64_tr_b16 v[154:155], v3 offset:8704
  v_mfma_f32_16x16x32_bf16 v[36:39], v[164:167], a[44:47], v[36:39]
  s_lshl_b32 s62, s93, 6
  s_add_u32 s62, s62, 98304
  v_add_u32 v188, s62, v188
  s_waitcnt lgkmcnt(8)
  v_mfma_f32_16x16x32_bf16 v[40:43], v[168:171], a[44:47], v[40:43]
  ds_read_b64_tr_b16 v[156:157], v5 offset:12288
  ds_read_b64_tr_b16 v[158:159], v5 offset:12800
  v_mfma_f32_16x16x32_bf16 v[32:35], v[168:171], a[40:43], v[32:35]
  s_waitcnt vmcnt(11)
  s_barrier
  s_waitcnt lgkmcnt(8)
  v_mfma_f32_16x16x32_bf16 v[12:15], v[140:143], a[48:51], v[12:15]
  ds_read_b64_tr_b16 v[160:161], v6 offset:12288
  ds_read_b64_tr_b16 v[162:163], v6 offset:12800
  v_mfma_f32_16x16x32_bf16 v[20:23], v[140:143], a[52:55], v[20:23]
  s_waitcnt lgkmcnt(8)
  v_mfma_f32_16x16x32_bf16 v[24:27], v[144:147], a[52:55], v[24:27]
  ds_read_b64_tr_b16 v[164:165], v2 offset:12288
  ds_read_b64_tr_b16 v[166:167], v2 offset:12800
  v_mfma_f32_16x16x32_bf16 v[16:19], v[144:147], a[48:51], v[16:19]
  buffer_load_dwordx4 a[8:11], v11, s[8:11], s48 offen offset:2048 sc1
  s_waitcnt lgkmcnt(8)
  v_mfma_f32_16x16x32_bf16 v[28:31], v[148:151], a[48:51], v[28:31]
  ds_read_b64_tr_b16 v[168:169], v3 offset:12288
  ds_read_b64_tr_b16 v[170:171], v3 offset:12800
  v_mfma_f32_16x16x32_bf16 v[36:39], v[148:151], a[52:55], v[36:39]
  s_waitcnt lgkmcnt(8)
  v_mfma_f32_16x16x32_bf16 v[40:43], v[152:155], a[52:55], v[40:43]
  ds_read_b64_tr_b16 v[140:141], v5 offset:16384
  ds_read_b64_tr_b16 v[142:143], v5 offset:16896
  v_mfma_f32_16x16x32_bf16 v[32:35], v[152:155], a[48:51], v[32:35]
  s_add_u32 s40, s33, 0x80
  s_add_u32 m0, s32, 81920
  s_add_u32 s41, s40, 65536
  buffer_load_dwordx4 v7, s[24:27], s40 offen lds
  s_add_u32 m0, s32, 82944
  s_nop 0
  buffer_load_dwordx4 v0, s[24:27], s41 offen lds
  s_waitcnt lgkmcnt(8)
  v_mfma_f32_16x16x32_bf16 v[12:15], v[156:159], a[56:59], v[12:15]
  ds_read_b64_tr_b16 v[144:145], v6 offset:16384
  ds_read_b64_tr_b16 v[146:147], v6 offset:16896
  v_mfma_f32_16x16x32_bf16 v[20:23], v[156:159], a[60:63], v[20:23]
  buffer_load_dwordx4 a[12:15], v11, s[8:11], s48 offen offset:3072 sc1
  s_waitcnt lgkmcnt(8)
  v_mfma_f32_16x16x32_bf16 v[24:27], v[160:163], a[60:63], v[24:27]
  ds_read_b64_tr_b16 v[148:149], v2 offset:16384
  ds_read_b64_tr_b16 v[150:151], v2 offset:16896
  v_mfma_f32_16x16x32_bf16 v[16:19], v[160:163], a[56:59], v[16:19]
  s_waitcnt lgkmcnt(8)
  v_mfma_f32_16x16x32_bf16 v[28:31], v[164:167], a[56:59], v[28:31]
  ds_read_b64_tr_b16 v[152:153], v3 offset:16384
  ds_read_b64_tr_b16 v[154:155], v3 offset:16896
  v_mfma_f32_16x16x32_bf16 v[36:39], v[164:167], a[60:63], v[36:39]
  s_waitcnt lgkmcnt(8)
  v_mfma_f32_16x16x32_bf16 v[40:43], v[168:171], a[60:63], v[40:43]
  ds_read_b64_tr_b16 v[156:157], v5 offset:20480
  ds_read_b64_tr_b16 v[158:159], v5 offset:20992
  v_mfma_f32_16x16x32_bf16 v[32:35], v[168:171], a[56:59], v[32:35]
  s_waitcnt lgkmcnt(8)
  v_mfma_f32_16x16x32_bf16 v[44:47], v[140:143], a[32:35], v[44:47]
  ds_read_b64_tr_b16 v[160:161], v6 offset:20480
  ds_read_b64_tr_b16 v[162:163], v6 offset:20992
  v_mfma_f32_16x16x32_bf16 v[52:55], v[140:143], a[36:39], v[52:55]
  buffer_load_dwordx4 a[16:19], v11, s[8:11], s49 offen offset:0 sc1
  s_waitcnt lgkmcnt(8)
  v_mfma_f32_16x16x32_bf16 v[56:59], v[144:147], a[36:39], v[56:59]
  ds_read_b64_tr_b16 v[164:165], v2 offset:20480
  ds_read_b64_tr_b16 v[166:167], v2 offset:20992
  v_mfma_f32_16x16x32_bf16 v[48:51], v[144:147], a[32:35], v[48:51]
  s_waitcnt lgkmcnt(8)
  v_mfma_f32_16x16x32_bf16 v[60:63], v[148:151], a[32:35], v[60:63]
  ds_read_b64_tr_b16 v[168:169], v3 offset:20480
  ds_read_b64_tr_b16 v[170:171], v3 offset:20992
  v_mfma_f32_16x16x32_bf16 v[68:71], v[148:151], a[36:39], v[68:71]
  v_cvt_pk_bf16_f32 v12, v12, v13
  v_cvt_pk_bf16_f32 v13, v14, v15
  v_cvt_pk_bf16_f32 v14, v16, v17
  v_cvt_pk_bf16_f32 v15, v18, v19
  s_waitcnt lgkmcnt(8)
  v_mfma_f32_16x16x32_bf16 v[72:75], v[152:155], a[36:39], v[72:75]
  ds_read_b64_tr_b16 v[140:141], v5 offset:24576
  ds_read_b64_tr_b16 v[142:143], v5 offset:25088
  v_mfma_f32_16x16x32_bf16 v[64:67], v[152:155], a[32:35], v[64:67]
  buffer_load_dwordx4 a[20:23], v11, s[8:11], s49 offen offset:1024 sc1
  v_cvt_pk_bf16_f32 v16, v20, v21
  v_cvt_pk_bf16_f32 v17, v22, v23
  v_cvt_pk_bf16_f32 v18, v24, v25
  v_cvt_pk_bf16_f32 v19, v26, v27
  s_waitcnt lgkmcnt(8)
  v_mfma_f32_16x16x32_bf16 v[44:47], v[156:159], a[40:43], v[44:47]
  ds_read_b64_tr_b16 v[144:145], v6 offset:24576
  ds_read_b64_tr_b16 v[146:147], v6 offset:25088
  v_mfma_f32_16x16x32_bf16 v[52:55], v[156:159], a[44:47], v[52:55]
  v_cvt_pk_bf16_f32 v20, v28, v29
  v_cvt_pk_bf16_f32 v21, v30, v31
  v_cvt_pk_bf16_f32 v22, v32, v33
  v_cvt_pk_bf16_f32 v23, v34, v35
  s_waitcnt lgkmcnt(8)
  v_mfma_f32_16x16x32_bf16 v[56:59], v[160:163], a[44:47], v[56:59]
  ds_read_b64_tr_b16 v[148:149], v2 offset:24576
  ds_read_b64_tr_b16 v[150:151], v2 offset:25088
  v_mfma_f32_16x16x32_bf16 v[48:51], v[160:163], a[40:43], v[48:51]
  v_cvt_pk_bf16_f32 v24, v36, v37
  v_cvt_pk_bf16_f32 v25, v38, v39
  v_cvt_pk_bf16_f32 v26, v40, v41
  v_cvt_pk_bf16_f32 v27, v42, v43
  s_waitcnt lgkmcnt(8)
  v_mfma_f32_16x16x32_bf16 v[60:63], v[164:167], a[40:43], v[60:63]
  ds_read_b64_tr_b16 v[152:153], v3 offset:24576
  ds_read_b64_tr_b16 v[154:155], v3 offset:25088
  v_mfma_f32_16x16x32_bf16 v[68:71], v[164:167], a[44:47], v[68:71]
  s_add_u32 s40, s36, 0x0
  buffer_store_dwordx4 v[12:15], v11, s[12:15], s40 offen offset:0 sc1
  s_waitcnt lgkmcnt(8)
  v_mfma_f32_16x16x32_bf16 v[72:75], v[168:171], a[44:47], v[72:75]
  ds_read_b64_tr_b16 v[156:157], v5 offset:28672
  ds_read_b64_tr_b16 v[158:159], v5 offset:29184
  v_mfma_f32_16x16x32_bf16 v[64:67], v[168:171], a[40:43], v[64:67]
  s_waitcnt vmcnt(14)
  s_barrier
  s_waitcnt lgkmcnt(8)
  v_mfma_f32_16x16x32_bf16 v[44:47], v[140:143], a[48:51], v[44:47]
  ds_read_b64_tr_b16 v[160:161], v6 offset:28672
  ds_read_b64_tr_b16 v[162:163], v6 offset:29184
  v_mfma_f32_16x16x32_bf16 v[52:55], v[140:143], a[52:55], v[52:55]
  s_waitcnt lgkmcnt(8)
  v_mfma_f32_16x16x32_bf16 v[56:59], v[144:147], a[52:55], v[56:59]
  ds_read_b64_tr_b16 v[164:165], v2 offset:28672
  ds_read_b64_tr_b16 v[166:167], v2 offset:29184
  v_mfma_f32_16x16x32_bf16 v[48:51], v[144:147], a[48:51], v[48:51]
  buffer_load_dwordx4 a[24:27], v11, s[8:11], s49 offen offset:2048 sc1
  s_waitcnt lgkmcnt(8)
  v_mfma_f32_16x16x32_bf16 v[60:63], v[148:151], a[48:51], v[60:63]
  ds_read_b64_tr_b16 v[168:169], v3 offset:28672
  ds_read_b64_tr_b16 v[170:171], v3 offset:29184
  v_mfma_f32_16x16x32_bf16 v[68:71], v[148:151], a[52:55], v[68:71]
  s_waitcnt lgkmcnt(8)
  v_mfma_f32_16x16x32_bf16 v[72:75], v[152:155], a[52:55], v[72:75]
  ds_read_b64_tr_b16 v[140:141], v5 offset:32768
  ds_read_b64_tr_b16 v[142:143], v5 offset:33280
  v_mfma_f32_16x16x32_bf16 v[64:67], v[152:155], a[48:51], v[64:67]
  s_add_u32 s40, s35, 0x0
  s_add_u32 m0, s32, 0
  s_add_u32 s41, s40, 22016
  buffer_load_dwordx4 v8, s[20:23], s40 offen lds
  s_add_u32 m0, s32, 1024
  s_nop 0
  buffer_load_dwordx4 v4, s[20:23], s41 offen lds
  s_waitcnt lgkmcnt(8)
  v_mfma_f32_16x16x32_bf16 v[44:47], v[156:159], a[56:59], v[44:47]
  ds_read_b64_tr_b16 v[144:145], v6 offset:32768
  ds_read_b64_tr_b16 v[146:147], v6 offset:33280
  v_mfma_f32_16x16x32_bf16 v[52:55], v[156:159], a[60:63], v[52:55]
  buffer_load_dwordx4 a[28:31], v11, s[8:11], s49 offen offset:3072 sc1
  s_waitcnt lgkmcnt(8)
  v_mfma_f32_16x16x32_bf16 v[56:59], v[160:163], a[60:63], v[56:59]
  ds_read_b64_tr_b16 v[148:149], v2 offset:32768
  ds_read_b64_tr_b16 v[150:151], v2 offset:33280
  v_mfma_f32_16x16x32_bf16 v[48:51], v[160:163], a[56:59], v[48:51]
  s_add_u32 s40, s36, 0x0
  buffer_store_dwordx4 v[16:19], v11, s[12:15], s40 offen offset:1024 sc1
  s_waitcnt lgkmcnt(8)
  v_mfma_f32_16x16x32_bf16 v[60:63], v[164:167], a[56:59], v[60:63]
  ds_read_b64_tr_b16 v[152:153], v3 offset:32768
  ds_read_b64_tr_b16 v[154:155], v3 offset:33280
  v_mfma_f32_16x16x32_bf16 v[68:71], v[164:167], a[60:63], v[68:71]
  s_waitcnt lgkmcnt(8)
  v_mfma_f32_16x16x32_bf16 v[72:75], v[168:171], a[60:63], v[72:75]
  ds_read_b64_tr_b16 v[156:157], v5 offset:36864
  ds_read_b64_tr_b16 v[158:159], v5 offset:37376
  v_mfma_f32_16x16x32_bf16 v[64:67], v[168:171], a[56:59], v[64:67]
  s_waitcnt lgkmcnt(8)
  v_mfma_f32_16x16x32_bf16 v[76:79], v[140:143], a[32:35], v[76:79]
  ds_read_b64_tr_b16 v[160:161], v6 offset:36864
  ds_read_b64_tr_b16 v[162:163], v6 offset:37376
  v_mfma_f32_16x16x32_bf16 v[84:87], v[140:143], a[36:39], v[84:87]
  s_waitcnt lgkmcnt(8)
  v_mfma_f32_16x16x32_bf16 v[88:91], v[144:147], a[36:39], v[88:91]
  ds_read_b64_tr_b16 v[164:165], v2 offset:36864
  ds_read_b64_tr_b16 v[166:167], v2 offset:37376
  v_mfma_f32_16x16x32_bf16 v[80:83], v[144:147], a[32:35], v[80:83]
  s_waitcnt vmcnt(16)
  s_waitcnt lgkmcnt(8)
  v_mfma_f32_16x16x32_bf16 v[92:95], v[148:151], a[32:35], v[92:95]
  ds_read_b64_tr_b16 v[168:169], v3 offset:36864
  ds_read_b64_tr_b16 v[170:171], v3 offset:37376
  v_mfma_f32_16x16x32_bf16 v[100:103], v[148:151], a[36:39], v[100:103]
  v_cvt_pk_bf16_f32 v44, v44, v45
  v_cvt_pk_bf16_f32 v45, v46, v47
  v_cvt_pk_bf16_f32 v46, v48, v49
  v_cvt_pk_bf16_f32 v47, v50, v51
  s_waitcnt lgkmcnt(8)
  v_mfma_f32_16x16x32_bf16 v[104:107], v[152:155], a[36:39], v[104:107]
  ds_read_b64_tr_b16 v[140:141], v5 offset:40960
  ds_read_b64_tr_b16 v[142:143], v5 offset:41472
  v_mfma_f32_16x16x32_bf16 v[96:99], v[152:155], a[32:35], v[96:99]
  v_cvt_pk_bf16_f32 v48, v52, v53
  v_cvt_pk_bf16_f32 v49, v54, v55
  v_cvt_pk_bf16_f32 v50, v56, v57
  v_cvt_pk_bf16_f32 v51, v58, v59
  s_waitcnt lgkmcnt(8)
  v_mfma_f32_16x16x32_bf16 v[76:79], v[156:159], a[40:43], v[76:79]
  ds_read_b64_tr_b16 v[144:145], v6 offset:40960
  ds_read_b64_tr_b16 v[146:147], v6 offset:41472
  v_mfma_f32_16x16x32_bf16 v[84:87], v[156:159], a[44:47], v[84:87]
  v_cvt_pk_bf16_f32 v52, v60, v61
  v_cvt_pk_bf16_f32 v53, v62, v63
  v_cvt_pk_bf16_f32 v54, v64, v65
  v_cvt_pk_bf16_f32 v55, v66, v67
  s_waitcnt lgkmcnt(8)
  v_mfma_f32_16x16x32_bf16 v[88:91], v[160:163], a[44:47], v[88:91]
  ds_read_b64_tr_b16 v[148:149], v2 offset:40960
  ds_read_b64_tr_b16 v[150:151], v2 offset:41472
  v_mfma_f32_16x16x32_bf16 v[80:83], v[160:163], a[40:43], v[80:83]
  v_cvt_pk_bf16_f32 v56, v68, v69
  v_cvt_pk_bf16_f32 v57, v70, v71
  v_cvt_pk_bf16_f32 v58, v72, v73
  v_cvt_pk_bf16_f32 v59, v74, v75
  s_waitcnt lgkmcnt(8)
  v_mfma_f32_16x16x32_bf16 v[92:95], v[164:167], a[40:43], v[92:95]
  ds_read_b64_tr_b16 v[152:153], v3 offset:40960
  ds_read_b64_tr_b16 v[154:155], v3 offset:41472
  v_mfma_f32_16x16x32_bf16 v[100:103], v[164:167], a[44:47], v[100:103]
  s_add_u32 s40, s36, 0x0
  buffer_store_dwordx4 v[20:23], v11, s[12:15], s40 offen offset:2048 sc1
  s_waitcnt lgkmcnt(8)
  v_mfma_f32_16x16x32_bf16 v[104:107], v[168:171], a[44:47], v[104:107]
  ds_read_b64_tr_b16 v[156:157], v5 offset:45056
  ds_read_b64_tr_b16 v[158:159], v5 offset:45568
  v_mfma_f32_16x16x32_bf16 v[96:99], v[168:171], a[40:43], v[96:99]
  s_waitcnt vmcnt(15)
  s_barrier
  s_waitcnt lgkmcnt(8)
  v_mfma_f32_16x16x32_bf16 v[76:79], v[140:143], a[48:51], v[76:79]
  ds_read_b64_tr_b16 v[160:161], v6 offset:45056
  ds_read_b64_tr_b16 v[162:163], v6 offset:45568
  v_mfma_f32_16x16x32_bf16 v[84:87], v[140:143], a[52:55], v[84:87]
  s_waitcnt lgkmcnt(8)
  v_mfma_f32_16x16x32_bf16 v[88:91], v[144:147], a[52:55], v[88:91]
  ds_read_b64_tr_b16 v[164:165], v2 offset:45056
  ds_read_b64_tr_b16 v[166:167], v2 offset:45568
  v_mfma_f32_16x16x32_bf16 v[80:83], v[144:147], a[48:51], v[80:83]
  s_waitcnt lgkmcnt(8)
  v_mfma_f32_16x16x32_bf16 v[92:95], v[148:151], a[48:51], v[92:95]
  ds_read_b64_tr_b16 v[168:169], v3 offset:45056
  ds_read_b64_tr_b16 v[170:171], v3 offset:45568
  v_mfma_f32_16x16x32_bf16 v[100:103], v[148:151], a[52:55], v[100:103]
  s_waitcnt lgkmcnt(8)
  v_mfma_f32_16x16x32_bf16 v[104:107], v[152:155], a[52:55], v[104:107]
  ds_read_b64_tr_b16 v[140:141], v5 offset:49152
  ds_read_b64_tr_b16 v[142:143], v5 offset:49664
  v_mfma_f32_16x16x32_bf16 v[96:99], v[152:155], a[48:51], v[96:99]
  s_add_u32 s40, s33, 0x100000
  s_add_u32 m0, s32, 16384
  s_add_u32 s41, s40, 65536
  buffer_load_dwordx4 v7, s[24:27], s40 offen lds
  s_add_u32 m0, s32, 17408
  s_nop 0
  buffer_load_dwordx4 v0, s[24:27], s41 offen lds
  s_waitcnt lgkmcnt(8)
  v_mfma_f32_16x16x32_bf16 v[76:79], v[156:159], a[56:59], v[76:79]
  ds_read_b64_tr_b16 v[144:145], v6 offset:49152
  ds_read_b64_tr_b16 v[146:147], v6 offset:49664
  v_mfma_f32_16x16x32_bf16 v[84:87], v[156:159], a[60:63], v[84:87]
  s_waitcnt lgkmcnt(8)
  v_mfma_f32_16x16x32_bf16 v[88:91], v[160:163], a[60:63], v[88:91]
  ds_read_b64_tr_b16 v[148:149], v2 offset:49152
  ds_read_b64_tr_b16 v[150:151], v2 offset:49664
  v_mfma_f32_16x16x32_bf16 v[80:83], v[160:163], a[56:59], v[80:83]
  s_add_u32 s40, s36, 0x0
  buffer_store_dwordx4 v[24:27], v11, s[12:15], s40 offen offset:3072 sc1
  s_waitcnt lgkmcnt(8)
  v_mfma_f32_16x16x32_bf16 v[92:95], v[164:167], a[56:59], v[92:95]
  ds_read_b64_tr_b16 v[152:153], v3 offset:49152
  ds_read_b64_tr_b16 v[154:155], v3 offset:49664
  v_mfma_f32_16x16x32_bf16 v[100:103], v[164:167], a[60:63], v[100:103]
  s_waitcnt lgkmcnt(8)
  v_mfma_f32_16x16x32_bf16 v[104:107], v[168:171], a[60:63], v[104:107]
  ds_read_b64_tr_b16 v[156:157], v5 offset:53248
  ds_read_b64_tr_b16 v[158:159], v5 offset:53760
  v_mfma_f32_16x16x32_bf16 v[96:99], v[168:171], a[56:59], v[96:99]
  s_waitcnt lgkmcnt(8)
  v_mfma_f32_16x16x32_bf16 v[108:111], v[140:143], a[32:35], v[108:111]
  ds_read_b64_tr_b16 v[160:161], v6 offset:53248
  ds_read_b64_tr_b16 v[162:163], v6 offset:53760
  v_mfma_f32_16x16x32_bf16 v[116:119], v[140:143], a[36:39], v[116:119]
  s_waitcnt lgkmcnt(8)
  v_mfma_f32_16x16x32_bf16 v[120:123], v[144:147], a[36:39], v[120:123]
  ds_read_b64_tr_b16 v[164:165], v2 offset:53248
  ds_read_b64_tr_b16 v[166:167], v2 offset:53760
  v_mfma_f32_16x16x32_bf16 v[112:115], v[144:147], a[32:35], v[112:115]
  s_waitcnt lgkmcnt(8)
  v_mfma_f32_16x16x32_bf16 v[124:127], v[148:151], a[32:35], v[124:127]
  ds_read_b64_tr_b16 v[168:169], v3 offset:53248
  ds_read_b64_tr_b16 v[170:171], v3 offset:53760
  v_mfma_f32_16x16x32_bf16 v[132:135], v[148:151], a[36:39], v[132:135]
  v_cvt_pk_bf16_f32 v76, v76, v77
  v_cvt_pk_bf16_f32 v77, v78, v79
  v_cvt_pk_bf16_f32 v78, v80, v81
  v_cvt_pk_bf16_f32 v79, v82, v83
  s_waitcnt lgkmcnt(8)
  v_mfma_f32_16x16x32_bf16 v[136:139], v[152:155], a[36:39], v[136:139]
  ds_read_b64_tr_b16 v[140:141], v5 offset:57344
  ds_read_b64_tr_b16 v[142:143], v5 offset:57856
  v_mfma_f32_16x16x32_bf16 v[128:131], v[152:155], a[32:35], v[128:131]
  v_cvt_pk_bf16_f32 v80, v84, v85
  v_cvt_pk_bf16_f32 v81, v86, v87
  v_cvt_pk_bf16_f32 v82, v88, v89
  v_cvt_pk_bf16_f32 v83, v90, v91
  s_waitcnt lgkmcnt(8)
  v_mfma_f32_16x16x32_bf16 v[108:111], v[156:159], a[40:43], v[108:111]
  ds_read_b64_tr_b16 v[144:145], v6 offset:57344
  ds_read_b64_tr_b16 v[146:147], v6 offset:57856
  v_mfma_f32_16x16x32_bf16 v[116:119], v[156:159], a[44:47], v[116:119]
  v_cvt_pk_bf16_f32 v84, v92, v93
  v_cvt_pk_bf16_f32 v85, v94, v95
  v_cvt_pk_bf16_f32 v86, v96, v97
  v_cvt_pk_bf16_f32 v87, v98, v99
  s_waitcnt lgkmcnt(8)
  v_mfma_f32_16x16x32_bf16 v[120:123], v[160:163], a[44:47], v[120:123]
  ds_read_b64_tr_b16 v[148:149], v2 offset:57344
  ds_read_b64_tr_b16 v[150:151], v2 offset:57856
  v_mfma_f32_16x16x32_bf16 v[112:115], v[160:163], a[40:43], v[112:115]
  v_cvt_pk_bf16_f32 v88, v100, v101
  v_cvt_pk_bf16_f32 v89, v102, v103
  v_cvt_pk_bf16_f32 v90, v104, v105
  v_cvt_pk_bf16_f32 v91, v106, v107
  s_waitcnt lgkmcnt(8)
  v_mfma_f32_16x16x32_bf16 v[124:127], v[164:167], a[40:43], v[124:127]
  ds_read_b64_tr_b16 v[152:153], v3 offset:57344
  ds_read_b64_tr_b16 v[154:155], v3 offset:57856
  v_mfma_f32_16x16x32_bf16 v[132:135], v[164:167], a[44:47], v[132:135]
  s_add_u32 s40, s36, 0x1000
  buffer_store_dwordx4 v[44:47], v11, s[12:15], s40 offen offset:0 sc1
  s_waitcnt lgkmcnt(8)
  v_mfma_f32_16x16x32_bf16 v[136:139], v[168:171], a[44:47], v[136:139]
  ds_read_b64_tr_b16 v[156:157], v5 offset:61440
  ds_read_b64_tr_b16 v[158:159], v5 offset:61952
  v_mfma_f32_16x16x32_bf16 v[128:131], v[168:171], a[40:43], v[128:131]
  s_waitcnt vmcnt(17)
  s_barrier
  s_waitcnt lgkmcnt(8)
  v_mfma_f32_16x16x32_bf16 v[108:111], v[140:143], a[48:51], v[108:111]
  ds_read_b64_tr_b16 v[160:161], v6 offset:61440
  ds_read_b64_tr_b16 v[162:163], v6 offset:61952
  v_mfma_f32_16x16x32_bf16 v[116:119], v[140:143], a[52:55], v[116:119]
  s_waitcnt lgkmcnt(8)
  v_mfma_f32_16x16x32_bf16 v[120:123], v[144:147], a[52:55], v[120:123]
  ds_read_b64_tr_b16 v[164:165], v2 offset:61440
  ds_read_b64_tr_b16 v[166:167], v2 offset:61952
  v_mfma_f32_16x16x32_bf16 v[112:115], v[144:147], a[48:51], v[112:115]
  s_waitcnt lgkmcnt(8)
  v_mfma_f32_16x16x32_bf16 v[124:127], v[148:151], a[48:51], v[124:127]
  ds_read_b64_tr_b16 v[168:169], v3 offset:61440
  ds_read_b64_tr_b16 v[170:171], v3 offset:61952
  v_mfma_f32_16x16x32_bf16 v[132:135], v[148:151], a[52:55], v[132:135]
  s_waitcnt lgkmcnt(8)
  v_mfma_f32_16x16x32_bf16 v[136:139], v[152:155], a[52:55], v[136:139]
  v_xor_b32 v5, 0x10000, v5
  ds_read_b64_tr_b16 v[140:141], v5 offset:0
  ds_read_b64_tr_b16 v[142:143], v5 offset:512
  v_mfma_f32_16x16x32_bf16 v[128:131], v[152:155], a[48:51], v[128:131]
  s_add_u32 s40, s33, 0x100080
  s_add_u32 m0, s32, 32768
  s_add_u32 s41, s40, 65536
  buffer_load_dwordx4 v7, s[24:27], s40 offen lds
  s_add_u32 m0, s32, 33792
  s_nop 0
  buffer_load_dwordx4 v0, s[24:27], s41 offen lds
  s_waitcnt lgkmcnt(8)
  v_mfma_f32_16x16x32_bf16 v[108:111], v[156:159], a[56:59], v[108:111]
  v_xor_b32 v6, 0x10000, v6
  ds_read_b64_tr_b16 v[144:145], v6 offset:0
  ds_read_b64_tr_b16 v[146:147], v6 offset:512
  v_mfma_f32_16x16x32_bf16 v[116:119], v[156:159], a[60:63], v[116:119]
  s_waitcnt lgkmcnt(8)
  v_mfma_f32_16x16x32_bf16 v[120:123], v[160:163], a[60:63], v[120:123]
  v_xor_b32 v2, 0x10000, v2
  ds_read_b64_tr_b16 v[148:149], v2 offset:0
  ds_read_b64_tr_b16 v[150:151], v2 offset:512
  v_mfma_f32_16x16x32_bf16 v[112:115], v[160:163], a[56:59], v[112:115]
  s_add_u32 s40, s36, 0x1000
  buffer_store_dwordx4 v[48:51], v11, s[12:15], s40 offen offset:1024 sc1
  s_waitcnt lgkmcnt(8)
  v_mfma_f32_16x16x32_bf16 v[124:127], v[164:167], a[56:59], v[124:127]
  v_xor_b32 v3, 0x10000, v3
  ds_read_b64_tr_b16 v[152:153], v3 offset:0
  ds_read_b64_tr_b16 v[154:155], v3 offset:512
  v_mfma_f32_16x16x32_bf16 v[132:135], v[164:167], a[60:63], v[132:135]
  s_waitcnt lgkmcnt(8)
  v_mfma_f32_16x16x32_bf16 v[136:139], v[168:171], a[60:63], v[136:139]
  ds_read_b64_tr_b16 v[156:157], v5 offset:4096
  ds_read_b64_tr_b16 v[158:159], v5 offset:4608
  v_mfma_f32_16x16x32_bf16 v[128:131], v[168:171], a[56:59], v[128:131]
  s_branch L_kv_end
L_kv_V:
  s_waitcnt vmcnt(12)
  ds_read_b128 a[0:3], v188 offset:0
  ds_read_b128 a[4:7], v188 offset:2048
  ds_read_b128 a[8:11], v189 offset:0
  ds_read_b128 a[12:15], v189 offset:2048
  s_waitcnt vmcnt(8)
  ds_read_b128 a[16:19], v188 offset:4096
  ds_read_b128 a[20:23], v188 offset:6144
  ds_read_b128 a[24:27], v189 offset:4096
  ds_read_b128 a[28:31], v189 offset:6144
  s_waitcnt lgkmcnt(4)
  s_add_u32 s40, s73, 1
  s_and_b32 s40, s40, 3
  s_lshl_b32 s40, s40, 8
  s_lshl_b32 s86, s44, 15
  s_add_u32 s86, s86, s40
  s_add_u32 s87, s86, 8192
  s_add_u32 s88, s86, 16384
  s_add_u32 s89, s86, 24576
  s_lshl2_add_u32 m0, s32, 98304
  s_nop 0
  buffer_load_dwordx4 v9, s[80:83], s86 offen offset:0 lds
  s_lshl2_add_u32 m0, s32, 99328
  s_nop 0
  buffer_load_dwordx4 v10, s[80:83], s87 offen offset:0 lds
  s_lshl2_add_u32 m0, s32, 100352
  s_nop 0
  buffer_load_dwordx4 v9, s[80:83], s88 offen offset:0 lds
  s_lshl2_add_u32 m0, s32, 101376
  s_nop 0
  buffer_load_dwordx4 v10, s[80:83], s89 offen offset:0 lds
  s_waitcnt lgkmcnt(0)
  s_lshl2_add_u32 m0, s32, 102272
  s_nop 0
  buffer_load_dwordx4 v9, s[80:83], s86 offen offset:128 lds
  s_lshl2_add_u32 m0, s32, 103296
  s_nop 0
  buffer_load_dwordx4 v10, s[80:83], s87 offen offset:128 lds
  s_lshl2_add_u32 m0, s32, 104320
  s_nop 0
  buffer_load_dwordx4 v9, s[80:83], s88 offen offset:128 lds
  s_lshl2_add_u32 m0, s32, 105344
  s_nop 0
  buffer_load_dwordx4 v10, s[80:83], s89 offen offset:128 lds
  s_waitcnt vmcnt(14)
  s_barrier
  ds_read_b128 v[180:183], v187
  ds_read_b64_tr_b16 v[140:141], v5 offset:0
  ds_read_b64_tr_b16 v[142:143], v5 offset:512
  ds_read_b64_tr_b16 v[144:145], v6 offset:0
  ds_read_b64_tr_b16 v[146:147], v6 offset:512
  ds_read_b64_tr_b16 v[148:149], v2 offset:0
  ds_read_b64_tr_b16 v[150:151], v2 offset:512
  ds_read_b64_tr_b16 v[152:153], v3 offset:0
  ds_read_b64_tr_b16 v[154:155], v3 offset:512
  ds_read_b64_tr_b16 v[156:157], v5 offset:4096
  ds_read_b64_tr_b16 v[158:159], v5 offset:4608
  s_waitcnt lgkmcnt(8)
  v_mfma_f32_16x16x32_bf16 v[12:15], a[0:3], v[140:143], 0
  ds_read_b64_tr_b16 v[160:161], v6 offset:4096
  ds_read_b64_tr_b16 v[162:163], v6 offset:4608
  v_mfma_f32_16x16x32_bf16 v[16:19], a[4:7], v[140:143], 0
  s_getreg_b32 s62, hwreg(HW_REG_XCC_ID, 0, 4)
  s_mul_i32 s63, s62, 6
  s_mov_b64 s[100:101], 1
  s_lshl_b64 s[100:101], s[100:101], s63
  s_cmp_gt_u32 s62, 7
  s_cselect_b32 s100, 0, s100
  s_cselect_b32 s101, 0, s101
  v_mov_b32 v176, s100
  v_mov_b32 v177, s101
  s_lshl_b32 s62, s93, 12
  v_lshl_add_u32 v178, v1, 12, s62
  s_and_b32 s62, s2, 7
  s_lshl_b32 s62, s62, 3
  s_add_u32 s62, s62, 128
  buffer_atomic_add_x2 v[176:177], v178, s[28:31], s62 offen
  s_waitcnt lgkmcnt(8)
  v_mfma_f32_16x16x32_bf16 v[24:27], a[4:7], v[144:147], 0
  ds_read_b64_tr_b16 v[164:165], v2 offset:4096
  ds_read_b64_tr_b16 v[166:167], v2 offset:4608
  v_mfma_f32_16x16x32_bf16 v[20:23], a[0:3], v[144:147], 0
  buffer_store_dwordx4 v[180:183], v4, s[8:11], s85 offen sc1
  s_lshl_b32 s62, s93, 6
  v_add_u32 v172, s62, v1
  v_cmp_eq_u32 vcc, 0, v172
  v_mov_b32 v173, 0
  v_mov_b32 v172, 0x7ffffff0
  v_cndmask_b32 v172, v172, v173, vcc
  s_lshl_b32 s62, s2, 8
  s_add_u32 s62, s62, 0x7000000
  s_cmp_lt_u32 s2, 160
  s_cselect_b32 s62, s62, 0x7ffffff0
  buffer_store_dword v173, v172, s[12:15], s62 offen sc1
  v_xor_b32 v4, 32, v8
  s_mov_b32 exec_lo, 0xc0cc0c0
  s_mov_b32 exec_hi, 0xc0cc0c0
  v_mov_b32 v8, 0x4000000
  s_mov_b32 exec_lo, 0x3033030
  s_mov_b32 exec_hi, 0x3033030
  v_mov_b32 v4, 0x4000000
  s_mov_b64 exec, -1
  s_waitcnt lgkmcnt(8)
  v_mfma_f32_16x16x32_bf16 v[28:31], a[0:3], v[148:151], 0
  ds_read_b64_tr_b16 v[168:169], v3 offset:4096
  ds_read_b64_tr_b16 v[170:171], v3 offset:4608
  v_mfma_f32_16x16x32_bf16 v[32:35], a[4:7], v[148:151], 0
  s_waitcnt lgkmcnt(8)
  v_mfma_f32_16x16x32_bf16 v[40:43], a[4:7], v[152:155], 0
  ds_read_b64_tr_b16 v[140:141], v5 offset:8192
  ds_read_b64_tr_b16 v[142:143], v5 offset:8704
  v_mfma_f32_16x16x32_bf16 v[36:39], a[0:3], v[152:155], 0
  s_add_u32 s40, s73, 1
  s_and_b32 s40, s40, 3
  s_lshl_b32 s40, s40, 20
  s_add_u32 s40, s40, s34
  s_add_u32 m0, s32, 65536
  s_add_u32 s41, s40, 65536
  buffer_load_dwordx4 v7, s[16:19], s40 offen lds
  s_add_u32 m0, s32, 66560
  s_nop 0
  buffer_load_dwordx4 v0, s[16:19], s41 offen lds
  s_waitcnt lgkmcnt(8)
  v_mfma_f32_16x16x32_bf16 v[12:15], a[8:11], v[156:159], v[12:15]
  ds_read_b64_tr_b16 v[144:145], v6 offset:8192
  ds_read_b64_tr_b16 v[146:147], v6 offset:8704
  v_mfma_f32_16x16x32_bf16 v[16:19], a[12:15], v[156:159], v[16:19]
  s_waitcnt lgkmcnt(8)
  v_mfma_f32_16x16x32_bf16 v[24:27], a[12:15], v[160:163], v[24:27]
  ds_read_b64_tr_b16 v[148:149], v2 offset:8192
  ds_read_b64_tr_b16 v[150:151], v2 offset:8704
  v_mfma_f32_16x16x32_bf16 v[20:23], a[8:11], v[160:163], v[20:23]
  s_waitcnt lgkmcnt(8)
  v_mfma_f32_16x16x32_bf16 v[28:31], a[8:11], v[164:167], v[28:31]
  ds_read_b64_tr_b16 v[152:153], v3 offset:8192
  ds_read_b64_tr_b16 v[154:155], v3 offset:8704
  v_mfma_f32_16x16x32_bf16 v[32:35], a[12:15], v[164:167], v[32:35]
  s_waitcnt lgkmcnt(8)
  v_mfma_f32_16x16x32_bf16 v[40:43], a[12:15], v[168:171], v[40:43]
  ds_read_b64_tr_b16 v[156:157], v5 offset:12288
  ds_read_b64_tr_b16 v[158:159], v5 offset:12800
  v_mfma_f32_16x16x32_bf16 v[36:39], a[8:11], v[168:171], v[36:39]
  s_waitcnt vmcnt(15)
  s_barrier
  s_waitcnt lgkmcnt(8)
  v_mfma_f32_16x16x32_bf16 v[12:15], a[16:19], v[140:143], v[12:15]
  ds_read_b64_tr_b16 v[160:161], v6 offset:12288
  ds_read_b64_tr_b16 v[162:163], v6 offset:12800
  v_mfma_f32_16x16x32_bf16 v[16:19], a[20:23], v[140:143], v[16:19]
  s_waitcnt lgkmcnt(8)
  v_mfma_f32_16x16x32_bf16 v[24:27], a[20:23], v[144:147], v[24:27]
  ds_read_b64_tr_b16 v[164:165], v2 offset:12288
  ds_read_b64_tr_b16 v[166:167], v2 offset:12800
  v_mfma_f32_16x16x32_bf16 v[20:23], a[16:19], v[144:147], v[20:23]
  s_add_u32 s40, s73, 1
  s_and_b32 s40, s40, 3
  s_lshl_b32 s40, s40, 20
  s_add_u32 s40, s40, s34
  s_add_u32 s40, s40, 128
  s_add_u32 m0, s32, 81920
  s_add_u32 s41, s40, 65536
  buffer_load_dwordx4 v7, s[16:19], s40 offen lds
  s_add_u32 m0, s32, 82944
  s_nop 0
  buffer_load_dwordx4 v0, s[16:19], s41 offen lds
  s_waitcnt lgkmcnt(8)
  v_mfma_f32_16x16x32_bf16 v[28:31], a[16:19], v[148:151], v[28:31]
  ds_read_b64_tr_b16 v[168:169], v3 offset:12288
  ds_read_b64_tr_b16 v[170:171], v3 offset:12800
  v_mfma_f32_16x16x32_bf16 v[32:35], a[20:23], v[148:151], v[32:35]
  s_waitcnt lgkmcnt(8)
  v_mfma_f32_16x16x32_bf16 v[40:43], a[20:23], v[152:155], v[40:43]
  ds_read_b64_tr_b16 v[140:141], v5 offset:16384
  ds_read_b64_tr_b16 v[142:143], v5 offset:16896
  v_mfma_f32_16x16x32_bf16 v[36:39], a[16:19], v[152:155], v[36:39]
  s_waitcnt lgkmcnt(8)
  v_mfma_f32_16x16x32_bf16 v[12:15], a[24:27], v[156:159], v[12:15]
  ds_read_b64_tr_b16 v[144:145], v6 offset:16384
  ds_read_b64_tr_b16 v[146:147], v6 offset:16896
  v_mfma_f32_16x16x32_bf16 v[16:19], a[28:31], v[156:159], v[16:19]
  s_waitcnt lgkmcnt(8)
  v_mfma_f32_16x16x32_bf16 v[24:27], a[28:31], v[160:163], v[24:27]
  ds_read_b64_tr_b16 v[148:149], v2 offset:16384
  ds_read_b64_tr_b16 v[150:151], v2 offset:16896
  v_mfma_f32_16x16x32_bf16 v[20:23], a[24:27], v[160:163], v[20:23]
  s_waitcnt lgkmcnt(8)
  v_mfma_f32_16x16x32_bf16 v[28:31], a[24:27], v[164:167], v[28:31]
  ds_read_b64_tr_b16 v[152:153], v3 offset:16384
  ds_read_b64_tr_b16 v[154:155], v3 offset:16896
  v_mfma_f32_16x16x32_bf16 v[32:35], a[28:31], v[164:167], v[32:35]
  s_waitcnt lgkmcnt(8)
  v_mfma_f32_16x16x32_bf16 v[40:43], a[28:31], v[168:171], v[40:43]
  ds_read_b64_tr_b16 v[156:157], v5 offset:20480
  ds_read_b64_tr_b16 v[158:159], v5 offset:20992
  v_mfma_f32_16x16x32_bf16 v[36:39], a[24:27], v[168:171], v[36:39]
  s_waitcnt lgkmcnt(8)
  v_mfma_f32_16x16x32_bf16 v[44:47], a[0:3], v[140:143], 0
  ds_read_b64_tr_b16 v[160:161], v6 offset:20480
  ds_read_b64_tr_b16 v[162:163], v6 offset:20992
  v_mfma_f32_16x16x32_bf16 v[48:51], a[4:7], v[140:143], 0
  s_waitcnt lgkmcnt(8)
  v_mfma_f32_16x16x32_bf16 v[56:59], a[4:7], v[144:147], 0
  ds_read_b64_tr_b16 v[164:165], v2 offset:20480
  ds_read_b64_tr_b16 v[166:167], v2 offset:20992
  v_mfma_f32_16x16x32_bf16 v[52:55], a[0:3], v[144:147], 0
  s_waitcnt lgkmcnt(8)
  v_mfma_f32_16x16x32_bf16 v[60:63], a[0:3], v[148:151], 0
  ds_read_b64_tr_b16 v[168:169], v3 offset:20480
  ds_read_b64_tr_b16 v[170:171], v3 offset:20992
  v_mfma_f32_16x16x32_bf16 v[64:67], a[4:7], v[148:151], 0
  s_waitcnt lgkmcnt(8)
  v_mfma_f32_16x16x32_bf16 v[72:75], a[4:7], v[152:155], 0
  ds_read_b64_tr_b16 v[140:141], v5 offset:24576
  ds_read_b64_tr_b16 v[142:143], v5 offset:25088
  v_mfma_f32_16x16x32_bf16 v[68:71], a[0:3], v[152:155], 0
  s_waitcnt lgkmcnt(8)
  v_mfma_f32_16x16x32_bf16 v[44:47], a[8:11], v[156:159], v[44:47]
  ds_read_b64_tr_b16 v[144:145], v6 offset:24576
  ds_read_b64_tr_b16 v[146:147], v6 offset:25088
  v_mfma_f32_16x16x32_bf16 v[48:51], a[12:15], v[156:159], v[48:51]
  s_waitcnt lgkmcnt(8)
  v_mfma_f32_16x16x32_bf16 v[56:59], a[12:15], v[160:163], v[56:59]
  ds_read_b64_tr_b16 v[148:149], v2 offset:24576
  ds_read_b64_tr_b16 v[150:151], v2 offset:25088
  v_mfma_f32_16x16x32_bf16 v[52:55], a[8:11], v[160:163], v[52:55]
  s_waitcnt lgkmcnt(8)
  v_mfma_f32_16x16x32_bf16 v[60:63], a[8:11], v[164:167], v[60:63]
  ds_read_b64_tr_b16 v[152:153], v3 offset:24576
  ds_read_b64_tr_b16 v[154:155], v3 offset:25088
  v_mfma_f32_16x16x32_bf16 v[64:67], a[12:15], v[164:167], v[64:67]
  s_waitcnt lgkmcnt(8)
  v_mfma_f32_16x16x32_bf16 v[72:75], a[12:15], v[168:171], v[72:75]
  ds_read_b64_tr_b16 v[156:157], v5 offset:28672
  ds_read_b64_tr_b16 v[158:159], v5 offset:29184
  v_mfma_f32_16x16x32_bf16 v[68:71], a[8:11], v[168:171], v[68:71]
  s_waitcnt vmcnt(4)
  s_barrier
  s_lshl_b32 s62, s93, 12
  v_lshl_add_u32 v186, v1, 12, s62
  v_mov_b32 v187, 1
  buffer_atomic_add v187, v186, s[28:31], s43 offen
  s_waitcnt lgkmcnt(8)
  v_mfma_f32_16x16x32_bf16 v[44:47], a[16:19], v[140:143], v[44:47]
  ds_read_b64_tr_b16 v[160:161], v6 offset:28672
  ds_read_b64_tr_b16 v[162:163], v6 offset:29184
  v_mfma_f32_16x16x32_bf16 v[48:51], a[20:23], v[140:143], v[48:51]
  s_waitcnt lgkmcnt(8)
  v_mfma_f32_16x16x32_bf16 v[56:59], a[20:23], v[144:147], v[56:59]
  ds_read_b64_tr_b16 v[164:165], v2 offset:28672
  ds_read_b64_tr_b16 v[166:167], v2 offset:29184
  v_mfma_f32_16x16x32_bf16 v[52:55], a[16:19], v[144:147], v[52:55]
  s_waitcnt lgkmcnt(8)
  v_mfma_f32_16x16x32_bf16 v[60:63], a[16:19], v[148:151], v[60:63]
  ds_read_b64_tr_b16 v[168:169], v3 offset:28672
  ds_read_b64_tr_b16 v[170:171], v3 offset:29184
  v_mfma_f32_16x16x32_bf16 v[64:67], a[20:23], v[148:151], v[64:67]
  s_waitcnt lgkmcnt(8)
  v_mfma_f32_16x16x32_bf16 v[72:75], a[20:23], v[152:155], v[72:75]
  ds_read_b64_tr_b16 v[140:141], v5 offset:32768
  ds_read_b64_tr_b16 v[142:143], v5 offset:33280
  v_mfma_f32_16x16x32_bf16 v[68:71], a[16:19], v[152:155], v[68:71]
  s_add_u32 s40, s73, 1
  s_and_b32 s40, s40, 3
  s_lshl_b32 s40, s40, 20
  s_add_u32 s40, s40, s34
  s_add_u32 s40, s40, 256
  s_add_u32 m0, s32, 0
  s_add_u32 s41, s40, 65536
  buffer_load_dwordx4 v7, s[16:19], s40 offen lds
  s_add_u32 m0, s32, 1024
  s_nop 0
  buffer_load_dwordx4 v0, s[16:19], s41 offen lds
  s_waitcnt lgkmcnt(8)
  v_mfma_f32_16x16x32_bf16 v[44:47], a[24:27], v[156:159], v[44:47]
  ds_read_b64_tr_b16 v[144:145], v6 offset:32768
  ds_read_b64_tr_b16 v[146:147], v6 offset:33280
  v_mfma_f32_16x16x32_bf16 v[48:51], a[28:31], v[156:159], v[48:51]
  s_waitcnt lgkmcnt(8)
  v_mfma_f32_16x16x32_bf16 v[56:59], a[28:31], v[160:163], v[56:59]
  ds_read_b64_tr_b16 v[148:149], v2 offset:32768
  ds_read_b64_tr_b16 v[150:151], v2 offset:33280
  v_mfma_f32_16x16x32_bf16 v[52:55], a[24:27], v[160:163], v[52:55]
  s_waitcnt lgkmcnt(8)
  v_mfma_f32_16x16x32_bf16 v[60:63], a[24:27], v[164:167], v[60:63]
  ds_read_b64_tr_b16 v[152:153], v3 offset:32768
  ds_read_b64_tr_b16 v[154:155], v3 offset:33280
  v_mfma_f32_16x16x32_bf16 v[64:67], a[28:31], v[164:167], v[64:67]
  s_waitcnt lgkmcnt(8)
  v_mfma_f32_16x16x32_bf16 v[72:75], a[28:31], v[168:171], v[72:75]
  ds_read_b64_tr_b16 v[156:157], v5 offset:36864
  ds_read_b64_tr_b16 v[158:159], v5 offset:37376
  v_mfma_f32_16x16x32_bf16 v[68:71], a[24:27], v[168:171], v[68:71]
  s_waitcnt lgkmcnt(8)
  v_mfma_f32_16x16x32_bf16 v[76:79], a[0:3], v[140:143], 0
  ds_read_b64_tr_b16 v[160:161], v6 offset:36864
  ds_read_b64_tr_b16 v[162:163], v6 offset:37376
  v_mfma_f32_16x16x32_bf16 v[80:83], a[4:7], v[140:143], 0
  ds_read_b128 a[32:35], v188 offset:0
  ds_read_b128 a[36:39], v188 offset:2048
  s_waitcnt lgkmcnt(10)
  v_mfma_f32_16x16x32_bf16 v[88:91], a[4:7], v[144:147], 0
  ds_read_b64_tr_b16 v[164:165], v2 offset:36864
  ds_read_b64_tr_b16 v[166:167], v2 offset:37376
  v_mfma_f32_16x16x32_bf16 v[84:87], a[0:3], v[144:147], 0
  ds_read_b128 a[40:43], v189 offset:0
  ds_read_b128 a[44:47], v189 offset:2048
  s_waitcnt lgkmcnt(12)
  v_mfma_f32_16x16x32_bf16 v[92:95], a[0:3], v[148:151], 0
  ds_read_b64_tr_b16 v[168:169], v3 offset:36864
  ds_read_b64_tr_b16 v[170:171], v3 offset:37376
  v_mfma_f32_16x16x32_bf16 v[96:99], a[4:7], v[148:151], 0
  s_waitcnt lgkmcnt(12)
  v_mfma_f32_16x16x32_bf16 v[104:107], a[4:7], v[152:155], 0
  ds_read_b64_tr_b16 v[140:141], v5 offset:40960
  ds_read_b64_tr_b16 v[142:143], v5 offset:41472
  v_mfma_f32_16x16x32_bf16 v[100:103], a[0:3], v[152:155], 0
  s_waitcnt lgkmcnt(12)
  v_mfma_f32_16x16x32_bf16 v[76:79], a[8:11], v[156:159], v[76:79]
  ds_read_b64_tr_b16 v[144:145], v6 offset:40960
  ds_read_b64_tr_b16 v[146:147], v6 offset:41472
  v_mfma_f32_16x16x32_bf16 v[80:83], a[12:15], v[156:159], v[80:83]
  s_waitcnt lgkmcnt(6)
  s_add_u32 s40, s73, 2
  s_and_b32 s40, s40, 3
  s_lshl_b32 s40, s40, 8
  s_lshl_b32 s86, s44, 15
  s_add_u32 s86, s86, s40
  s_add_u32 s87, s86, 8192
  s_add_u32 s88, s86, 16384
  s_add_u32 s89, s86, 24576
  s_lshl2_add_u32 m0, s32, 98304
  s_nop 0
  buffer_load_dwordx4 v9, s[80:83], s86 offen offset:0 lds
  v_mfma_f32_16x16x32_bf16 v[88:91], a[12:15], v[160:163], v[88:91]
  ds_read_b64_tr_b16 v[148:149], v2 offset:40960
  ds_read_b64_tr_b16 v[150:151], v2 offset:41472
  v_mfma_f32_16x16x32_bf16 v[84:87], a[8:11], v[160:163], v[84:87]
  v_mfma_f32_16x16x32_bf16 v[92:95], a[8:11], v[164:167], v[92:95]
  ds_read_b64_tr_b16 v[152:153], v3 offset:40960
  ds_read_b64_tr_b16 v[154:155], v3 offset:41472
  v_mfma_f32_16x16x32_bf16 v[96:99], a[12:15], v[164:167], v[96:99]
  s_lshl2_add_u32 m0, s32, 99328
  s_nop 0
  buffer_load_dwordx4 v10, s[80:83], s87 offen offset:0 lds
  s_waitcnt lgkmcnt(8)
  v_mfma_f32_16x16x32_bf16 v[104:107], a[12:15], v[168:171], v[104:107]
  ds_read_b64_tr_b16 v[156:157], v5 offset:45056
  ds_read_b64_tr_b16 v[158:159], v5 offset:45568
  v_mfma_f32_16x16x32_bf16 v[100:103], a[8:11], v[168:171], v[100:103]
  s_barrier
  s_waitcnt lgkmcnt(8)
  v_mfma_f32_16x16x32_bf16 v[76:79], a[16:19], v[140:143], v[76:79]
  ds_read_b64_tr_b16 v[160:161], v6 offset:45056
  ds_read_b64_tr_b16 v[162:163], v6 offset:45568
  v_mfma_f32_16x16x32_bf16 v[80:83], a[20:23], v[140:143], v[80:83]
  ds_read_b128 a[48:51], v188 offset:4096
  ds_read_b128 a[52:55], v188 offset:6144
  s_waitcnt lgkmcnt(10)
  v_mfma_f32_16x16x32_bf16 v[88:91], a[20:23], v[144:147], v[88:91]
  ds_read_b64_tr_b16 v[164:165], v2 offset:45056
  ds_read_b64_tr_b16 v[166:167], v2 offset:45568
  v_mfma_f32_16x16x32_bf16 v[84:87], a[16:19], v[144:147], v[84:87]
  ds_read_b128 a[56:59], v189 offset:4096
  ds_read_b128 a[60:63], v189 offset:6144
  s_lshl2_add_u32 m0, s32, 100352
  s_nop 0
  buffer_load_dwordx4 v9, s[80:83], s88 offen offset:0 lds
  s_waitcnt lgkmcnt(12)
  v_mfma_f32_16x16x32_bf16 v[92:95], a[16:19], v[148:151], v[92:95]
  ds_read_b64_tr_b16 v[168:169], v3 offset:45056
  ds_read_b64_tr_b16 v[170:171], v3 offset:45568
  v_mfma_f32_16x16x32_bf16 v[96:99], a[20:23], v[148:151], v[96:99]
  s_waitcnt lgkmcnt(12)
  v_mfma_f32_16x16x32_bf16 v[104:107], a[20:23], v[152:155], v[104:107]
  ds_read_b64_tr_b16 v[140:141], v5 offset:49152
  ds_read_b64_tr_b16 v[142:143], v5 offset:49664
  v_mfma_f32_16x16x32_bf16 v[100:103], a[16:19], v[152:155], v[100:103]
  s_add_u32 s40, s73, 1
  s_and_b32 s40, s40, 3
  s_lshl_b32 s40, s40, 20
  s_add_u32 s40, s40, s34
  s_add_u32 s40, s40, 384
  s_add_u32 m0, s32, 16384
  s_add_u32 s41, s40, 65536
  buffer_load_dwordx4 v7, s[16:19], s40 offen lds
  s_add_u32 m0, s32, 17408
  s_nop 0
  buffer_load_dwordx4 v0, s[16:19], s41 offen lds
  s_waitcnt lgkmcnt(12)
  v_mfma_f32_16x16x32_bf16 v[76:79], a[24:27], v[156:159], v[76:79]
  ds_read_b64_tr_b16 v[144:145], v6 offset:49152
  ds_read_b64_tr_b16 v[146:147], v6 offset:49664
  v_mfma_f32_16x16x32_bf16 v[80:83], a[28:31], v[156:159], v[80:83]
  s_waitcnt lgkmcnt(12)
  v_mfma_f32_16x16x32_bf16 v[88:91], a[28:31], v[160:163], v[88:91]
  ds_read_b64_tr_b16 v[148:149], v2 offset:49152
  ds_read_b64_tr_b16 v[150:151], v2 offset:49664
  v_mfma_f32_16x16x32_bf16 v[84:87], a[24:27], v[160:163], v[84:87]
  s_lshl2_add_u32 m0, s32, 101376
  s_nop 0
  buffer_load_dwordx4 v10, s[80:83], s89 offen offset:0 lds
  s_waitcnt lgkmcnt(10)
  v_mfma_f32_16x16x32_bf16 v[92:95], a[24:27], v[164:167], v[92:95]
  ds_read_b64_tr_b16 v[152:153], v3 offset:49152
  ds_read_b64_tr_b16 v[154:155], v3 offset:49664
  v_mfma_f32_16x16x32_bf16 v[96:99], a[28:31], v[164:167], v[96:99]
  s_waitcnt lgkmcnt(8)
  v_mfma_f32_16x16x32_bf16 v[104:107], a[28:31], v[168:171], v[104:107]
  ds_read_b64_tr_b16 v[156:157], v5 offset:53248
  ds_read_b64_tr_b16 v[158:159], v5 offset:53760
  v_mfma_f32_16x16x32_bf16 v[100:103], a[24:27], v[168:171], v[100:103]
  s_waitcnt lgkmcnt(8)
  v_mfma_f32_16x16x32_bf16 v[108:111], a[0:3], v[140:143], 0
  ds_read_b64_tr_b16 v[160:161], v6 offset:53248
  ds_read_b64_tr_b16 v[162:163], v6 offset:53760
  v_mfma_f32_16x16x32_bf16 v[112:115], a[4:7], v[140:143], 0
  s_waitcnt lgkmcnt(8)
  v_mfma_f32_16x16x32_bf16 v[120:123], a[4:7], v[144:147], 0
  ds_read_b64_tr_b16 v[164:165], v2 offset:53248
  ds_read_b64_tr_b16 v[166:167], v2 offset:53760
  v_mfma_f32_16x16x32_bf16 v[116:119], a[0:3], v[144:147], 0
  s_lshl2_add_u32 m0, s32, 102272
  s_nop 0
  buffer_load_dwordx4 v9, s[80:83], s86 offen offset:128 lds
  s_waitcnt lgkmcnt(8)
  v_mfma_f32_16x16x32_bf16 v[124:127], a[0:3], v[148:151], 0
  ds_read_b64_tr_b16 v[168:169], v3 offset:53248
  ds_read_b64_tr_b16 v[170:171], v3 offset:53760
  v_mfma_f32_16x16x32_bf16 v[128:131], a[4:7], v[148:151], 0
  s_waitcnt lgkmcnt(8)
  v_mfma_f32_16x16x32_bf16 v[136:139], a[4:7], v[152:155], 0
  ds_read_b64_tr_b16 v[140:141], v5 offset:57344
  ds_read_b64_tr_b16 v[142:143], v5 offset:57856
  v_mfma_f32_16x16x32_bf16 v[132:135], a[0:3], v[152:155], 0
  s_waitcnt lgkmcnt(8)
  v_mfma_f32_16x16x32_bf16 v[108:111], a[8:11], v[156:159], v[108:111]
  ds_read_b64_tr_b16 v[144:145], v6 offset:57344
  ds_read_b64_tr_b16 v[146:147], v6 offset:57856
  v_mfma_f32_16x16x32_bf16 v[112:115], a[12:15], v[156:159], v[112:115]
  s_lshl2_add_u32 m0, s32, 103296
  s_nop 0
  buffer_load_dwordx4 v10, s[80:83], s87 offen offset:128 lds
  s_waitcnt lgkmcnt(8)
  v_mfma_f32_16x16x32_bf16 v[120:123], a[12:15], v[160:163], v[120:123]
  ds_read_b64_tr_b16 v[148:149], v2 offset:57344
  ds_read_b64_tr_b16 v[150:151], v2 offset:57856
  v_mfma_f32_16x16x32_bf16 v[116:119], a[8:11], v[160:163], v[116:119]
  s_waitcnt lgkmcnt(8)
  v_mfma_f32_16x16x32_bf16 v[124:127], a[8:11], v[164:167], v[124:127]
  ds_read_b64_tr_b16 v[152:153], v3 offset:57344
  ds_read_b64_tr_b16 v[154:155], v3 offset:57856
  v_mfma_f32_16x16x32_bf16 v[128:131], a[12:15], v[164:167], v[128:131]
  s_waitcnt lgkmcnt(8)
  v_mfma_f32_16x16x32_bf16 v[136:139], a[12:15], v[168:171], v[136:139]
  ds_read_b64_tr_b16 v[156:157], v5 offset:61440
  ds_read_b64_tr_b16 v[158:159], v5 offset:61952
  v_mfma_f32_16x16x32_bf16 v[132:135], a[8:11], v[168:171], v[132:135]
  s_waitcnt vmcnt(12)
  s_barrier
  s_waitcnt lgkmcnt(8)
  v_mfma_f32_16x16x32_bf16 v[108:111], a[16:19], v[140:143], v[108:111]
  ds_read_b64_tr_b16 v[160:161], v6 offset:61440
  ds_read_b64_tr_b16 v[162:163], v6 offset:61952
  v_mfma_f32_16x16x32_bf16 v[112:115], a[20:23], v[140:143], v[112:115]
  s_waitcnt lgkmcnt(8)
  v_mfma_f32_16x16x32_bf16 v[120:123], a[20:23], v[144:147], v[120:123]
  ds_read_b64_tr_b16 v[164:165], v2 offset:61440
  ds_read_b64_tr_b16 v[166:167], v2 offset:61952
  v_mfma_f32_16x16x32_bf16 v[116:119], a[16:19], v[144:147], v[116:119]
  s_lshl2_add_u32 m0, s32, 104320
  s_nop 0
  buffer_load_dwordx4 v9, s[80:83], s88 offen offset:128 lds
  s_waitcnt lgkmcnt(8)
  v_mfma_f32_16x16x32_bf16 v[124:127], a[16:19], v[148:151], v[124:127]
  ds_read_b64_tr_b16 v[168:169], v3 offset:61440
  ds_read_b64_tr_b16 v[170:171], v3 offset:61952
  v_mfma_f32_16x16x32_bf16 v[128:131], a[20:23], v[148:151], v[128:131]
  s_waitcnt lgkmcnt(8)
  v_mfma_f32_16x16x32_bf16 v[136:139], a[20:23], v[152:155], v[136:139]
  v_xor_b32 v5, 0x10000, v5
  ds_read_b64_tr_b16 v[140:141], v5 offset:0
  ds_read_b64_tr_b16 v[142:143], v5 offset:512
  v_mfma_f32_16x16x32_bf16 v[132:135], a[16:19], v[152:155], v[132:135]
  s_add_u32 s40, s73, 2
  s_and_b32 s40, s40, 3
  s_lshl_b32 s40, s40, 20
  s_add_u32 s40, s40, s34
  s_add_u32 m0, s32, 32768
  s_add_u32 s41, s40, 65536
  buffer_load_dwordx4 v7, s[16:19], s40 offen lds
  s_add_u32 m0, s32, 33792
  s_nop 0
  buffer_load_dwordx4 v0, s[16:19], s41 offen lds
  s_waitcnt lgkmcnt(8)
  v_mfma_f32_16x16x32_bf16 v[108:111], a[24:27], v[156:159], v[108:111]
  v_xor_b32 v6, 0x10000, v6
  ds_read_b64_tr_b16 v[144:145], v6 offset:0
  ds_read_b64_tr_b16 v[146:147], v6 offset:512
  v_mfma_f32_16x16x32_bf16 v[112:115], a[28:31], v[156:159], v[112:115]
  s_waitcnt lgkmcnt(8)
  v_mfma_f32_16x16x32_bf16 v[120:123], a[28:31], v[160:163], v[120:123]
  v_xor_b32 v2, 0x10000, v2
  ds_read_b64_tr_b16 v[148:149], v2 offset:0
  ds_read_b64_tr_b16 v[150:151], v2 offset:512
  v_mfma_f32_16x16x32_bf16 v[116:119], a[24:27], v[160:163], v[116:119]
  s_lshl2_add_u32 m0, s32, 105344
  s_nop 0
  buffer_load_dwordx4 v10, s[80:83], s89 offen offset:128 lds
  s_waitcnt lgkmcnt(8)
  v_mfma_f32_16x16x32_bf16 v[124:127], a[24:27], v[164:167], v[124:127]
  v_xor_b32 v3, 0x10000, v3
  ds_read_b64_tr_b16 v[152:153], v3 offset:0
  ds_read_b64_tr_b16 v[154:155], v3 offset:512
  v_mfma_f32_16x16x32_bf16 v[128:131], a[28:31], v[164:167], v[128:131]
  s_waitcnt lgkmcnt(8)
  v_mfma_f32_16x16x32_bf16 v[136:139], a[28:31], v[168:171], v[136:139]
  ds_read_b64_tr_b16 v[156:157], v5 offset:4096
  ds_read_b64_tr_b16 v[158:159], v5 offset:4608
  v_mfma_f32_16x16x32_bf16 v[132:135], a[24:27], v[168:171], v[132:135]
  s_waitcnt lgkmcnt(8)
  v_mfma_f32_16x16x32_bf16 v[12:15], a[32:35], v[140:143], v[12:15]
  ds_read_b64_tr_b16 v[160:161], v6 offset:4096
  ds_read_b64_tr_b16 v[162:163], v6 offset:4608
  v_mfma_f32_16x16x32_bf16 v[16:19], a[36:39], v[140:143], v[16:19]
  s_waitcnt lgkmcnt(8)
  v_mfma_f32_16x16x32_bf16 v[24:27], a[36:39], v[144:147], v[24:27]
  ds_read_b64_tr_b16 v[164:165], v2 offset:4096
  ds_read_b64_tr_b16 v[166:167], v2 offset:4608
  v_mfma_f32_16x16x32_bf16 v[20:23], a[32:35], v[144:147], v[20:23]
  s_waitcnt lgkmcnt(8)
  v_mfma_f32_16x16x32_bf16 v[28:31], a[32:35], v[148:151], v[28:31]
  ds_read_b64_tr_b16 v[168:169], v3 offset:4096
  ds_read_b64_tr_b16 v[170:171], v3 offset:4608
  v_mfma_f32_16x16x32_bf16 v[32:35], a[36:39], v[148:151], v[32:35]
  v_lshrrev_b32 v175, 3, v1
  v_bfe_u32 v174, v1, 2, 1
  v_lshlrev_b32 v174, 10, v174
  v_lshl_add_u32 v174, v175, 21, v174
  v_and_b32 v175, 3, v1
  v_lshl_add_u32 v174, v175, 7, v174
  v_bfe_u32 v176, v1, 4, 1
  v_and_b32 v177, 14, v1
  v_lshlrev_b32 v177, 6, v177
  v_lshl_add_u32 v176, v176, 13, v177
  s_lshl_b32 s62, s84, 14
  s_and_b32 s63, s2, 7
  s_lshl_b32 s63, s63, 10
  s_add_u32 s62, s62, s63
  buffer_load_dword v178, v176, s[24:27], s62 offen
  s_waitcnt lgkmcnt(8)
  v_mfma_f32_16x16x32_bf16 v[40:43], a[36:39], v[152:155], v[40:43]
  ds_read_b64_tr_b16 v[140:141], v5 offset:8192
  ds_read_b64_tr_b16 v[142:143], v5 offset:8704
  v_mfma_f32_16x16x32_bf16 v[36:39], a[32:35], v[152:155], v[36:39]
  s_waitcnt lgkmcnt(8)
  v_mfma_f32_16x16x32_bf16 v[12:15], a[40:43], v[156:159], v[12:15]
  ds_read_b64_tr_b16 v[144:145], v6 offset:8192
  ds_read_b64_tr_b16 v[146:147], v6 offset:8704
  v_mfma_f32_16x16x32_bf16 v[16:19], a[44:47], v[156:159], v[16:19]
  s_waitcnt lgkmcnt(8)
  v_mfma_f32_16x16x32_bf16 v[24:27], a[44:47], v[160:163], v[24:27]
  ds_read_b64_tr_b16 v[148:149], v2 offset:8192
  ds_read_b64_tr_b16 v[150:151], v2 offset:8704
  v_mfma_f32_16x16x32_bf16 v[20:23], a[40:43], v[160:163], v[20:23]
  v_bfe_u32 v179, v1, 3, 1
  v_mul_u32_u24 v179, 2752, v179
  v_and_b32 v180, 7, v1
  v_lshl_add_u32 v179, v180, 6, v179
  s_and_b32 s63, s2, 7
  s_lshl_b32 s63, s63, 3
  s_mov_b32 s100, 0xc080400
  s_mov_b32 s101, 0x1a16130f
  s_lshr_b64 s[100:101], s[100:101], s63
  s_and_b32 s62, s100, 0xff
  s_mul_i32 s62, s62, 96
  s_mul_i32 s63, s84, 5504
  s_add_u32 s62, s62, s63
  buffer_load_dword v181, v179, s[20:23], s62 offen
  s_waitcnt lgkmcnt(8)
  v_mfma_f32_16x16x32_bf16 v[28:31], a[40:43], v[164:167], v[28:31]
  ds_read_b64_tr_b16 v[152:153], v3 offset:8192
  ds_read_b64_tr_b16 v[154:155], v3 offset:8704
  v_mfma_f32_16x16x32_bf16 v[32:35], a[44:47], v[164:167], v[32:35]
  s_waitcnt lgkmcnt(8)
  v_mfma_f32_16x16x32_bf16 v[40:43], a[44:47], v[168:171], v[40:43]
  ds_read_b64_tr_b16 v[156:157], v5 offset:12288
  ds_read_b64_tr_b16 v[158:159], v5 offset:12800
  v_mfma_f32_16x16x32_bf16 v[36:39], a[40:43], v[168:171], v[36:39]
  s_waitcnt vmcnt(16)
  s_barrier
  s_waitcnt lgkmcnt(8)
  v_mfma_f32_16x16x32_bf16 v[12:15], a[48:51], v[140:143], v[12:15]
  ds_read_b64_tr_b16 v[160:161], v6 offset:12288
  ds_read_b64_tr_b16 v[162:163], v6 offset:12800
  v_mfma_f32_16x16x32_bf16 v[16:19], a[52:55], v[140:143], v[16:19]
  s_waitcnt lgkmcnt(8)
  v_mfma_f32_16x16x32_bf16 v[24:27], a[52:55], v[144:147], v[24:27]
  ds_read_b64_tr_b16 v[164:165], v2 offset:12288
  ds_read_b64_tr_b16 v[166:167], v2 offset:12800
  v_mfma_f32_16x16x32_bf16 v[20:23], a[48:51], v[144:147], v[20:23]
  s_waitcnt lgkmcnt(8)
  v_mfma_f32_16x16x32_bf16 v[28:31], a[48:51], v[148:151], v[28:31]
  ds_read_b64_tr_b16 v[168:169], v3 offset:12288
  ds_read_b64_tr_b16 v[170:171], v3 offset:12800
  v_mfma_f32_16x16x32_bf16 v[32:35], a[52:55], v[148:151], v[32:35]
  s_waitcnt lgkmcnt(8)
  v_mfma_f32_16x16x32_bf16 v[40:43], a[52:55], v[152:155], v[40:43]
  ds_read_b64_tr_b16 v[140:141], v5 offset:16384
  ds_read_b64_tr_b16 v[142:143], v5 offset:16896
  v_mfma_f32_16x16x32_bf16 v[36:39], a[48:51], v[152:155], v[36:39]
  s_add_u32 s40, s73, 2
  s_and_b32 s40, s40, 3
  s_lshl_b32 s40, s40, 20
  s_add_u32 s40, s40, s34
  s_add_u32 s40, s40, 128
  s_add_u32 m0, s32, 49152
  s_add_u32 s41, s40, 65536
  buffer_load_dwordx4 v7, s[16:19], s40 offen lds
  s_add_u32 m0, s32, 50176
  s_nop 0
  buffer_load_dwordx4 v0, s[16:19], s41 offen lds
  s_waitcnt lgkmcnt(8)
  v_mfma_f32_16x16x32_bf16 v[12:15], a[56:59], v[156:159], v[12:15]
  ds_read_b64_tr_b16 v[144:145], v6 offset:16384
  ds_read_b64_tr_b16 v[146:147], v6 offset:16896
  v_mfma_f32_16x16x32_bf16 v[16:19], a[60:63], v[156:159], v[16:19]
  s_waitcnt lgkmcnt(8)
  v_mfma_f32_16x16x32_bf16 v[24:27], a[60:63], v[160:163], v[24:27]
  ds_read_b64_tr_b16 v[148:149], v2 offset:16384
  ds_read_b64_tr_b16 v[150:151], v2 offset:16896
  v_mfma_f32_16x16x32_bf16 v[20:23], a[56:59], v[160:163], v[20:23]
  s_waitcnt lgkmcnt(8)
  v_mfma_f32_16x16x32_bf16 v[28:31], a[56:59], v[164:167], v[28:31]
  ds_read_b64_tr_b16 v[152:153], v3 offset:16384
  ds_read_b64_tr_b16 v[154:155], v3 offset:16896
  v_mfma_f32_16x16x32_bf16 v[32:35], a[60:63], v[164:167], v[32:35]
  s_waitcnt lgkmcnt(8)
  v_mfma_f32_16x16x32_bf16 v[40:43], a[60:63], v[168:171], v[40:43]
  ds_read_b64_tr_b16 v[156:157], v5 offset:20480
  ds_read_b64_tr_b16 v[158:159], v5 offset:20992
  v_mfma_f32_16x16x32_bf16 v[36:39], a[56:59], v[168:171], v[36:39]
  s_waitcnt lgkmcnt(8)
  v_mfma_f32_16x16x32_bf16 v[44:47], a[32:35], v[140:143], v[44:47]
  ds_read_b64_tr_b16 v[160:161], v6 offset:20480
  ds_read_b64_tr_b16 v[162:163], v6 offset:20992
  v_mfma_f32_16x16x32_bf16 v[48:51], a[36:39], v[140:143], v[48:51]
  s_waitcnt lgkmcnt(8)
  v_mfma_f32_16x16x32_bf16 v[56:59], a[36:39], v[144:147], v[56:59]
  ds_read_b64_tr_b16 v[164:165], v2 offset:20480
  ds_read_b64_tr_b16 v[166:167], v2 offset:20992
  v_mfma_f32_16x16x32_bf16 v[52:55], a[32:35], v[144:147], v[52:55]
  s_waitcnt lgkmcnt(8)
  v_mfma_f32_16x16x32_bf16 v[60:63], a[32:35], v[148:151], v[60:63]
  ds_read_b64_tr_b16 v[168:169], v3 offset:20480
  ds_read_b64_tr_b16 v[170:171], v3 offset:20992
  v_mfma_f32_16x16x32_bf16 v[64:67], a[36:39], v[148:151], v[64:67]
  s_waitcnt lgkmcnt(8)
  v_mfma_f32_16x16x32_bf16 v[72:75], a[36:39], v[152:155], v[72:75]
  ds_read_b64_tr_b16 v[140:141], v5 offset:24576
  ds_read_b64_tr_b16 v[142:143], v5 offset:25088
  v_mfma_f32_16x16x32_bf16 v[68:71], a[32:35], v[152:155], v[68:71]
  s_waitcnt lgkmcnt(8)
  v_mfma_f32_16x16x32_bf16 v[44:47], a[40:43], v[156:159], v[44:47]
  ds_read_b64_tr_b16 v[144:145], v6 offset:24576
  ds_read_b64_tr_b16 v[146:147], v6 offset:25088
  v_mfma_f32_16x16x32_bf16 v[48:51], a[44:47], v[156:159], v[48:51]
  s_waitcnt lgkmcnt(8)
  v_mfma_f32_16x16x32_bf16 v[56:59], a[44:47], v[160:163], v[56:59]
  ds_read_b64_tr_b16 v[148:149], v2 offset:24576
  ds_read_b64_tr_b16 v[150:151], v2 offset:25088
  v_mfma_f32_16x16x32_bf16 v[52:55], a[40:43], v[160:163], v[52:55]
  s_mov_b32 s96, s78
  s_mov_b32 s97, s79
  s_mov_b32 s98, 0x158000
  s_mov_b32 s99, 0x00020000
  s_mov_b64 exec, 0xff
  buffer_load_dword v175, v174, s[96:99], s68 offen
  s_mov_b64 exec, -1
  s_waitcnt lgkmcnt(8)
  v_mfma_f32_16x16x32_bf16 v[60:63], a[40:43], v[164:167], v[60:63]
  ds_read_b64_tr_b16 v[152:153], v3 offset:24576
  ds_read_b64_tr_b16 v[154:155], v3 offset:25088
  v_mfma_f32_16x16x32_bf16 v[64:67], a[44:47], v[164:167], v[64:67]
  s_waitcnt lgkmcnt(8)
  v_mfma_f32_16x16x32_bf16 v[72:75], a[44:47], v[168:171], v[72:75]
  ds_read_b64_tr_b16 v[156:157], v5 offset:28672
  ds_read_b64_tr_b16 v[158:159], v5 offset:29184
  v_mfma_f32_16x16x32_bf16 v[68:71], a[40:43], v[168:171], v[68:71]
  s_waitcnt vmcnt(17)
  s_barrier
  s_waitcnt lgkmcnt(8)
  v_mfma_f32_16x16x32_bf16 v[44:47], a[48:51], v[140:143], v[44:47]
  ds_read_b64_tr_b16 v[160:161], v6 offset:28672
  ds_read_b64_tr_b16 v[162:163], v6 offset:29184
  v_mfma_f32_16x16x32_bf16 v[48:51], a[52:55], v[140:143], v[48:51]
  s_waitcnt lgkmcnt(8)
  v_mfma_f32_16x16x32_bf16 v[56:59], a[52:55], v[144:147], v[56:59]
  ds_read_b64_tr_b16 v[164:165], v2 offset:28672
  ds_read_b64_tr_b16 v[166:167], v2 offset:29184
  v_mfma_f32_16x16x32_bf16 v[52:55], a[48:51], v[144:147], v[52:55]
  s_waitcnt lgkmcnt(8)
  v_mfma_f32_16x16x32_bf16 v[60:63], a[48:51], v[148:151], v[60:63]
  ds_read_b64_tr_b16 v[168:169], v3 offset:28672
  ds_read_b64_tr_b16 v[170:171], v3 offset:29184
  v_mfma_f32_16x16x32_bf16 v[64:67], a[52:55], v[148:151], v[64:67]
  s_waitcnt lgkmcnt(8)
  v_mfma_f32_16x16x32_bf16 v[72:75], a[52:55], v[152:155], v[72:75]
  v_xor_b32 v5, 0x10000, v5
  ds_read_b64_tr_b16 v[140:141], v5 offset:0
  ds_read_b64_tr_b16 v[142:143], v5 offset:512
  v_mfma_f32_16x16x32_bf16 v[68:71], a[48:51], v[152:155], v[68:71]
  s_add_u32 s40, s73, 2
  s_and_b32 s40, s40, 3
  s_lshl_b32 s40, s40, 20
  s_add_u32 s40, s40, s34
  s_add_u32 s40, s40, 256
  s_add_u32 m0, s32, 65536
  s_add_u32 s41, s40, 65536
  buffer_load_dwordx4 v7, s[16:19], s40 offen lds
  s_add_u32 m0, s32, 66560
  s_nop 0
  buffer_load_dwordx4 v0, s[16:19], s41 offen lds
  s_waitcnt lgkmcnt(8)
  v_mfma_f32_16x16x32_bf16 v[44:47], a[56:59], v[156:159], v[44:47]
  v_xor_b32 v6, 0x10000, v6
  ds_read_b64_tr_b16 v[144:145], v6 offset:0
  ds_read_b64_tr_b16 v[146:147], v6 offset:512
  v_mfma_f32_16x16x32_bf16 v[48:51], a[60:63], v[156:159], v[48:51]
  s_waitcnt lgkmcnt(8)
  v_mfma_f32_16x16x32_bf16 v[56:59], a[60:63], v[160:163], v[56:59]
  v_xor_b32 v2, 0x10000, v2
  ds_read_b64_tr_b16 v[148:149], v2 offset:0
  ds_read_b64_tr_b16 v[150:151], v2 offset:512
  v_mfma_f32_16x16x32_bf16 v[52:55], a[56:59], v[160:163], v[52:55]
  s_waitcnt lgkmcnt(8)
  v_mfma_f32_16x16x32_bf16 v[60:63], a[56:59], v[164:167], v[60:63]
  v_xor_b32 v3, 0x10000, v3
  ds_read_b64_tr_b16 v[152:153], v3 offset:0
  ds_read_b64_tr_b16 v[154:155], v3 offset:512
  v_mfma_f32_16x16x32_bf16 v[64:67], a[60:63], v[164:167], v[64:67]
  s_waitcnt lgkmcnt(8)
  v_mfma_f32_16x16x32_bf16 v[72:75], a[60:63], v[168:171], v[72:75]
  ds_read_b64_tr_b16 v[156:157], v5 offset:4096
  ds_read_b64_tr_b16 v[158:159], v5 offset:4608
  v_mfma_f32_16x16x32_bf16 v[68:71], a[56:59], v[168:171], v[68:71]
  s_waitcnt lgkmcnt(8)
  v_mfma_f32_16x16x32_bf16 v[76:79], a[32:35], v[140:143], v[76:79]
  ds_read_b64_tr_b16 v[160:161], v6 offset:4096
  ds_read_b64_tr_b16 v[162:163], v6 offset:4608
  v_mfma_f32_16x16x32_bf16 v[80:83], a[36:39], v[140:143], v[80:83]
  s_waitcnt vmcnt(13)
  ds_read_b128 a[0:3], v188 offset:0
  ds_read_b128 a[4:7], v188 offset:2048
  s_waitcnt lgkmcnt(10)
  v_mfma_f32_16x16x32_bf16 v[88:91], a[36:39], v[144:147], v[88:91]
  ds_read_b64_tr_b16 v[164:165], v2 offset:4096
  ds_read_b64_tr_b16 v[166:167], v2 offset:4608
  v_mfma_f32_16x16x32_bf16 v[84:87], a[32:35], v[144:147], v[84:87]
  ds_read_b128 a[8:11], v189 offset:0
  ds_read_b128 a[12:15], v189 offset:2048
  s_waitcnt lgkmcnt(12)
  v_mfma_f32_16x16x32_bf16 v[92:95], a[32:35], v[148:151], v[92:95]
  ds_read_b64_tr_b16 v[168:169], v3 offset:4096
  ds_read_b64_tr_b16 v[170:171], v3 offset:4608
  v_mfma_f32_16x16x32_bf16 v[96:99], a[36:39], v[148:151], v[96:99]
  s_waitcnt lgkmcnt(12)
  v_mfma_f32_16x16x32_bf16 v[104:107], a[36:39], v[152:155], v[104:107]
  ds_read_b64_tr_b16 v[140:141], v5 offset:8192
  ds_read_b64_tr_b16 v[142:143], v5 offset:8704
  v_mfma_f32_16x16x32_bf16 v[100:103], a[32:35], v[152:155], v[100:103]
  s_waitcnt lgkmcnt(12)
  v_mfma_f32_16x16x32_bf16 v[76:79], a[40:43], v[156:159], v[76:79]
  ds_read_b64_tr_b16 v[144:145], v6 offset:8192
  ds_read_b64_tr_b16 v[146:147], v6 offset:8704
  v_mfma_f32_16x16x32_bf16 v[80:83], a[44:47], v[156:159], v[80:83]
  s_waitcnt lgkmcnt(6)
  s_add_u32 s40, s73, 3
  s_and_b32 s40, s40, 3
  s_lshl_b32 s40, s40, 8
  s_lshl_b32 s86, s44, 15
  s_add_u32 s86, s86, s40
  s_add_u32 s87, s86, 8192
  s_add_u32 s88, s86, 16384
  s_add_u32 s89, s86, 24576
  s_lshl2_add_u32 m0, s32, 98304
  s_nop 0
  buffer_load_dwordx4 v9, s[80:83], s86 offen offset:0 lds
  v_mfma_f32_16x16x32_bf16 v[88:91], a[44:47], v[160:163], v[88:91]
  ds_read_b64_tr_b16 v[148:149], v2 offset:8192
  ds_read_b64_tr_b16 v[150:151], v2 offset:8704
  v_mfma_f32_16x16x32_bf16 v[84:87], a[40:43], v[160:163], v[84:87]
  v_mfma_f32_16x16x32_bf16 v[92:95], a[40:43], v[164:167], v[92:95]
  ds_read_b64_tr_b16 v[152:153], v3 offset:8192
  ds_read_b64_tr_b16 v[154:155], v3 offset:8704
  v_mfma_f32_16x16x32_bf16 v[96:99], a[44:47], v[164:167], v[96:99]
  s_lshl2_add_u32 m0, s32, 99328
  s_nop 0
  buffer_load_dwordx4 v10, s[80:83], s87 offen offset:0 lds
  s_waitcnt lgkmcnt(8)
  v_mfma_f32_16x16x32_bf16 v[104:107], a[44:47], v[168:171], v[104:107]
  ds_read_b64_tr_b16 v[156:157], v5 offset:12288
  ds_read_b64_tr_b16 v[158:159], v5 offset:12800
  v_mfma_f32_16x16x32_bf16 v[100:103], a[40:43], v[168:171], v[100:103]
  s_barrier
  s_waitcnt lgkmcnt(8)
  v_mfma_f32_16x16x32_bf16 v[76:79], a[48:51], v[140:143], v[76:79]
  ds_read_b64_tr_b16 v[160:161], v6 offset:12288
  ds_read_b64_tr_b16 v[162:163], v6 offset:12800
  v_mfma_f32_16x16x32_bf16 v[80:83], a[52:55], v[140:143], v[80:83]
  s_waitcnt vmcnt(9)
  ds_read_b128 a[16:19], v188 offset:4096
  ds_read_b128 a[20:23], v188 offset:6144
  s_waitcnt lgkmcnt(10)
  v_mfma_f32_16x16x32_bf16 v[88:91], a[52:55], v[144:147], v[88:91]
  ds_read_b64_tr_b16 v[164:165], v2 offset:12288
  ds_read_b64_tr_b16 v[166:167], v2 offset:12800
  v_mfma_f32_16x16x32_bf16 v[84:87], a[48:51], v[144:147], v[84:87]
  ds_read_b128 a[24:27], v189 offset:4096
  ds_read_b128 a[28:31], v189 offset:6144
  s_lshl2_add_u32 m0, s32, 100352
  s_nop 0
  buffer_load_dwordx4 v9, s[80:83], s88 offen offset:0 lds
  s_waitcnt lgkmcnt(12)
  v_mfma_f32_16x16x32_bf16 v[92:95], a[48:51], v[148:151], v[92:95]
  ds_read_b64_tr_b16 v[168:169], v3 offset:12288
  ds_read_b64_tr_b16 v[170:171], v3 offset:12800
  v_mfma_f32_16x16x32_bf16 v[96:99], a[52:55], v[148:151], v[96:99]
  s_waitcnt lgkmcnt(12)
  v_mfma_f32_16x16x32_bf16 v[104:107], a[52:55], v[152:155], v[104:107]
  ds_read_b64_tr_b16 v[140:141], v5 offset:16384
  ds_read_b64_tr_b16 v[142:143], v5 offset:16896
  v_mfma_f32_16x16x32_bf16 v[100:103], a[48:51], v[152:155], v[100:103]
  s_add_u32 s40, s73, 2
  s_and_b32 s40, s40, 3
  s_lshl_b32 s40, s40, 20
  s_add_u32 s40, s40, s34
  s_add_u32 s40, s40, 384
  s_add_u32 m0, s32, 81920
  s_add_u32 s41, s40, 65536
  buffer_load_dwordx4 v7, s[16:19], s40 offen lds
  s_add_u32 m0, s32, 82944
  s_nop 0
  buffer_load_dwordx4 v0, s[16:19], s41 offen lds
  s_waitcnt lgkmcnt(12)
  v_mfma_f32_16x16x32_bf16 v[76:79], a[56:59], v[156:159], v[76:79]
  ds_read_b64_tr_b16 v[144:145], v6 offset:16384
  ds_read_b64_tr_b16 v[146:147], v6 offset:16896
  v_mfma_f32_16x16x32_bf16 v[80:83], a[60:63], v[156:159], v[80:83]
  s_waitcnt lgkmcnt(12)
  v_mfma_f32_16x16x32_bf16 v[88:91], a[60:63], v[160:163], v[88:91]
  ds_read_b64_tr_b16 v[148:149], v2 offset:16384
  ds_read_b64_tr_b16 v[150:151], v2 offset:16896
  v_mfma_f32_16x16x32_bf16 v[84:87], a[56:59], v[160:163], v[84:87]
  s_lshl2_add_u32 m0, s32, 101376
  s_nop 0
  buffer_load_dwordx4 v10, s[80:83], s89 offen offset:0 lds
  v_and_b32 v173, 15, v1
  v_lshlrev_b32 v173, 2, v173
  buffer_load_dword v172, v173, s[28:31], 0 offen sc1
  s_waitcnt lgkmcnt(10)
  v_mfma_f32_16x16x32_bf16 v[92:95], a[56:59], v[164:167], v[92:95]
  ds_read_b64_tr_b16 v[152:153], v3 offset:16384
  ds_read_b64_tr_b16 v[154:155], v3 offset:16896
  v_mfma_f32_16x16x32_bf16 v[96:99], a[60:63], v[164:167], v[96:99]
  s_waitcnt lgkmcnt(8)
  v_mfma_f32_16x16x32_bf16 v[104:107], a[60:63], v[168:171], v[104:107]
  ds_read_b64_tr_b16 v[156:157], v5 offset:20480
  ds_read_b64_tr_b16 v[158:159], v5 offset:20992
  v_mfma_f32_16x16x32_bf16 v[100:103], a[56:59], v[168:171], v[100:103]
  s_waitcnt lgkmcnt(8)
  v_mfma_f32_16x16x32_bf16 v[108:111], a[32:35], v[140:143], v[108:111]
  ds_read_b64_tr_b16 v[160:161], v6 offset:20480
  ds_read_b64_tr_b16 v[162:163], v6 offset:20992
  v_mfma_f32_16x16x32_bf16 v[112:115], a[36:39], v[140:143], v[112:115]
  s_waitcnt lgkmcnt(8)
  v_mfma_f32_16x16x32_bf16 v[120:123], a[36:39], v[144:147], v[120:123]
  ds_read_b64_tr_b16 v[164:165], v2 offset:20480
  ds_read_b64_tr_b16 v[166:167], v2 offset:20992
  v_mfma_f32_16x16x32_bf16 v[116:119], a[32:35], v[144:147], v[116:119]
  s_lshl2_add_u32 m0, s32, 102272
  s_nop 0
  buffer_load_dwordx4 v9, s[80:83], s86 offen offset:128 lds
  s_waitcnt lgkmcnt(8)
  v_mfma_f32_16x16x32_bf16 v[124:127], a[32:35], v[148:151], v[124:127]
  ds_read_b64_tr_b16 v[168:169], v3 offset:20480
  ds_read_b64_tr_b16 v[170:171], v3 offset:20992
  v_mfma_f32_16x16x32_bf16 v[128:131], a[36:39], v[148:151], v[128:131]
  s_waitcnt lgkmcnt(8)
  v_mfma_f32_16x16x32_bf16 v[136:139], a[36:39], v[152:155], v[136:139]
  ds_read_b64_tr_b16 v[140:141], v5 offset:24576
  ds_read_b64_tr_b16 v[142:143], v5 offset:25088
  v_mfma_f32_16x16x32_bf16 v[132:135], a[32:35], v[152:155], v[132:135]
  s_waitcnt lgkmcnt(8)
  v_mfma_f32_16x16x32_bf16 v[108:111], a[40:43], v[156:159], v[108:111]
  ds_read_b64_tr_b16 v[144:145], v6 offset:24576
  ds_read_b64_tr_b16 v[146:147], v6 offset:25088
  v_mfma_f32_16x16x32_bf16 v[112:115], a[44:47], v[156:159], v[112:115]
  s_lshl2_add_u32 m0, s32, 103296
  s_nop 0
  buffer_load_dwordx4 v10, s[80:83], s87 offen offset:128 lds
  s_waitcnt lgkmcnt(8)
  v_mfma_f32_16x16x32_bf16 v[120:123], a[44:47], v[160:163], v[120:123]
  ds_read_b64_tr_b16 v[148:149], v2 offset:24576
  ds_read_b64_tr_b16 v[150:151], v2 offset:25088
  v_mfma_f32_16x16x32_bf16 v[116:119], a[40:43], v[160:163], v[116:119]
  s_waitcnt lgkmcnt(8)
  v_mfma_f32_16x16x32_bf16 v[124:127], a[40:43], v[164:167], v[124:127]
  ds_read_b64_tr_b16 v[152:153], v3 offset:24576
  ds_read_b64_tr_b16 v[154:155], v3 offset:25088
  v_mfma_f32_16x16x32_bf16 v[128:131], a[44:47], v[164:167], v[128:131]
  s_waitcnt lgkmcnt(8)
  v_mfma_f32_16x16x32_bf16 v[136:139], a[44:47], v[168:171], v[136:139]
  ds_read_b64_tr_b16 v[156:157], v5 offset:28672
  ds_read_b64_tr_b16 v[158:159], v5 offset:29184
  v_mfma_f32_16x16x32_bf16 v[132:135], a[40:43], v[168:171], v[132:135]
  s_barrier
  s_waitcnt lgkmcnt(8)
  v_mfma_f32_16x16x32_bf16 v[108:111], a[48:51], v[140:143], v[108:111]
  ds_read_b64_tr_b16 v[160:161], v6 offset:28672
  ds_read_b64_tr_b16 v[162:163], v6 offset:29184
  v_mfma_f32_16x16x32_bf16 v[112:115], a[52:55], v[140:143], v[112:115]
  s_waitcnt lgkmcnt(8)
  v_mfma_f32_16x16x32_bf16 v[120:123], a[52:55], v[144:147], v[120:123]
  ds_read_b64_tr_b16 v[164:165], v2 offset:28672
  ds_read_b64_tr_b16 v[166:167], v2 offset:29184
  v_mfma_f32_16x16x32_bf16 v[116:119], a[48:51], v[144:147], v[116:119]
  s_lshl2_add_u32 m0, s32, 104320
  s_nop 0
  buffer_load_dwordx4 v9, s[80:83], s88 offen offset:128 lds
  s_waitcnt lgkmcnt(8)
  v_mfma_f32_16x16x32_bf16 v[124:127], a[48:51], v[148:151], v[124:127]
  ds_read_b64_tr_b16 v[168:169], v3 offset:28672
  ds_read_b64_tr_b16 v[170:171], v3 offset:29184
  v_mfma_f32_16x16x32_bf16 v[128:131], a[52:55], v[148:151], v[128:131]
  s_waitcnt lgkmcnt(8)
  v_mfma_f32_16x16x32_bf16 v[136:139], a[52:55], v[152:155], v[136:139]
  ds_read_b64_tr_b16 v[140:141], v5 offset:32768
  ds_read_b64_tr_b16 v[142:143], v5 offset:33280
  v_mfma_f32_16x16x32_bf16 v[132:135], a[48:51], v[152:155], v[132:135]
  s_add_u32 s40, s73, 3
  s_and_b32 s40, s40, 3
  s_lshl_b32 s40, s40, 20
  s_add_u32 s40, s40, s34
  s_add_u32 m0, s32, 0
  s_add_u32 s41, s40, 65536
  buffer_load_dwordx4 v7, s[16:19], s40 offen lds
  s_add_u32 m0, s32, 1024
  s_nop 0
  buffer_load_dwordx4 v0, s[16:19], s41 offen lds
  s_waitcnt lgkmcnt(8)
  v_mfma_f32_16x16x32_bf16 v[108:111], a[56:59], v[156:159], v[108:111]
  ds_read_b64_tr_b16 v[144:145], v6 offset:32768
  ds_read_b64_tr_b16 v[146:147], v6 offset:33280
  v_mfma_f32_16x16x32_bf16 v[112:115], a[60:63], v[156:159], v[112:115]
  s_waitcnt lgkmcnt(8)
  v_mfma_f32_16x16x32_bf16 v[120:123], a[60:63], v[160:163], v[120:123]
  ds_read_b64_tr_b16 v[148:149], v2 offset:32768
  ds_read_b64_tr_b16 v[150:151], v2 offset:33280
  v_mfma_f32_16x16x32_bf16 v[116:119], a[56:59], v[160:163], v[116:119]
  s_lshl2_add_u32 m0, s32, 105344
  s_nop 0
  buffer_load_dwordx4 v10, s[80:83], s89 offen offset:128 lds
  s_waitcnt lgkmcnt(8)
  v_mfma_f32_16x16x32_bf16 v[124:127], a[56:59], v[164:167], v[124:127]
  ds_read_b64_tr_b16 v[152:153], v3 offset:32768
  ds_read_b64_tr_b16 v[154:155], v3 offset:33280
  v_mfma_f32_16x16x32_bf16 v[128:131], a[60:63], v[164:167], v[128:131]
  s_waitcnt vmcnt(6)
  s_cmp_lg_u32 s93, 0
  s_cbranch_scc1 L_attn_spun_4
  v_cmp_ne_u32 vcc, 16, v172
  s_cbranch_vccnz L_attn_spin_3
L_attn_spun_4:
  s_waitcnt lgkmcnt(8)
  v_mfma_f32_16x16x32_bf16 v[136:139], a[60:63], v[168:171], v[136:139]
  ds_read_b64_tr_b16 v[156:157], v5 offset:36864
  ds_read_b64_tr_b16 v[158:159], v5 offset:37376
  v_mfma_f32_16x16x32_bf16 v[132:135], a[56:59], v[168:171], v[132:135]
  s_and_b32 s62, s2, 7
  s_lshl_b32 s62, s62, 3
  s_add_u32 s62, s62, 128
  buffer_load_dwordx2 v[184:185], off, s[28:31], s62 sc1
  s_waitcnt lgkmcnt(8)
  v_mfma_f32_16x16x32_bf16 v[12:15], a[0:3], v[140:143], v[12:15]
  ds_read_b64_tr_b16 v[160:161], v6 offset:36864
  ds_read_b64_tr_b16 v[162:163], v6 offset:37376
  v_mfma_f32_16x16x32_bf16 v[16:19], a[4:7], v[140:143], v[16:19]
  s_waitcnt lgkmcnt(8)
  v_mfma_f32_16x16x32_bf16 v[24:27], a[4:7], v[144:147], v[24:27]
  ds_read_b64_tr_b16 v[164:165], v2 offset:36864
  ds_read_b64_tr_b16 v[166:167], v2 offset:37376
  v_mfma_f32_16x16x32_bf16 v[20:23], a[0:3], v[144:147], v[20:23]
  s_waitcnt lgkmcnt(8)
  v_mfma_f32_16x16x32_bf16 v[28:31], a[0:3], v[148:151], v[28:31]
  ds_read_b64_tr_b16 v[168:169], v3 offset:36864
  ds_read_b64_tr_b16 v[170:171], v3 offset:37376
  v_mfma_f32_16x16x32_bf16 v[32:35], a[4:7], v[148:151], v[32:35]
  s_waitcnt lgkmcnt(8)
  v_mfma_f32_16x16x32_bf16 v[40:43], a[4:7], v[152:155], v[40:43]
  ds_read_b64_tr_b16 v[140:141], v5 offset:40960
  ds_read_b64_tr_b16 v[142:143], v5 offset:41472
  v_mfma_f32_16x16x32_bf16 v[36:39], a[0:3], v[152:155], v[36:39]
  s_waitcnt lgkmcnt(8)
  v_mfma_f32_16x16x32_bf16 v[12:15], a[8:11], v[156:159], v[12:15]
  ds_read_b64_tr_b16 v[144:145], v6 offset:40960
  ds_read_b64_tr_b16 v[146:147], v6 offset:41472
  v_mfma_f32_16x16x32_bf16 v[16:19], a[12:15], v[156:159], v[16:19]
  s_waitcnt lgkmcnt(8)
  v_mfma_f32_16x16x32_bf16 v[24:27], a[12:15], v[160:163], v[24:27]
  ds_read_b64_tr_b16 v[148:149], v2 offset:40960
  ds_read_b64_tr_b16 v[150:151], v2 offset:41472
  v_mfma_f32_16x16x32_bf16 v[20:23], a[8:11], v[160:163], v[20:23]
  s_waitcnt lgkmcnt(8)
  v_mfma_f32_16x16x32_bf16 v[28:31], a[8:11], v[164:167], v[28:31]
  ds_read_b64_tr_b16 v[152:153], v3 offset:40960
  ds_read_b64_tr_b16 v[154:155], v3 offset:41472
  v_mfma_f32_16x16x32_bf16 v[32:35], a[12:15], v[164:167], v[32:35]
  s_waitcnt lgkmcnt(8)
  v_mfma_f32_16x16x32_bf16 v[40:43], a[12:15], v[168:171], v[40:43]
  ds_read_b64_tr_b16 v[156:157], v5 offset:45056
  ds_read_b64_tr_b16 v[158:159], v5 offset:45568
  v_mfma_f32_16x16x32_bf16 v[36:39], a[8:11], v[168:171], v[36:39]
  s_barrier
  s_waitcnt lgkmcnt(8)
  v_mfma_f32_16x16x32_bf16 v[12:15], a[16:19], v[140:143], v[12:15]
  ds_read_b64_tr_b16 v[160:161], v6 offset:45056
  ds_read_b64_tr_b16 v[162:163], v6 offset:45568
  v_mfma_f32_16x16x32_bf16 v[16:19], a[20:23], v[140:143], v[16:19]
  s_lshr_b32 s62, s2, 6
  s_lshl_b32 s62, s62, 3
  s_add_u32 s62, s62, s93
  s_cmp_lt_u32 s62, 16
  s_cselect_b32 s63, s65, s66
  s_and_b32 s62, s62, 15
  s_lshl_b32 s62, s62, 13
  s_lshl_b32 s63, s63, 15
  s_add_u32 s62, s62, s63
  v_lshl_add_u32 v182, v1, 7, s62
  s_add_u32 s28, s60, 0x7000000
  s_addc_u32 s29, s61, 0
  s_mov_b32 s30, 4096
  s_mov_b32 exec_lo, 0xffff
  s_mov_b32 exec_hi, 0x0
  buffer_load_dword v183, v182, s[8:11], 0 offen
  s_mov_b64 exec, -1
  s_waitcnt lgkmcnt(8)
  v_mfma_f32_16x16x32_bf16 v[24:27], a[20:23], v[144:147], v[24:27]
  ds_read_b64_tr_b16 v[164:165], v2 offset:45056
  ds_read_b64_tr_b16 v[166:167], v2 offset:45568
  v_mfma_f32_16x16x32_bf16 v[20:23], a[16:19], v[144:147], v[20:23]
  s_waitcnt lgkmcnt(8)
  v_mfma_f32_16x16x32_bf16 v[28:31], a[16:19], v[148:151], v[28:31]
  ds_read_b64_tr_b16 v[168:169], v3 offset:45056
  ds_read_b64_tr_b16 v[170:171], v3 offset:45568
  v_mfma_f32_16x16x32_bf16 v[32:35], a[20:23], v[148:151], v[32:35]
  s_waitcnt lgkmcnt(8)
  v_mfma_f32_16x16x32_bf16 v[40:43], a[20:23], v[152:155], v[40:43]
  ds_read_b64_tr_b16 v[140:141], v5 offset:49152
  ds_read_b64_tr_b16 v[142:143], v5 offset:49664
  v_mfma_f32_16x16x32_bf16 v[36:39], a[16:19], v[152:155], v[36:39]
  s_add_u32 s40, s73, 3
  s_and_b32 s40, s40, 3
  s_lshl_b32 s40, s40, 20
  s_add_u32 s40, s40, s34
  s_add_u32 s40, s40, 128
  s_add_u32 m0, s32, 16384
  s_add_u32 s41, s40, 65536
  buffer_load_dwordx4 v7, s[16:19], s40 offen lds
  s_add_u32 m0, s32, 17408
  s_nop 0
  buffer_load_dwordx4 v0, s[16:19], s41 offen lds
  s_waitcnt lgkmcnt(8)
  v_mfma_f32_16x16x32_bf16 v[12:15], a[24:27], v[156:159], v[12:15]
  ds_read_b64_tr_b16 v[144:145], v6 offset:49152
  ds_read_b64_tr_b16 v[146:147], v6 offset:49664
  v_mfma_f32_16x16x32_bf16 v[16:19], a[28:31], v[156:159], v[16:19]
  s_waitcnt lgkmcnt(8)
  v_mfma_f32_16x16x32_bf16 v[24:27], a[28:31], v[160:163], v[24:27]
  ds_read_b64_tr_b16 v[148:149], v2 offset:49152
  ds_read_b64_tr_b16 v[150:151], v2 offset:49664
  v_mfma_f32_16x16x32_bf16 v[20:23], a[24:27], v[160:163], v[20:23]
  s_waitcnt lgkmcnt(8)
  v_mfma_f32_16x16x32_bf16 v[28:31], a[24:27], v[164:167], v[28:31]
  ds_read_b64_tr_b16 v[152:153], v3 offset:49152
  ds_read_b64_tr_b16 v[154:155], v3 offset:49664
  v_mfma_f32_16x16x32_bf16 v[32:35], a[28:31], v[164:167], v[32:35]
  s_waitcnt lgkmcnt(8)
  v_mfma_f32_16x16x32_bf16 v[40:43], a[28:31], v[168:171], v[40:43]
  ds_read_b64_tr_b16 v[156:157], v5 offset:53248
  ds_read_b64_tr_b16 v[158:159], v5 offset:53760
  v_mfma_f32_16x16x32_bf16 v[36:39], a[24:27], v[168:171], v[36:39]
  s_waitcnt lgkmcnt(8)
  v_mfma_f32_16x16x32_bf16 v[44:47], a[0:3], v[140:143], v[44:47]
  ds_read_b64_tr_b16 v[160:161], v6 offset:53248
  ds_read_b64_tr_b16 v[162:163], v6 offset:53760
  v_mfma_f32_16x16x32_bf16 v[48:51], a[4:7], v[140:143], v[48:51]
  s_waitcnt lgkmcnt(8)
  v_mfma_f32_16x16x32_bf16 v[56:59], a[4:7], v[144:147], v[56:59]
  ds_read_b64_tr_b16 v[164:165], v2 offset:53248
  ds_read_b64_tr_b16 v[166:167], v2 offset:53760
  v_mfma_f32_16x16x32_bf16 v[52:55], a[0:3], v[144:147], v[52:55]
  s_waitcnt lgkmcnt(8)
  v_mfma_f32_16x16x32_bf16 v[60:63], a[0:3], v[148:151], v[60:63]
  ds_read_b64_tr_b16 v[168:169], v3 offset:53248
  ds_read_b64_tr_b16 v[170:171], v3 offset:53760
  v_mfma_f32_16x16x32_bf16 v[64:67], a[4:7], v[148:151], v[64:67]
  s_mov_b32 exec_lo, 0xffff0000
  s_mov_b32 exec_hi, 0x0
  buffer_load_dword v183, v182, s[8:11], 0 offen
  s_mov_b64 exec, -1
  s_waitcnt lgkmcnt(8)
  v_mfma_f32_16x16x32_bf16 v[72:75], a[4:7], v[152:155], v[72:75]
  ds_read_b64_tr_b16 v[140:141], v5 offset:57344
  ds_read_b64_tr_b16 v[142:143], v5 offset:57856
  v_mfma_f32_16x16x32_bf16 v[68:71], a[0:3], v[152:155], v[68:71]
  s_waitcnt lgkmcnt(8)
  v_mfma_f32_16x16x32_bf16 v[44:47], a[8:11], v[156:159], v[44:47]
  ds_read_b64_tr_b16 v[144:145], v6 offset:57344
  ds_read_b64_tr_b16 v[146:147], v6 offset:57856
  v_mfma_f32_16x16x32_bf16 v[48:51], a[12:15], v[156:159], v[48:51]
  s_waitcnt lgkmcnt(8)
  v_mfma_f32_16x16x32_bf16 v[56:59], a[12:15], v[160:163], v[56:59]
  ds_read_b64_tr_b16 v[148:149], v2 offset:57344
  ds_read_b64_tr_b16 v[150:151], v2 offset:57856
  v_mfma_f32_16x16x32_bf16 v[52:55], a[8:11], v[160:163], v[52:55]
  s_waitcnt lgkmcnt(8)
  v_mfma_f32_16x16x32_bf16 v[60:63], a[8:11], v[164:167], v[60:63]
  ds_read_b64_tr_b16 v[152:153], v3 offset:57344
  ds_read_b64_tr_b16 v[154:155], v3 offset:57856
  v_mfma_f32_16x16x32_bf16 v[64:67], a[12:15], v[164:167], v[64:67]
  s_waitcnt lgkmcnt(8)
  v_mfma_f32_16x16x32_bf16 v[72:75], a[12:15], v[168:171], v[72:75]
  ds_read_b64_tr_b16 v[156:157], v5 offset:61440
  ds_read_b64_tr_b16 v[158:159], v5 offset:61952
  v_mfma_f32_16x16x32_bf16 v[68:71], a[8:11], v[168:171], v[68:71]
  s_barrier
  s_waitcnt lgkmcnt(8)
  v_mfma_f32_16x16x32_bf16 v[44:47], a[16:19], v[140:143], v[44:47]
  ds_read_b64_tr_b16 v[160:161], v6 offset:61440
  ds_read_b64_tr_b16 v[162:163], v6 offset:61952
  v_mfma_f32_16x16x32_bf16 v[48:51], a[20:23], v[140:143], v[48:51]
  s_waitcnt lgkmcnt(8)
  v_mfma_f32_16x16x32_bf16 v[56:59], a[20:23], v[144:147], v[56:59]
  ds_read_b64_tr_b16 v[164:165], v2 offset:61440
  ds_read_b64_tr_b16 v[166:167], v2 offset:61952
  v_mfma_f32_16x16x32_bf16 v[52:55], a[16:19], v[144:147], v[52:55]
  s_mov_b32 exec_lo, 0x0
  s_mov_b32 exec_hi, 0xffff
  buffer_load_dword v183, v182, s[8:11], 0 offen
  s_mov_b64 exec, -1
  s_waitcnt lgkmcnt(8)
  v_mfma_f32_16x16x32_bf16 v[60:63], a[16:19], v[148:151], v[60:63]
  ds_read_b64_tr_b16 v[168:169], v3 offset:61440
  ds_read_b64_tr_b16 v[170:171], v3 offset:61952
  v_mfma_f32_16x16x32_bf16 v[64:67], a[20:23], v[148:151], v[64:67]
  s_waitcnt lgkmcnt(8)
  v_mfma_f32_16x16x32_bf16 v[72:75], a[20:23], v[152:155], v[72:75]
  v_xor_b32 v5, 0x10000, v5
  ds_read_b64_tr_b16 v[140:141], v5 offset:0
  ds_read_b64_tr_b16 v[142:143], v5 offset:512
  v_mfma_f32_16x16x32_bf16 v[68:71], a[16:19], v[152:155], v[68:71]
  s_add_u32 s40, s73, 3
  s_and_b32 s40, s40, 3
  s_lshl_b32 s40, s40, 20
  s_add_u32 s40, s40, s34
  s_add_u32 s40, s40, 256
  s_add_u32 m0, s32, 32768
  s_add_u32 s41, s40, 65536
  buffer_load_dwordx4 v7, s[16:19], s40 offen lds
  s_add_u32 m0, s32, 33792
  s_nop 0
  buffer_load_dwordx4 v0, s[16:19], s41 offen lds
  s_waitcnt lgkmcnt(8)
  v_mfma_f32_16x16x32_bf16 v[44:47], a[24:27], v[156:159], v[44:47]
  v_xor_b32 v6, 0x10000, v6
  ds_read_b64_tr_b16 v[144:145], v6 offset:0
  ds_read_b64_tr_b16 v[146:147], v6 offset:512
  v_mfma_f32_16x16x32_bf16 v[48:51], a[28:31], v[156:159], v[48:51]
  s_waitcnt lgkmcnt(8)
  v_mfma_f32_16x16x32_bf16 v[56:59], a[28:31], v[160:163], v[56:59]
  v_xor_b32 v2, 0x10000, v2
  ds_read_b64_tr_b16 v[148:149], v2 offset:0
  ds_read_b64_tr_b16 v[150:151], v2 offset:512
  v_mfma_f32_16x16x32_bf16 v[52:55], a[24:27], v[160:163], v[52:55]
  s_waitcnt lgkmcnt(8)
  v_mfma_f32_16x16x32_bf16 v[60:63], a[24:27], v[164:167], v[60:63]
  v_xor_b32 v3, 0x10000, v3
  ds_read_b64_tr_b16 v[152:153], v3 offset:0
  ds_read_b64_tr_b16 v[154:155], v3 offset:512
  v_mfma_f32_16x16x32_bf16 v[64:67], a[28:31], v[164:167], v[64:67]
  s_waitcnt lgkmcnt(8)
  v_mfma_f32_16x16x32_bf16 v[72:75], a[28:31], v[168:171], v[72:75]
  ds_read_b64_tr_b16 v[156:157], v5 offset:4096
  ds_read_b64_tr_b16 v[158:159], v5 offset:4608
  v_mfma_f32_16x16x32_bf16 v[68:71], a[24:27], v[168:171], v[68:71]
  s_waitcnt lgkmcnt(8)
  v_mfma_f32_16x16x32_bf16 v[76:79], a[0:3], v[140:143], v[76:79]
  ds_read_b64_tr_b16 v[160:161], v6 offset:4096
  ds_read_b64_tr_b16 v[162:163], v6 offset:4608
  v_mfma_f32_16x16x32_bf16 v[80:83], a[4:7], v[140:143], v[80:83]
  ds_read_b128 a[32:35], v188 offset:0
  ds_read_b128 a[36:39], v188 offset:2048
  s_waitcnt lgkmcnt(10)
  v_mfma_f32_16x16x32_bf16 v[88:91], a[4:7], v[144:147], v[88:91]
  ds_read_b64_tr_b16 v[164:165], v2 offset:4096
  ds_read_b64_tr_b16 v[166:167], v2 offset:4608
  v_mfma_f32_16x16x32_bf16 v[84:87], a[0:3], v[144:147], v[84:87]
  ds_read_b128 a[40:43], v189 offset:0
  ds_read_b128 a[44:47], v189 offset:2048
  s_waitcnt lgkmcnt(12)
  v_mfma_f32_16x16x32_bf16 v[92:95], a[0:3], v[148:151], v[92:95]
  ds_read_b64_tr_b16 v[168:169], v3 offset:4096
  ds_read_b64_tr_b16 v[170:171], v3 offset:4608
  v_mfma_f32_16x16x32_bf16 v[96:99], a[4:7], v[148:151], v[96:99]
  s_waitcnt lgkmcnt(12)
  v_mfma_f32_16x16x32_bf16 v[104:107], a[4:7], v[152:155], v[104:107]
  ds_read_b64_tr_b16 v[140:141], v5 offset:8192
  ds_read_b64_tr_b16 v[142:143], v5 offset:8704
  v_mfma_f32_16x16x32_bf16 v[100:103], a[0:3], v[152:155], v[100:103]
  s_waitcnt lgkmcnt(12)
  v_mfma_f32_16x16x32_bf16 v[76:79], a[8:11], v[156:159], v[76:79]
  ds_read_b64_tr_b16 v[144:145], v6 offset:8192
  ds_read_b64_tr_b16 v[146:147], v6 offset:8704
  v_mfma_f32_16x16x32_bf16 v[80:83], a[12:15], v[156:159], v[80:83]
  s_mov_b32 exec_lo, 0x0
  s_mov_b32 exec_hi, 0xffff0000
  buffer_load_dword v183, v182, s[8:11], 0 offen
  s_mov_b64 exec, -1
  s_waitcnt lgkmcnt(12)
  v_mfma_f32_16x16x32_bf16 v[88:91], a[12:15], v[160:163], v[88:91]
  ds_read_b64_tr_b16 v[148:149], v2 offset:8192
  ds_read_b64_tr_b16 v[150:151], v2 offset:8704
  v_mfma_f32_16x16x32_bf16 v[84:87], a[8:11], v[160:163], v[84:87]
  s_waitcnt vmcnt(8)
  v_readfirstlane_b32 s100, v184
  v_readfirstlane_b32 s101, v185
  s_getreg_b32 s62, hwreg(HW_REG_XCC_ID, 0, 4)
  s_mul_i32 s63, s62, 6
  s_lshr_b64 s[100:101], s[100:101], s63
  s_and_b32 s100, s100, 63
  s_cmp_eq_u32 s100, 32
  s_cselect_b32 s43, 1, 0
  s_cmp_gt_u32 s62, 7
  s_cselect_b32 s43, 0, s43
  s_waitcnt lgkmcnt(10)
  v_mfma_f32_16x16x32_bf16 v[92:95], a[8:11], v[164:167], v[92:95]
  ds_read_b64_tr_b16 v[152:153], v3 offset:8192
  ds_read_b64_tr_b16 v[154:155], v3 offset:8704
  v_mfma_f32_16x16x32_bf16 v[96:99], a[12:15], v[164:167], v[96:99]
  s_waitcnt lgkmcnt(8)
  v_mfma_f32_16x16x32_bf16 v[104:107], a[12:15], v[168:171], v[104:107]
  ds_read_b64_tr_b16 v[156:157], v5 offset:12288
  ds_read_b64_tr_b16 v[158:159], v5 offset:12800
  v_mfma_f32_16x16x32_bf16 v[100:103], a[8:11], v[168:171], v[100:103]
  s_barrier
  s_waitcnt lgkmcnt(8)
  v_mfma_f32_16x16x32_bf16 v[76:79], a[16:19], v[140:143], v[76:79]
  ds_read_b64_tr_b16 v[160:161], v6 offset:12288
  ds_read_b64_tr_b16 v[162:163], v6 offset:12800
  v_mfma_f32_16x16x32_bf16 v[80:83], a[20:23], v[140:143], v[80:83]
  ds_read_b128 a[48:51], v188 offset:4096
  ds_read_b128 a[52:55], v188 offset:6144
  s_waitcnt lgkmcnt(10)
  v_mfma_f32_16x16x32_bf16 v[88:91], a[20:23], v[144:147], v[88:91]
  ds_read_b64_tr_b16 v[164:165], v2 offset:12288
  ds_read_b64_tr_b16 v[166:167], v2 offset:12800
  v_mfma_f32_16x16x32_bf16 v[84:87], a[16:19], v[144:147], v[84:87]
  ds_read_b128 a[56:59], v189 offset:4096
  ds_read_b128 a[60:63], v189 offset:6144
  s_waitcnt lgkmcnt(12)
  v_mfma_f32_16x16x32_bf16 v[92:95], a[16:19], v[148:151], v[92:95]
  ds_read_b64_tr_b16 v[168:169], v3 offset:12288
  ds_read_b64_tr_b16 v[170:171], v3 offset:12800
  v_mfma_f32_16x16x32_bf16 v[96:99], a[20:23], v[148:151], v[96:99]
  s_waitcnt lgkmcnt(12)
  v_mfma_f32_16x16x32_bf16 v[104:107], a[20:23], v[152:155], v[104:107]
  ds_read_b64_tr_b16 v[140:141], v5 offset:16384
  ds_read_b64_tr_b16 v[142:143], v5 offset:16896
  v_mfma_f32_16x16x32_bf16 v[100:103], a[16:19], v[152:155], v[100:103]
  s_add_u32 s40, s73, 3
  s_and_b32 s40, s40, 3
  s_lshl_b32 s40, s40, 20
  s_add_u32 s40, s40, s34
  s_add_u32 s40, s40, 384
  s_add_u32 m0, s32, 49152
  s_add_u32 s41, s40, 65536
  buffer_load_dwordx4 v7, s[16:19], s40 offen lds
  s_add_u32 m0, s32, 50176
  s_nop 0
  buffer_load_dwordx4 v0, s[16:19], s41 offen lds
  s_waitcnt lgkmcnt(12)
  v_mfma_f32_16x16x32_bf16 v[76:79], a[24:27], v[156:159], v[76:79]
  ds_read_b64_tr_b16 v[144:145], v6 offset:16384
  ds_read_b64_tr_b16 v[146:147], v6 offset:16896
  v_mfma_f32_16x16x32_bf16 v[80:83], a[28:31], v[156:159], v[80:83]
  s_waitcnt lgkmcnt(12)
  v_mfma_f32_16x16x32_bf16 v[88:91], a[28:31], v[160:163], v[88:91]
  ds_read_b64_tr_b16 v[148:149], v2 offset:16384
  ds_read_b64_tr_b16 v[150:151], v2 offset:16896
  v_mfma_f32_16x16x32_bf16 v[84:87], a[24:27], v[160:163], v[84:87]
  s_waitcnt lgkmcnt(10)
  v_mfma_f32_16x16x32_bf16 v[92:95], a[24:27], v[164:167], v[92:95]
  ds_read_b64_tr_b16 v[152:153], v3 offset:16384
  ds_read_b64_tr_b16 v[154:155], v3 offset:16896
  v_mfma_f32_16x16x32_bf16 v[96:99], a[28:31], v[164:167], v[96:99]
  s_waitcnt lgkmcnt(8)
  v_mfma_f32_16x16x32_bf16 v[104:107], a[28:31], v[168:171], v[104:107]
  ds_read_b64_tr_b16 v[156:157], v5 offset:20480
  ds_read_b64_tr_b16 v[158:159], v5 offset:20992
  v_mfma_f32_16x16x32_bf16 v[100:103], a[24:27], v[168:171], v[100:103]
  s_waitcnt lgkmcnt(8)
  v_mfma_f32_16x16x32_bf16 v[108:111], a[0:3], v[140:143], v[108:111]
  ds_read_b64_tr_b16 v[160:161], v6 offset:20480
  ds_read_b64_tr_b16 v[162:163], v6 offset:20992
  v_mfma_f32_16x16x32_bf16 v[112:115], a[4:7], v[140:143], v[112:115]
  s_waitcnt lgkmcnt(8)
  v_mfma_f32_16x16x32_bf16 v[120:123], a[4:7], v[144:147], v[120:123]
  ds_read_b64_tr_b16 v[164:165], v2 offset:20480
  ds_read_b64_tr_b16 v[166:167], v2 offset:20992
  v_mfma_f32_16x16x32_bf16 v[116:119], a[0:3], v[144:147], v[116:119]
  s_waitcnt lgkmcnt(8)
  v_mfma_f32_16x16x32_bf16 v[124:127], a[0:3], v[148:151], v[124:127]
  ds_read_b64_tr_b16 v[168:169], v3 offset:20480
  ds_read_b64_tr_b16 v[170:171], v3 offset:20992
  v_mfma_f32_16x16x32_bf16 v[128:131], a[4:7], v[148:151], v[128:131]
  s_waitcnt lgkmcnt(8)
  v_mfma_f32_16x16x32_bf16 v[136:139], a[4:7], v[152:155], v[136:139]
  ds_read_b64_tr_b16 v[140:141], v5 offset:24576
  ds_read_b64_tr_b16 v[142:143], v5 offset:25088
  v_mfma_f32_16x16x32_bf16 v[132:135], a[0:3], v[152:155], v[132:135]
  s_waitcnt lgkmcnt(8)
  v_mfma_f32_16x16x32_bf16 v[108:111], a[8:11], v[156:159], v[108:111]
  ds_read_b64_tr_b16 v[144:145], v6 offset:24576
  ds_read_b64_tr_b16 v[146:147], v6 offset:25088
  v_mfma_f32_16x16x32_bf16 v[112:115], a[12:15], v[156:159], v[112:115]
  s_waitcnt lgkmcnt(8)
  v_mfma_f32_16x16x32_bf16 v[120:123], a[12:15], v[160:163], v[120:123]
  ds_read_b64_tr_b16 v[148:149], v2 offset:24576
  ds_read_b64_tr_b16 v[150:151], v2 offset:25088
  v_mfma_f32_16x16x32_bf16 v[116:119], a[8:11], v[160:163], v[116:119]
  s_waitcnt lgkmcnt(8)
  v_mfma_f32_16x16x32_bf16 v[124:127], a[8:11], v[164:167], v[124:127]
  ds_read_b64_tr_b16 v[152:153], v3 offset:24576
  ds_read_b64_tr_b16 v[154:155], v3 offset:25088
  v_mfma_f32_16x16x32_bf16 v[128:131], a[12:15], v[164:167], v[128:131]
  s_waitcnt lgkmcnt(8)
  v_mfma_f32_16x16x32_bf16 v[136:139], a[12:15], v[168:171], v[136:139]
  ds_read_b64_tr_b16 v[156:157], v5 offset:28672
  ds_read_b64_tr_b16 v[158:159], v5 offset:29184
  v_mfma_f32_16x16x32_bf16 v[132:135], a[8:11], v[168:171], v[132:135]
  s_barrier
  s_waitcnt lgkmcnt(8)
  v_mfma_f32_16x16x32_bf16 v[108:111], a[16:19], v[140:143], v[108:111]
  ds_read_b64_tr_b16 v[160:161], v6 offset:28672
  ds_read_b64_tr_b16 v[162:163], v6 offset:29184
  v_mfma_f32_16x16x32_bf16 v[112:115], a[20:23], v[140:143], v[112:115]
  s_waitcnt lgkmcnt(8)
  v_mfma_f32_16x16x32_bf16 v[120:123], a[20:23], v[144:147], v[120:123]
  ds_read_b64_tr_b16 v[164:165], v2 offset:28672
  ds_read_b64_tr_b16 v[166:167], v2 offset:29184
  v_mfma_f32_16x16x32_bf16 v[116:119], a[16:19], v[144:147], v[116:119]
  s_waitcnt lgkmcnt(8)
  v_mfma_f32_16x16x32_bf16 v[124:127], a[16:19], v[148:151], v[124:127]
  ds_read_b64_tr_b16 v[168:169], v3 offset:28672
  ds_read_b64_tr_b16 v[170:171], v3 offset:29184
  v_mfma_f32_16x16x32_bf16 v[128:131], a[20:23], v[148:151], v[128:131]
  s_waitcnt lgkmcnt(8)
  v_mfma_f32_16x16x32_bf16 v[136:139], a[20:23], v[152:155], v[136:139]
  v_xor_b32 v5, 0x10000, v5
  ds_read_b64_tr_b16 v[140:141], v5 offset:0
  ds_read_b64_tr_b16 v[142:143], v5 offset:512
  v_mfma_f32_16x16x32_bf16 v[132:135], a[16:19], v[152:155], v[132:135]
  s_add_u32 s40, s33, 0x0
  s_add_u32 m0, s32, 65536
  s_add_u32 s41, s40, 65536
  buffer_load_dwordx4 v7, s[24:27], s40 offen lds
  s_add_u32 m0, s32, 66560
  s_nop 0
  buffer_load_dwordx4 v0, s[24:27], s41 offen lds
  s_waitcnt lgkmcnt(8)
  v_mfma_f32_16x16x32_bf16 v[108:111], a[24:27], v[156:159], v[108:111]
  v_xor_b32 v6, 0x10000, v6
  ds_read_b64_tr_b16 v[144:145], v6 offset:0
  ds_read_b64_tr_b16 v[146:147], v6 offset:512
  v_mfma_f32_16x16x32_bf16 v[112:115], a[28:31], v[156:159], v[112:115]
  s_waitcnt lgkmcnt(8)
  v_mfma_f32_16x16x32_bf16 v[120:123], a[28:31], v[160:163], v[120:123]
  v_xor_b32 v2, 0x10000, v2
  ds_read_b64_tr_b16 v[148:149], v2 offset:0
  ds_read_b64_tr_b16 v[150:151], v2 offset:512
  v_mfma_f32_16x16x32_bf16 v[116:119], a[24:27], v[160:163], v[116:119]
  s_waitcnt lgkmcnt(8)
  v_mfma_f32_16x16x32_bf16 v[124:127], a[24:27], v[164:167], v[124:127]
  v_xor_b32 v3, 0x10000, v3
  ds_read_b64_tr_b16 v[152:153], v3 offset:0
  ds_read_b64_tr_b16 v[154:155], v3 offset:512
  v_mfma_f32_16x16x32_bf16 v[128:131], a[28:31], v[164:167], v[128:131]
  s_waitcnt lgkmcnt(8)
  v_mfma_f32_16x16x32_bf16 v[136:139], a[28:31], v[168:171], v[136:139]
  ds_read_b64_tr_b16 v[156:157], v5 offset:4096
  ds_read_b64_tr_b16 v[158:159], v5 offset:4608
  v_mfma_f32_16x16x32_bf16 v[132:135], a[24:27], v[168:171], v[132:135]
  s_waitcnt lgkmcnt(8)
  v_mfma_f32_16x16x32_bf16 v[12:15], a[32:35], v[140:143], v[12:15]
  ds_read_b64_tr_b16 v[160:161], v6 offset:4096
  ds_read_b64_tr_b16 v[162:163], v6 offset:4608
  v_mfma_f32_16x16x32_bf16 v[16:19], a[36:39], v[140:143], v[16:19]
  buffer_load_dwordx4 a[0:3], v11, s[8:11], s48 offen offset:0 sc1
  s_waitcnt lgkmcnt(8)
  v_mfma_f32_16x16x32_bf16 v[24:27], a[36:39], v[144:147], v[24:27]
  ds_read_b64_tr_b16 v[164:165], v2 offset:4096
  ds_read_b64_tr_b16 v[166:167], v2 offset:4608
  v_mfma_f32_16x16x32_bf16 v[20:23], a[32:35], v[144:147], v[20:23]
  s_waitcnt lgkmcnt(8)
  v_mfma_f32_16x16x32_bf16 v[28:31], a[32:35], v[148:151], v[28:31]
  ds_read_b64_tr_b16 v[168:169], v3 offset:4096
  ds_read_b64_tr_b16 v[170:171], v3 offset:4608
  v_mfma_f32_16x16x32_bf16 v[32:35], a[36:39], v[148:151], v[32:35]
  v_lshrrev_b32 v9, 5, v1
  v_and_b32 v10, 31, v1
  v_lshlrev_b32 v189, 4, v10
  s_waitcnt lgkmcnt(8)
  v_mfma_f32_16x16x32_bf16 v[40:43], a[36:39], v[152:155], v[40:43]
  ds_read_b64_tr_b16 v[140:141], v5 offset:8192
  ds_read_b64_tr_b16 v[142:143], v5 offset:8704
  v_mfma_f32_16x16x32_bf16 v[36:39], a[32:35], v[152:155], v[36:39]
  buffer_load_dwordx4 a[4:7], v11, s[8:11], s48 offen offset:1024 sc1
  v_lshl_add_u32 v189, v9, 10, v189
  v_lshlrev_b32 v9, 3, v9
  v_bfe_u32 v10, v1, 2, 2
  s_waitcnt lgkmcnt(8)
  v_mfma_f32_16x16x32_bf16 v[12:15], a[40:43], v[156:159], v[12:15]
  ds_read_b64_tr_b16 v[144:145], v6 offset:8192
  ds_read_b64_tr_b16 v[146:147], v6 offset:8704
  v_mfma_f32_16x16x32_bf16 v[16:19], a[44:47], v[156:159], v[16:19]
  v_add_u32 v9, v9, v10
  v_lshlrev_b32 v188, 9, v9
  v_bfe_u32 v9, v1, 4, 1
  s_waitcnt lgkmcnt(8)
  v_mfma_f32_16x16x32_bf16 v[24:27], a[44:47], v[160:163], v[24:27]
  ds_read_b64_tr_b16 v[148:149], v2 offset:8192
  ds_read_b64_tr_b16 v[150:151], v2 offset:8704
  v_mfma_f32_16x16x32_bf16 v[20:23], a[40:43], v[160:163], v[20:23]
  v_lshl_add_u32 v188, v9, 5, v188
  v_and_b32 v9, 3, v1
  v_lshl_add_u32 v188, v9, 3, v188
  s_waitcnt lgkmcnt(8)
  v_mfma_f32_16x16x32_bf16 v[28:31], a[40:43], v[164:167], v[28:31]
  ds_read_b64_tr_b16 v[152:153], v3 offset:8192
  ds_read_b64_tr_b16 v[154:155], v3 offset:8704
  v_mfma_f32_16x16x32_bf16 v[32:35], a[44:47], v[164:167], v[32:35]
  s_lshl_b32 s62, s93, 6
  s_add_u32 s62, s62, 98304
  v_add_u32 v188, s62, v188
  s_waitcnt lgkmcnt(8)
  v_mfma_f32_16x16x32_bf16 v[40:43], a[44:47], v[168:171], v[40:43]
  ds_read_b64_tr_b16 v[156:157], v5 offset:12288
  ds_read_b64_tr_b16 v[158:159], v5 offset:12800
  v_mfma_f32_16x16x32_bf16 v[36:39], a[40:43], v[168:171], v[36:39]
  s_waitcnt vmcnt(11)
  s_barrier
  s_waitcnt lgkmcnt(8)
  v_mfma_f32_16x16x32_bf16 v[12:15], a[48:51], v[140:143], v[12:15]
  ds_read_b64_tr_b16 v[160:161], v6 offset:12288
  ds_read_b64_tr_b16 v[162:163], v6 offset:12800
  v_mfma_f32_16x16x32_bf16 v[16:19], a[52:55], v[140:143], v[16:19]
  s_waitcnt lgkmcnt(8)
  v_mfma_f32_16x16x32_bf16 v[24:27], a[52:55], v[144:147], v[24:27]
  ds_read_b64_tr_b16 v[164:165], v2 offset:12288
  ds_read_b64_tr_b16 v[166:167], v2 offset:12800
  v_mfma_f32_16x16x32_bf16 v[20:23], a[48:51], v[144:147], v[20:23]
  buffer_load_dwordx4 a[8:11], v11, s[8:11], s48 offen offset:2048 sc1
  s_waitcnt lgkmcnt(8)
  v_mfma_f32_16x16x32_bf16 v[28:31], a[48:51], v[148:151], v[28:31]
  ds_read_b64_tr_b16 v[168:169], v3 offset:12288
  ds_read_b64_tr_b16 v[170:171], v3 offset:12800
  v_mfma_f32_16x16x32_bf16 v[32:35], a[52:55], v[148:151], v[32:35]
  s_waitcnt lgkmcnt(8)
  v_mfma_f32_16x16x32_bf16 v[40:43], a[52:55], v[152:155], v[40:43]
  ds_read_b64_tr_b16 v[140:141], v5 offset:16384
  ds_read_b64_tr_b16 v[142:143], v5 offset:16896
  v_mfma_f32_16x16x32_bf16 v[36:39], a[48:51], v[152:155], v[36:39]
  s_add_u32 s40, s33, 0x80
  s_add_u32 m0, s32, 81920
  s_add_u32 s41, s40, 65536
  buffer_load_dwordx4 v7, s[24:27], s40 offen lds
  s_add_u32 m0, s32, 82944
  s_nop 0
  buffer_load_dwordx4 v0, s[24:27], s41 offen lds
  s_waitcnt lgkmcnt(8)
  v_mfma_f32_16x16x32_bf16 v[12:15], a[56:59], v[156:159], v[12:15]
  ds_read_b64_tr_b16 v[144:145], v6 offset:16384
  ds_read_b64_tr_b16 v[146:147], v6 offset:16896
  v_mfma_f32_16x16x32_bf16 v[16:19], a[60:63], v[156:159], v[16:19]
  buffer_load_dwordx4 a[12:15], v11, s[8:11], s48 offen offset:3072 sc1
  s_waitcnt lgkmcnt(8)
  v_mfma_f32_16x16x32_bf16 v[24:27], a[60:63], v[160:163], v[24:27]
  ds_read_b64_tr_b16 v[148:149], v2 offset:16384
  ds_read_b64_tr_b16 v[150:151], v2 offset:16896
  v_mfma_f32_16x16x32_bf16 v[20:23], a[56:59], v[160:163], v[20:23]
  s_waitcnt lgkmcnt(8)
  v_mfma_f32_16x16x32_bf16 v[28:31], a[56:59], v[164:167], v[28:31]
  ds_read_b64_tr_b16 v[152:153], v3 offset:16384
  ds_read_b64_tr_b16 v[154:155], v3 offset:16896
  v_mfma_f32_16x16x32_bf16 v[32:35], a[60:63], v[164:167], v[32:35]
  s_waitcnt lgkmcnt(8)
  v_mfma_f32_16x16x32_bf16 v[40:43], a[60:63], v[168:171], v[40:43]
  ds_read_b64_tr_b16 v[156:157], v5 offset:20480
  ds_read_b64_tr_b16 v[158:159], v5 offset:20992
  v_mfma_f32_16x16x32_bf16 v[36:39], a[56:59], v[168:171], v[36:39]
  s_waitcnt lgkmcnt(8)
  v_mfma_f32_16x16x32_bf16 v[44:47], a[32:35], v[140:143], v[44:47]
  ds_read_b64_tr_b16 v[160:161], v6 offset:20480
  ds_read_b64_tr_b16 v[162:163], v6 offset:20992
  v_mfma_f32_16x16x32_bf16 v[48:51], a[36:39], v[140:143], v[48:51]
  buffer_load_dwordx4 a[16:19], v11, s[8:11], s49 offen offset:0 sc1
  s_waitcnt lgkmcnt(8)
  v_mfma_f32_16x16x32_bf16 v[56:59], a[36:39], v[144:147], v[56:59]
  ds_read_b64_tr_b16 v[164:165], v2 offset:20480
  ds_read_b64_tr_b16 v[166:167], v2 offset:20992
  v_mfma_f32_16x16x32_bf16 v[52:55], a[32:35], v[144:147], v[52:55]
  s_waitcnt lgkmcnt(8)
  v_mfma_f32_16x16x32_bf16 v[60:63], a[32:35], v[148:151], v[60:63]
  ds_read_b64_tr_b16 v[168:169], v3 offset:20480
  ds_read_b64_tr_b16 v[170:171], v3 offset:20992
  v_mfma_f32_16x16x32_bf16 v[64:67], a[36:39], v[148:151], v[64:67]
  v_cvt_pk_bf16_f32 v12, v12, v13
  v_cvt_pk_bf16_f32 v13, v14, v15
  v_cvt_pk_bf16_f32 v14, v16, v17
  v_cvt_pk_bf16_f32 v15, v18, v19
  s_waitcnt lgkmcnt(8)
  v_mfma_f32_16x16x32_bf16 v[72:75], a[36:39], v[152:155], v[72:75]
  ds_read_b64_tr_b16 v[140:141], v5 offset:24576
  ds_read_b64_tr_b16 v[142:143], v5 offset:25088
  v_mfma_f32_16x16x32_bf16 v[68:71], a[32:35], v[152:155], v[68:71]
  buffer_load_dwordx4 a[20:23], v11, s[8:11], s49 offen offset:1024 sc1
  v_cvt_pk_bf16_f32 v16, v20, v21
  v_cvt_pk_bf16_f32 v17, v22, v23
  v_cvt_pk_bf16_f32 v18, v24, v25
  v_cvt_pk_bf16_f32 v19, v26, v27
  s_waitcnt lgkmcnt(8)
  v_mfma_f32_16x16x32_bf16 v[44:47], a[40:43], v[156:159], v[44:47]
  ds_read_b64_tr_b16 v[144:145], v6 offset:24576
  ds_read_b64_tr_b16 v[146:147], v6 offset:25088
  v_mfma_f32_16x16x32_bf16 v[48:51], a[44:47], v[156:159], v[48:51]
  v_cvt_pk_bf16_f32 v20, v28, v29
  v_cvt_pk_bf16_f32 v21, v30, v31
  v_cvt_pk_bf16_f32 v22, v32, v33
  v_cvt_pk_bf16_f32 v23, v34, v35
  s_waitcnt lgkmcnt(8)
  v_mfma_f32_16x16x32_bf16 v[56:59], a[44:47], v[160:163], v[56:59]
  ds_read_b64_tr_b16 v[148:149], v2 offset:24576
  ds_read_b64_tr_b16 v[150:151], v2 offset:25088
  v_mfma_f32_16x16x32_bf16 v[52:55], a[40:43], v[160:163], v[52:55]
  v_cvt_pk_bf16_f32 v24, v36, v37
  v_cvt_pk_bf16_f32 v25, v38, v39
  v_cvt_pk_bf16_f32 v26, v40, v41
  v_cvt_pk_bf16_f32 v27, v42, v43
  s_waitcnt lgkmcnt(8)
  v_mfma_f32_16x16x32_bf16 v[60:63], a[40:43], v[164:167], v[60:63]
  ds_read_b64_tr_b16 v[152:153], v3 offset:24576
  ds_read_b64_tr_b16 v[154:155], v3 offset:25088
  v_mfma_f32_16x16x32_bf16 v[64:67], a[44:47], v[164:167], v[64:67]
  s_add_u32 s40, s36, 0x0
  buffer_store_dwordx4 v[12:15], v11, s[12:15], s40 offen offset:0 sc1
  s_waitcnt lgkmcnt(8)
  v_mfma_f32_16x16x32_bf16 v[72:75], a[44:47], v[168:171], v[72:75]
  ds_read_b64_tr_b16 v[156:157], v5 offset:28672
  ds_read_b64_tr_b16 v[158:159], v5 offset:29184
  v_mfma_f32_16x16x32_bf16 v[68:71], a[40:43], v[168:171], v[68:71]
  s_waitcnt vmcnt(14)
  s_barrier
  s_waitcnt lgkmcnt(8)
  v_mfma_f32_16x16x32_bf16 v[44:47], a[48:51], v[140:143], v[44:47]
  ds_read_b64_tr_b16 v[160:161], v6 offset:28672
  ds_read_b64_tr_b16 v[162:163], v6 offset:29184
  v_mfma_f32_16x16x32_bf16 v[48:51], a[52:55], v[140:143], v[48:51]
  s_waitcnt lgkmcnt(8)
  v_mfma_f32_16x16x32_bf16 v[56:59], a[52:55], v[144:147], v[56:59]
  ds_read_b64_tr_b16 v[164:165], v2 offset:28672
  ds_read_b64_tr_b16 v[166:167], v2 offset:29184
  v_mfma_f32_16x16x32_bf16 v[52:55], a[48:51], v[144:147], v[52:55]
  buffer_load_dwordx4 a[24:27], v11, s[8:11], s49 offen offset:2048 sc1
  s_waitcnt lgkmcnt(8)
  v_mfma_f32_16x16x32_bf16 v[60:63], a[48:51], v[148:151], v[60:63]
  ds_read_b64_tr_b16 v[168:169], v3 offset:28672
  ds_read_b64_tr_b16 v[170:171], v3 offset:29184
  v_mfma_f32_16x16x32_bf16 v[64:67], a[52:55], v[148:151], v[64:67]
  s_waitcnt lgkmcnt(8)
  v_mfma_f32_16x16x32_bf16 v[72:75], a[52:55], v[152:155], v[72:75]
  ds_read_b64_tr_b16 v[140:141], v5 offset:32768
  ds_read_b64_tr_b16 v[142:143], v5 offset:33280
  v_mfma_f32_16x16x32_bf16 v[68:71], a[48:51], v[152:155], v[68:71]
  s_add_u32 s40, s35, 0x0
  s_add_u32 m0, s32, 0
  s_add_u32 s41, s40, 22016
  buffer_load_dwordx4 v8, s[20:23], s40 offen lds
  s_add_u32 m0, s32, 1024
  s_nop 0
  buffer_load_dwordx4 v4, s[20:23], s41 offen lds
  s_waitcnt lgkmcnt(8)
  v_mfma_f32_16x16x32_bf16 v[44:47], a[56:59], v[156:159], v[44:47]
  ds_read_b64_tr_b16 v[144:145], v6 offset:32768
  ds_read_b64_tr_b16 v[146:147], v6 offset:33280
  v_mfma_f32_16x16x32_bf16 v[48:51], a[60:63], v[156:159], v[48:51]
  buffer_load_dwordx4 a[28:31], v11, s[8:11], s49 offen offset:3072 sc1
  s_waitcnt lgkmcnt(8)
  v_mfma_f32_16x16x32_bf16 v[56:59], a[60:63], v[160:163], v[56:59]
  ds_read_b64_tr_b16 v[148:149], v2 offset:32768
  ds_read_b64_tr_b16 v[150:151], v2 offset:33280
  v_mfma_f32_16x16x32_bf16 v[52:55], a[56:59], v[160:163], v[52:55]
  s_add_u32 s40, s36, 0x0
  buffer_store_dwordx4 v[16:19], v11, s[12:15], s40 offen offset:1024 sc1
  s_waitcnt lgkmcnt(8)
  v_mfma_f32_16x16x32_bf16 v[60:63], a[56:59], v[164:167], v[60:63]
  ds_read_b64_tr_b16 v[152:153], v3 offset:32768
  ds_read_b64_tr_b16 v[154:155], v3 offset:33280
  v_mfma_f32_16x16x32_bf16 v[64:67], a[60:63], v[164:167], v[64:67]
  s_waitcnt lgkmcnt(8)
  v_mfma_f32_16x16x32_bf16 v[72:75], a[60:63], v[168:171], v[72:75]
  ds_read_b64_tr_b16 v[156:157], v5 offset:36864
  ds_read_b64_tr_b16 v[158:159], v5 offset:37376
  v_mfma_f32_16x16x32_bf16 v[68:71], a[56:59], v[168:171], v[68:71]
  s_waitcnt lgkmcnt(8)
  v_mfma_f32_16x16x32_bf16 v[76:79], a[32:35], v[140:143], v[76:79]
  ds_read_b64_tr_b16 v[160:161], v6 offset:36864
  ds_read_b64_tr_b16 v[162:163], v6 offset:37376
  v_mfma_f32_16x16x32_bf16 v[80:83], a[36:39], v[140:143], v[80:83]
  s_waitcnt lgkmcnt(8)
  v_mfma_f32_16x16x32_bf16 v[88:91], a[36:39], v[144:147], v[88:91]
  ds_read_b64_tr_b16 v[164:165], v2 offset:36864
  ds_read_b64_tr_b16 v[166:167], v2 offset:37376
  v_mfma_f32_16x16x32_bf16 v[84:87], a[32:35], v[144:147], v[84:87]
  s_waitcnt vmcnt(16)
  s_waitcnt lgkmcnt(8)
  v_mfma_f32_16x16x32_bf16 v[92:95], a[32:35], v[148:151], v[92:95]
  ds_read_b64_tr_b16 v[168:169], v3 offset:36864
  ds_read_b64_tr_b16 v[170:171], v3 offset:37376
  v_mfma_f32_16x16x32_bf16 v[96:99], a[36:39], v[148:151], v[96:99]
  v_cvt_pk_bf16_f32 v44, v44, v45
  v_cvt_pk_bf16_f32 v45, v46, v47
  v_cvt_pk_bf16_f32 v46, v48, v49
  v_cvt_pk_bf16_f32 v47, v50, v51
  s_waitcnt lgkmcnt(8)
  v_mfma_f32_16x16x32_bf16 v[104:107], a[36:39], v[152:155], v[104:107]
  ds_read_b64_tr_b16 v[140:141], v5 offset:40960
  ds_read_b64_tr_b16 v[142:143], v5 offset:41472
  v_mfma_f32_16x16x32_bf16 v[100:103], a[32:35], v[152:155], v[100:103]
  v_cvt_pk_bf16_f32 v48, v52, v53
  v_cvt_pk_bf16_f32 v49, v54, v55
  v_cvt_pk_bf16_f32 v50, v56, v57
  v_cvt_pk_bf16_f32 v51, v58, v59
  s_waitcnt lgkmcnt(8)
  v_mfma_f32_16x16x32_bf16 v[76:79], a[40:43], v[156:159], v[76:79]
  ds_read_b64_tr_b16 v[144:145], v6 offset:40960
  ds_read_b64_tr_b16 v[146:147], v6 offset:41472
  v_mfma_f32_16x16x32_bf16 v[80:83], a[44:47], v[156:159], v[80:83]
  v_cvt_pk_bf16_f32 v52, v60, v61
  v_cvt_pk_bf16_f32 v53, v62, v63
  v_cvt_pk_bf16_f32 v54, v64, v65
  v_cvt_pk_bf16_f32 v55, v66, v67
  s_waitcnt lgkmcnt(8)
  v_mfma_f32_16x16x32_bf16 v[88:91], a[44:47], v[160:163], v[88:91]
  ds_read_b64_tr_b16 v[148:149], v2 offset:40960
  ds_read_b64_tr_b16 v[150:151], v2 offset:41472
  v_mfma_f32_16x16x32_bf16 v[84:87], a[40:43], v[160:163], v[84:87]
  v_cvt_pk_bf16_f32 v56, v68, v69
  v_cvt_pk_bf16_f32 v57, v70, v71
  v_cvt_pk_bf16_f32 v58, v72, v73
  v_cvt_pk_bf16_f32 v59, v74, v75
  s_waitcnt lgkmcnt(8)
  v_mfma_f32_16x16x32_bf16 v[92:95], a[40:43], v[164:167], v[92:95]
  ds_read_b64_tr_b16 v[152:153], v3 offset:40960
  ds_read_b64_tr_b16 v[154:155], v3 offset:41472
  v_mfma_f32_16x16x32_bf16 v[96:99], a[44:47], v[164:167], v[96:99]
  s_add_u32 s40, s36, 0x0
  buffer_store_dwordx4 v[20:23], v11, s[12:15], s40 offen offset:2048 sc1
  s_waitcnt lgkmcnt(8)
  v_mfma_f32_16x16x32_bf16 v[104:107], a[44:47], v[168:171], v[104:107]
  ds_read_b64_tr_b16 v[156:157], v5 offset:45056
  ds_read_b64_tr_b16 v[158:159], v5 offset:45568
  v_mfma_f32_16x16x32_bf16 v[100:103], a[40:43], v[168:171], v[100:103]
  s_waitcnt vmcnt(15)
  s_barrier
  s_waitcnt lgkmcnt(8)
  v_mfma_f32_16x16x32_bf16 v[76:79], a[48:51], v[140:143], v[76:79]
  ds_read_b64_tr_b16 v[160:161], v6 offset:45056
  ds_read_b64_tr_b16 v[162:163], v6 offset:45568
  v_mfma_f32_16x16x32_bf16 v[80:83], a[52:55], v[140:143], v[80:83]
  s_waitcnt lgkmcnt(8)
  v_mfma_f32_16x16x32_bf16 v[88:91], a[52:55], v[144:147], v[88:91]
  ds_read_b64_tr_b16 v[164:165], v2 offset:45056
  ds_read_b64_tr_b16 v[166:167], v2 offset:45568
  v_mfma_f32_16x16x32_bf16 v[84:87], a[48:51], v[144:147], v[84:87]
  s_waitcnt lgkmcnt(8)
  v_mfma_f32_16x16x32_bf16 v[92:95], a[48:51], v[148:151], v[92:95]
  ds_read_b64_tr_b16 v[168:169], v3 offset:45056
  ds_read_b64_tr_b16 v[170:171], v3 offset:45568
  v_mfma_f32_16x16x32_bf16 v[96:99], a[52:55], v[148:151], v[96:99]
  s_waitcnt lgkmcnt(8)
  v_mfma_f32_16x16x32_bf16 v[104:107], a[52:55], v[152:155], v[104:107]
  ds_read_b64_tr_b16 v[140:141], v5 offset:49152
  ds_read_b64_tr_b16 v[142:143], v5 offset:49664
  v_mfma_f32_16x16x32_bf16 v[100:103], a[48:51], v[152:155], v[100:103]
  s_add_u32 s40, s33, 0x100000
  s_add_u32 m0, s32, 16384
  s_add_u32 s41, s40, 65536
  buffer_load_dwordx4 v7, s[24:27], s40 offen lds
  s_add_u32 m0, s32, 17408
  s_nop 0
  buffer_load_dwordx4 v0, s[24:27], s41 offen lds
  s_waitcnt lgkmcnt(8)
  v_mfma_f32_16x16x32_bf16 v[76:79], a[56:59], v[156:159], v[76:79]
  ds_read_b64_tr_b16 v[144:145], v6 offset:49152
  ds_read_b64_tr_b16 v[146:147], v6 offset:49664
  v_mfma_f32_16x16x32_bf16 v[80:83], a[60:63], v[156:159], v[80:83]
  s_waitcnt lgkmcnt(8)
  v_mfma_f32_16x16x32_bf16 v[88:91], a[60:63], v[160:163], v[88:91]
  ds_read_b64_tr_b16 v[148:149], v2 offset:49152
  ds_read_b64_tr_b16 v[150:151], v2 offset:49664
  v_mfma_f32_16x16x32_bf16 v[84:87], a[56:59], v[160:163], v[84:87]
  s_add_u32 s40, s36, 0x0
  buffer_store_dwordx4 v[24:27], v11, s[12:15], s40 offen offset:3072 sc1
  s_waitcnt lgkmcnt(8)
  v_mfma_f32_16x16x32_bf16 v[92:95], a[56:59], v[164:167], v[92:95]
  ds_read_b64_tr_b16 v[152:153], v3 offset:49152
  ds_read_b64_tr_b16 v[154:155], v3 offset:49664
  v_mfma_f32_16x16x32_bf16 v[96:99], a[60:63], v[164:167], v[96:99]
  s_waitcnt lgkmcnt(8)
  v_mfma_f32_16x16x32_bf16 v[104:107], a[60:63], v[168:171], v[104:107]
  ds_read_b64_tr_b16 v[156:157], v5 offset:53248
  ds_read_b64_tr_b16 v[158:159], v5 offset:53760
  v_mfma_f32_16x16x32_bf16 v[100:103], a[56:59], v[168:171], v[100:103]
  s_waitcnt lgkmcnt(8)
  v_mfma_f32_16x16x32_bf16 v[108:111], a[32:35], v[140:143], v[108:111]
  ds_read_b64_tr_b16 v[160:161], v6 offset:53248
  ds_read_b64_tr_b16 v[162:163], v6 offset:53760
  v_mfma_f32_16x16x32_bf16 v[112:115], a[36:39], v[140:143], v[112:115]
  s_waitcnt lgkmcnt(8)
  v_mfma_f32_16x16x32_bf16 v[120:123], a[36:39], v[144:147], v[120:123]
  ds_read_b64_tr_b16 v[164:165], v2 offset:53248
  ds_read_b64_tr_b16 v[166:167], v2 offset:53760
  v_mfma_f32_16x16x32_bf16 v[116:119], a[32:35], v[144:147], v[116:119]
  s_waitcnt lgkmcnt(8)
  v_mfma_f32_16x16x32_bf16 v[124:127], a[32:35], v[148:151], v[124:127]
  ds_read_b64_tr_b16 v[168:169], v3 offset:53248
  ds_read_b64_tr_b16 v[170:171], v3 offset:53760
  v_mfma_f32_16x16x32_bf16 v[128:131], a[36:39], v[148:151], v[128:131]
  v_cvt_pk_bf16_f32 v76, v76, v77
  v_cvt_pk_bf16_f32 v77, v78, v79
  v_cvt_pk_bf16_f32 v78, v80, v81
  v_cvt_pk_bf16_f32 v79, v82, v83
  s_waitcnt lgkmcnt(8)
  v_mfma_f32_16x16x32_bf16 v[136:139], a[36:39], v[152:155], v[136:139]
  ds_read_b64_tr_b16 v[140:141], v5 offset:57344
  ds_read_b64_tr_b16 v[142:143], v5 offset:57856
  v_mfma_f32_16x16x32_bf16 v[132:135], a[32:35], v[152:155], v[132:135]
  v_cvt_pk_bf16_f32 v80, v84, v85
  v_cvt_pk_bf16_f32 v81, v86, v87
  v_cvt_pk_bf16_f32 v82, v88, v89
  v_cvt_pk_bf16_f32 v83, v90, v91
  s_waitcnt lgkmcnt(8)
  v_mfma_f32_16x16x32_bf16 v[108:111], a[40:43], v[156:159], v[108:111]
  ds_read_b64_tr_b16 v[144:145], v6 offset:57344
  ds_read_b64_tr_b16 v[146:147], v6 offset:57856
  v_mfma_f32_16x16x32_bf16 v[112:115], a[44:47], v[156:159], v[112:115]
  v_cvt_pk_bf16_f32 v84, v92, v93
  v_cvt_pk_bf16_f32 v85, v94, v95
  v_cvt_pk_bf16_f32 v86, v96, v97
  v_cvt_pk_bf16_f32 v87, v98, v99
  s_waitcnt lgkmcnt(8)
  v_mfma_f32_16x16x32_bf16 v[120:123], a[44:47], v[160:163], v[120:123]
  ds_read_b64_tr_b16 v[148:149], v2 offset:57344
  ds_read_b64_tr_b16 v[150:151], v2 offset:57856
  v_mfma_f32_16x16x32_bf16 v[116:119], a[40:43], v[160:163], v[116:119]
  v_cvt_pk_bf16_f32 v88, v100, v101
  v_cvt_pk_bf16_f32 v89, v102, v103
  v_cvt_pk_bf16_f32 v90, v104, v105
  v_cvt_pk_bf16_f32 v91, v106, v107
  s_waitcnt lgkmcnt(8)
  v_mfma_f32_16x16x32_bf16 v[124:127], a[40:43], v[164:167], v[124:127]
  ds_read_b64_tr_b16 v[152:153], v3 offset:57344
  ds_read_b64_tr_b16 v[154:155], v3 offset:57856
  v_mfma_f32_16x16x32_bf16 v[128:131], a[44:47], v[164:167], v[128:131]
  s_add_u32 s40, s36, 0x1000
  buffer_store_dwordx4 v[44:47], v11, s[12:15], s40 offen offset:0 sc1
  s_waitcnt lgkmcnt(8)
  v_mfma_f32_16x16x32_bf16 v[136:139], a[44:47], v[168:171], v[136:139]
  ds_read_b64_tr_b16 v[156:157], v5 offset:61440
  ds_read_b64_tr_b16 v[158:159], v5 offset:61952
  v_mfma_f32_16x16x32_bf16 v[132:135], a[40:43], v[168:171], v[132:135]
  s_waitcnt vmcnt(17)
  s_barrier
  s_waitcnt lgkmcnt(8)
  v_mfma_f32_16x16x32_bf16 v[108:111], a[48:51], v[140:143], v[108:111]
  ds_read_b64_tr_b16 v[160:161], v6 offset:61440
  ds_read_b64_tr_b16 v[162:163], v6 offset:61952
  v_mfma_f32_16x16x32_bf16 v[112:115], a[52:55], v[140:143], v[112:115]
  s_waitcnt lgkmcnt(8)
  v_mfma_f32_16x16x32_bf16 v[120:123], a[52:55], v[144:147], v[120:123]
  ds_read_b64_tr_b16 v[164:165], v2 offset:61440
  ds_read_b64_tr_b16 v[166:167], v2 offset:61952
  v_mfma_f32_16x16x32_bf16 v[116:119], a[48:51], v[144:147], v[116:119]
  s_waitcnt lgkmcnt(8)
  v_mfma_f32_16x16x32_bf16 v[124:127], a[48:51], v[148:151], v[124:127]
  ds_read_b64_tr_b16 v[168:169], v3 offset:61440
  ds_read_b64_tr_b16 v[170:171], v3 offset:61952
  v_mfma_f32_16x16x32_bf16 v[128:131], a[52:55], v[148:151], v[128:131]
  s_waitcnt lgkmcnt(8)
  v_mfma_f32_16x16x32_bf16 v[136:139], a[52:55], v[152:155], v[136:139]
  v_xor_b32 v5, 0x10000, v5
  ds_read_b64_tr_b16 v[140:141], v5 offset:0
  ds_read_b64_tr_b16 v[142:143], v5 offset:512
  v_mfma_f32_16x16x32_bf16 v[132:135], a[48:51], v[152:155], v[132:135]
  s_add_u32 s40, s33, 0x100080
  s_add_u32 m0, s32, 32768
  s_add_u32 s41, s40, 65536
  buffer_load_dwordx4 v7, s[24:27], s40 offen lds
  s_add_u32 m0, s32, 33792
  s_nop 0
  buffer_load_dwordx4 v0, s[24:27], s41 offen lds
  s_waitcnt lgkmcnt(8)
  v_mfma_f32_16x16x32_bf16 v[108:111], a[56:59], v[156:159], v[108:111]
  v_xor_b32 v6, 0x10000, v6
  ds_read_b64_tr_b16 v[144:145], v6 offset:0
  ds_read_b64_tr_b16 v[146:147], v6 offset:512
  v_mfma_f32_16x16x32_bf16 v[112:115], a[60:63], v[156:159], v[112:115]
  s_waitcnt lgkmcnt(8)
  v_mfma_f32_16x16x32_bf16 v[120:123], a[60:63], v[160:163], v[120:123]
  v_xor_b32 v2, 0x10000, v2
  ds_read_b64_tr_b16 v[148:149], v2 offset:0
  ds_read_b64_tr_b16 v[150:151], v2 offset:512
  v_mfma_f32_16x16x32_bf16 v[116:119], a[56:59], v[160:163], v[116:119]
  s_add_u32 s40, s36, 0x1000
  buffer_store_dwordx4 v[48:51], v11, s[12:15], s40 offen offset:1024 sc1
  s_waitcnt lgkmcnt(8)
  v_mfma_f32_16x16x32_bf16 v[124:127], a[56:59], v[164:167], v[124:127]
  v_xor_b32 v3, 0x10000, v3
  ds_read_b64_tr_b16 v[152:153], v3 offset:0
  ds_read_b64_tr_b16 v[154:155], v3 offset:512
  v_mfma_f32_16x16x32_bf16 v[128:131], a[60:63], v[164:167], v[128:131]
  s_waitcnt lgkmcnt(8)
  v_mfma_f32_16x16x32_bf16 v[136:139], a[60:63], v[168:171], v[136:139]
  ds_read_b64_tr_b16 v[156:157], v5 offset:4096
  ds_read_b64_tr_b16 v[158:159], v5 offset:4608
  v_mfma_f32_16x16x32_bf16 v[132:135], a[56:59], v[168:171], v[132:135]
L_kv_end:
  s_branch L_qh_H
L_attn_spin_1:
  s_mov_b32 s42, 0x40000
L_attn_spin_1_l:
  s_sleep 2
  buffer_load_dword v172, v173, s[28:31], 0 offen sc1
  s_waitcnt vmcnt(0)
  v_cmp_ne_u32 vcc, 16, v172
  s_cbranch_vccz L_attn_spun_2
  s_sub_u32 s42, s42, 1
  s_cbranch_scc0 L_attn_spin_1_l
  s_branch L_attn_spun_2
L_attn_spin_3:
  s_mov_b32 s42, 0x40000
L_attn_spin_3_l:
  s_sleep 2
  buffer_load_dword v172, v173, s[28:31], 0 offen sc1
  s_waitcnt vmcnt(0)
  v_cmp_ne_u32 vcc, 16, v172
  s_cbranch_vccz L_attn_spun_4
  s_sub_u32 s42, s42, 1
  s_cbranch_scc0 L_attn_spin_3_l
  s_branch L_attn_spun_4
L_qh_H:
  s_waitcnt vmcnt(9)
  s_waitcnt lgkmcnt(8)
  v_mfma_f32_16x16x32_bf16 v[28:31], v[140:143], a[0:3], 0
  ds_read_b64_tr_b16 v[160:161], v6 offset:4096
  ds_read_b64_tr_b16 v[162:163], v6 offset:4608
  v_mfma_f32_16x16x32_bf16 v[36:39], v[140:143], a[4:7], 0
  buffer_load_dwordx4 a[32:35], v11, s[8:11], s50 offen offset:0 sc1
  s_waitcnt lgkmcnt(8)
  v_mfma_f32_16x16x32_bf16 v[40:43], v[144:147], a[4:7], 0
  ds_read_b64_tr_b16 v[164:165], v2 offset:4096
  ds_read_b64_tr_b16 v[166:167], v2 offset:4608
  v_mfma_f32_16x16x32_bf16 v[32:35], v[144:147], a[0:3], 0
  buffer_load_dwordx4 a[36:39], v11, s[8:11], s50 offen offset:1024 sc1
  s_waitcnt lgkmcnt(8)
  v_mfma_f32_16x16x32_bf16 v[60:63], v[148:151], a[0:3], 0
  ds_read_b64_tr_b16 v[168:169], v3 offset:4096
  ds_read_b64_tr_b16 v[170:171], v3 offset:4608
  v_mfma_f32_16x16x32_bf16 v[68:71], v[148:151], a[4:7], 0
  v_cvt_pk_bf16_f32 v108, v108, v109
  v_cvt_pk_bf16_f32 v109, v110, v111
  v_cvt_pk_bf16_f32 v110, v112, v113
  v_cvt_pk_bf16_f32 v111, v114, v115
  s_waitcnt lgkmcnt(8)
  v_mfma_f32_16x16x32_bf16 v[72:75], v[152:155], a[4:7], 0
  ds_read_b64_tr_b16 v[140:141], v5 offset:8192
  ds_read_b64_tr_b16 v[142:143], v5 offset:8704
  v_mfma_f32_16x16x32_bf16 v[64:67], v[152:155], a[0:3], 0
  buffer_load_dwordx4 a[40:43], v11, s[8:11], s50 offen offset:2048 sc1
  v_cvt_pk_bf16_f32 v112, v116, v117
  v_cvt_pk_bf16_f32 v113, v118, v119
  v_cvt_pk_bf16_f32 v114, v120, v121
  v_cvt_pk_bf16_f32 v115, v122, v123
  s_waitcnt lgkmcnt(8)
  v_mfma_f32_16x16x32_bf16 v[28:31], v[156:159], a[8:11], v[28:31]
  ds_read_b64_tr_b16 v[144:145], v6 offset:8192
  ds_read_b64_tr_b16 v[146:147], v6 offset:8704
  v_mfma_f32_16x16x32_bf16 v[36:39], v[156:159], a[12:15], v[36:39]
  v_cvt_pk_bf16_f32 v116, v124, v125
  v_cvt_pk_bf16_f32 v117, v126, v127
  v_cvt_pk_bf16_f32 v118, v128, v129
  v_cvt_pk_bf16_f32 v119, v130, v131
  s_waitcnt lgkmcnt(8)
  v_mfma_f32_16x16x32_bf16 v[40:43], v[160:163], a[12:15], v[40:43]
  ds_read_b64_tr_b16 v[148:149], v2 offset:8192
  ds_read_b64_tr_b16 v[150:151], v2 offset:8704
  v_mfma_f32_16x16x32_bf16 v[32:35], v[160:163], a[8:11], v[32:35]
  buffer_load_dwordx4 a[44:47], v11, s[8:11], s50 offen offset:3072 sc1
  v_cvt_pk_bf16_f32 v120, v132, v133
  v_cvt_pk_bf16_f32 v121, v134, v135
  v_cvt_pk_bf16_f32 v122, v136, v137
  v_cvt_pk_bf16_f32 v123, v138, v139
  s_waitcnt lgkmcnt(8)
  v_mfma_f32_16x16x32_bf16 v[60:63], v[164:167], a[8:11], v[60:63]
  ds_read_b64_tr_b16 v[152:153], v3 offset:8192
  ds_read_b64_tr_b16 v[154:155], v3 offset:8704
  v_mfma_f32_16x16x32_bf16 v[68:71], v[164:167], a[12:15], v[68:71]
  s_add_u32 s40, s36, 0x1000
  buffer_store_dwordx4 v[52:55], v11, s[12:15], s40 offen offset:2048 sc1
  s_waitcnt lgkmcnt(8)
  v_mfma_f32_16x16x32_bf16 v[72:75], v[168:171], a[12:15], v[72:75]
  ds_read_b64_tr_b16 v[156:157], v5 offset:12288
  ds_read_b64_tr_b16 v[158:159], v5 offset:12800
  v_mfma_f32_16x16x32_bf16 v[64:67], v[168:171], a[8:11], v[64:67]
  s_barrier
  s_waitcnt lgkmcnt(8)
  v_mfma_f32_16x16x32_bf16 v[28:31], v[140:143], a[16:19], v[28:31]
  ds_read_b64_tr_b16 v[160:161], v6 offset:12288
  ds_read_b64_tr_b16 v[162:163], v6 offset:12800
  v_mfma_f32_16x16x32_bf16 v[36:39], v[140:143], a[20:23], v[36:39]
  s_waitcnt lgkmcnt(8)
  v_mfma_f32_16x16x32_bf16 v[40:43], v[144:147], a[20:23], v[40:43]
  ds_read_b64_tr_b16 v[164:165], v2 offset:12288
  ds_read_b64_tr_b16 v[166:167], v2 offset:12800
  v_mfma_f32_16x16x32_bf16 v[32:35], v[144:147], a[16:19], v[32:35]
  buffer_load_dwordx4 a[48:51], v11, s[8:11], s51 offen offset:0 sc1
  s_waitcnt lgkmcnt(8)
  v_mfma_f32_16x16x32_bf16 v[60:63], v[148:151], a[16:19], v[60:63]
  ds_read_b64_tr_b16 v[168:169], v3 offset:12288
  ds_read_b64_tr_b16 v[170:171], v3 offset:12800
  v_mfma_f32_16x16x32_bf16 v[68:71], v[148:151], a[20:23], v[68:71]
  s_waitcnt lgkmcnt(8)
  v_mfma_f32_16x16x32_bf16 v[72:75], v[152:155], a[20:23], v[72:75]
  ds_read_b64_tr_b16 v[140:141], v5 offset:16384
  ds_read_b64_tr_b16 v[142:143], v5 offset:16896
  v_mfma_f32_16x16x32_bf16 v[64:67], v[152:155], a[16:19], v[64:67]
  buffer_load_dwordx4 a[52:55], v11, s[8:11], s51 offen offset:1024 sc1
  s_waitcnt lgkmcnt(8)
  v_mfma_f32_16x16x32_bf16 v[28:31], v[156:159], a[24:27], v[28:31]
  ds_read_b64_tr_b16 v[144:145], v6 offset:16384
  ds_read_b64_tr_b16 v[146:147], v6 offset:16896
  v_mfma_f32_16x16x32_bf16 v[36:39], v[156:159], a[28:31], v[36:39]
  buffer_load_dwordx4 a[56:59], v11, s[8:11], s51 offen offset:2048 sc1
  s_waitcnt lgkmcnt(8)
  v_mfma_f32_16x16x32_bf16 v[40:43], v[160:163], a[28:31], v[40:43]
  ds_read_b64_tr_b16 v[148:149], v2 offset:16384
  ds_read_b64_tr_b16 v[150:151], v2 offset:16896
  v_mfma_f32_16x16x32_bf16 v[32:35], v[160:163], a[24:27], v[32:35]
  s_add_u32 s40, s36, 0x1000
  buffer_store_dwordx4 v[56:59], v11, s[12:15], s40 offen offset:3072 sc1
  s_waitcnt lgkmcnt(8)
  v_mfma_f32_16x16x32_bf16 v[60:63], v[164:167], a[24:27], v[60:63]
  ds_read_b64_tr_b16 v[152:153], v3 offset:16384
  ds_read_b64_tr_b16 v[154:155], v3 offset:16896
  v_mfma_f32_16x16x32_bf16 v[68:71], v[164:167], a[28:31], v[68:71]
  buffer_load_dwordx4 a[60:63], v11, s[8:11], s51 offen offset:3072 sc1
  s_waitcnt lgkmcnt(8)
  v_mfma_f32_16x16x32_bf16 v[72:75], v[168:171], a[28:31], v[72:75]
  ds_read_b64_tr_b16 v[156:157], v5 offset:20480
  ds_read_b64_tr_b16 v[158:159], v5 offset:20992
  v_mfma_f32_16x16x32_bf16 v[64:67], v[168:171], a[24:27], v[64:67]
  s_add_u32 s40, s35, 0x56000
  s_add_u32 m0, s32, 49152
  s_add_u32 s41, s40, 22016
  buffer_load_dwordx4 v8, s[20:23], s40 offen lds
  s_add_u32 m0, s32, 50176
  s_nop 0
  buffer_load_dwordx4 v4, s[20:23], s41 offen lds
  s_waitcnt lgkmcnt(8)
  v_mfma_f32_16x16x32_bf16 v[92:95], v[140:143], a[0:3], 0
  ds_read_b64_tr_b16 v[160:161], v6 offset:20480
  ds_read_b64_tr_b16 v[162:163], v6 offset:20992
  v_mfma_f32_16x16x32_bf16 v[100:103], v[140:143], a[4:7], 0
  s_waitcnt lgkmcnt(8)
  v_mfma_f32_16x16x32_bf16 v[104:107], v[144:147], a[4:7], 0
  ds_read_b64_tr_b16 v[164:165], v2 offset:20480
  ds_read_b64_tr_b16 v[166:167], v2 offset:20992
  v_mfma_f32_16x16x32_bf16 v[96:99], v[144:147], a[0:3], 0
  s_waitcnt lgkmcnt(8)
  v_mfma_f32_16x16x32_bf16 v[124:127], v[148:151], a[0:3], 0
  ds_read_b64_tr_b16 v[168:169], v3 offset:20480
  ds_read_b64_tr_b16 v[170:171], v3 offset:20992
  v_mfma_f32_16x16x32_bf16 v[132:135], v[148:151], a[4:7], 0
  s_waitcnt lgkmcnt(8)
  v_mfma_f32_16x16x32_bf16 v[136:139], v[152:155], a[4:7], 0
  ds_read_b64_tr_b16 v[140:141], v5 offset:24576
  ds_read_b64_tr_b16 v[142:143], v5 offset:25088
  v_mfma_f32_16x16x32_bf16 v[128:131], v[152:155], a[0:3], 0
  s_waitcnt lgkmcnt(8)
  v_mfma_f32_16x16x32_bf16 v[92:95], v[156:159], a[8:11], v[92:95]
  ds_read_b64_tr_b16 v[144:145], v6 offset:24576
  ds_read_b64_tr_b16 v[146:147], v6 offset:25088
  v_mfma_f32_16x16x32_bf16 v[100:103], v[156:159], a[12:15], v[100:103]
  s_waitcnt lgkmcnt(8)
  v_mfma_f32_16x16x32_bf16 v[104:107], v[160:163], a[12:15], v[104:107]
  ds_read_b64_tr_b16 v[148:149], v2 offset:24576
  ds_read_b64_tr_b16 v[150:151], v2 offset:25088
  v_mfma_f32_16x16x32_bf16 v[96:99], v[160:163], a[8:11], v[96:99]
  s_waitcnt lgkmcnt(8)
  v_mfma_f32_16x16x32_bf16 v[124:127], v[164:167], a[8:11], v[124:127]
  ds_read_b64_tr_b16 v[152:153], v3 offset:24576
  ds_read_b64_tr_b16 v[154:155], v3 offset:25088
  v_mfma_f32_16x16x32_bf16 v[132:135], v[164:167], a[12:15], v[132:135]
  s_add_u32 s40, s36, 0x80000
  buffer_store_dwordx4 v[76:79], v11, s[12:15], s40 offen offset:0 sc1
  s_waitcnt lgkmcnt(8)
  v_mfma_f32_16x16x32_bf16 v[136:139], v[168:171], a[12:15], v[136:139]
  ds_read_b64_tr_b16 v[156:157], v5 offset:28672
  ds_read_b64_tr_b16 v[158:159], v5 offset:29184
  v_mfma_f32_16x16x32_bf16 v[128:131], v[168:171], a[8:11], v[128:131]
  s_barrier
  s_waitcnt lgkmcnt(8)
  v_mfma_f32_16x16x32_bf16 v[92:95], v[140:143], a[16:19], v[92:95]
  ds_read_b64_tr_b16 v[160:161], v6 offset:28672
  ds_read_b64_tr_b16 v[162:163], v6 offset:29184
  v_mfma_f32_16x16x32_bf16 v[100:103], v[140:143], a[20:23], v[100:103]
  s_waitcnt lgkmcnt(8)
  v_mfma_f32_16x16x32_bf16 v[104:107], v[144:147], a[20:23], v[104:107]
  ds_read_b64_tr_b16 v[164:165], v2 offset:28672
  ds_read_b64_tr_b16 v[166:167], v2 offset:29184
  v_mfma_f32_16x16x32_bf16 v[96:99], v[144:147], a[16:19], v[96:99]
  s_waitcnt lgkmcnt(8)
  v_mfma_f32_16x16x32_bf16 v[124:127], v[148:151], a[16:19], v[124:127]
  ds_read_b64_tr_b16 v[168:169], v3 offset:28672
  ds_read_b64_tr_b16 v[170:171], v3 offset:29184
  v_mfma_f32_16x16x32_bf16 v[132:135], v[148:151], a[20:23], v[132:135]
  s_waitcnt lgkmcnt(8)
  v_mfma_f32_16x16x32_bf16 v[136:139], v[152:155], a[20:23], v[136:139]
  v_xor_b32 v5, 0x10000, v5
  ds_read_b64_tr_b16 v[140:141], v5 offset:0
  ds_read_b64_tr_b16 v[142:143], v5 offset:512
  v_mfma_f32_16x16x32_bf16 v[128:131], v[152:155], a[16:19], v[128:131]
  s_add_u32 s40, s33, 0x200000
  s_add_u32 m0, s32, 65536
  s_add_u32 s41, s40, 65536
  buffer_load_dwordx4 v7, s[24:27], s40 offen lds
  s_add_u32 m0, s32, 66560
  s_nop 0
  buffer_load_dwordx4 v0, s[24:27], s41 offen lds
  s_waitcnt lgkmcnt(8)
  v_mfma_f32_16x16x32_bf16 v[92:95], v[156:159], a[24:27], v[92:95]
  v_xor_b32 v6, 0x10000, v6
  ds_read_b64_tr_b16 v[144:145], v6 offset:0
  ds_read_b64_tr_b16 v[146:147], v6 offset:512
  v_mfma_f32_16x16x32_bf16 v[100:103], v[156:159], a[28:31], v[100:103]
  s_waitcnt lgkmcnt(8)
  v_mfma_f32_16x16x32_bf16 v[104:107], v[160:163], a[28:31], v[104:107]
  v_xor_b32 v2, 0x10000, v2
  ds_read_b64_tr_b16 v[148:149], v2 offset:0
  ds_read_b64_tr_b16 v[150:151], v2 offset:512
  v_mfma_f32_16x16x32_bf16 v[96:99], v[160:163], a[24:27], v[96:99]
  s_add_u32 s40, s36, 0x80000
  buffer_store_dwordx4 v[80:83], v11, s[12:15], s40 offen offset:1024 sc1
  s_waitcnt lgkmcnt(8)
  v_mfma_f32_16x16x32_bf16 v[124:127], v[164:167], a[24:27], v[124:127]
  v_mfma_f32_16x16x32_bf16 v[132:135], v[164:167], a[28:31], v[132:135]
  s_waitcnt lgkmcnt(6)
  v_mfma_f32_16x16x32_bf16 v[136:139], v[168:171], a[28:31], v[136:139]
  ds_read_b64_tr_b16 v[156:157], v5 offset:4096
  ds_read_b64_tr_b16 v[158:159], v5 offset:4608
  v_mfma_f32_16x16x32_bf16 v[128:131], v[168:171], a[24:27], v[128:131]
  s_waitcnt lgkmcnt(6)
  v_mfma_f32_16x16x32_bf16 v[172:175], v[140:143], a[0:3], 0
  ds_read_b64_tr_b16 v[160:161], v6 offset:4096
  ds_read_b64_tr_b16 v[162:163], v6 offset:4608
  v_mfma_f32_16x16x32_bf16 v[176:179], v[140:143], a[4:7], 0
  s_waitcnt lgkmcnt(6)
  v_mfma_f32_16x16x32_bf16 v[184:187], v[144:147], a[4:7], 0
  ds_read_b64_tr_b16 v[164:165], v2 offset:4096
  ds_read_b64_tr_b16 v[166:167], v2 offset:4608
  v_mfma_f32_16x16x32_bf16 v[180:183], v[144:147], a[0:3], 0
  s_waitcnt lgkmcnt(6)
  v_mfma_f32_16x16x32_bf16 v[12:15], v[148:151], a[0:3], 0
  v_mfma_f32_16x16x32_bf16 v[16:19], v[148:151], a[4:7], 0
  ds_read_b64_tr_b16 v[140:141], v5 offset:8192
  ds_read_b64_tr_b16 v[142:143], v5 offset:8704
  s_waitcnt lgkmcnt(6)
  v_mfma_f32_16x16x32_bf16 v[172:175], v[156:159], a[8:11], v[172:175]
  ds_read_b64_tr_b16 v[144:145], v6 offset:8192
  ds_read_b64_tr_b16 v[146:147], v6 offset:8704
  v_mfma_f32_16x16x32_bf16 v[176:179], v[156:159], a[12:15], v[176:179]
  s_waitcnt lgkmcnt(6)
  v_mfma_f32_16x16x32_bf16 v[184:187], v[160:163], a[12:15], v[184:187]
  ds_read_b64_tr_b16 v[148:149], v2 offset:8192
  ds_read_b64_tr_b16 v[150:151], v2 offset:8704
  v_mfma_f32_16x16x32_bf16 v[180:183], v[160:163], a[8:11], v[180:183]
  s_waitcnt lgkmcnt(6)
  v_mfma_f32_16x16x32_bf16 v[12:15], v[164:167], a[8:11], v[12:15]
  v_mfma_f32_16x16x32_bf16 v[16:19], v[164:167], a[12:15], v[16:19]
  s_add_u32 s40, s36, 0x80000
  buffer_store_dwordx4 v[84:87], v11, s[12:15], s40 offen offset:2048 sc1
  ds_read_b64_tr_b16 v[156:157], v5 offset:12288
  ds_read_b64_tr_b16 v[158:159], v5 offset:12800
  s_waitcnt vmcnt(22)
  s_barrier
  s_waitcnt lgkmcnt(6)
  v_mfma_f32_16x16x32_bf16 v[172:175], v[140:143], a[16:19], v[172:175]
  ds_read_b64_tr_b16 v[160:161], v6 offset:12288
  ds_read_b64_tr_b16 v[162:163], v6 offset:12800
  v_mfma_f32_16x16x32_bf16 v[176:179], v[140:143], a[20:23], v[176:179]
  s_waitcnt lgkmcnt(6)
  v_mfma_f32_16x16x32_bf16 v[184:187], v[144:147], a[20:23], v[184:187]
  ds_read_b64_tr_b16 v[164:165], v2 offset:12288
  ds_read_b64_tr_b16 v[166:167], v2 offset:12800
  v_mfma_f32_16x16x32_bf16 v[180:183], v[144:147], a[16:19], v[180:183]
  s_waitcnt lgkmcnt(6)
  v_mfma_f32_16x16x32_bf16 v[12:15], v[148:151], a[16:19], v[12:15]
  v_mfma_f32_16x16x32_bf16 v[16:19], v[148:151], a[20:23], v[16:19]
  ds_read_b64_tr_b16 v[140:141], v5 offset:16384
  ds_read_b64_tr_b16 v[142:143], v5 offset:16896
  s_add_u32 s40, s33, 0x200080
  s_add_u32 m0, s32, 81920
  s_add_u32 s41, s40, 65536
  buffer_load_dwordx4 v7, s[24:27], s40 offen lds
  s_add_u32 m0, s32, 82944
  s_nop 0
  buffer_load_dwordx4 v0, s[24:27], s41 offen lds
  s_waitcnt lgkmcnt(6)
  v_mfma_f32_16x16x32_bf16 v[172:175], v[156:159], a[24:27], v[172:175]
  ds_read_b64_tr_b16 v[144:145], v6 offset:16384
  ds_read_b64_tr_b16 v[146:147], v6 offset:16896
  v_mfma_f32_16x16x32_bf16 v[176:179], v[156:159], a[28:31], v[176:179]
  s_waitcnt lgkmcnt(6)
  v_mfma_f32_16x16x32_bf16 v[184:187], v[160:163], a[28:31], v[184:187]
  ds_read_b64_tr_b16 v[148:149], v2 offset:16384
  ds_read_b64_tr_b16 v[150:151], v2 offset:16896
  v_mfma_f32_16x16x32_bf16 v[180:183], v[160:163], a[24:27], v[180:183]
  s_add_u32 s40, s36, 0x80000
  buffer_store_dwordx4 v[88:91], v11, s[12:15], s40 offen offset:3072 sc1
  s_waitcnt lgkmcnt(6)
  v_mfma_f32_16x16x32_bf16 v[12:15], v[164:167], a[24:27], v[12:15]
  v_xor_b32 v3, 0x10000, v3
  ds_read_b64_tr_b16 v[152:153], v3 offset:16384
  ds_read_b64_tr_b16 v[154:155], v3 offset:16896
  v_mfma_f32_16x16x32_bf16 v[16:19], v[164:167], a[28:31], v[16:19]
  ds_read_b64_tr_b16 v[156:157], v5 offset:20480
  ds_read_b64_tr_b16 v[158:159], v5 offset:20992
  s_waitcnt vmcnt(10)
  s_waitcnt lgkmcnt(8)
  v_mfma_f32_16x16x32_bf16 v[28:31], v[140:143], a[32:35], v[28:31]
  ds_read_b64_tr_b16 v[160:161], v6 offset:20480
  ds_read_b64_tr_b16 v[162:163], v6 offset:20992
  v_mfma_f32_16x16x32_bf16 v[36:39], v[140:143], a[36:39], v[36:39]
  buffer_load_dwordx4 a[0:3], v11, s[8:11], s56 offen offset:0 sc1
  s_waitcnt lgkmcnt(8)
  v_mfma_f32_16x16x32_bf16 v[40:43], v[144:147], a[36:39], v[40:43]
  ds_read_b64_tr_b16 v[164:165], v2 offset:20480
  ds_read_b64_tr_b16 v[166:167], v2 offset:20992
  v_mfma_f32_16x16x32_bf16 v[32:35], v[144:147], a[32:35], v[32:35]
  buffer_load_dwordx4 a[4:7], v11, s[8:11], s56 offen offset:1024 sc1
  s_waitcnt lgkmcnt(8)
  v_mfma_f32_16x16x32_bf16 v[60:63], v[148:151], a[32:35], v[60:63]
  ds_read_b64_tr_b16 v[168:169], v3 offset:20480
  ds_read_b64_tr_b16 v[170:171], v3 offset:20992
  v_mfma_f32_16x16x32_bf16 v[68:71], v[148:151], a[36:39], v[68:71]
  s_waitcnt lgkmcnt(8)
  v_mfma_f32_16x16x32_bf16 v[72:75], v[152:155], a[36:39], v[72:75]
  ds_read_b64_tr_b16 v[140:141], v5 offset:24576
  ds_read_b64_tr_b16 v[142:143], v5 offset:25088
  v_mfma_f32_16x16x32_bf16 v[64:67], v[152:155], a[32:35], v[64:67]
  buffer_load_dwordx4 a[8:11], v11, s[8:11], s56 offen offset:2048 sc1
  s_waitcnt lgkmcnt(8)
  v_mfma_f32_16x16x32_bf16 v[28:31], v[156:159], a[40:43], v[28:31]
  ds_read_b64_tr_b16 v[144:145], v6 offset:24576
  ds_read_b64_tr_b16 v[146:147], v6 offset:25088
  v_mfma_f32_16x16x32_bf16 v[36:39], v[156:159], a[44:47], v[36:39]
  s_waitcnt lgkmcnt(8)
  v_mfma_f32_16x16x32_bf16 v[40:43], v[160:163], a[44:47], v[40:43]
  ds_read_b64_tr_b16 v[148:149], v2 offset:24576
  ds_read_b64_tr_b16 v[150:151], v2 offset:25088
  v_mfma_f32_16x16x32_bf16 v[32:35], v[160:163], a[40:43], v[32:35]
  buffer_load_dwordx4 a[12:15], v11, s[8:11], s56 offen offset:3072 sc1
  s_waitcnt lgkmcnt(8)
  v_mfma_f32_16x16x32_bf16 v[60:63], v[164:167], a[40:43], v[60:63]
  ds_read_b64_tr_b16 v[152:153], v3 offset:24576
  ds_read_b64_tr_b16 v[154:155], v3 offset:25088
  v_mfma_f32_16x16x32_bf16 v[68:71], v[164:167], a[44:47], v[68:71]
  s_add_u32 s40, s36, 0x81000
  buffer_store_dwordx4 v[108:111], v11, s[12:15], s40 offen offset:0 sc1
  s_waitcnt lgkmcnt(8)
  v_mfma_f32_16x16x32_bf16 v[72:75], v[168:171], a[44:47], v[72:75]
  ds_read_b64_tr_b16 v[156:157], v5 offset:28672
  ds_read_b64_tr_b16 v[158:159], v5 offset:29184
  v_mfma_f32_16x16x32_bf16 v[64:67], v[168:171], a[40:43], v[64:67]
  s_barrier
  s_waitcnt lgkmcnt(8)
  v_mfma_f32_16x16x32_bf16 v[28:31], v[140:143], a[48:51], v[28:31]
  ds_read_b64_tr_b16 v[160:161], v6 offset:28672
  ds_read_b64_tr_b16 v[162:163], v6 offset:29184
  v_mfma_f32_16x16x32_bf16 v[36:39], v[140:143], a[52:55], v[36:39]
  s_waitcnt lgkmcnt(8)
  v_mfma_f32_16x16x32_bf16 v[40:43], v[144:147], a[52:55], v[40:43]
  ds_read_b64_tr_b16 v[164:165], v2 offset:28672
  ds_read_b64_tr_b16 v[166:167], v2 offset:29184
  v_mfma_f32_16x16x32_bf16 v[32:35], v[144:147], a[48:51], v[32:35]
  buffer_load_dwordx4 a[16:19], v11, s[8:11], s57 offen offset:0 sc1
  s_waitcnt lgkmcnt(8)
  v_mfma_f32_16x16x32_bf16 v[60:63], v[148:151], a[48:51], v[60:63]
  ds_read_b64_tr_b16 v[168:169], v3 offset:28672
  ds_read_b64_tr_b16 v[170:171], v3 offset:29184
  v_mfma_f32_16x16x32_bf16 v[68:71], v[148:151], a[52:55], v[68:71]
  s_waitcnt lgkmcnt(8)
  v_mfma_f32_16x16x32_bf16 v[72:75], v[152:155], a[52:55], v[72:75]
  ds_read_b64_tr_b16 v[140:141], v5 offset:32768
  ds_read_b64_tr_b16 v[142:143], v5 offset:33280
  v_mfma_f32_16x16x32_bf16 v[64:67], v[152:155], a[48:51], v[64:67]
  buffer_load_dwordx4 a[20:23], v11, s[8:11], s57 offen offset:1024 sc1
  s_waitcnt lgkmcnt(8)
  v_mfma_f32_16x16x32_bf16 v[28:31], v[156:159], a[56:59], v[28:31]
  ds_read_b64_tr_b16 v[144:145], v6 offset:32768
  ds_read_b64_tr_b16 v[146:147], v6 offset:33280
  v_mfma_f32_16x16x32_bf16 v[36:39], v[156:159], a[60:63], v[36:39]
  buffer_load_dwordx4 a[24:27], v11, s[8:11], s57 offen offset:2048 sc1
  s_waitcnt lgkmcnt(8)
  v_mfma_f32_16x16x32_bf16 v[40:43], v[160:163], a[60:63], v[40:43]
  ds_read_b64_tr_b16 v[148:149], v2 offset:32768
  ds_read_b64_tr_b16 v[150:151], v2 offset:33280
  v_mfma_f32_16x16x32_bf16 v[32:35], v[160:163], a[56:59], v[32:35]
  s_add_u32 s40, s36, 0x81000
  buffer_store_dwordx4 v[112:115], v11, s[12:15], s40 offen offset:1024 sc1
  s_waitcnt lgkmcnt(8)
  v_mfma_f32_16x16x32_bf16 v[60:63], v[164:167], a[56:59], v[60:63]
  ds_read_b64_tr_b16 v[152:153], v3 offset:32768
  ds_read_b64_tr_b16 v[154:155], v3 offset:33280
  v_mfma_f32_16x16x32_bf16 v[68:71], v[164:167], a[60:63], v[68:71]
  buffer_load_dwordx4 a[28:31], v11, s[8:11], s57 offen offset:3072 sc1
  s_waitcnt lgkmcnt(8)
  v_mfma_f32_16x16x32_bf16 v[72:75], v[168:171], a[60:63], v[72:75]
  ds_read_b64_tr_b16 v[156:157], v5 offset:36864
  ds_read_b64_tr_b16 v[158:159], v5 offset:37376
  v_mfma_f32_16x16x32_bf16 v[64:67], v[168:171], a[56:59], v[64:67]
  s_add_u32 s40, s35, 0xac000
  s_add_u32 m0, s32, 0
  s_add_u32 s41, s40, 22016
  buffer_load_dwordx4 v8, s[20:23], s40 offen lds
  s_add_u32 m0, s32, 1024
  s_nop 0
  buffer_load_dwordx4 v4, s[20:23], s41 offen lds
  s_waitcnt lgkmcnt(8)
  v_mfma_f32_16x16x32_bf16 v[92:95], v[140:143], a[32:35], v[92:95]
  ds_read_b64_tr_b16 v[160:161], v6 offset:36864
  ds_read_b64_tr_b16 v[162:163], v6 offset:37376
  v_mfma_f32_16x16x32_bf16 v[100:103], v[140:143], a[36:39], v[100:103]
  s_waitcnt lgkmcnt(8)
  v_mfma_f32_16x16x32_bf16 v[104:107], v[144:147], a[36:39], v[104:107]
  ds_read_b64_tr_b16 v[164:165], v2 offset:36864
  ds_read_b64_tr_b16 v[166:167], v2 offset:37376
  v_mfma_f32_16x16x32_bf16 v[96:99], v[144:147], a[32:35], v[96:99]
  s_waitcnt lgkmcnt(8)
  v_mfma_f32_16x16x32_bf16 v[124:127], v[148:151], a[32:35], v[124:127]
  ds_read_b64_tr_b16 v[168:169], v3 offset:36864
  ds_read_b64_tr_b16 v[170:171], v3 offset:37376
  v_mfma_f32_16x16x32_bf16 v[132:135], v[148:151], a[36:39], v[132:135]
  s_waitcnt lgkmcnt(8)
  v_mfma_f32_16x16x32_bf16 v[136:139], v[152:155], a[36:39], v[136:139]
  ds_read_b64_tr_b16 v[140:141], v5 offset:40960
  ds_read_b64_tr_b16 v[142:143], v5 offset:41472
  v_mfma_f32_16x16x32_bf16 v[128:131], v[152:155], a[32:35], v[128:131]
  s_waitcnt lgkmcnt(8)
  v_mfma_f32_16x16x32_bf16 v[92:95], v[156:159], a[40:43], v[92:95]
  ds_read_b64_tr_b16 v[144:145], v6 offset:40960
  ds_read_b64_tr_b16 v[146:147], v6 offset:41472
  v_mfma_f32_16x16x32_bf16 v[100:103], v[156:159], a[44:47], v[100:103]
  s_waitcnt lgkmcnt(8)
  v_mfma_f32_16x16x32_bf16 v[104:107], v[160:163], a[44:47], v[104:107]
  ds_read_b64_tr_b16 v[148:149], v2 offset:40960
  ds_read_b64_tr_b16 v[150:151], v2 offset:41472
  v_mfma_f32_16x16x32_bf16 v[96:99], v[160:163], a[40:43], v[96:99]
  s_waitcnt lgkmcnt(8)
  v_mfma_f32_16x16x32_bf16 v[124:127], v[164:167], a[40:43], v[124:127]
  ds_read_b64_tr_b16 v[152:153], v3 offset:40960
  ds_read_b64_tr_b16 v[154:155], v3 offset:41472
  v_mfma_f32_16x16x32_bf16 v[132:135], v[164:167], a[44:47], v[132:135]
  s_add_u32 s40, s36, 0x81000
  buffer_store_dwordx4 v[116:119], v11, s[12:15], s40 offen offset:2048 sc1
  s_waitcnt lgkmcnt(8)
  v_mfma_f32_16x16x32_bf16 v[136:139], v[168:171], a[44:47], v[136:139]
  ds_read_b64_tr_b16 v[156:157], v5 offset:45056
  ds_read_b64_tr_b16 v[158:159], v5 offset:45568
  v_mfma_f32_16x16x32_bf16 v[128:131], v[168:171], a[40:43], v[128:131]
  s_waitcnt vmcnt(21)
  s_barrier
  s_waitcnt lgkmcnt(8)
  v_mfma_f32_16x16x32_bf16 v[92:95], v[140:143], a[48:51], v[92:95]
  ds_read_b64_tr_b16 v[160:161], v6 offset:45056
  ds_read_b64_tr_b16 v[162:163], v6 offset:45568
  v_mfma_f32_16x16x32_bf16 v[100:103], v[140:143], a[52:55], v[100:103]
  s_waitcnt lgkmcnt(8)
  v_mfma_f32_16x16x32_bf16 v[104:107], v[144:147], a[52:55], v[104:107]
  ds_read_b64_tr_b16 v[164:165], v2 offset:45056
  ds_read_b64_tr_b16 v[166:167], v2 offset:45568
  v_mfma_f32_16x16x32_bf16 v[96:99], v[144:147], a[48:51], v[96:99]
  s_waitcnt lgkmcnt(8)
  v_mfma_f32_16x16x32_bf16 v[124:127], v[148:151], a[48:51], v[124:127]
  ds_read_b64_tr_b16 v[168:169], v3 offset:45056
  ds_read_b64_tr_b16 v[170:171], v3 offset:45568
  v_mfma_f32_16x16x32_bf16 v[132:135], v[148:151], a[52:55], v[132:135]
  s_waitcnt lgkmcnt(8)
  v_mfma_f32_16x16x32_bf16 v[136:139], v[152:155], a[52:55], v[136:139]
  ds_read_b64_tr_b16 v[140:141], v5 offset:49152
  ds_read_b64_tr_b16 v[142:143], v5 offset:49664
  v_mfma_f32_16x16x32_bf16 v[128:131], v[152:155], a[48:51], v[128:131]
  s_add_u32 s40, s33, 0x300000
  s_add_u32 m0, s32, 16384
  s_add_u32 s41, s40, 65536
  buffer_load_dwordx4 v7, s[24:27], s40 offen lds
  s_add_u32 m0, s32, 17408
  s_nop 0
  buffer_load_dwordx4 v0, s[24:27], s41 offen lds
  s_waitcnt lgkmcnt(8)
  v_mfma_f32_16x16x32_bf16 v[92:95], v[156:159], a[56:59], v[92:95]
  ds_read_b64_tr_b16 v[144:145], v6 offset:49152
  ds_read_b64_tr_b16 v[146:147], v6 offset:49664
  v_mfma_f32_16x16x32_bf16 v[100:103], v[156:159], a[60:63], v[100:103]
  s_waitcnt lgkmcnt(8)
  v_mfma_f32_16x16x32_bf16 v[104:107], v[160:163], a[60:63], v[104:107]
  ds_read_b64_tr_b16 v[148:149], v2 offset:49152
  ds_read_b64_tr_b16 v[150:151], v2 offset:49664
  v_mfma_f32_16x16x32_bf16 v[96:99], v[160:163], a[56:59], v[96:99]
  s_add_u32 s40, s36, 0x81000
  buffer_store_dwordx4 v[120:123], v11, s[12:15], s40 offen offset:3072 sc1
  s_waitcnt lgkmcnt(8)
  v_mfma_f32_16x16x32_bf16 v[124:127], v[164:167], a[56:59], v[124:127]
  v_mfma_f32_16x16x32_bf16 v[132:135], v[164:167], a[60:63], v[132:135]
  s_waitcnt lgkmcnt(6)
  v_mfma_f32_16x16x32_bf16 v[136:139], v[168:171], a[60:63], v[136:139]
  ds_read_b64_tr_b16 v[156:157], v5 offset:53248
  ds_read_b64_tr_b16 v[158:159], v5 offset:53760
  v_mfma_f32_16x16x32_bf16 v[128:131], v[168:171], a[56:59], v[128:131]
  s_waitcnt lgkmcnt(6)
  v_mfma_f32_16x16x32_bf16 v[172:175], v[140:143], a[32:35], v[172:175]
  ds_read_b64_tr_b16 v[160:161], v6 offset:53248
  ds_read_b64_tr_b16 v[162:163], v6 offset:53760
  v_mfma_f32_16x16x32_bf16 v[176:179], v[140:143], a[36:39], v[176:179]
  s_waitcnt lgkmcnt(6)
  v_mfma_f32_16x16x32_bf16 v[184:187], v[144:147], a[36:39], v[184:187]
  ds_read_b64_tr_b16 v[164:165], v2 offset:53248
  ds_read_b64_tr_b16 v[166:167], v2 offset:53760
  v_mfma_f32_16x16x32_bf16 v[180:183], v[144:147], a[32:35], v[180:183]
  s_waitcnt lgkmcnt(6)
  v_mfma_f32_16x16x32_bf16 v[12:15], v[148:151], a[32:35], v[12:15]
  v_mfma_f32_16x16x32_bf16 v[16:19], v[148:151], a[36:39], v[16:19]
  ds_read_b64_tr_b16 v[140:141], v5 offset:57344
  ds_read_b64_tr_b16 v[142:143], v5 offset:57856
  s_waitcnt lgkmcnt(6)
  v_mfma_f32_16x16x32_bf16 v[172:175], v[156:159], a[40:43], v[172:175]
  ds_read_b64_tr_b16 v[144:145], v6 offset:57344
  ds_read_b64_tr_b16 v[146:147], v6 offset:57856
  v_mfma_f32_16x16x32_bf16 v[176:179], v[156:159], a[44:47], v[176:179]
  s_mov_b32 s96, s78
  s_mov_b32 s97, s79
  s_mov_b32 s98, 0x158000
  s_mov_b32 s99, 0x00020000
  s_lshr_b32 s62, s32, 1
  s_add_u32 m0, s62, 114688
  s_nop 0
  buffer_load_dwordx4 v189, s[96:99], s68 offen lds
  s_waitcnt lgkmcnt(6)
  v_mfma_f32_16x16x32_bf16 v[184:187], v[160:163], a[44:47], v[184:187]
  ds_read_b64_tr_b16 v[148:149], v2 offset:57344
  ds_read_b64_tr_b16 v[150:151], v2 offset:57856
  v_mfma_f32_16x16x32_bf16 v[180:183], v[160:163], a[40:43], v[180:183]
  s_waitcnt lgkmcnt(6)
  v_mfma_f32_16x16x32_bf16 v[12:15], v[164:167], a[40:43], v[12:15]
  v_mfma_f32_16x16x32_bf16 v[16:19], v[164:167], a[44:47], v[16:19]
  ds_read_b64_tr_b16 v[156:157], v5 offset:61440
  ds_read_b64_tr_b16 v[158:159], v5 offset:61952
  s_waitcnt vmcnt(1)
  s_barrier
  s_cmp_lg_u32 s93, 0
  s_cbranch_scc1 L_attn_norel_5
  s_cmp_eq_u32 s43, 1
  s_cbranch_scc1 L_attn_norel_5
  buffer_wbl2 sc1
  s_waitcnt vmcnt(0)
L_attn_norel_5:
  s_lshl_b32 s62, s93, 12
  v_lshl_add_u32 v9, v1, 12, s62
  v_mov_b32 v10, 1
  buffer_atomic_add v10, v9, s[28:31], s47 offen
  s_waitcnt lgkmcnt(6)
  v_mfma_f32_16x16x32_bf16 v[172:175], v[140:143], a[48:51], v[172:175]
  ds_read_b64_tr_b16 v[160:161], v6 offset:61440
  ds_read_b64_tr_b16 v[162:163], v6 offset:61952
  v_mfma_f32_16x16x32_bf16 v[176:179], v[140:143], a[52:55], v[176:179]
  s_waitcnt lgkmcnt(6)
  v_mfma_f32_16x16x32_bf16 v[184:187], v[144:147], a[52:55], v[184:187]
  ds_read_b64_tr_b16 v[164:165], v2 offset:61440
  ds_read_b64_tr_b16 v[166:167], v2 offset:61952
  v_mfma_f32_16x16x32_bf16 v[180:183], v[144:147], a[48:51], v[180:183]
  s_waitcnt lgkmcnt(6)
  v_mfma_f32_16x16x32_bf16 v[12:15], v[148:151], a[48:51], v[12:15]
  v_mfma_f32_16x16x32_bf16 v[16:19], v[148:151], a[52:55], v[16:19]
  v_xor_b32 v5, 0x10000, v5
  ds_read_b64_tr_b16 v[140:141], v5 offset:0
  ds_read_b64_tr_b16 v[142:143], v5 offset:512
  s_add_u32 s40, s33, 0x300080
  s_add_u32 m0, s32, 32768
  s_add_u32 s41, s40, 65536
  buffer_load_dwordx4 v7, s[24:27], s40 offen lds
  s_add_u32 m0, s32, 33792
  s_nop 0
  buffer_load_dwordx4 v0, s[24:27], s41 offen lds
  s_waitcnt lgkmcnt(6)
  v_mfma_f32_16x16x32_bf16 v[172:175], v[156:159], a[56:59], v[172:175]
  v_xor_b32 v6, 0x10000, v6
  ds_read_b64_tr_b16 v[144:145], v6 offset:0
  ds_read_b64_tr_b16 v[146:147], v6 offset:512
  v_mfma_f32_16x16x32_bf16 v[176:179], v[156:159], a[60:63], v[176:179]
  s_waitcnt lgkmcnt(6)
  v_mfma_f32_16x16x32_bf16 v[184:187], v[160:163], a[60:63], v[184:187]
  v_xor_b32 v2, 0x10000, v2
  ds_read_b64_tr_b16 v[148:149], v2 offset:0
  ds_read_b64_tr_b16 v[150:151], v2 offset:512
  v_mfma_f32_16x16x32_bf16 v[180:183], v[160:163], a[56:59], v[180:183]
  s_waitcnt lgkmcnt(6)
  v_mfma_f32_16x16x32_bf16 v[12:15], v[164:167], a[56:59], v[12:15]
  v_xor_b32 v3, 0x10000, v3
  ds_read_b64_tr_b16 v[152:153], v3 offset:0
  ds_read_b64_tr_b16 v[154:155], v3 offset:512
  v_mfma_f32_16x16x32_bf16 v[16:19], v[164:167], a[60:63], v[16:19]
  ds_read_b64_tr_b16 v[156:157], v5 offset:4096
  ds_read_b64_tr_b16 v[158:159], v5 offset:4608
  s_waitcnt lgkmcnt(8)
  v_mfma_f32_16x16x32_bf16 v[28:31], v[140:143], a[0:3], v[28:31]
  ds_read_b64_tr_b16 v[160:161], v6 offset:4096
  ds_read_b64_tr_b16 v[162:163], v6 offset:4608
  v_mfma_f32_16x16x32_bf16 v[36:39], v[140:143], a[4:7], v[36:39]
  buffer_load_dwordx4 a[32:35], v11, s[8:11], s58 offen offset:0 sc1
  s_waitcnt lgkmcnt(8)
  v_mfma_f32_16x16x32_bf16 v[40:43], v[144:147], a[4:7], v[40:43]
  ds_read_b64_tr_b16 v[164:165], v2 offset:4096
  ds_read_b64_tr_b16 v[166:167], v2 offset:4608
  v_mfma_f32_16x16x32_bf16 v[32:35], v[144:147], a[0:3], v[32:35]
  buffer_load_dwordx4 a[36:39], v11, s[8:11], s58 offen offset:1024 sc1
  s_waitcnt lgkmcnt(8)
  v_mfma_f32_16x16x32_bf16 v[60:63], v[148:151], a[0:3], v[60:63]
  ds_read_b64_tr_b16 v[168:169], v3 offset:4096
  ds_read_b64_tr_b16 v[170:171], v3 offset:4608
  v_mfma_f32_16x16x32_bf16 v[68:71], v[148:151], a[4:7], v[68:71]
  s_waitcnt lgkmcnt(8)
  v_mfma_f32_16x16x32_bf16 v[72:75], v[152:155], a[4:7], v[72:75]
  ds_read_b64_tr_b16 v[140:141], v5 offset:8192
  ds_read_b64_tr_b16 v[142:143], v5 offset:8704
  v_mfma_f32_16x16x32_bf16 v[64:67], v[152:155], a[0:3], v[64:67]
  buffer_load_dwordx4 a[40:43], v11, s[8:11], s58 offen offset:2048 sc1
  s_waitcnt lgkmcnt(8)
  v_mfma_f32_16x16x32_bf16 v[28:31], v[156:159], a[8:11], v[28:31]
  ds_read_b64_tr_b16 v[144:145], v6 offset:8192
  ds_read_b64_tr_b16 v[146:147], v6 offset:8704
  v_mfma_f32_16x16x32_bf16 v[36:39], v[156:159], a[12:15], v[36:39]
  s_waitcnt lgkmcnt(8)
  v_mfma_f32_16x16x32_bf16 v[40:43], v[160:163], a[12:15], v[40:43]
  ds_read_b64_tr_b16 v[148:149], v2 offset:8192
  ds_read_b64_tr_b16 v[150:151], v2 offset:8704
  v_mfma_f32_16x16x32_bf16 v[32:35], v[160:163], a[8:11], v[32:35]
  buffer_load_dwordx4 a[44:47], v11, s[8:11], s58 offen offset:3072 sc1
  s_waitcnt lgkmcnt(8)
  v_mfma_f32_16x16x32_bf16 v[60:63], v[164:167], a[8:11], v[60:63]
  ds_read_b64_tr_b16 v[152:153], v3 offset:8192
  ds_read_b64_tr_b16 v[154:155], v3 offset:8704
  v_mfma_f32_16x16x32_bf16 v[68:71], v[164:167], a[12:15], v[68:71]
  s_waitcnt lgkmcnt(8)
  v_mfma_f32_16x16x32_bf16 v[72:75], v[168:171], a[12:15], v[72:75]
  ds_read_b64_tr_b16 v[156:157], v5 offset:12288
  ds_read_b64_tr_b16 v[158:159], v5 offset:12800
  v_mfma_f32_16x16x32_bf16 v[64:67], v[168:171], a[8:11], v[64:67]
  s_barrier
  s_waitcnt lgkmcnt(8)
  v_mfma_f32_16x16x32_bf16 v[28:31], v[140:143], a[16:19], v[28:31]
  ds_read_b64_tr_b16 v[160:161], v6 offset:12288
  ds_read_b64_tr_b16 v[162:163], v6 offset:12800
  v_mfma_f32_16x16x32_bf16 v[36:39], v[140:143], a[20:23], v[36:39]
  s_waitcnt lgkmcnt(8)
  v_mfma_f32_16x16x32_bf16 v[40:43], v[144:147], a[20:23], v[40:43]
  ds_read_b64_tr_b16 v[164:165], v2 offset:12288
  ds_read_b64_tr_b16 v[166:167], v2 offset:12800
  v_mfma_f32_16x16x32_bf16 v[32:35], v[144:147], a[16:19], v[32:35]
  buffer_load_dwordx4 a[48:51], v11, s[8:11], s59 offen offset:0 sc1
  s_waitcnt lgkmcnt(8)
  v_mfma_f32_16x16x32_bf16 v[60:63], v[148:151], a[16:19], v[60:63]
  ds_read_b64_tr_b16 v[168:169], v3 offset:12288
  ds_read_b64_tr_b16 v[170:171], v3 offset:12800
  v_mfma_f32_16x16x32_bf16 v[68:71], v[148:151], a[20:23], v[68:71]
  s_waitcnt lgkmcnt(8)
  v_mfma_f32_16x16x32_bf16 v[72:75], v[152:155], a[20:23], v[72:75]
  ds_read_b64_tr_b16 v[140:141], v5 offset:16384
  ds_read_b64_tr_b16 v[142:143], v5 offset:16896
  v_mfma_f32_16x16x32_bf16 v[64:67], v[152:155], a[16:19], v[64:67]
  buffer_load_dwordx4 a[52:55], v11, s[8:11], s59 offen offset:1024 sc1
  s_waitcnt lgkmcnt(8)
  v_mfma_f32_16x16x32_bf16 v[28:31], v[156:159], a[24:27], v[28:31]
  ds_read_b64_tr_b16 v[144:145], v6 offset:16384
  ds_read_b64_tr_b16 v[146:147], v6 offset:16896
  v_mfma_f32_16x16x32_bf16 v[36:39], v[156:159], a[28:31], v[36:39]
  buffer_load_dwordx4 a[56:59], v11, s[8:11], s59 offen offset:2048 sc1
  s_waitcnt lgkmcnt(8)
  v_mfma_f32_16x16x32_bf16 v[40:43], v[160:163], a[28:31], v[40:43]
  ds_read_b64_tr_b16 v[148:149], v2 offset:16384
  ds_read_b64_tr_b16 v[150:151], v2 offset:16896
  v_mfma_f32_16x16x32_bf16 v[32:35], v[160:163], a[24:27], v[32:35]
  s_add_u32 s40, s35, 0x102000
  s_add_u32 m0, s32, 49152
  s_add_u32 s41, s40, 22016
  buffer_load_dwordx4 v8, s[20:23], s40 offen lds
  s_add_u32 m0, s32, 50176
  s_nop 0
  buffer_load_dwordx4 v4, s[20:23], s41 offen lds
  s_waitcnt lgkmcnt(8)
  v_mfma_f32_16x16x32_bf16 v[60:63], v[164:167], a[24:27], v[60:63]
  ds_read_b64_tr_b16 v[152:153], v3 offset:16384
  ds_read_b64_tr_b16 v[154:155], v3 offset:16896
  v_mfma_f32_16x16x32_bf16 v[68:71], v[164:167], a[28:31], v[68:71]
  buffer_load_dwordx4 a[60:63], v11, s[8:11], s59 offen offset:3072 sc1
  s_waitcnt lgkmcnt(8)
  v_mfma_f32_16x16x32_bf16 v[72:75], v[168:171], a[28:31], v[72:75]
  ds_read_b64_tr_b16 v[156:157], v5 offset:20480
  ds_read_b64_tr_b16 v[158:159], v5 offset:20992
  v_mfma_f32_16x16x32_bf16 v[64:67], v[168:171], a[24:27], v[64:67]
  s_waitcnt lgkmcnt(8)
  v_mfma_f32_16x16x32_bf16 v[92:95], v[140:143], a[0:3], v[92:95]
  ds_read_b64_tr_b16 v[160:161], v6 offset:20480
  ds_read_b64_tr_b16 v[162:163], v6 offset:20992
  v_mfma_f32_16x16x32_bf16 v[100:103], v[140:143], a[4:7], v[100:103]
  s_waitcnt lgkmcnt(8)
  v_mfma_f32_16x16x32_bf16 v[104:107], v[144:147], a[4:7], v[104:107]
  ds_read_b64_tr_b16 v[164:165], v2 offset:20480
  ds_read_b64_tr_b16 v[166:167], v2 offset:20992
  v_mfma_f32_16x16x32_bf16 v[96:99], v[144:147], a[0:3], v[96:99]
  s_waitcnt lgkmcnt(8)
  v_mfma_f32_16x16x32_bf16 v[124:127], v[148:151], a[0:3], v[124:127]
  ds_read_b64_tr_b16 v[168:169], v3 offset:20480
  ds_read_b64_tr_b16 v[170:171], v3 offset:20992
  v_mfma_f32_16x16x32_bf16 v[132:135], v[148:151], a[4:7], v[132:135]
  s_waitcnt lgkmcnt(8)
  v_mfma_f32_16x16x32_bf16 v[136:139], v[152:155], a[4:7], v[136:139]
  ds_read_b64_tr_b16 v[140:141], v5 offset:24576
  ds_read_b64_tr_b16 v[142:143], v5 offset:25088
  v_mfma_f32_16x16x32_bf16 v[128:131], v[152:155], a[0:3], v[128:131]
  s_waitcnt lgkmcnt(8)
  v_mfma_f32_16x16x32_bf16 v[92:95], v[156:159], a[8:11], v[92:95]
  ds_read_b64_tr_b16 v[144:145], v6 offset:24576
  ds_read_b64_tr_b16 v[146:147], v6 offset:25088
  v_mfma_f32_16x16x32_bf16 v[100:103], v[156:159], a[12:15], v[100:103]
  s_waitcnt lgkmcnt(8)
  v_mfma_f32_16x16x32_bf16 v[104:107], v[160:163], a[12:15], v[104:107]
  ds_read_b64_tr_b16 v[148:149], v2 offset:24576
  ds_read_b64_tr_b16 v[150:151], v2 offset:25088
  v_mfma_f32_16x16x32_bf16 v[96:99], v[160:163], a[8:11], v[96:99]
  s_waitcnt lgkmcnt(8)
  v_mfma_f32_16x16x32_bf16 v[124:127], v[164:167], a[8:11], v[124:127]
  ds_read_b64_tr_b16 v[152:153], v3 offset:24576
  ds_read_b64_tr_b16 v[154:155], v3 offset:25088
  v_mfma_f32_16x16x32_bf16 v[132:135], v[164:167], a[12:15], v[132:135]
  s_waitcnt lgkmcnt(8)
  v_mfma_f32_16x16x32_bf16 v[136:139], v[168:171], a[12:15], v[136:139]
  ds_read_b64_tr_b16 v[156:157], v5 offset:28672
  ds_read_b64_tr_b16 v[158:159], v5 offset:29184
  v_mfma_f32_16x16x32_bf16 v[128:131], v[168:171], a[8:11], v[128:131]
  s_waitcnt vmcnt(12)
  s_barrier
  s_waitcnt lgkmcnt(8)
  v_mfma_f32_16x16x32_bf16 v[92:95], v[140:143], a[16:19], v[92:95]
  ds_read_b64_tr_b16 v[160:161], v6 offset:28672
  ds_read_b64_tr_b16 v[162:163], v6 offset:29184
  v_mfma_f32_16x16x32_bf16 v[100:103], v[140:143], a[20:23], v[100:103]
  ds_read_b64_tr_b16 v[20:21], v188 offset:16384
  ds_read_b64_tr_b16 v[22:23], v188 offset:18432
  s_waitcnt lgkmcnt(10)
  v_mfma_f32_16x16x32_bf16 v[104:107], v[144:147], a[20:23], v[104:107]
  ds_read_b64_tr_b16 v[164:165], v2 offset:28672
  ds_read_b64_tr_b16 v[166:167], v2 offset:29184
  v_mfma_f32_16x16x32_bf16 v[96:99], v[144:147], a[16:19], v[96:99]
  s_waitcnt lgkmcnt(10)
  v_mfma_f32_16x16x32_bf16 v[124:127], v[148:151], a[16:19], v[124:127]
  ds_read_b64_tr_b16 v[168:169], v3 offset:28672
  ds_read_b64_tr_b16 v[170:171], v3 offset:29184
  v_mfma_f32_16x16x32_bf16 v[132:135], v[148:151], a[20:23], v[132:135]
  s_waitcnt lgkmcnt(4)
  buffer_store_dwordx4 v[20:23], v11, s[12:15], s69 offen sc1
  v_mfma_f32_16x16x32_bf16 v[136:139], v[152:155], a[20:23], v[136:139]
  v_xor_b32 v5, 0x10000, v5
  ds_read_b64_tr_b16 v[140:141], v5 offset:0
  ds_read_b64_tr_b16 v[142:143], v5 offset:512
  v_mfma_f32_16x16x32_bf16 v[128:131], v[152:155], a[16:19], v[128:131]
  v_mfma_f32_16x16x32_bf16 v[92:95], v[156:159], a[24:27], v[92:95]
  v_xor_b32 v6, 0x10000, v6
  ds_read_b64_tr_b16 v[144:145], v6 offset:0
  ds_read_b64_tr_b16 v[146:147], v6 offset:512
  v_mfma_f32_16x16x32_bf16 v[100:103], v[156:159], a[28:31], v[100:103]
  v_mfma_f32_16x16x32_bf16 v[104:107], v[160:163], a[28:31], v[104:107]
  v_xor_b32 v2, 0x10000, v2
  ds_read_b64_tr_b16 v[148:149], v2 offset:0
  ds_read_b64_tr_b16 v[150:151], v2 offset:512
  v_mfma_f32_16x16x32_bf16 v[96:99], v[160:163], a[24:27], v[96:99]
  s_waitcnt lgkmcnt(8)
  v_mfma_f32_16x16x32_bf16 v[124:127], v[164:167], a[24:27], v[124:127]
  v_mfma_f32_16x16x32_bf16 v[132:135], v[164:167], a[28:31], v[132:135]
  s_waitcnt lgkmcnt(6)
  v_mfma_f32_16x16x32_bf16 v[136:139], v[168:171], a[28:31], v[136:139]
  ds_read_b64_tr_b16 v[156:157], v5 offset:4096
  ds_read_b64_tr_b16 v[158:159], v5 offset:4608
  v_mfma_f32_16x16x32_bf16 v[128:131], v[168:171], a[24:27], v[128:131]
  s_waitcnt lgkmcnt(6)
  v_mfma_f32_16x16x32_bf16 v[172:175], v[140:143], a[0:3], v[172:175]
  ds_read_b64_tr_b16 v[160:161], v6 offset:4096
  ds_read_b64_tr_b16 v[162:163], v6 offset:4608
  v_mfma_f32_16x16x32_bf16 v[176:179], v[140:143], a[4:7], v[176:179]
  s_waitcnt lgkmcnt(6)
  v_mfma_f32_16x16x32_bf16 v[184:187], v[144:147], a[4:7], v[184:187]
  ds_read_b64_tr_b16 v[164:165], v2 offset:4096
  ds_read_b64_tr_b16 v[166:167], v2 offset:4608
  v_mfma_f32_16x16x32_bf16 v[180:183], v[144:147], a[0:3], v[180:183]
  s_waitcnt lgkmcnt(6)
  v_mfma_f32_16x16x32_bf16 v[12:15], v[148:151], a[0:3], v[12:15]
  v_mfma_f32_16x16x32_bf16 v[16:19], v[148:151], a[4:7], v[16:19]
  ds_read_b64_tr_b16 v[140:141], v5 offset:8192
  ds_read_b64_tr_b16 v[142:143], v5 offset:8704
  s_waitcnt lgkmcnt(6)
  v_mfma_f32_16x16x32_bf16 v[172:175], v[156:159], a[8:11], v[172:175]
  ds_read_b64_tr_b16 v[144:145], v6 offset:8192
  ds_read_b64_tr_b16 v[146:147], v6 offset:8704
  v_mfma_f32_16x16x32_bf16 v[176:179], v[156:159], a[12:15], v[176:179]
  s_waitcnt lgkmcnt(6)
  v_mfma_f32_16x16x32_bf16 v[184:187], v[160:163], a[12:15], v[184:187]
  ds_read_b64_tr_b16 v[148:149], v2 offset:8192
  ds_read_b64_tr_b16 v[150:151], v2 offset:8704
  v_mfma_f32_16x16x32_bf16 v[180:183], v[160:163], a[8:11], v[180:183]
  s_waitcnt lgkmcnt(6)
  v_mfma_f32_16x16x32_bf16 v[12:15], v[164:167], a[8:11], v[12:15]
  v_mfma_f32_16x16x32_bf16 v[16:19], v[164:167], a[12:15], v[16:19]
  ds_read_b64_tr_b16 v[156:157], v5 offset:12288
  ds_read_b64_tr_b16 v[158:159], v5 offset:12800
  s_barrier
  s_waitcnt lgkmcnt(6)
  v_mfma_f32_16x16x32_bf16 v[172:175], v[140:143], a[16:19], v[172:175]
  ds_read_b64_tr_b16 v[160:161], v6 offset:12288
  ds_read_b64_tr_b16 v[162:163], v6 offset:12800
  v_mfma_f32_16x16x32_bf16 v[176:179], v[140:143], a[20:23], v[176:179]
  s_waitcnt lgkmcnt(6)
  v_mfma_f32_16x16x32_bf16 v[184:187], v[144:147], a[20:23], v[184:187]
  ds_read_b64_tr_b16 v[164:165], v2 offset:12288
  ds_read_b64_tr_b16 v[166:167], v2 offset:12800
  v_mfma_f32_16x16x32_bf16 v[180:183], v[144:147], a[16:19], v[180:183]
  s_waitcnt lgkmcnt(6)
  v_mfma_f32_16x16x32_bf16 v[12:15], v[148:151], a[16:19], v[12:15]
  v_mfma_f32_16x16x32_bf16 v[16:19], v[148:151], a[20:23], v[16:19]
  ds_read_b64_tr_b16 v[140:141], v5 offset:16384
  ds_read_b64_tr_b16 v[142:143], v5 offset:16896
  s_waitcnt lgkmcnt(6)
  v_mfma_f32_16x16x32_bf16 v[172:175], v[156:159], a[24:27], v[172:175]
  ds_read_b64_tr_b16 v[144:145], v6 offset:16384
  ds_read_b64_tr_b16 v[146:147], v6 offset:16896
  v_mfma_f32_16x16x32_bf16 v[176:179], v[156:159], a[28:31], v[176:179]
  s_waitcnt lgkmcnt(6)
  v_mfma_f32_16x16x32_bf16 v[184:187], v[160:163], a[28:31], v[184:187]
  ds_read_b64_tr_b16 v[148:149], v2 offset:16384
  ds_read_b64_tr_b16 v[150:151], v2 offset:16896
  v_mfma_f32_16x16x32_bf16 v[180:183], v[160:163], a[24:27], v[180:183]
  v_mov_b32 v10, 0
  buffer_load_dword v9, v10, s[28:31], s64 offen sc1
  s_waitcnt lgkmcnt(6)
  v_mfma_f32_16x16x32_bf16 v[12:15], v[164:167], a[24:27], v[12:15]
  v_xor_b32 v3, 0x10000, v3
  ds_read_b64_tr_b16 v[152:153], v3 offset:16384
  ds_read_b64_tr_b16 v[154:155], v3 offset:16896
  v_mfma_f32_16x16x32_bf16 v[16:19], v[164:167], a[28:31], v[16:19]
  ds_read_b64_tr_b16 v[156:157], v5 offset:20480
  ds_read_b64_tr_b16 v[158:159], v5 offset:20992
  s_waitcnt vmcnt(2)
  s_waitcnt lgkmcnt(8)
  v_mfma_f32_16x16x32_bf16 v[28:31], v[140:143], a[32:35], v[28:31]
  ds_read_b64_tr_b16 v[160:161], v6 offset:20480
  ds_read_b64_tr_b16 v[162:163], v6 offset:20992
  v_mfma_f32_16x16x32_bf16 v[36:39], v[140:143], a[36:39], v[36:39]
  s_waitcnt lgkmcnt(8)
  v_mfma_f32_16x16x32_bf16 v[40:43], v[144:147], a[36:39], v[40:43]
  ds_read_b64_tr_b16 v[164:165], v2 offset:20480
  ds_read_b64_tr_b16 v[166:167], v2 offset:20992
  v_mfma_f32_16x16x32_bf16 v[32:35], v[144:147], a[32:35], v[32:35]
  s_waitcnt lgkmcnt(8)
  v_mfma_f32_16x16x32_bf16 v[60:63], v[148:151], a[32:35], v[60:63]
  ds_read_b64_tr_b16 v[168:169], v3 offset:20480
  ds_read_b64_tr_b16 v[170:171], v3 offset:20992
  v_mfma_f32_16x16x32_bf16 v[68:71], v[148:151], a[36:39], v[68:71]
  v_accvgpr_write_b32 a0, 0
  v_accvgpr_write_b32 a1, 0
  v_accvgpr_write_b32 a2, 0
  s_waitcnt lgkmcnt(8)
  v_mfma_f32_16x16x32_bf16 v[72:75], v[152:155], a[36:39], v[72:75]
  ds_read_b64_tr_b16 v[140:141], v5 offset:24576
  ds_read_b64_tr_b16 v[142:143], v5 offset:25088
  v_mfma_f32_16x16x32_bf16 v[64:67], v[152:155], a[32:35], v[64:67]
  v_accvgpr_write_b32 a3, 0
  v_accvgpr_write_b32 a4, 0
  v_accvgpr_write_b32 a5, 0
  s_waitcnt lgkmcnt(8)
  v_mfma_f32_16x16x32_bf16 v[28:31], v[156:159], a[40:43], v[28:31]
  ds_read_b64_tr_b16 v[144:145], v6 offset:24576
  ds_read_b64_tr_b16 v[146:147], v6 offset:25088
  v_mfma_f32_16x16x32_bf16 v[36:39], v[156:159], a[44:47], v[36:39]
  v_accvgpr_write_b32 a6, 0
  v_accvgpr_write_b32 a7, 0
  v_accvgpr_write_b32 a8, 0
  s_waitcnt lgkmcnt(8)
  v_mfma_f32_16x16x32_bf16 v[40:43], v[160:163], a[44:47], v[40:43]
  ds_read_b64_tr_b16 v[148:149], v2 offset:24576
  ds_read_b64_tr_b16 v[150:151], v2 offset:25088
  v_mfma_f32_16x16x32_bf16 v[32:35], v[160:163], a[40:43], v[32:35]
  v_accvgpr_write_b32 a9, 0
  v_accvgpr_write_b32 a10, 0
  v_accvgpr_write_b32 a11, 0
  s_waitcnt lgkmcnt(8)
  v_mfma_f32_16x16x32_bf16 v[60:63], v[164:167], a[40:43], v[60:63]
  ds_read_b64_tr_b16 v[152:153], v3 offset:24576
  ds_read_b64_tr_b16 v[154:155], v3 offset:25088
  v_mfma_f32_16x16x32_bf16 v[68:71], v[164:167], a[44:47], v[68:71]
  v_accvgpr_write_b32 a12, 0
  v_accvgpr_write_b32 a13, 0
  v_accvgpr_write_b32 a14, 0
  s_waitcnt lgkmcnt(8)
  v_mfma_f32_16x16x32_bf16 v[72:75], v[168:171], a[44:47], v[72:75]
  ds_read_b64_tr_b16 v[156:157], v5 offset:28672
  ds_read_b64_tr_b16 v[158:159], v5 offset:29184
  v_mfma_f32_16x16x32_bf16 v[64:67], v[168:171], a[40:43], v[64:67]
  s_barrier
  v_accvgpr_write_b32 a15, 0
  v_accvgpr_write_b32 a16, 0
  v_accvgpr_write_b32 a17, 0
  s_waitcnt lgkmcnt(8)
  v_mfma_f32_16x16x32_bf16 v[28:31], v[140:143], a[48:51], v[28:31]
  ds_read_b64_tr_b16 v[160:161], v6 offset:28672
  ds_read_b64_tr_b16 v[162:163], v6 offset:29184
  v_mfma_f32_16x16x32_bf16 v[36:39], v[140:143], a[52:55], v[36:39]
  v_accvgpr_write_b32 a18, 0
  v_accvgpr_write_b32 a19, 0
  v_accvgpr_write_b32 a20, 0
  s_waitcnt lgkmcnt(8)
  v_mfma_f32_16x16x32_bf16 v[40:43], v[144:147], a[52:55], v[40:43]
  ds_read_b64_tr_b16 v[164:165], v2 offset:28672
  ds_read_b64_tr_b16 v[166:167], v2 offset:29184
  v_mfma_f32_16x16x32_bf16 v[32:35], v[144:147], a[48:51], v[32:35]
  v_accvgpr_write_b32 a21, 0
  v_accvgpr_write_b32 a22, 0
  v_accvgpr_write_b32 a23, 0
  s_waitcnt lgkmcnt(8)
  v_mfma_f32_16x16x32_bf16 v[60:63], v[148:151], a[48:51], v[60:63]
  ds_read_b64_tr_b16 v[168:169], v3 offset:28672
  ds_read_b64_tr_b16 v[170:171], v3 offset:29184
  v_mfma_f32_16x16x32_bf16 v[68:71], v[148:151], a[52:55], v[68:71]
  v_accvgpr_write_b32 a24, 0
  v_accvgpr_write_b32 a25, 0
  v_accvgpr_write_b32 a26, 0
  s_waitcnt lgkmcnt(8)
  v_mfma_f32_16x16x32_bf16 v[72:75], v[152:155], a[52:55], v[72:75]
  ds_read_b64_tr_b16 v[140:141], v5 offset:32768
  ds_read_b64_tr_b16 v[142:143], v5 offset:33280
  v_mfma_f32_16x16x32_bf16 v[64:67], v[152:155], a[48:51], v[64:67]
  v_accvgpr_write_b32 a27, 0
  v_accvgpr_write_b32 a28, 0
  v_accvgpr_write_b32 a29, 0
  s_waitcnt lgkmcnt(8)
  v_mfma_f32_16x16x32_bf16 v[28:31], v[156:159], a[56:59], v[28:31]
  ds_read_b64_tr_b16 v[144:145], v6 offset:32768
  ds_read_b64_tr_b16 v[146:147], v6 offset:33280
  v_mfma_f32_16x16x32_bf16 v[36:39], v[156:159], a[60:63], v[36:39]
  v_accvgpr_write_b32 a30, 0
  v_accvgpr_write_b32 a31, 0
  s_waitcnt lgkmcnt(8)
  v_mfma_f32_16x16x32_bf16 v[40:43], v[160:163], a[60:63], v[40:43]
  ds_read_b64_tr_b16 v[148:149], v2 offset:32768
  ds_read_b64_tr_b16 v[150:151], v2 offset:33280
  v_mfma_f32_16x16x32_bf16 v[32:35], v[160:163], a[56:59], v[32:35]
  s_waitcnt lgkmcnt(8)
  v_mfma_f32_16x16x32_bf16 v[60:63], v[164:167], a[56:59], v[60:63]
  ds_read_b64_tr_b16 v[152:153], v3 offset:32768
  ds_read_b64_tr_b16 v[154:155], v3 offset:33280
  v_mfma_f32_16x16x32_bf16 v[68:71], v[164:167], a[60:63], v[68:71]
  s_waitcnt vmcnt(0)
  s_cmp_lg_u32 s93, 0
  s_cbranch_scc1 L_attn_spun_7
  v_cmp_ne_u32 vcc, 16, v9
  s_cbranch_vccnz L_attn_spin_6
L_attn_spun_7:
  s_cmp_lg_u32 s93, 0
  s_cbranch_scc1 L_attn_noinv_8
  s_cmp_eq_u32 s43, 1
  s_cbranch_scc1 L_attn_noinv_8
  buffer_inv sc1
L_attn_noinv_8:
  s_waitcnt lgkmcnt(8)
  v_mfma_f32_16x16x32_bf16 v[72:75], v[168:171], a[60:63], v[72:75]
  ds_read_b64_tr_b16 v[156:157], v5 offset:36864
  ds_read_b64_tr_b16 v[158:159], v5 offset:37376
  v_mfma_f32_16x16x32_bf16 v[64:67], v[168:171], a[56:59], v[64:67]
  s_waitcnt lgkmcnt(8)
  v_mfma_f32_16x16x32_bf16 v[92:95], v[140:143], a[32:35], v[92:95]
  ds_read_b64_tr_b16 v[160:161], v6 offset:36864
  ds_read_b64_tr_b16 v[162:163], v6 offset:37376
  v_mfma_f32_16x16x32_bf16 v[100:103], v[140:143], a[36:39], v[100:103]
  s_waitcnt lgkmcnt(8)
  v_mfma_f32_16x16x32_bf16 v[104:107], v[144:147], a[36:39], v[104:107]
  ds_read_b64_tr_b16 v[164:165], v2 offset:36864
  ds_read_b64_tr_b16 v[166:167], v2 offset:37376
  v_mfma_f32_16x16x32_bf16 v[96:99], v[144:147], a[32:35], v[96:99]
  s_waitcnt lgkmcnt(8)
  v_mfma_f32_16x16x32_bf16 v[124:127], v[148:151], a[32:35], v[124:127]
  ds_read_b64_tr_b16 v[168:169], v3 offset:36864
  ds_read_b64_tr_b16 v[170:171], v3 offset:37376
  v_mfma_f32_16x16x32_bf16 v[132:135], v[148:151], a[36:39], v[132:135]
  v_mul_f32 v28, 0x3e0293ee, v28
  v_mul_f32 v29, 0x3e0293ee, v29
  v_cvt_pk_bf16_f32 v28, v28, v29
  v_mul_f32 v30, 0x3e0293ee, v30
  s_waitcnt lgkmcnt(8)
  v_mfma_f32_16x16x32_bf16 v[136:139], v[152:155], a[36:39], v[136:139]
  ds_read_b64_tr_b16 v[140:141], v5 offset:40960
  ds_read_b64_tr_b16 v[142:143], v5 offset:41472
  v_mfma_f32_16x16x32_bf16 v[128:131], v[152:155], a[32:35], v[128:131]
  v_mul_f32 v31, 0x3e0293ee, v31
  v_cvt_pk_bf16_f32 v29, v30, v31
  v_mul_f32 v32, 0x3e0293ee, v32
  v_mul_f32 v33, 0x3e0293ee, v33
  s_waitcnt lgkmcnt(8)
  v_mfma_f32_16x16x32_bf16 v[92:95], v[156:159], a[40:43], v[92:95]
  ds_read_b64_tr_b16 v[144:145], v6 offset:40960
  ds_read_b64_tr_b16 v[146:147], v6 offset:41472
  v_mfma_f32_16x16x32_bf16 v[100:103], v[156:159], a[44:47], v[100:103]
  v_cvt_pk_bf16_f32 v30, v32, v33
  v_mul_f32 v34, 0x3e0293ee, v34
  v_mul_f32 v35, 0x3e0293ee, v35
  v_cvt_pk_bf16_f32 v31, v34, v35
  s_waitcnt lgkmcnt(8)
  v_mfma_f32_16x16x32_bf16 v[104:107], v[160:163], a[44:47], v[104:107]
  ds_read_b64_tr_b16 v[148:149], v2 offset:40960
  ds_read_b64_tr_b16 v[150:151], v2 offset:41472
  v_mfma_f32_16x16x32_bf16 v[96:99], v[160:163], a[40:43], v[96:99]
  v_mul_f32 v36, 0x3e0293ee, v36
  v_mul_f32 v37, 0x3e0293ee, v37
  v_cvt_pk_bf16_f32 v32, v36, v37
  v_mul_f32 v38, 0x3e0293ee, v38
  s_waitcnt lgkmcnt(8)
  v_mfma_f32_16x16x32_bf16 v[124:127], v[164:167], a[40:43], v[124:127]
  ds_read_b64_tr_b16 v[152:153], v3 offset:40960
  ds_read_b64_tr_b16 v[154:155], v3 offset:41472
  v_mfma_f32_16x16x32_bf16 v[132:135], v[164:167], a[44:47], v[132:135]
  v_mul_f32 v39, 0x3e0293ee, v39
  v_cvt_pk_bf16_f32 v33, v38, v39
  v_mul_f32 v40, 0x3e0293ee, v40
  v_mul_f32 v41, 0x3e0293ee, v41
  s_waitcnt lgkmcnt(8)
  v_mfma_f32_16x16x32_bf16 v[136:139], v[168:171], a[44:47], v[136:139]
  ds_read_b64_tr_b16 v[156:157], v5 offset:45056
  ds_read_b64_tr_b16 v[158:159], v5 offset:45568
  v_mfma_f32_16x16x32_bf16 v[128:131], v[168:171], a[40:43], v[128:131]
  s_cmp_lg_u32 s93, 0
  s_cbranch_scc1 L_attn_noacq_9
  s_cmp_eq_u32 s43, 1
  s_cbranch_scc1 L_attn_noacq_9
  s_waitcnt vmcnt(0)
L_attn_noacq_9:
  s_barrier
  s_lshl_b32 s62, s70, 19
  s_add_u32 s63, s62, 0x2000000
  s_add_u32 s8, s60, s63
  s_addc_u32 s9, s61, 0
  s_mov_b32 s10, 0x80000
  v_cvt_pk_bf16_f32 v34, v40, v41
  v_mul_f32 v42, 0x3e0293ee, v42
  v_mul_f32 v43, 0x3e0293ee, v43
  v_cvt_pk_bf16_f32 v35, v42, v43
  s_waitcnt lgkmcnt(8)
  v_mfma_f32_16x16x32_bf16 v[92:95], v[140:143], a[48:51], v[92:95]
  ds_read_b64_tr_b16 v[160:161], v6 offset:45056
  ds_read_b64_tr_b16 v[162:163], v6 offset:45568
  v_mfma_f32_16x16x32_bf16 v[100:103], v[140:143], a[52:55], v[100:103]
  s_add_u32 s63, s62, 0x3000000
  s_add_u32 s96, s60, s63
  s_addc_u32 s97, s61, 0
  s_mov_b32 s98, 0x80000
  s_mov_b32 s99, 0x00020000
  v_mul_f32 v60, 0x3e0293ee, v60
  v_mul_f32 v61, 0x3e0293ee, v61
  v_cvt_pk_bf16_f32 v60, v60, v61
  v_mul_f32 v62, 0x3e0293ee, v62
  s_waitcnt lgkmcnt(8)
  v_mfma_f32_16x16x32_bf16 v[104:107], v[144:147], a[52:55], v[104:107]
  ds_read_b64_tr_b16 v[164:165], v2 offset:45056
  ds_read_b64_tr_b16 v[166:167], v2 offset:45568
  v_mfma_f32_16x16x32_bf16 v[96:99], v[144:147], a[48:51], v[96:99]
  s_add_u32 m0, s32, 98304
  s_add_u32 s62, s32, 0
  buffer_load_dwordx4 v11, s[8:11], s62 offen lds
  buffer_load_dwordx4 v11, s[8:11], s62 offen offset:1024 lds
  v_mul_f32 v63, 0x3e0293ee, v63
  v_cvt_pk_bf16_f32 v61, v62, v63
  v_mul_f32 v64, 0x3e0293ee, v64
  v_mul_f32 v65, 0x3e0293ee, v65
  s_waitcnt lgkmcnt(8)
  v_mfma_f32_16x16x32_bf16 v[124:127], v[148:151], a[48:51], v[124:127]
  ds_read_b64_tr_b16 v[168:169], v3 offset:45056
  ds_read_b64_tr_b16 v[170:171], v3 offset:45568
  v_mfma_f32_16x16x32_bf16 v[132:135], v[148:151], a[52:55], v[132:135]
  s_add_u32 m0, s32, 114688
  s_add_u32 s62, s32, 16384
  buffer_load_dwordx4 v11, s[8:11], s62 offen lds
  buffer_load_dwordx4 v11, s[8:11], s62 offen offset:1024 lds
  v_cvt_pk_bf16_f32 v62, v64, v65
  v_mul_f32 v66, 0x3e0293ee, v66
  v_mul_f32 v67, 0x3e0293ee, v67
  v_cvt_pk_bf16_f32 v63, v66, v67
  s_waitcnt lgkmcnt(8)
  v_mfma_f32_16x16x32_bf16 v[136:139], v[152:155], a[52:55], v[136:139]
  ds_read_b64_tr_b16 v[140:141], v5 offset:49152
  ds_read_b64_tr_b16 v[142:143], v5 offset:49664
  v_mfma_f32_16x16x32_bf16 v[128:131], v[152:155], a[48:51], v[128:131]
  s_add_u32 m0, s32, 131072
  s_add_u32 s62, s32, 0
  buffer_load_dwordx4 v11, s[96:99], s62 offen lds
  buffer_load_dwordx4 v11, s[96:99], s62 offen offset:1024 lds
  v_mul_f32 v68, 0x3e0293ee, v68
  v_mul_f32 v69, 0x3e0293ee, v69
  v_cvt_pk_bf16_f32 v64, v68, v69
  v_mul_f32 v70, 0x3e0293ee, v70
  s_waitcnt lgkmcnt(8)
  v_mfma_f32_16x16x32_bf16 v[92:95], v[156:159], a[56:59], v[92:95]
  ds_read_b64_tr_b16 v[144:145], v6 offset:49152
  ds_read_b64_tr_b16 v[146:147], v6 offset:49664
  v_mfma_f32_16x16x32_bf16 v[100:103], v[156:159], a[60:63], v[100:103]
  s_add_u32 m0, s32, 147456
  s_add_u32 s62, s32, 16384
  buffer_load_dwordx4 v11, s[96:99], s62 offen lds
  buffer_load_dwordx4 v11, s[96:99], s62 offen offset:1024 lds
  v_mul_f32 v71, 0x3e0293ee, v71
  v_cvt_pk_bf16_f32 v65, v70, v71
  v_mul_f32 v72, 0x3e0293ee, v72
  v_mul_f32 v73, 0x3e0293ee, v73
  s_waitcnt lgkmcnt(8)
  v_mfma_f32_16x16x32_bf16 v[104:107], v[160:163], a[60:63], v[104:107]
  ds_read_b64_tr_b16 v[148:149], v2 offset:49152
  ds_read_b64_tr_b16 v[150:151], v2 offset:49664
  v_mfma_f32_16x16x32_bf16 v[96:99], v[160:163], a[56:59], v[96:99]
  s_add_u32 m0, s32, 65536
  s_add_u32 s62, s32, 32768
  buffer_load_dwordx4 v11, s[8:11], s62 offen lds
  buffer_load_dwordx4 v11, s[8:11], s62 offen offset:1024 lds
  v_cvt_pk_bf16_f32 v66, v72, v73
  v_mul_f32 v74, 0x3e0293ee, v74
  v_mul_f32 v75, 0x3e0293ee, v75
  v_cvt_pk_bf16_f32 v67, v74, v75
  s_waitcnt lgkmcnt(8)
  v_mfma_f32_16x16x32_bf16 v[124:127], v[164:167], a[56:59], v[124:127]
  v_mfma_f32_16x16x32_bf16 v[132:135], v[164:167], a[60:63], v[132:135]
  s_add_u32 m0, s32, 81920
  s_add_u32 s62, s32, 49152
  buffer_load_dwordx4 v11, s[8:11], s62 offen lds
  buffer_load_dwordx4 v11, s[8:11], s62 offen offset:1024 lds
  s_waitcnt lgkmcnt(6)
  v_mfma_f32_16x16x32_bf16 v[136:139], v[168:171], a[60:63], v[136:139]
  ds_read_b64_tr_b16 v[156:157], v5 offset:53248
  ds_read_b64_tr_b16 v[158:159], v5 offset:53760
  v_mfma_f32_16x16x32_bf16 v[128:131], v[168:171], a[56:59], v[128:131]
  s_waitcnt lgkmcnt(6)
  v_mfma_f32_16x16x32_bf16 v[172:175], v[140:143], a[32:35], v[172:175]
  ds_read_b64_tr_b16 v[160:161], v6 offset:53248
  ds_read_b64_tr_b16 v[162:163], v6 offset:53760
  v_mfma_f32_16x16x32_bf16 v[176:179], v[140:143], a[36:39], v[176:179]
  s_waitcnt lgkmcnt(6)
  v_mfma_f32_16x16x32_bf16 v[184:187], v[144:147], a[36:39], v[184:187]
  ds_read_b64_tr_b16 v[164:165], v2 offset:53248
  ds_read_b64_tr_b16 v[166:167], v2 offset:53760
  v_mfma_f32_16x16x32_bf16 v[180:183], v[144:147], a[32:35], v[180:183]
  s_nop 1
  s_waitcnt lgkmcnt(6)
  v_mfma_f32_16x16x32_bf16 v[12:15], v[148:151], a[32:35], v[12:15]
  v_mfma_f32_16x16x32_bf16 v[16:19], v[148:151], a[36:39], v[16:19]
  v_mul_f32 v92, 0x3e0293ee, v92
  v_mul_f32 v93, 0x3e0293ee, v93
  v_cvt_pk_bf16_f32 v92, v92, v93
  v_mul_f32 v94, 0x3e0293ee, v94
  ds_read_b64_tr_b16 v[140:141], v5 offset:57344
  ds_read_b64_tr_b16 v[142:143], v5 offset:57856
  v_mul_f32 v95, 0x3e0293ee, v95
  v_cvt_pk_bf16_f32 v93, v94, v95
  v_mul_f32 v96, 0x3e0293ee, v96
  v_mul_f32 v97, 0x3e0293ee, v97
  s_waitcnt lgkmcnt(6)
  v_mfma_f32_16x16x32_bf16 v[172:175], v[156:159], a[40:43], v[172:175]
  ds_read_b64_tr_b16 v[144:145], v6 offset:57344
  ds_read_b64_tr_b16 v[146:147], v6 offset:57856
  v_mfma_f32_16x16x32_bf16 v[176:179], v[156:159], a[44:47], v[176:179]
  v_cvt_pk_bf16_f32 v94, v96, v97
  v_mul_f32 v98, 0x3e0293ee, v98
  v_mul_f32 v99, 0x3e0293ee, v99
  v_cvt_pk_bf16_f32 v95, v98, v99
  s_waitcnt lgkmcnt(6)
  v_mfma_f32_16x16x32_bf16 v[184:187], v[160:163], a[44:47], v[184:187]
  ds_read_b64_tr_b16 v[148:149], v2 offset:57344
  ds_read_b64_tr_b16 v[150:151], v2 offset:57856
  v_mfma_f32_16x16x32_bf16 v[180:183], v[160:163], a[40:43], v[180:183]
  v_mul_f32 v100, 0x3e0293ee, v100
  v_mul_f32 v101, 0x3e0293ee, v101
  v_cvt_pk_bf16_f32 v96, v100, v101
  v_mul_f32 v102, 0x3e0293ee, v102
  s_waitcnt lgkmcnt(6)
  v_mfma_f32_16x16x32_bf16 v[12:15], v[164:167], a[40:43], v[12:15]
  v_mfma_f32_16x16x32_bf16 v[16:19], v[164:167], a[44:47], v[16:19]
  v_mul_f32 v103, 0x3e0293ee, v103
  v_cvt_pk_bf16_f32 v97, v102, v103
  v_mul_f32 v104, 0x3e0293ee, v104
  v_mul_f32 v105, 0x3e0293ee, v105
  ds_read_b64_tr_b16 v[156:157], v5 offset:61440
  ds_read_b64_tr_b16 v[158:159], v5 offset:61952
  v_cvt_pk_bf16_f32 v98, v104, v105
  v_mul_f32 v106, 0x3e0293ee, v106
  v_mul_f32 v107, 0x3e0293ee, v107
  v_cvt_pk_bf16_f32 v99, v106, v107
  s_waitcnt lgkmcnt(6)
  v_mfma_f32_16x16x32_bf16 v[172:175], v[140:143], a[48:51], v[172:175]
  ds_read_b64_tr_b16 v[160:161], v6 offset:61440
  ds_read_b64_tr_b16 v[162:163], v6 offset:61952
  v_mfma_f32_16x16x32_bf16 v[176:179], v[140:143], a[52:55], v[176:179]
  v_mul_f32 v124, 0x3e0293ee, v124
  v_mul_f32 v125, 0x3e0293ee, v125
  v_cvt_pk_bf16_f32 v124, v124, v125
  v_mul_f32 v126, 0x3e0293ee, v126
  s_waitcnt lgkmcnt(6)
  v_mfma_f32_16x16x32_bf16 v[184:187], v[144:147], a[52:55], v[184:187]
  ds_read_b64_tr_b16 v[164:165], v2 offset:61440
  ds_read_b64_tr_b16 v[166:167], v2 offset:61952
  v_mfma_f32_16x16x32_bf16 v[180:183], v[144:147], a[48:51], v[180:183]
  v_mul_f32 v127, 0x3e0293ee, v127
  v_cvt_pk_bf16_f32 v125, v126, v127
  v_mul_f32 v128, 0x3e0293ee, v128
  v_mul_f32 v129, 0x3e0293ee, v129
  s_waitcnt lgkmcnt(6)
  v_mfma_f32_16x16x32_bf16 v[12:15], v[148:151], a[48:51], v[12:15]
  v_mfma_f32_16x16x32_bf16 v[16:19], v[148:151], a[52:55], v[16:19]
  v_cvt_pk_bf16_f32 v126, v128, v129
  v_mul_f32 v130, 0x3e0293ee, v130
  v_mul_f32 v131, 0x3e0293ee, v131
  v_cvt_pk_bf16_f32 v127, v130, v131
  v_mul_f32 v132, 0x3e0293ee, v132
  v_mul_f32 v133, 0x3e0293ee, v133
  v_cvt_pk_bf16_f32 v128, v132, v133
  v_mul_f32 v134, 0x3e0293ee, v134
  s_waitcnt lgkmcnt(4)
  v_mfma_f32_16x16x32_bf16 v[172:175], v[156:159], a[56:59], v[172:175]
  v_mfma_f32_16x16x32_bf16 v[176:179], v[156:159], a[60:63], v[176:179]
  v_mul_f32 v135, 0x3e0293ee, v135
  v_cvt_pk_bf16_f32 v129, v134, v135
  v_mul_f32 v136, 0x3e0293ee, v136
  v_mul_f32 v137, 0x3e0293ee, v137
  s_waitcnt lgkmcnt(2)
  v_mfma_f32_16x16x32_bf16 v[184:187], v[160:163], a[60:63], v[184:187]
  v_mfma_f32_16x16x32_bf16 v[180:183], v[160:163], a[56:59], v[180:183]
  v_cvt_pk_bf16_f32 v130, v136, v137
  v_mul_f32 v138, 0x3e0293ee, v138
  v_mul_f32 v139, 0x3e0293ee, v139
  v_cvt_pk_bf16_f32 v131, v138, v139
  s_waitcnt lgkmcnt(0)
  v_mfma_f32_16x16x32_bf16 v[12:15], v[164:167], a[56:59], v[12:15]
  v_mfma_f32_16x16x32_bf16 v[16:19], v[164:167], a[60:63], v[16:19]
  s_nop 1
  s_nop 7
  v_max_f32 v172, 0, v172
  v_max_f32 v173, 0, v173
  v_cvt_pk_bf16_f32 v172, v172, v173
  v_max_f32 v174, 0, v174
  v_max_f32 v175, 0, v175
  v_cvt_pk_bf16_f32 v173, v174, v175
  v_max_f32 v176, 0, v176
  v_max_f32 v177, 0, v177
  v_cvt_pk_bf16_f32 v174, v176, v177
  v_max_f32 v178, 0, v178
  v_max_f32 v179, 0, v179
  v_cvt_pk_bf16_f32 v175, v178, v179
  v_max_f32 v180, 0, v180
  v_max_f32 v181, 0, v181
  v_cvt_pk_bf16_f32 v176, v180, v181
  v_max_f32 v182, 0, v182
  v_max_f32 v183, 0, v183
  v_cvt_pk_bf16_f32 v177, v182, v183
  v_max_f32 v184, 0, v184
  v_max_f32 v185, 0, v185
  v_cvt_pk_bf16_f32 v178, v184, v185
  v_max_f32 v186, 0, v186
  v_max_f32 v187, 0, v187
  v_cvt_pk_bf16_f32 v179, v186, v187
  v_max_f32 v12, 0, v12
  v_max_f32 v13, 0, v13
  v_cvt_pk_bf16_f32 v12, v12, v13
  v_max_f32 v14, 0, v14
  v_max_f32 v15, 0, v15
  v_cvt_pk_bf16_f32 v13, v14, v15
  v_max_f32 v16, 0, v16
  v_max_f32 v17, 0, v17
  v_cvt_pk_bf16_f32 v14, v16, v17
  v_max_f32 v18, 0, v18
  v_max_f32 v19, 0, v19
  v_cvt_pk_bf16_f32 v15, v18, v19
  s_nop 1
  v_permlane16_swap_b32 v172, v174
  v_permlane16_swap_b32 v173, v175
  v_permlane16_swap_b32 v176, v178
  v_permlane16_swap_b32 v177, v179
  v_permlane16_swap_b32 v12, v14
  v_permlane16_swap_b32 v13, v15
  s_waitcnt vmcnt(0)
  buffer_store_dwordx4 v[172:175], v11, s[12:15], s37 offen offset:0 sc1
  buffer_store_dwordx4 v[176:179], v11, s[12:15], s37 offen offset:1024 sc1
  buffer_store_dwordx4 v[12:15], v11, s[12:15], s38 offen offset:0 sc1
  s_waitcnt lgkmcnt(0)
  s_branch L_qh_end
L_attn_spin_6:
  s_mov_b32 s42, 0x40000
L_attn_spin_6_l:
  s_sleep 2
  buffer_load_dword v9, v10, s[28:31], s64 offen sc1
  s_waitcnt vmcnt(0)
  v_cmp_ne_u32 vcc, 16, v9
  s_cbranch_vccz L_attn_spun_7
  s_sub_u32 s42, s42, 1
  s_cbranch_scc0 L_attn_spin_6_l
  s_branch L_attn_spun_7
L_qh_end:
  s_lshl_b32 s62, s93, 6
  v_add_u32 v0, s62, v1
  s_barrier
  s_mov_b32 s59, s43
  s_and_b32 s62, s2, 7
  s_lshr_b32 s63, s2, 3
  s_lshl_b32 s27, s62, 2
  s_lshr_b32 s62, s63, 3
  s_add_u32 s27, s27, s62
  s_and_b32 s63, s63, 7
  v_and_b32 v1, 63, v0
  v_lshrrev_b32 v2, 6, v0
  v_lshlrev_b32 v9, 4, v1
  v_readfirstlane_b32 s24, v2
  s_sub_u32 s28, 15, s63
  s_lshl_b32 s37, s27, 19
  s_add_u32 s38, s37, 0x2004000
  s_and_b32 s25, s24, 3
  s_lshr_b32 s26, s24, 2
  s_add_u32 s8, s60, s38
  s_addc_u32 s9, s61, 0
  s_mov_b32 s10, 0x7c000
  s_mov_b32 s11, 0x00020000
  s_add_u32 s38, s37, 0x3000000
  s_add_u32 s12, s60, s38
  s_addc_u32 s13, s61, 0
  s_mov_b32 s14, 0x80000
  s_mov_b32 s15, 0x00020000
  s_lshl_b32 s41, s25, 11
  s_add_u32 s40, s41, 0x20000
  s_add_u32 s34, s41, 0x18000
  s_add_u32 s35, s41, 0x10000
  v_add_u32 v8, s41, v9
  v_add_u32 v7, 0x20000, v9
  v_add_u32 v6, 0x18000, v9
  ds_read_b128 v[88:91], v6 offset:0
  ds_read_b128 v[168:171], v6 offset:1024
  ds_read_b128 v[172:175], v6 offset:2048
  ds_read_b128 v[100:103], v6 offset:3072
  ds_read_b128 v[104:107], v6 offset:4096
  ds_read_b128 v[108:111], v6 offset:5120
  ds_read_b128 v[112:115], v6 offset:6144
  ds_read_b128 v[116:119], v6 offset:7168
  s_cmp_lg_u32 s26, 0
  s_cbranch_scc1 L_attn_nostart_10
  s_mov_b32 s30, 16384
  s_add_u32 m0, s35, 0
  s_nop 0
  buffer_load_dwordx4 v8, s[8:11], s30 offen offset:0 lds
  buffer_load_dwordx4 v8, s[8:11], s30 offen offset:1024 lds
  s_mov_b32 s30, 24576
  s_add_u32 m0, s35, 8192
  s_nop 0
  buffer_load_dwordx4 v8, s[8:11], s30 offen offset:0 lds
  buffer_load_dwordx4 v8, s[8:11], s30 offen offset:1024 lds
  s_mov_b32 s30, 32768
  s_add_u32 m0, s41, 0
  s_nop 0
  buffer_load_dwordx4 v8, s[12:15], s30 offen offset:0 lds
  buffer_load_dwordx4 v8, s[12:15], s30 offen offset:1024 lds
  s_add_u32 m0, s35, 16384
  s_nop 0
  buffer_load_dwordx4 v8, s[8:11], s30 offen offset:0 lds
  buffer_load_dwordx4 v8, s[8:11], s30 offen offset:1024 lds
L_attn_nostart_10:
  s_sub_u32 s37, 3, s25
  s_cmp_eq_u32 s26, 0
  s_cselect_b32 s28, s28, s63
  s_cselect_b32 s25, s25, s37
  s_lshl_b32 s32, s28, 2
  s_add_u32 s32, s32, s25
  s_sub_u32 s32, s32, 3
  s_mov_b32 s31, -2
  s_sub_u32 s33, s28, 1
  s_add_u32 s37, s63, 1
  s_cmp_lt_i32 s63, 5
  s_cselect_b32 s43, 1, 0
  s_cselect_b32 s33, s37, s33
  s_cmp_eq_u32 s24, 7
  s_cselect_b32 s45, s43, 0
  s_lshl_b32 s37, s63, 2
  s_add_u32 s37, s37, 6
  s_cmp_lg_u32 s45, 0
  s_cselect_b32 s44, s37, 0x7fffffff
  s_cmp_eq_u32 s24, 1
  s_cselect_b32 s42, s33, -1
  s_add_u32 s20, s60, 0x4000000
  s_addc_u32 s21, s61, 0
  s_mov_b32 s22, 0x4000000
  s_mov_b32 s23, 0x00020000
  v_and_b32 v2, 15, v1
  v_lshrrev_b32 v3, 4, v1
  v_lshlrev_b32 v4, 2, v3
  v_sub_u32 v14, v2, v4
  v_mov_b32 v16, 0xf149f2ca
  v_mov_b32 v12, 0x42000000
  s_lshl_b32 s37, s28, 2
  s_add_u32 s37, s37, s25
  s_lshl_b32 s37, s37, 18
  s_lshl_b32 s38, s27, 13
  s_add_u32 s37, s37, s38
  s_add_u32 s37, s37, 0x1000000
  v_add_u32 v18, s37, v9
  s_lshl_b32 s37, s24, 8
  s_add_u32 s37, s37, 32768
  v_lshl_add_u32 v17, v1, 2, s37
  v_and_b32 v19, 7, v1
  v_lshlrev_b32 v19, 8, v19
  v_add_u32 v19, 32768, v19
  v_mov_b32 v13, -1
  ds_write_b32 v17, v13
  ds_write_b32 v17, v13 offset:2048
  v_mov_b32 v20, 0
  v_mov_b32 v10, 0
  v_mov_b32 v11, 0
  v_mov_b32 v72, 0x3f803f80
  v_mov_b32 v73, 0x3f803f80
  v_mov_b32 v74, 0x3f803f80
  v_mov_b32 v75, 0x3f803f80
  v_mov_b32 v184, 0
  v_mov_b32 v185, 0
  v_mov_b32 v186, 0
  v_mov_b32 v187, 0
  v_mov_b32 v188, 0
  v_mov_b32 v189, 0
  v_mov_b32 v190, 0
  v_mov_b32 v191, 0
  s_waitcnt lgkmcnt(0)
  v_mfma_f32_16x16x32_bf16 v[156:159], v[88:91], v[28:31], 0
  v_accvgpr_write_b32 a32, 0
  v_accvgpr_write_b32 a33, 0
  v_accvgpr_write_b32 a34, 0
  v_accvgpr_write_b32 a35, 0
  v_mfma_f32_16x16x32_bf16 v[40:43], v[88:91], v[32:35], 0
  ds_read_b128 v[88:91], v6 offset:8192
  v_accvgpr_write_b32 a36, 0
  v_accvgpr_write_b32 a37, 0
  v_accvgpr_write_b32 a38, 0
  v_mfma_f32_16x16x32_bf16 v[44:47], v[168:171], v[32:35], 0
  v_accvgpr_write_b32 a39, 0
  v_accvgpr_write_b32 a40, 0
  v_accvgpr_write_b32 a41, 0
  v_accvgpr_write_b32 a42, 0
  v_mfma_f32_16x16x32_bf16 v[36:39], v[168:171], v[28:31], 0
  ds_read_b128 v[168:171], v6 offset:9216
  v_accvgpr_write_b32 a43, 0
  v_accvgpr_write_b32 a44, 0
  v_accvgpr_write_b32 a45, 0
  v_mfma_f32_16x16x32_bf16 v[156:159], v[172:175], v[60:63], v[156:159]
  v_accvgpr_write_b32 a46, 0
  v_accvgpr_write_b32 a47, 0
  v_accvgpr_write_b32 a48, 0
  v_accvgpr_write_b32 a49, 0
  v_mfma_f32_16x16x32_bf16 v[40:43], v[172:175], v[64:67], v[40:43]
  ds_read_b128 v[172:175], v6 offset:10240
  v_accvgpr_write_b32 a50, 0
  v_accvgpr_write_b32 a51, 0
  v_accvgpr_write_b32 a52, 0
  v_mfma_f32_16x16x32_bf16 v[44:47], v[100:103], v[64:67], v[44:47]
  v_accvgpr_write_b32 a53, 0
  v_accvgpr_write_b32 a54, 0
  v_accvgpr_write_b32 a55, 0
  v_accvgpr_write_b32 a56, 0
  v_mfma_f32_16x16x32_bf16 v[36:39], v[100:103], v[60:63], v[36:39]
  ds_read_b128 v[100:103], v6 offset:11264
  v_accvgpr_write_b32 a57, 0
  v_accvgpr_write_b32 a58, 0
  v_accvgpr_write_b32 a59, 0
  v_mfma_f32_16x16x32_bf16 v[156:159], v[104:107], v[92:95], v[156:159]
  v_accvgpr_write_b32 a60, 0
  v_accvgpr_write_b32 a61, 0
  v_accvgpr_write_b32 a62, 0
  v_accvgpr_write_b32 a63, 0
  v_mfma_f32_16x16x32_bf16 v[40:43], v[104:107], v[96:99], v[40:43]
  ds_read_b128 v[104:107], v6 offset:12288
  v_mfma_f32_16x16x32_bf16 v[44:47], v[108:111], v[96:99], v[44:47]
  v_mfma_f32_16x16x32_bf16 v[36:39], v[108:111], v[92:95], v[36:39]
  ds_read_b128 v[108:111], v6 offset:13312
  v_mfma_f32_16x16x32_bf16 v[156:159], v[112:115], v[124:127], v[156:159]
  v_mfma_f32_16x16x32_bf16 v[40:43], v[112:115], v[128:131], v[40:43]
  ds_read_b128 v[112:115], v6 offset:14336
  v_mfma_f32_16x16x32_bf16 v[44:47], v[116:119], v[128:131], v[44:47]
  v_mfma_f32_16x16x32_bf16 v[36:39], v[116:119], v[124:127], v[36:39]
  ds_read_b128 v[116:119], v6 offset:15360
  s_nop 7
  s_cmp_lg_u32 s32, -3
  s_cbranch_scc1 L_attn_nomask0
  v_cmp_ge_i32 s[48:49], v14, 0
  v_cmp_ge_i32 s[50:51], v14, 1
  v_cmp_ge_i32 s[52:53], v14, 2
  v_cmp_ge_i32 s[54:55], v14, 3
  v_mov_b32 v36, v16
  v_mov_b32 v37, v16
  v_mov_b32 v38, v16
  v_mov_b32 v39, v16
  v_cndmask_b32 v156, v16, v156, s[48:49]
  v_cndmask_b32 v157, v16, v157, s[50:51]
  v_cndmask_b32 v158, v16, v158, s[52:53]
  v_cndmask_b32 v159, v16, v159, s[54:55]
  v_cndmask_b32 v44, v16, v44, s[48:49]
  v_cndmask_b32 v45, v16, v45, s[50:51]
  v_cndmask_b32 v46, v16, v46, s[52:53]
  v_cndmask_b32 v47, v16, v47, s[54:55]
L_attn_nomask0:
  v_max3_f32 v21, v156, v157, v158
  v_max3_f32 v21, v21, v159, v36
  v_max3_f32 v21, v21, v37, v38
  v_max_f32 v21, v21, v39
  v_max3_f32 v10, v40, v41, v42
  v_max3_f32 v10, v10, v43, v44
  v_max3_f32 v10, v10, v45, v46
  v_max_f32 v10, v10, v47
  v_mov_b32 v2, v21
  v_mov_b32 v3, v10
  s_nop 1
  v_permlane16_swap_b32 v2, v21
  v_permlane16_swap_b32 v3, v10
  v_max_f32 v21, v21, v2
  v_max_f32 v10, v10, v3
  v_mov_b32 v2, v21
  v_mov_b32 v3, v10
  s_nop 1
  v_permlane32_swap_b32 v2, v21
  v_permlane32_swap_b32 v3, v10
  v_max_f32 v21, v21, v2
  v_max_f32 v10, v10, v3
  v_max_f32 v21, 0xe0ad78ec, v21
  v_max_f32 v10, 0xe0ad78ec, v10
  v_sub_f32 v156, v156, v21
  v_sub_f32 v157, v157, v21
  v_sub_f32 v158, v158, v21
  v_sub_f32 v159, v159, v21
  v_sub_f32 v36, v36, v21
  v_sub_f32 v37, v37, v21
  v_sub_f32 v38, v38, v21
  v_sub_f32 v39, v39, v21
  v_sub_f32 v40, v40, v10
  v_sub_f32 v41, v41, v10
  v_sub_f32 v42, v42, v10
  v_sub_f32 v43, v43, v10
  v_sub_f32 v44, v44, v10
  v_sub_f32 v45, v45, v10
  v_sub_f32 v46, v46, v10
  v_sub_f32 v47, v47, v10
  v_sub_f32 v164, 0, v21
  v_sub_f32 v165, 0, v21
  v_sub_f32 v166, 0, v21
  v_sub_f32 v167, 0, v21
  v_sub_f32 v68, 0, v10
  v_sub_f32 v69, 0, v10
  v_sub_f32 v70, 0, v10
  v_sub_f32 v71, 0, v10
  s_waitcnt lgkmcnt(0)
  s_barrier
  s_setprio 2
  s_cmp_eq_u32 s26, 0
  s_cbranch_scc1 L_attn_lgo_11
  s_waitcnt vmcnt(0)
L_attn_lgo_11:
  s_waitcnt vmcnt(6) lgkmcnt(0)
  v_add_u32 v13, 1, v13
  v_cmp_gt_i32 vcc, s31, v20
  ds_write_b32 v17, v13
  s_cbranch_vccnz L_attn_spin_12
L_attn_spun_13:
  s_cmp_eq_u32 s32, -3
  s_cbranch_scc1 L_attn_L0
  s_cmp_lg_u32 s26, 0
  s_cbranch_scc1 L_attn_N0
  .p2align 3
L_attn_loop:
  v_mfma_f32_16x16x32_bf16 v[48:51], v[88:91], v[28:31], v[164:167]
  ds_read_b128 v[120:123], v7 offset:0
  v_mfma_f32_16x16x32_bf16 v[56:59], v[88:91], v[32:35], v[68:71]
  ds_read_b128 v[176:179], v7 offset:1024
  v_exp_f32 v156, v156
  v_mfma_f32_16x16x32_bf16 v[160:163], v[168:171], v[32:35], v[68:71]
  ds_read_b128 v[180:183], v7 offset:2048
  v_exp_f32 v157, v157
  v_mfma_f32_16x16x32_bf16 v[52:55], v[168:171], v[28:31], v[164:167]
  ds_read_b128 v[132:135], v7 offset:3072
  v_exp_f32 v158, v158
  v_mfma_f32_16x16x32_bf16 v[48:51], v[172:175], v[60:63], v[48:51]
  ds_read_b128 v[136:139], v7 offset:4096
  v_mfma_f32_16x16x32_bf16 v[56:59], v[172:175], v[64:67], v[56:59]
  ds_read_b128 v[140:143], v7 offset:5120
  v_exp_f32 v159, v159
  v_mfma_f32_16x16x32_bf16 v[160:163], v[100:103], v[64:67], v[160:163]
  ds_read_b128 v[144:147], v7 offset:6144
  v_exp_f32 v36, v36
  v_mfma_f32_16x16x32_bf16 v[52:55], v[100:103], v[60:63], v[52:55]
  ds_read_b128 v[148:151], v7 offset:7168
  v_exp_f32 v37, v37
  v_mfma_f32_16x16x32_bf16 v[48:51], v[104:107], v[92:95], v[48:51]
  v_exp_f32 v38, v38
  v_mfma_f32_16x16x32_bf16 v[56:59], v[104:107], v[96:99], v[56:59]
  v_exp_f32 v39, v39
  v_cvt_pk_bf16_f32 v80, v156, v157
  s_add_u32 m0, s35, 24576
  s_add_u32 s30, s30, 8192
  buffer_load_dwordx4 v8, s[8:11], s30 offen offset:0 lds
  v_mfma_f32_16x16x32_bf16 v[160:163], v[108:111], v[96:99], v[160:163]
  v_cvt_pk_bf16_f32 v81, v158, v159
  v_cvt_pk_bf16_f32 v82, v36, v37
  v_mfma_f32_16x16x32_bf16 v[52:55], v[108:111], v[92:95], v[52:55]
  v_cvt_pk_bf16_f32 v83, v38, v39
  v_exp_f32 v40, v40
  v_mfma_f32_16x16x32_bf16 v[48:51], v[112:115], v[124:127], v[48:51]
  v_exp_f32 v41, v41
  v_mfma_f32_16x16x32_bf16 v[56:59], v[112:115], v[128:131], v[56:59]
  v_exp_f32 v42, v42
  v_mfma_f32_16x16x32_bf16 v[160:163], v[116:119], v[128:131], v[160:163]
  v_exp_f32 v43, v43
  buffer_load_dwordx4 v8, s[8:11], s30 offen offset:1024 lds
  v_mfma_f32_16x16x32_bf16 v[52:55], v[116:119], v[124:127], v[52:55]
  v_exp_f32 v44, v44
  v_exp_f32 v45, v45
  v_mfma_f32_16x16x32_bf16 v[184:187], v[72:75], v[80:83], v[184:187]
  ds_read_b128 v[88:91], v6 offset:16384
  s_waitcnt lgkmcnt(1)
  v_mfma_f32_16x16x32_bf16 a[0:3], v[120:123], v[80:83], a[0:3]
  ds_read_b128 v[168:171], v6 offset:17408
  v_exp_f32 v46, v46
  v_mfma_f32_16x16x32_bf16 a[8:11], v[176:179], v[80:83], a[8:11]
  ds_read_b128 v[172:175], v6 offset:18432
  v_exp_f32 v47, v47
  v_mfma_f32_16x16x32_bf16 a[16:19], v[180:183], v[80:83], a[16:19]
  ds_read_b128 v[100:103], v6 offset:19456
  v_cvt_pk_bf16_f32 v84, v40, v41
  v_cvt_pk_bf16_f32 v85, v42, v43
  v_mfma_f32_16x16x32_bf16 a[24:27], v[132:135], v[80:83], a[24:27]
  ds_read_b128 v[104:107], v6 offset:20480
  v_cvt_pk_bf16_f32 v86, v44, v45
  v_mfma_f32_16x16x32_bf16 a[32:35], v[136:139], v[80:83], a[32:35]
  ds_read_b128 v[108:111], v6 offset:21504
  v_cvt_pk_bf16_f32 v87, v46, v47
  v_max3_f32 v21, v48, v49, v50
  v_mfma_f32_16x16x32_bf16 a[40:43], v[140:143], v[80:83], a[40:43]
  ds_read_b128 v[112:115], v6 offset:22528
  v_max3_f32 v21, v21, v51, v52
  v_mfma_f32_16x16x32_bf16 a[48:51], v[144:147], v[80:83], a[48:51]
  ds_read_b128 v[116:119], v6 offset:23552
  s_add_u32 m0, s41, 8192
  s_nop 0
  v_mfma_f32_16x16x32_bf16 a[56:59], v[148:151], v[80:83], a[56:59]
  buffer_load_dwordx4 v8, s[12:15], s30 offen offset:0 lds
  v_mfma_f32_16x16x32_bf16 v[188:191], v[72:75], v[84:87], v[188:191]
  v_max3_f32 v21, v21, v53, v54
  v_max3_f32 v21, v21, v55, v56
  v_max3_f32 v21, v21, v57, v58
  v_mfma_f32_16x16x32_bf16 a[4:7], v[120:123], v[84:87], a[4:7]
  ds_read_b32 v20, v19
  s_add_u32 s31, s31, 1
  v_mfma_f32_16x16x32_bf16 a[12:15], v[176:179], v[84:87], a[12:15]
  v_max3_f32 v21, v21, v59, v160
  v_max3_f32 v21, v21, v161, v162
  v_max_f32 v21, v21, v163
  v_mfma_f32_16x16x32_bf16 a[20:23], v[180:183], v[84:87], a[20:23]
  buffer_load_dwordx4 v8, s[12:15], s30 offen offset:1024 lds
  v_mfma_f32_16x16x32_bf16 a[28:31], v[132:135], v[84:87], a[28:31]
  v_cmp_ge_f32 s[48:49], v21, v12
  v_mfma_f32_16x16x32_bf16 a[36:39], v[136:139], v[84:87], a[36:39]
  s_waitcnt vmcnt(8) lgkmcnt(0)
  v_add_u32 v13, 1, v13
  v_cmp_gt_i32 vcc, s31, v20
  v_mfma_f32_16x16x32_bf16 a[44:47], v[140:143], v[84:87], a[44:47]
  ds_write_b32 v17, v13
  v_mfma_f32_16x16x32_bf16 a[52:55], v[144:147], v[84:87], a[52:55]
  v_mfma_f32_16x16x32_bf16 a[60:63], v[148:151], v[84:87], a[60:63]
  s_or_b64 vcc, vcc, s[48:49]
  s_cbranch_vccnz L_attn_hnd_16
L_attn_spun_15:
  v_mfma_f32_16x16x32_bf16 v[156:159], v[88:91], v[28:31], v[164:167]
  ds_read_b128 v[120:123], v7 offset:8192
  v_mfma_f32_16x16x32_bf16 v[40:43], v[88:91], v[32:35], v[68:71]
  ds_read_b128 v[176:179], v7 offset:9216
  v_exp_f32 v48, v48
  v_mfma_f32_16x16x32_bf16 v[44:47], v[168:171], v[32:35], v[68:71]
  ds_read_b128 v[180:183], v7 offset:10240
  v_exp_f32 v49, v49
  v_mfma_f32_16x16x32_bf16 v[36:39], v[168:171], v[28:31], v[164:167]
  ds_read_b128 v[132:135], v7 offset:11264
  v_exp_f32 v50, v50
  v_mfma_f32_16x16x32_bf16 v[156:159], v[172:175], v[60:63], v[156:159]
  ds_read_b128 v[136:139], v7 offset:12288
  v_mfma_f32_16x16x32_bf16 v[40:43], v[172:175], v[64:67], v[40:43]
  ds_read_b128 v[140:143], v7 offset:13312
  v_exp_f32 v51, v51
  v_mfma_f32_16x16x32_bf16 v[44:47], v[100:103], v[64:67], v[44:47]
  ds_read_b128 v[144:147], v7 offset:14336
  v_exp_f32 v52, v52
  v_mfma_f32_16x16x32_bf16 v[36:39], v[100:103], v[60:63], v[36:39]
  ds_read_b128 v[148:151], v7 offset:15360
  v_exp_f32 v53, v53
  v_mfma_f32_16x16x32_bf16 v[156:159], v[104:107], v[92:95], v[156:159]
  v_exp_f32 v54, v54
  v_mfma_f32_16x16x32_bf16 v[40:43], v[104:107], v[96:99], v[40:43]
  v_exp_f32 v55, v55
  v_cvt_pk_bf16_f32 v80, v48, v49
  s_add_u32 m0, s34, 0
  s_add_u32 s30, s30, 8192
  buffer_load_dwordx4 v8, s[8:11], s30 offen offset:0 lds
  v_mfma_f32_16x16x32_bf16 v[44:47], v[108:111], v[96:99], v[44:47]
  v_cvt_pk_bf16_f32 v81, v50, v51
  v_cvt_pk_bf16_f32 v82, v52, v53
  v_mfma_f32_16x16x32_bf16 v[36:39], v[108:111], v[92:95], v[36:39]
  v_cvt_pk_bf16_f32 v83, v54, v55
  v_exp_f32 v56, v56
  v_mfma_f32_16x16x32_bf16 v[156:159], v[112:115], v[124:127], v[156:159]
  v_exp_f32 v57, v57
  v_mfma_f32_16x16x32_bf16 v[40:43], v[112:115], v[128:131], v[40:43]
  v_exp_f32 v58, v58
  v_mfma_f32_16x16x32_bf16 v[44:47], v[116:119], v[128:131], v[44:47]
  v_exp_f32 v59, v59
  buffer_load_dwordx4 v8, s[8:11], s30 offen offset:1024 lds
  v_mfma_f32_16x16x32_bf16 v[36:39], v[116:119], v[124:127], v[36:39]
  v_exp_f32 v160, v160
  v_exp_f32 v161, v161
  v_mfma_f32_16x16x32_bf16 v[184:187], v[72:75], v[80:83], v[184:187]
  ds_read_b128 v[88:91], v6 offset:24576
  s_waitcnt lgkmcnt(1)
  v_mfma_f32_16x16x32_bf16 a[0:3], v[120:123], v[80:83], a[0:3]
  ds_read_b128 v[168:171], v6 offset:25600
  v_exp_f32 v162, v162
  v_mfma_f32_16x16x32_bf16 a[8:11], v[176:179], v[80:83], a[8:11]
  ds_read_b128 v[172:175], v6 offset:26624
  v_exp_f32 v163, v163
  v_mfma_f32_16x16x32_bf16 a[16:19], v[180:183], v[80:83], a[16:19]
  ds_read_b128 v[100:103], v6 offset:27648
  v_cvt_pk_bf16_f32 v84, v56, v57
  v_cvt_pk_bf16_f32 v85, v58, v59
  v_mfma_f32_16x16x32_bf16 a[24:27], v[132:135], v[80:83], a[24:27]
  ds_read_b128 v[104:107], v6 offset:28672
  v_cvt_pk_bf16_f32 v86, v160, v161
  v_mfma_f32_16x16x32_bf16 a[32:35], v[136:139], v[80:83], a[32:35]
  ds_read_b128 v[108:111], v6 offset:29696
  v_cvt_pk_bf16_f32 v87, v162, v163
  v_max3_f32 v21, v156, v157, v158
  v_mfma_f32_16x16x32_bf16 a[40:43], v[140:143], v[80:83], a[40:43]
  ds_read_b128 v[112:115], v6 offset:30720
  v_max3_f32 v21, v21, v159, v36
  v_mfma_f32_16x16x32_bf16 a[48:51], v[144:147], v[80:83], a[48:51]
  ds_read_b128 v[116:119], v6 offset:31744
  s_add_u32 m0, s41, 16384
  s_nop 0
  v_mfma_f32_16x16x32_bf16 a[56:59], v[148:151], v[80:83], a[56:59]
  buffer_load_dwordx4 v8, s[12:15], s30 offen offset:0 lds
  v_mfma_f32_16x16x32_bf16 v[188:191], v[72:75], v[84:87], v[188:191]
  v_max3_f32 v21, v21, v37, v38
  v_max3_f32 v21, v21, v39, v40
  v_max3_f32 v21, v21, v41, v42
  v_mfma_f32_16x16x32_bf16 a[4:7], v[120:123], v[84:87], a[4:7]
  ds_read_b32 v20, v19
  s_add_u32 s31, s31, 1
  v_mfma_f32_16x16x32_bf16 a[12:15], v[176:179], v[84:87], a[12:15]
  v_max3_f32 v21, v21, v43, v44
  v_max3_f32 v21, v21, v45, v46
  v_max_f32 v21, v21, v47
  v_mfma_f32_16x16x32_bf16 a[20:23], v[180:183], v[84:87], a[20:23]
  buffer_load_dwordx4 v8, s[12:15], s30 offen offset:1024 lds
  v_mfma_f32_16x16x32_bf16 a[28:31], v[132:135], v[84:87], a[28:31]
  v_cmp_ge_f32 s[48:49], v21, v12
  v_mfma_f32_16x16x32_bf16 a[36:39], v[136:139], v[84:87], a[36:39]
  s_waitcnt vmcnt(8) lgkmcnt(0)
  v_add_u32 v13, 1, v13
  v_cmp_gt_i32 vcc, s31, v20
  v_mfma_f32_16x16x32_bf16 a[44:47], v[140:143], v[84:87], a[44:47]
  ds_write_b32 v17, v13
  v_mfma_f32_16x16x32_bf16 a[52:55], v[144:147], v[84:87], a[52:55]
  v_mfma_f32_16x16x32_bf16 a[60:63], v[148:151], v[84:87], a[60:63]
  s_or_b64 vcc, vcc, s[48:49]
  v_xor_b32 v6, 0x8000, v6
  s_cbranch_vccnz L_attn_hnd_20
L_attn_spun_19:
  v_mfma_f32_16x16x32_bf16 v[48:51], v[88:91], v[28:31], v[164:167]
  ds_read_b128 v[120:123], v7 offset:16384
  v_mfma_f32_16x16x32_bf16 v[56:59], v[88:91], v[32:35], v[68:71]
  ds_read_b128 v[176:179], v7 offset:17408
  v_exp_f32 v156, v156
  v_mfma_f32_16x16x32_bf16 v[160:163], v[168:171], v[32:35], v[68:71]
  ds_read_b128 v[180:183], v7 offset:18432
  v_exp_f32 v157, v157
  v_mfma_f32_16x16x32_bf16 v[52:55], v[168:171], v[28:31], v[164:167]
  ds_read_b128 v[132:135], v7 offset:19456
  v_exp_f32 v158, v158
  v_mfma_f32_16x16x32_bf16 v[48:51], v[172:175], v[60:63], v[48:51]
  ds_read_b128 v[136:139], v7 offset:20480
  v_mfma_f32_16x16x32_bf16 v[56:59], v[172:175], v[64:67], v[56:59]
  ds_read_b128 v[140:143], v7 offset:21504
  v_exp_f32 v159, v159
  v_mfma_f32_16x16x32_bf16 v[160:163], v[100:103], v[64:67], v[160:163]
  ds_read_b128 v[144:147], v7 offset:22528
  v_exp_f32 v36, v36
  v_mfma_f32_16x16x32_bf16 v[52:55], v[100:103], v[60:63], v[52:55]
  ds_read_b128 v[148:151], v7 offset:23552
  v_exp_f32 v37, v37
  v_mfma_f32_16x16x32_bf16 v[48:51], v[104:107], v[92:95], v[48:51]
  v_exp_f32 v38, v38
  v_mfma_f32_16x16x32_bf16 v[56:59], v[104:107], v[96:99], v[56:59]
  v_exp_f32 v39, v39
  v_cvt_pk_bf16_f32 v80, v156, v157
  s_add_u32 m0, s34, 8192
  s_add_u32 s30, s30, 8192
  buffer_load_dwordx4 v8, s[8:11], s30 offen offset:0 lds
  v_mfma_f32_16x16x32_bf16 v[160:163], v[108:111], v[96:99], v[160:163]
  v_cvt_pk_bf16_f32 v81, v158, v159
  v_cvt_pk_bf16_f32 v82, v36, v37
  v_mfma_f32_16x16x32_bf16 v[52:55], v[108:111], v[92:95], v[52:55]
  v_cvt_pk_bf16_f32 v83, v38, v39
  v_exp_f32 v40, v40
  v_mfma_f32_16x16x32_bf16 v[48:51], v[112:115], v[124:127], v[48:51]
  v_exp_f32 v41, v41
  v_mfma_f32_16x16x32_bf16 v[56:59], v[112:115], v[128:131], v[56:59]
  v_exp_f32 v42, v42
  v_mfma_f32_16x16x32_bf16 v[160:163], v[116:119], v[128:131], v[160:163]
  v_exp_f32 v43, v43
  buffer_load_dwordx4 v8, s[8:11], s30 offen offset:1024 lds
  v_mfma_f32_16x16x32_bf16 v[52:55], v[116:119], v[124:127], v[52:55]
  v_exp_f32 v44, v44
  v_exp_f32 v45, v45
  v_mfma_f32_16x16x32_bf16 v[184:187], v[72:75], v[80:83], v[184:187]
  ds_read_b128 v[88:91], v6 offset:0
  s_waitcnt lgkmcnt(1)
  v_mfma_f32_16x16x32_bf16 a[0:3], v[120:123], v[80:83], a[0:3]
  ds_read_b128 v[168:171], v6 offset:1024
  v_exp_f32 v46, v46
  v_mfma_f32_16x16x32_bf16 a[8:11], v[176:179], v[80:83], a[8:11]
  ds_read_b128 v[172:175], v6 offset:2048
  v_exp_f32 v47, v47
  v_mfma_f32_16x16x32_bf16 a[16:19], v[180:183], v[80:83], a[16:19]
  ds_read_b128 v[100:103], v6 offset:3072
  v_cvt_pk_bf16_f32 v84, v40, v41
  v_cvt_pk_bf16_f32 v85, v42, v43
  v_mfma_f32_16x16x32_bf16 a[24:27], v[132:135], v[80:83], a[24:27]
  ds_read_b128 v[104:107], v6 offset:4096
  v_cvt_pk_bf16_f32 v86, v44, v45
  v_mfma_f32_16x16x32_bf16 a[32:35], v[136:139], v[80:83], a[32:35]
  ds_read_b128 v[108:111], v6 offset:5120
  v_cvt_pk_bf16_f32 v87, v46, v47
  v_max3_f32 v21, v48, v49, v50
  v_mfma_f32_16x16x32_bf16 a[40:43], v[140:143], v[80:83], a[40:43]
  ds_read_b128 v[112:115], v6 offset:6144
  v_max3_f32 v21, v21, v51, v52
  v_mfma_f32_16x16x32_bf16 a[48:51], v[144:147], v[80:83], a[48:51]
  ds_read_b128 v[116:119], v6 offset:7168
  s_add_u32 m0, s41, 24576
  s_nop 0
  v_mfma_f32_16x16x32_bf16 a[56:59], v[148:151], v[80:83], a[56:59]
  buffer_load_dwordx4 v8, s[12:15], s30 offen offset:0 lds
  v_mfma_f32_16x16x32_bf16 v[188:191], v[72:75], v[84:87], v[188:191]
  v_max3_f32 v21, v21, v53, v54
  v_max3_f32 v21, v21, v55, v56
  v_max3_f32 v21, v21, v57, v58
  v_mfma_f32_16x16x32_bf16 a[4:7], v[120:123], v[84:87], a[4:7]
  ds_read_b32 v20, v19
  s_add_u32 s31, s31, 1
  v_mfma_f32_16x16x32_bf16 a[12:15], v[176:179], v[84:87], a[12:15]
  v_max3_f32 v21, v21, v59, v160
  v_max3_f32 v21, v21, v161, v162
  v_max_f32 v21, v21, v163
  v_mfma_f32_16x16x32_bf16 a[20:23], v[180:183], v[84:87], a[20:23]
  buffer_load_dwordx4 v8, s[12:15], s30 offen offset:1024 lds
  v_mfma_f32_16x16x32_bf16 a[28:31], v[132:135], v[84:87], a[28:31]
  v_cmp_ge_f32 s[48:49], v21, v12
  v_mfma_f32_16x16x32_bf16 a[36:39], v[136:139], v[84:87], a[36:39]
  s_waitcnt vmcnt(8) lgkmcnt(0)
  v_add_u32 v13, 1, v13
  v_cmp_gt_i32 vcc, s31, v20
  v_mfma_f32_16x16x32_bf16 a[44:47], v[140:143], v[84:87], a[44:47]
  ds_write_b32 v17, v13
  v_mfma_f32_16x16x32_bf16 a[52:55], v[144:147], v[84:87], a[52:55]
  v_mfma_f32_16x16x32_bf16 a[60:63], v[148:151], v[84:87], a[60:63]
  s_or_b64 vcc, vcc, s[48:49]
  s_cbranch_vccnz L_attn_hnd_24
L_attn_spun_23:
  v_mfma_f32_16x16x32_bf16 v[156:159], v[88:91], v[28:31], v[164:167]
  ds_read_b128 v[120:123], v7 offset:24576
  v_mfma_f32_16x16x32_bf16 v[40:43], v[88:91], v[32:35], v[68:71]
  ds_read_b128 v[176:179], v7 offset:25600
  v_exp_f32 v48, v48
  v_mfma_f32_16x16x32_bf16 v[44:47], v[168:171], v[32:35], v[68:71]
  ds_read_b128 v[180:183], v7 offset:26624
  v_exp_f32 v49, v49
  v_mfma_f32_16x16x32_bf16 v[36:39], v[168:171], v[28:31], v[164:167]
  ds_read_b128 v[132:135], v7 offset:27648
  v_exp_f32 v50, v50
  v_mfma_f32_16x16x32_bf16 v[156:159], v[172:175], v[60:63], v[156:159]
  ds_read_b128 v[136:139], v7 offset:28672
  v_mfma_f32_16x16x32_bf16 v[40:43], v[172:175], v[64:67], v[40:43]
  ds_read_b128 v[140:143], v7 offset:29696
  v_exp_f32 v51, v51
  v_mfma_f32_16x16x32_bf16 v[44:47], v[100:103], v[64:67], v[44:47]
  ds_read_b128 v[144:147], v7 offset:30720
  v_exp_f32 v52, v52
  v_mfma_f32_16x16x32_bf16 v[36:39], v[100:103], v[60:63], v[36:39]
  ds_read_b128 v[148:151], v7 offset:31744
  v_exp_f32 v53, v53
  v_mfma_f32_16x16x32_bf16 v[156:159], v[104:107], v[92:95], v[156:159]
  v_exp_f32 v54, v54
  v_mfma_f32_16x16x32_bf16 v[40:43], v[104:107], v[96:99], v[40:43]
  v_exp_f32 v55, v55
  v_cvt_pk_bf16_f32 v80, v48, v49
  s_add_u32 m0, s34, 16384
  s_add_u32 s30, s30, 8192
  buffer_load_dwordx4 v8, s[8:11], s30 offen offset:0 lds
  v_mfma_f32_16x16x32_bf16 v[44:47], v[108:111], v[96:99], v[44:47]
  v_cvt_pk_bf16_f32 v81, v50, v51
  v_cvt_pk_bf16_f32 v82, v52, v53
  v_mfma_f32_16x16x32_bf16 v[36:39], v[108:111], v[92:95], v[36:39]
  v_cvt_pk_bf16_f32 v83, v54, v55
  v_exp_f32 v56, v56
  v_mfma_f32_16x16x32_bf16 v[156:159], v[112:115], v[124:127], v[156:159]
  v_exp_f32 v57, v57
  v_mfma_f32_16x16x32_bf16 v[40:43], v[112:115], v[128:131], v[40:43]
  v_exp_f32 v58, v58
  v_mfma_f32_16x16x32_bf16 v[44:47], v[116:119], v[128:131], v[44:47]
  v_exp_f32 v59, v59
  buffer_load_dwordx4 v8, s[8:11], s30 offen offset:1024 lds
  v_mfma_f32_16x16x32_bf16 v[36:39], v[116:119], v[124:127], v[36:39]
  v_exp_f32 v160, v160
  v_exp_f32 v161, v161
  v_xor_b32 v7, 0x20000, v7
  v_mfma_f32_16x16x32_bf16 v[184:187], v[72:75], v[80:83], v[184:187]
  ds_read_b128 v[88:91], v6 offset:8192
  s_waitcnt lgkmcnt(1)
  v_mfma_f32_16x16x32_bf16 a[0:3], v[120:123], v[80:83], a[0:3]
  ds_read_b128 v[168:171], v6 offset:9216
  v_exp_f32 v162, v162
  v_mfma_f32_16x16x32_bf16 a[8:11], v[176:179], v[80:83], a[8:11]
  ds_read_b128 v[172:175], v6 offset:10240
  v_exp_f32 v163, v163
  v_mfma_f32_16x16x32_bf16 a[16:19], v[180:183], v[80:83], a[16:19]
  ds_read_b128 v[100:103], v6 offset:11264
  v_cvt_pk_bf16_f32 v84, v56, v57
  v_cvt_pk_bf16_f32 v85, v58, v59
  v_mfma_f32_16x16x32_bf16 a[24:27], v[132:135], v[80:83], a[24:27]
  ds_read_b128 v[104:107], v6 offset:12288
  v_cvt_pk_bf16_f32 v86, v160, v161
  v_mfma_f32_16x16x32_bf16 a[32:35], v[136:139], v[80:83], a[32:35]
  ds_read_b128 v[108:111], v6 offset:13312
  v_cvt_pk_bf16_f32 v87, v162, v163
  v_max3_f32 v21, v156, v157, v158
  v_mfma_f32_16x16x32_bf16 a[40:43], v[140:143], v[80:83], a[40:43]
  ds_read_b128 v[112:115], v6 offset:14336
  v_max3_f32 v21, v21, v159, v36
  v_mfma_f32_16x16x32_bf16 a[48:51], v[144:147], v[80:83], a[48:51]
  ds_read_b128 v[116:119], v6 offset:15360
  s_add_u32 m0, s40, 0
  s_nop 0
  v_mfma_f32_16x16x32_bf16 a[56:59], v[148:151], v[80:83], a[56:59]
  buffer_load_dwordx4 v8, s[12:15], s30 offen offset:0 lds
  v_mfma_f32_16x16x32_bf16 v[188:191], v[72:75], v[84:87], v[188:191]
  v_max3_f32 v21, v21, v37, v38
  v_max3_f32 v21, v21, v39, v40
  v_max3_f32 v21, v21, v41, v42
  v_mfma_f32_16x16x32_bf16 a[4:7], v[120:123], v[84:87], a[4:7]
  ds_read_b32 v20, v19
  s_add_u32 s31, s31, 1
  v_mfma_f32_16x16x32_bf16 a[12:15], v[176:179], v[84:87], a[12:15]
  v_max3_f32 v21, v21, v43, v44
  v_max3_f32 v21, v21, v45, v46
  v_max_f32 v21, v21, v47
  v_mfma_f32_16x16x32_bf16 a[20:23], v[180:183], v[84:87], a[20:23]
  buffer_load_dwordx4 v8, s[12:15], s30 offen offset:1024 lds
  s_xor_b32 s34, s34, 0x8000
  s_xor_b32 s35, s35, 0x8000
  s_xor_b32 s40, s40, 0x20000
  s_xor_b32 s41, s41, 0x20000
  v_mfma_f32_16x16x32_bf16 a[28:31], v[132:135], v[84:87], a[28:31]
  v_cmp_ge_f32 s[48:49], v21, v12
  v_mfma_f32_16x16x32_bf16 a[36:39], v[136:139], v[84:87], a[36:39]
  s_waitcnt vmcnt(8) lgkmcnt(0)
  v_add_u32 v13, 1, v13
  v_cmp_gt_i32 vcc, s31, v20
  v_mfma_f32_16x16x32_bf16 a[44:47], v[140:143], v[84:87], a[44:47]
  ds_write_b32 v17, v13
  v_mfma_f32_16x16x32_bf16 a[52:55], v[144:147], v[84:87], a[52:55]
  v_mfma_f32_16x16x32_bf16 a[60:63], v[148:151], v[84:87], a[60:63]
  s_or_b64 vcc, vcc, s[48:49]
  s_cbranch_vccnz L_attn_hnd_28
L_attn_spun_27:
  s_cmp_eq_u32 s33, s42
  s_cbranch_scc1 L_attn_qdsig
L_attn_qdback:
  s_sub_u32 s33, s33, 1
  s_cmp_lg_u32 s33, 0
  s_cbranch_scc1 L_attn_loop
  s_cmp_lg_u32 s43, 0
  s_cbranch_scc1 L_attn_T0
  v_mfma_f32_16x16x32_bf16 v[48:51], v[88:91], v[28:31], v[164:167]
  ds_read_b128 v[120:123], v7 offset:0
  v_mfma_f32_16x16x32_bf16 v[56:59], v[88:91], v[32:35], v[68:71]
  ds_read_b128 v[176:179], v7 offset:1024
  v_exp_f32 v156, v156
  v_mfma_f32_16x16x32_bf16 v[160:163], v[168:171], v[32:35], v[68:71]
  ds_read_b128 v[180:183], v7 offset:2048
  v_exp_f32 v157, v157
  v_mfma_f32_16x16x32_bf16 v[52:55], v[168:171], v[28:31], v[164:167]
  ds_read_b128 v[132:135], v7 offset:3072
  v_exp_f32 v158, v158
  v_mfma_f32_16x16x32_bf16 v[48:51], v[172:175], v[60:63], v[48:51]
  ds_read_b128 v[136:139], v7 offset:4096
  v_mfma_f32_16x16x32_bf16 v[56:59], v[172:175], v[64:67], v[56:59]
  ds_read_b128 v[140:143], v7 offset:5120
  v_exp_f32 v159, v159
  v_mfma_f32_16x16x32_bf16 v[160:163], v[100:103], v[64:67], v[160:163]
  ds_read_b128 v[144:147], v7 offset:6144
  v_exp_f32 v36, v36
  v_mfma_f32_16x16x32_bf16 v[52:55], v[100:103], v[60:63], v[52:55]
  ds_read_b128 v[148:151], v7 offset:7168
  v_exp_f32 v37, v37
  v_mfma_f32_16x16x32_bf16 v[48:51], v[104:107], v[92:95], v[48:51]
  v_exp_f32 v38, v38
  v_mfma_f32_16x16x32_bf16 v[56:59], v[104:107], v[96:99], v[56:59]
  v_exp_f32 v39, v39
  v_cvt_pk_bf16_f32 v80, v156, v157
  s_add_u32 m0, s35, 24576
  s_add_u32 s30, s30, 8192
  buffer_load_dwordx4 v8, s[8:11], s30 offen offset:0 lds
  v_mfma_f32_16x16x32_bf16 v[160:163], v[108:111], v[96:99], v[160:163]
  v_cvt_pk_bf16_f32 v81, v158, v159
  v_cvt_pk_bf16_f32 v82, v36, v37
  v_mfma_f32_16x16x32_bf16 v[52:55], v[108:111], v[92:95], v[52:55]
  v_cvt_pk_bf16_f32 v83, v38, v39
  v_exp_f32 v40, v40
  v_mfma_f32_16x16x32_bf16 v[48:51], v[112:115], v[124:127], v[48:51]
  v_exp_f32 v41, v41
  v_mfma_f32_16x16x32_bf16 v[56:59], v[112:115], v[128:131], v[56:59]
  v_exp_f32 v42, v42
  v_mfma_f32_16x16x32_bf16 v[160:163], v[116:119], v[128:131], v[160:163]
  v_exp_f32 v43, v43
  buffer_load_dwordx4 v8, s[8:11], s30 offen offset:1024 lds
  v_mfma_f32_16x16x32_bf16 v[52:55], v[116:119], v[124:127], v[52:55]
  v_exp_f32 v44, v44
  v_exp_f32 v45, v45
  v_mfma_f32_16x16x32_bf16 v[184:187], v[72:75], v[80:83], v[184:187]
  ds_read_b128 v[88:91], v6 offset:16384
  s_waitcnt lgkmcnt(1)
  v_mfma_f32_16x16x32_bf16 a[0:3], v[120:123], v[80:83], a[0:3]
  ds_read_b128 v[168:171], v6 offset:17408
  v_exp_f32 v46, v46
  v_mfma_f32_16x16x32_bf16 a[8:11], v[176:179], v[80:83], a[8:11]
  ds_read_b128 v[172:175], v6 offset:18432
  v_exp_f32 v47, v47
  v_mfma_f32_16x16x32_bf16 a[16:19], v[180:183], v[80:83], a[16:19]
  ds_read_b128 v[100:103], v6 offset:19456
  v_cvt_pk_bf16_f32 v84, v40, v41
  v_cvt_pk_bf16_f32 v85, v42, v43
  v_mfma_f32_16x16x32_bf16 a[24:27], v[132:135], v[80:83], a[24:27]
  ds_read_b128 v[104:107], v6 offset:20480
  v_cvt_pk_bf16_f32 v86, v44, v45
  v_mfma_f32_16x16x32_bf16 a[32:35], v[136:139], v[80:83], a[32:35]
  ds_read_b128 v[108:111], v6 offset:21504
  v_cvt_pk_bf16_f32 v87, v46, v47
  v_max3_f32 v21, v48, v49, v50
  v_mfma_f32_16x16x32_bf16 a[40:43], v[140:143], v[80:83], a[40:43]
  ds_read_b128 v[112:115], v6 offset:22528
  v_max3_f32 v21, v21, v51, v52
  v_mfma_f32_16x16x32_bf16 a[48:51], v[144:147], v[80:83], a[48:51]
  ds_read_b128 v[116:119], v6 offset:23552
  s_add_u32 m0, s41, 8192
  s_nop 0
  v_mfma_f32_16x16x32_bf16 a[56:59], v[148:151], v[80:83], a[56:59]
  buffer_load_dwordx4 v8, s[12:15], s30 offen offset:0 lds
  v_mfma_f32_16x16x32_bf16 v[188:191], v[72:75], v[84:87], v[188:191]
  v_max3_f32 v21, v21, v53, v54
  v_max3_f32 v21, v21, v55, v56
  v_max3_f32 v21, v21, v57, v58
  v_mfma_f32_16x16x32_bf16 a[4:7], v[120:123], v[84:87], a[4:7]
  ds_read_b32 v20, v19
  s_add_u32 s31, s31, 1
  v_mfma_f32_16x16x32_bf16 a[12:15], v[176:179], v[84:87], a[12:15]
  v_max3_f32 v21, v21, v59, v160
  v_max3_f32 v21, v21, v161, v162
  v_max_f32 v21, v21, v163
  v_mfma_f32_16x16x32_bf16 a[20:23], v[180:183], v[84:87], a[20:23]
  buffer_load_dwordx4 v8, s[12:15], s30 offen offset:1024 lds
  v_mfma_f32_16x16x32_bf16 a[28:31], v[132:135], v[84:87], a[28:31]
  v_cmp_ge_f32 s[48:49], v21, v12
  v_mfma_f32_16x16x32_bf16 a[36:39], v[136:139], v[84:87], a[36:39]
  s_waitcnt vmcnt(8) lgkmcnt(0)
  v_add_u32 v13, 1, v13
  v_cmp_gt_i32 vcc, s31, v20
  v_mfma_f32_16x16x32_bf16 a[44:47], v[140:143], v[84:87], a[44:47]
  ds_write_b32 v17, v13
  v_mfma_f32_16x16x32_bf16 a[52:55], v[144:147], v[84:87], a[52:55]
  v_mfma_f32_16x16x32_bf16 a[60:63], v[148:151], v[84:87], a[60:63]
  s_or_b64 vcc, vcc, s[48:49]
  s_cbranch_vccnz L_attn_hnd_32
L_attn_spun_31:
  v_mfma_f32_16x16x32_bf16 v[156:159], v[88:91], v[28:31], v[164:167]
  ds_read_b128 v[120:123], v7 offset:8192
  v_mfma_f32_16x16x32_bf16 v[40:43], v[88:91], v[32:35], v[68:71]
  ds_read_b128 v[176:179], v7 offset:9216
  v_exp_f32 v48, v48
  v_mfma_f32_16x16x32_bf16 v[44:47], v[168:171], v[32:35], v[68:71]
  ds_read_b128 v[180:183], v7 offset:10240
  v_exp_f32 v49, v49
  v_mfma_f32_16x16x32_bf16 v[36:39], v[168:171], v[28:31], v[164:167]
  ds_read_b128 v[132:135], v7 offset:11264
  v_exp_f32 v50, v50
  v_mfma_f32_16x16x32_bf16 v[156:159], v[172:175], v[60:63], v[156:159]
  ds_read_b128 v[136:139], v7 offset:12288
  v_mfma_f32_16x16x32_bf16 v[40:43], v[172:175], v[64:67], v[40:43]
  ds_read_b128 v[140:143], v7 offset:13312
  v_exp_f32 v51, v51
  v_mfma_f32_16x16x32_bf16 v[44:47], v[100:103], v[64:67], v[44:47]
  ds_read_b128 v[144:147], v7 offset:14336
  v_exp_f32 v52, v52
  v_mfma_f32_16x16x32_bf16 v[36:39], v[100:103], v[60:63], v[36:39]
  ds_read_b128 v[148:151], v7 offset:15360
  v_exp_f32 v53, v53
  v_mfma_f32_16x16x32_bf16 v[156:159], v[104:107], v[92:95], v[156:159]
  v_exp_f32 v54, v54
  v_mfma_f32_16x16x32_bf16 v[40:43], v[104:107], v[96:99], v[40:43]
  v_exp_f32 v55, v55
  v_cvt_pk_bf16_f32 v80, v48, v49
  v_mfma_f32_16x16x32_bf16 v[44:47], v[108:111], v[96:99], v[44:47]
  v_cvt_pk_bf16_f32 v81, v50, v51
  v_cvt_pk_bf16_f32 v82, v52, v53
  v_mfma_f32_16x16x32_bf16 v[36:39], v[108:111], v[92:95], v[36:39]
  v_cvt_pk_bf16_f32 v83, v54, v55
  v_exp_f32 v56, v56
  v_mfma_f32_16x16x32_bf16 v[156:159], v[112:115], v[124:127], v[156:159]
  v_exp_f32 v57, v57
  v_mfma_f32_16x16x32_bf16 v[40:43], v[112:115], v[128:131], v[40:43]
  v_exp_f32 v58, v58
  s_add_u32 m0, s41, 16384
  v_mfma_f32_16x16x32_bf16 v[44:47], v[116:119], v[128:131], v[44:47]
  v_exp_f32 v59, v59
  s_add_u32 s30, s30, 8192
  buffer_load_dwordx4 v8, s[12:15], s30 offen offset:0 lds
  v_mfma_f32_16x16x32_bf16 v[36:39], v[116:119], v[124:127], v[36:39]
  v_exp_f32 v160, v160
  v_mfma_f32_16x16x32_bf16 v[184:187], v[72:75], v[80:83], v[184:187]
  ds_read_b128 v[88:91], v6 offset:24576
  v_exp_f32 v161, v161
  s_waitcnt lgkmcnt(1)
  v_mfma_f32_16x16x32_bf16 a[0:3], v[120:123], v[80:83], a[0:3]
  ds_read_b128 v[168:171], v6 offset:25600
  v_exp_f32 v162, v162
  v_mfma_f32_16x16x32_bf16 a[8:11], v[176:179], v[80:83], a[8:11]
  ds_read_b128 v[172:175], v6 offset:26624
  v_max3_f32 v21, v156, v157, v158
  v_mfma_f32_16x16x32_bf16 a[16:19], v[180:183], v[80:83], a[16:19]
  ds_read_b128 v[100:103], v6 offset:27648
  v_exp_f32 v163, v163
  v_mfma_f32_16x16x32_bf16 a[24:27], v[132:135], v[80:83], a[24:27]
  ds_read_b128 v[104:107], v6 offset:28672
  v_cvt_pk_bf16_f32 v84, v56, v57
  v_mfma_f32_16x16x32_bf16 a[32:35], v[136:139], v[80:83], a[32:35]
  ds_read_b128 v[108:111], v6 offset:29696
  v_cvt_pk_bf16_f32 v85, v58, v59
  v_cvt_pk_bf16_f32 v86, v160, v161
  v_mfma_f32_16x16x32_bf16 a[40:43], v[140:143], v[80:83], a[40:43]
  ds_read_b128 v[112:115], v6 offset:30720
  v_cvt_pk_bf16_f32 v87, v162, v163
  v_mfma_f32_16x16x32_bf16 a[48:51], v[144:147], v[80:83], a[48:51]
  ds_read_b128 v[116:119], v6 offset:31744
  v_max3_f32 v21, v21, v159, v36
  v_max3_f32 v21, v21, v37, v38
  v_mfma_f32_16x16x32_bf16 a[56:59], v[148:151], v[80:83], a[56:59]
  v_max3_f32 v21, v21, v39, v40
  v_max3_f32 v21, v21, v41, v42
  v_mfma_f32_16x16x32_bf16 v[188:191], v[72:75], v[84:87], v[188:191]
  v_max3_f32 v21, v21, v43, v44
  v_max3_f32 v21, v21, v45, v46
  v_max_f32 v21, v21, v47
  v_mfma_f32_16x16x32_bf16 a[4:7], v[120:123], v[84:87], a[4:7]
  ds_read_b32 v20, v19
  s_add_u32 s31, s31, 1
  v_mfma_f32_16x16x32_bf16 a[12:15], v[176:179], v[84:87], a[12:15]
  v_cmp_ge_f32 s[48:49], v21, v12
  v_mfma_f32_16x16x32_bf16 a[20:23], v[180:183], v[84:87], a[20:23]
  buffer_load_dwordx4 v8, s[12:15], s30 offen offset:1024 lds
  v_mfma_f32_16x16x32_bf16 a[28:31], v[132:135], v[84:87], a[28:31]
  v_mfma_f32_16x16x32_bf16 a[36:39], v[136:139], v[84:87], a[36:39]
  s_waitcnt vmcnt(6) lgkmcnt(0)
  v_add_u32 v13, 1, v13
  v_cmp_gt_i32 vcc, s31, v20
  v_mfma_f32_16x16x32_bf16 a[44:47], v[140:143], v[84:87], a[44:47]
  ds_write_b32 v17, v13
  v_mfma_f32_16x16x32_bf16 a[52:55], v[144:147], v[84:87], a[52:55]
  v_mfma_f32_16x16x32_bf16 a[60:63], v[148:151], v[84:87], a[60:63]
  s_or_b64 vcc, vcc, s[48:49]
  v_xor_b32 v6, 0x8000, v6
  s_cbranch_vccnz L_attn_hnd_36
L_attn_spun_35:
  v_mfma_f32_16x16x32_bf16 v[48:51], v[88:91], v[28:31], v[164:167]
  ds_read_b128 v[120:123], v7 offset:16384
  v_mfma_f32_16x16x32_bf16 v[56:59], v[88:91], v[32:35], v[68:71]
  ds_read_b128 v[176:179], v7 offset:17408
  v_exp_f32 v156, v156
  v_mfma_f32_16x16x32_bf16 v[160:163], v[168:171], v[32:35], v[68:71]
  ds_read_b128 v[180:183], v7 offset:18432
  v_exp_f32 v157, v157
  v_mfma_f32_16x16x32_bf16 v[52:55], v[168:171], v[28:31], v[164:167]
  ds_read_b128 v[132:135], v7 offset:19456
  v_exp_f32 v158, v158
  v_mfma_f32_16x16x32_bf16 v[48:51], v[172:175], v[60:63], v[48:51]
  ds_read_b128 v[136:139], v7 offset:20480
  v_mfma_f32_16x16x32_bf16 v[56:59], v[172:175], v[64:67], v[56:59]
  ds_read_b128 v[140:143], v7 offset:21504
  v_exp_f32 v159, v159
  v_mfma_f32_16x16x32_bf16 v[160:163], v[100:103], v[64:67], v[160:163]
  ds_read_b128 v[144:147], v7 offset:22528
  v_exp_f32 v36, v36
  v_mfma_f32_16x16x32_bf16 v[52:55], v[100:103], v[60:63], v[52:55]
  ds_read_b128 v[148:151], v7 offset:23552
  v_exp_f32 v37, v37
  v_mfma_f32_16x16x32_bf16 v[48:51], v[104:107], v[92:95], v[48:51]
  v_exp_f32 v38, v38
  v_mfma_f32_16x16x32_bf16 v[56:59], v[104:107], v[96:99], v[56:59]
  v_exp_f32 v39, v39
  v_cvt_pk_bf16_f32 v80, v156, v157
  v_mfma_f32_16x16x32_bf16 v[160:163], v[108:111], v[96:99], v[160:163]
  v_cvt_pk_bf16_f32 v81, v158, v159
  v_cvt_pk_bf16_f32 v82, v36, v37
  v_mfma_f32_16x16x32_bf16 v[52:55], v[108:111], v[92:95], v[52:55]
  v_cvt_pk_bf16_f32 v83, v38, v39
  v_exp_f32 v40, v40
  v_mfma_f32_16x16x32_bf16 v[48:51], v[112:115], v[124:127], v[48:51]
  v_exp_f32 v41, v41
  v_mfma_f32_16x16x32_bf16 v[56:59], v[112:115], v[128:131], v[56:59]
  v_exp_f32 v42, v42
  s_add_u32 m0, s41, 24576
  v_mfma_f32_16x16x32_bf16 v[160:163], v[116:119], v[128:131], v[160:163]
  v_exp_f32 v43, v43
  s_add_u32 s30, s30, 8192
  buffer_load_dwordx4 v8, s[12:15], s30 offen offset:0 lds
  v_mfma_f32_16x16x32_bf16 v[52:55], v[116:119], v[124:127], v[52:55]
  v_exp_f32 v44, v44
  v_mfma_f32_16x16x32_bf16 v[184:187], v[72:75], v[80:83], v[184:187]
  ds_read_b128 v[88:91], v6 offset:0
  v_exp_f32 v45, v45
  s_waitcnt lgkmcnt(1)
  v_mfma_f32_16x16x32_bf16 a[0:3], v[120:123], v[80:83], a[0:3]
  ds_read_b128 v[168:171], v6 offset:1024
  v_exp_f32 v46, v46
  v_mfma_f32_16x16x32_bf16 a[8:11], v[176:179], v[80:83], a[8:11]
  ds_read_b128 v[172:175], v6 offset:2048
  v_max3_f32 v21, v48, v49, v50
  v_mfma_f32_16x16x32_bf16 a[16:19], v[180:183], v[80:83], a[16:19]
  ds_read_b128 v[100:103], v6 offset:3072
  v_exp_f32 v47, v47
  v_mfma_f32_16x16x32_bf16 a[24:27], v[132:135], v[80:83], a[24:27]
  ds_read_b128 v[104:107], v6 offset:4096
  v_cvt_pk_bf16_f32 v84, v40, v41
  v_mfma_f32_16x16x32_bf16 a[32:35], v[136:139], v[80:83], a[32:35]
  ds_read_b128 v[108:111], v6 offset:5120
  v_cvt_pk_bf16_f32 v85, v42, v43
  v_cvt_pk_bf16_f32 v86, v44, v45
  v_mfma_f32_16x16x32_bf16 a[40:43], v[140:143], v[80:83], a[40:43]
  ds_read_b128 v[112:115], v6 offset:6144
  v_cvt_pk_bf16_f32 v87, v46, v47
  v_mfma_f32_16x16x32_bf16 a[48:51], v[144:147], v[80:83], a[48:51]
  ds_read_b128 v[116:119], v6 offset:7168
  v_max3_f32 v21, v21, v51, v52
  v_max3_f32 v21, v21, v53, v54
  v_mfma_f32_16x16x32_bf16 a[56:59], v[148:151], v[80:83], a[56:59]
  v_max3_f32 v21, v21, v55, v56
  v_max3_f32 v21, v21, v57, v58
  v_mfma_f32_16x16x32_bf16 v[188:191], v[72:75], v[84:87], v[188:191]
  v_max3_f32 v21, v21, v59, v160
  v_max3_f32 v21, v21, v161, v162
  v_max_f32 v21, v21, v163
  v_mfma_f32_16x16x32_bf16 a[4:7], v[120:123], v[84:87], a[4:7]
  ds_read_b32 v20, v19
  s_add_u32 s31, s31, 1
  v_mfma_f32_16x16x32_bf16 a[12:15], v[176:179], v[84:87], a[12:15]
  v_cmp_ge_f32 s[48:49], v21, v12
  v_mfma_f32_16x16x32_bf16 a[20:23], v[180:183], v[84:87], a[20:23]
  buffer_load_dwordx4 v8, s[12:15], s30 offen offset:1024 lds
  v_mfma_f32_16x16x32_bf16 a[28:31], v[132:135], v[84:87], a[28:31]
  v_mfma_f32_16x16x32_bf16 a[36:39], v[136:139], v[84:87], a[36:39]
  s_waitcnt vmcnt(4) lgkmcnt(0)
  v_add_u32 v13, 1, v13
  v_cmp_gt_i32 vcc, s31, v20
  v_mfma_f32_16x16x32_bf16 a[44:47], v[140:143], v[84:87], a[44:47]
  ds_write_b32 v17, v13
  v_mfma_f32_16x16x32_bf16 a[52:55], v[144:147], v[84:87], a[52:55]
  v_mfma_f32_16x16x32_bf16 a[60:63], v[148:151], v[84:87], a[60:63]
  s_or_b64 vcc, vcc, s[48:49]
  s_cbranch_vccnz L_attn_hnd_40
L_attn_spun_39:
  s_cmp_eq_u32 s31, s32
  s_cbranch_scc1 L_attn_M3
  v_mfma_f32_16x16x32_bf16 v[156:159], v[88:91], v[28:31], v[164:167]
  ds_read_b128 v[120:123], v7 offset:24576
  v_mfma_f32_16x16x32_bf16 v[40:43], v[88:91], v[32:35], v[68:71]
  ds_read_b128 v[176:179], v7 offset:25600
  v_exp_f32 v48, v48
  v_mfma_f32_16x16x32_bf16 v[44:47], v[168:171], v[32:35], v[68:71]
  ds_read_b128 v[180:183], v7 offset:26624
  v_exp_f32 v49, v49
  v_mfma_f32_16x16x32_bf16 v[36:39], v[168:171], v[28:31], v[164:167]
  ds_read_b128 v[132:135], v7 offset:27648
  v_exp_f32 v50, v50
  v_mfma_f32_16x16x32_bf16 v[156:159], v[172:175], v[60:63], v[156:159]
  ds_read_b128 v[136:139], v7 offset:28672
  v_mfma_f32_16x16x32_bf16 v[40:43], v[172:175], v[64:67], v[40:43]
  ds_read_b128 v[140:143], v7 offset:29696
  v_exp_f32 v51, v51
  v_mfma_f32_16x16x32_bf16 v[44:47], v[100:103], v[64:67], v[44:47]
  ds_read_b128 v[144:147], v7 offset:30720
  v_exp_f32 v52, v52
  v_mfma_f32_16x16x32_bf16 v[36:39], v[100:103], v[60:63], v[36:39]
  ds_read_b128 v[148:151], v7 offset:31744
  v_exp_f32 v53, v53
  v_mfma_f32_16x16x32_bf16 v[156:159], v[104:107], v[92:95], v[156:159]
  v_exp_f32 v54, v54
  v_mfma_f32_16x16x32_bf16 v[40:43], v[104:107], v[96:99], v[40:43]
  v_exp_f32 v55, v55
  v_cvt_pk_bf16_f32 v80, v48, v49
  v_mfma_f32_16x16x32_bf16 v[44:47], v[108:111], v[96:99], v[44:47]
  v_cvt_pk_bf16_f32 v81, v50, v51
  v_cvt_pk_bf16_f32 v82, v52, v53
  v_mfma_f32_16x16x32_bf16 v[36:39], v[108:111], v[92:95], v[36:39]
  v_cvt_pk_bf16_f32 v83, v54, v55
  v_exp_f32 v56, v56
  v_mfma_f32_16x16x32_bf16 v[156:159], v[112:115], v[124:127], v[156:159]
  v_exp_f32 v57, v57
  v_mfma_f32_16x16x32_bf16 v[40:43], v[112:115], v[128:131], v[40:43]
  v_exp_f32 v58, v58
  v_mfma_f32_16x16x32_bf16 v[44:47], v[116:119], v[128:131], v[44:47]
  v_exp_f32 v59, v59
  v_mfma_f32_16x16x32_bf16 v[36:39], v[116:119], v[124:127], v[36:39]
  v_exp_f32 v160, v160
  v_exp_f32 v161, v161
  v_xor_b32 v7, 0x20000, v7
  v_mfma_f32_16x16x32_bf16 v[184:187], v[72:75], v[80:83], v[184:187]
  ds_read_b128 v[88:91], v6 offset:8192
  s_waitcnt lgkmcnt(1)
  v_mfma_f32_16x16x32_bf16 a[0:3], v[120:123], v[80:83], a[0:3]
  ds_read_b128 v[168:171], v6 offset:9216
  v_exp_f32 v162, v162
  v_mfma_f32_16x16x32_bf16 a[8:11], v[176:179], v[80:83], a[8:11]
  ds_read_b128 v[172:175], v6 offset:10240
  v_exp_f32 v163, v163
  v_mfma_f32_16x16x32_bf16 a[16:19], v[180:183], v[80:83], a[16:19]
  ds_read_b128 v[100:103], v6 offset:11264
  v_cvt_pk_bf16_f32 v84, v56, v57
  v_cvt_pk_bf16_f32 v85, v58, v59
  v_mfma_f32_16x16x32_bf16 a[24:27], v[132:135], v[80:83], a[24:27]
  ds_read_b128 v[104:107], v6 offset:12288
  v_cvt_pk_bf16_f32 v86, v160, v161
  v_mfma_f32_16x16x32_bf16 a[32:35], v[136:139], v[80:83], a[32:35]
  ds_read_b128 v[108:111], v6 offset:13312
  v_cvt_pk_bf16_f32 v87, v162, v163
  v_max3_f32 v21, v156, v157, v158
  v_mfma_f32_16x16x32_bf16 a[40:43], v[140:143], v[80:83], a[40:43]
  ds_read_b128 v[112:115], v6 offset:14336
  v_max3_f32 v21, v21, v159, v36
  v_mfma_f32_16x16x32_bf16 a[48:51], v[144:147], v[80:83], a[48:51]
  ds_read_b128 v[116:119], v6 offset:15360
  v_max3_f32 v21, v21, v37, v38
  v_max3_f32 v21, v21, v39, v40
  v_mfma_f32_16x16x32_bf16 a[56:59], v[148:151], v[80:83], a[56:59]
  v_max3_f32 v21, v21, v41, v42
  v_max3_f32 v21, v21, v43, v44
  v_mfma_f32_16x16x32_bf16 v[188:191], v[72:75], v[84:87], v[188:191]
  v_max3_f32 v21, v21, v45, v46
  v_max_f32 v21, v21, v47
  v_cmp_ge_f32 s[48:49], v21, v12
  v_mfma_f32_16x16x32_bf16 a[4:7], v[120:123], v[84:87], a[4:7]
  ds_read_b32 v20, v19
  s_add_u32 s31, s31, 1
  v_mfma_f32_16x16x32_bf16 a[12:15], v[176:179], v[84:87], a[12:15]
  v_mfma_f32_16x16x32_bf16 a[20:23], v[180:183], v[84:87], a[20:23]
  v_mfma_f32_16x16x32_bf16 a[28:31], v[132:135], v[84:87], a[28:31]
  v_mfma_f32_16x16x32_bf16 a[36:39], v[136:139], v[84:87], a[36:39]
  s_waitcnt vmcnt(0) lgkmcnt(0)
  v_add_u32 v13, 1, v13
  v_cmp_gt_i32 vcc, s31, v20
  v_mfma_f32_16x16x32_bf16 a[44:47], v[140:143], v[84:87], a[44:47]
  ds_write_b32 v17, v13
  v_mfma_f32_16x16x32_bf16 a[52:55], v[144:147], v[84:87], a[52:55]
  v_mfma_f32_16x16x32_bf16 a[60:63], v[148:151], v[84:87], a[60:63]
  s_or_b64 vcc, vcc, s[48:49]
  s_cbranch_vccnz L_attn_hnd_44
L_attn_spun_43:
  .p2align 3
L_attn_N0:
  s_cmp_eq_u32 s31, s32
  s_cbranch_scc1 L_attn_M0
  v_mfma_f32_16x16x32_bf16 v[48:51], v[88:91], v[28:31], v[164:167]
  ds_read_b128 v[120:123], v7 offset:0
  v_mfma_f32_16x16x32_bf16 v[56:59], v[88:91], v[32:35], v[68:71]
  ds_read_b128 v[176:179], v7 offset:1024
  v_exp_f32 v156, v156
  v_mfma_f32_16x16x32_bf16 v[160:163], v[168:171], v[32:35], v[68:71]
  ds_read_b128 v[180:183], v7 offset:2048
  v_exp_f32 v157, v157
  v_mfma_f32_16x16x32_bf16 v[52:55], v[168:171], v[28:31], v[164:167]
  ds_read_b128 v[132:135], v7 offset:3072
  v_exp_f32 v158, v158
  v_mfma_f32_16x16x32_bf16 v[48:51], v[172:175], v[60:63], v[48:51]
  ds_read_b128 v[136:139], v7 offset:4096
  v_mfma_f32_16x16x32_bf16 v[56:59], v[172:175], v[64:67], v[56:59]
  ds_read_b128 v[140:143], v7 offset:5120
  v_exp_f32 v159, v159
  v_mfma_f32_16x16x32_bf16 v[160:163], v[100:103], v[64:67], v[160:163]
  ds_read_b128 v[144:147], v7 offset:6144
  v_exp_f32 v36, v36
  v_mfma_f32_16x16x32_bf16 v[52:55], v[100:103], v[60:63], v[52:55]
  ds_read_b128 v[148:151], v7 offset:7168
  v_exp_f32 v37, v37
  v_mfma_f32_16x16x32_bf16 v[48:51], v[104:107], v[92:95], v[48:51]
  v_exp_f32 v38, v38
  v_mfma_f32_16x16x32_bf16 v[56:59], v[104:107], v[96:99], v[56:59]
  v_exp_f32 v39, v39
  v_cvt_pk_bf16_f32 v80, v156, v157
  v_mfma_f32_16x16x32_bf16 v[160:163], v[108:111], v[96:99], v[160:163]
  v_cvt_pk_bf16_f32 v81, v158, v159
  v_cvt_pk_bf16_f32 v82, v36, v37
  v_mfma_f32_16x16x32_bf16 v[52:55], v[108:111], v[92:95], v[52:55]
  v_cvt_pk_bf16_f32 v83, v38, v39
  v_exp_f32 v40, v40
  v_mfma_f32_16x16x32_bf16 v[48:51], v[112:115], v[124:127], v[48:51]
  v_exp_f32 v41, v41
  v_mfma_f32_16x16x32_bf16 v[56:59], v[112:115], v[128:131], v[56:59]
  v_exp_f32 v42, v42
  v_mfma_f32_16x16x32_bf16 v[160:163], v[116:119], v[128:131], v[160:163]
  v_exp_f32 v43, v43
  v_mfma_f32_16x16x32_bf16 v[52:55], v[116:119], v[124:127], v[52:55]
  v_exp_f32 v44, v44
  v_exp_f32 v45, v45
  v_mfma_f32_16x16x32_bf16 v[184:187], v[72:75], v[80:83], v[184:187]
  ds_read_b128 v[88:91], v6 offset:16384
  s_waitcnt lgkmcnt(1)
  v_mfma_f32_16x16x32_bf16 a[0:3], v[120:123], v[80:83], a[0:3]
  ds_read_b128 v[168:171], v6 offset:17408
  v_exp_f32 v46, v46
  v_mfma_f32_16x16x32_bf16 a[8:11], v[176:179], v[80:83], a[8:11]
  ds_read_b128 v[172:175], v6 offset:18432
  v_exp_f32 v47, v47
  v_mfma_f32_16x16x32_bf16 a[16:19], v[180:183], v[80:83], a[16:19]
  ds_read_b128 v[100:103], v6 offset:19456
  v_cvt_pk_bf16_f32 v84, v40, v41
  v_cvt_pk_bf16_f32 v85, v42, v43
  v_mfma_f32_16x16x32_bf16 a[24:27], v[132:135], v[80:83], a[24:27]
  ds_read_b128 v[104:107], v6 offset:20480
  v_cvt_pk_bf16_f32 v86, v44, v45
  v_mfma_f32_16x16x32_bf16 a[32:35], v[136:139], v[80:83], a[32:35]
  ds_read_b128 v[108:111], v6 offset:21504
  v_cvt_pk_bf16_f32 v87, v46, v47
  v_max3_f32 v21, v48, v49, v50
  v_mfma_f32_16x16x32_bf16 a[40:43], v[140:143], v[80:83], a[40:43]
  ds_read_b128 v[112:115], v6 offset:22528
  v_max3_f32 v21, v21, v51, v52
  v_mfma_f32_16x16x32_bf16 a[48:51], v[144:147], v[80:83], a[48:51]
  ds_read_b128 v[116:119], v6 offset:23552
  v_max3_f32 v21, v21, v53, v54
  v_max3_f32 v21, v21, v55, v56
  v_mfma_f32_16x16x32_bf16 a[56:59], v[148:151], v[80:83], a[56:59]
  v_max3_f32 v21, v21, v57, v58
  v_max3_f32 v21, v21, v59, v160
  v_mfma_f32_16x16x32_bf16 v[188:191], v[72:75], v[84:87], v[188:191]
  v_max3_f32 v21, v21, v161, v162
  v_max_f32 v21, v21, v163
  v_cmp_ge_f32 s[48:49], v21, v12
  v_mfma_f32_16x16x32_bf16 a[4:7], v[120:123], v[84:87], a[4:7]
  ds_read_b32 v20, v19
  s_add_u32 s31, s31, 1
  v_mfma_f32_16x16x32_bf16 a[12:15], v[176:179], v[84:87], a[12:15]
  v_mfma_f32_16x16x32_bf16 a[20:23], v[180:183], v[84:87], a[20:23]
  v_mfma_f32_16x16x32_bf16 a[28:31], v[132:135], v[84:87], a[28:31]
  v_mfma_f32_16x16x32_bf16 a[36:39], v[136:139], v[84:87], a[36:39]
  s_waitcnt vmcnt(0) lgkmcnt(0)
  v_add_u32 v13, 1, v13
  v_cmp_gt_i32 vcc, s31, v20
  v_mfma_f32_16x16x32_bf16 a[44:47], v[140:143], v[84:87], a[44:47]
  ds_write_b32 v17, v13
  v_mfma_f32_16x16x32_bf16 a[52:55], v[144:147], v[84:87], a[52:55]
  v_mfma_f32_16x16x32_bf16 a[60:63], v[148:151], v[84:87], a[60:63]
  s_or_b64 vcc, vcc, s[48:49]
  s_cbranch_vccnz L_attn_hnd_48
L_attn_spun_47:
L_attn_N1:
  s_cmp_eq_u32 s31, s32
  s_cbranch_scc1 L_attn_M1
  v_mfma_f32_16x16x32_bf16 v[156:159], v[88:91], v[28:31], v[164:167]
  ds_read_b128 v[120:123], v7 offset:8192
  v_mfma_f32_16x16x32_bf16 v[40:43], v[88:91], v[32:35], v[68:71]
  ds_read_b128 v[176:179], v7 offset:9216
  v_exp_f32 v48, v48
  v_mfma_f32_16x16x32_bf16 v[44:47], v[168:171], v[32:35], v[68:71]
  ds_read_b128 v[180:183], v7 offset:10240
  v_exp_f32 v49, v49
  v_mfma_f32_16x16x32_bf16 v[36:39], v[168:171], v[28:31], v[164:167]
  ds_read_b128 v[132:135], v7 offset:11264
  v_exp_f32 v50, v50
  v_mfma_f32_16x16x32_bf16 v[156:159], v[172:175], v[60:63], v[156:159]
  ds_read_b128 v[136:139], v7 offset:12288
  v_mfma_f32_16x16x32_bf16 v[40:43], v[172:175], v[64:67], v[40:43]
  ds_read_b128 v[140:143], v7 offset:13312
  v_exp_f32 v51, v51
  v_mfma_f32_16x16x32_bf16 v[44:47], v[100:103], v[64:67], v[44:47]
  ds_read_b128 v[144:147], v7 offset:14336
  v_exp_f32 v52, v52
  v_mfma_f32_16x16x32_bf16 v[36:39], v[100:103], v[60:63], v[36:39]
  ds_read_b128 v[148:151], v7 offset:15360
  v_exp_f32 v53, v53
  v_mfma_f32_16x16x32_bf16 v[156:159], v[104:107], v[92:95], v[156:159]
  v_exp_f32 v54, v54
  v_mfma_f32_16x16x32_bf16 v[40:43], v[104:107], v[96:99], v[40:43]
  v_exp_f32 v55, v55
  v_cvt_pk_bf16_f32 v80, v48, v49
  v_mfma_f32_16x16x32_bf16 v[44:47], v[108:111], v[96:99], v[44:47]
  v_cvt_pk_bf16_f32 v81, v50, v51
  v_cvt_pk_bf16_f32 v82, v52, v53
  v_mfma_f32_16x16x32_bf16 v[36:39], v[108:111], v[92:95], v[36:39]
  v_cvt_pk_bf16_f32 v83, v54, v55
  v_exp_f32 v56, v56
  v_mfma_f32_16x16x32_bf16 v[156:159], v[112:115], v[124:127], v[156:159]
  v_exp_f32 v57, v57
  v_mfma_f32_16x16x32_bf16 v[40:43], v[112:115], v[128:131], v[40:43]
  v_exp_f32 v58, v58
  v_mfma_f32_16x16x32_bf16 v[44:47], v[116:119], v[128:131], v[44:47]
  v_exp_f32 v59, v59
  v_mfma_f32_16x16x32_bf16 v[36:39], v[116:119], v[124:127], v[36:39]
  v_exp_f32 v160, v160
  v_exp_f32 v161, v161
  v_mfma_f32_16x16x32_bf16 v[184:187], v[72:75], v[80:83], v[184:187]
  ds_read_b128 v[88:91], v6 offset:24576
  s_waitcnt lgkmcnt(1)
  v_mfma_f32_16x16x32_bf16 a[0:3], v[120:123], v[80:83], a[0:3]
  ds_read_b128 v[168:171], v6 offset:25600
  v_exp_f32 v162, v162
  v_mfma_f32_16x16x32_bf16 a[8:11], v[176:179], v[80:83], a[8:11]
  ds_read_b128 v[172:175], v6 offset:26624
  v_exp_f32 v163, v163
  v_mfma_f32_16x16x32_bf16 a[16:19], v[180:183], v[80:83], a[16:19]
  ds_read_b128 v[100:103], v6 offset:27648
  v_cvt_pk_bf16_f32 v84, v56, v57
  v_cvt_pk_bf16_f32 v85, v58, v59
  v_mfma_f32_16x16x32_bf16 a[24:27], v[132:135], v[80:83], a[24:27]
  ds_read_b128 v[104:107], v6 offset:28672
  v_cvt_pk_bf16_f32 v86, v160, v161
  v_mfma_f32_16x16x32_bf16 a[32:35], v[136:139], v[80:83], a[32:35]
  ds_read_b128 v[108:111], v6 offset:29696
  v_cvt_pk_bf16_f32 v87, v162, v163
  v_max3_f32 v21, v156, v157, v158
  v_mfma_f32_16x16x32_bf16 a[40:43], v[140:143], v[80:83], a[40:43]
  ds_read_b128 v[112:115], v6 offset:30720
  v_max3_f32 v21, v21, v159, v36
  v_mfma_f32_16x16x32_bf16 a[48:51], v[144:147], v[80:83], a[48:51]
  ds_read_b128 v[116:119], v6 offset:31744
  v_max3_f32 v21, v21, v37, v38
  v_max3_f32 v21, v21, v39, v40
  v_mfma_f32_16x16x32_bf16 a[56:59], v[148:151], v[80:83], a[56:59]
  v_max3_f32 v21, v21, v41, v42
  v_max3_f32 v21, v21, v43, v44
  v_mfma_f32_16x16x32_bf16 v[188:191], v[72:75], v[84:87], v[188:191]
  v_max3_f32 v21, v21, v45, v46
  v_max_f32 v21, v21, v47
  v_cmp_ge_f32 s[48:49], v21, v12
  v_mfma_f32_16x16x32_bf16 a[4:7], v[120:123], v[84:87], a[4:7]
  ds_read_b32 v20, v19
  s_add_u32 s31, s31, 1
  v_mfma_f32_16x16x32_bf16 a[12:15], v[176:179], v[84:87], a[12:15]
  v_mfma_f32_16x16x32_bf16 a[20:23], v[180:183], v[84:87], a[20:23]
  v_mfma_f32_16x16x32_bf16 a[28:31], v[132:135], v[84:87], a[28:31]
  v_mfma_f32_16x16x32_bf16 a[36:39], v[136:139], v[84:87], a[36:39]
  s_waitcnt vmcnt(0) lgkmcnt(0)
  v_add_u32 v13, 1, v13
  v_cmp_gt_i32 vcc, s31, v20
  v_mfma_f32_16x16x32_bf16 a[44:47], v[140:143], v[84:87], a[44:47]
  ds_write_b32 v17, v13
  v_mfma_f32_16x16x32_bf16 a[52:55], v[144:147], v[84:87], a[52:55]
  v_mfma_f32_16x16x32_bf16 a[60:63], v[148:151], v[84:87], a[60:63]
  s_or_b64 vcc, vcc, s[48:49]
  v_xor_b32 v6, 0x8000, v6
  s_cbranch_vccnz L_attn_hnd_52
L_attn_spun_51:
L_attn_N2:
  s_cmp_eq_u32 s31, s32
  s_cbranch_scc1 L_attn_M2
  v_mfma_f32_16x16x32_bf16 v[48:51], v[88:91], v[28:31], v[164:167]
  ds_read_b128 v[120:123], v7 offset:16384
  v_mfma_f32_16x16x32_bf16 v[56:59], v[88:91], v[32:35], v[68:71]
  ds_read_b128 v[176:179], v7 offset:17408
  v_exp_f32 v156, v156
  v_mfma_f32_16x16x32_bf16 v[160:163], v[168:171], v[32:35], v[68:71]
  ds_read_b128 v[180:183], v7 offset:18432
  v_exp_f32 v157, v157
  v_mfma_f32_16x16x32_bf16 v[52:55], v[168:171], v[28:31], v[164:167]
  ds_read_b128 v[132:135], v7 offset:19456
  v_exp_f32 v158, v158
  v_mfma_f32_16x16x32_bf16 v[48:51], v[172:175], v[60:63], v[48:51]
  ds_read_b128 v[136:139], v7 offset:20480
  v_mfma_f32_16x16x32_bf16 v[56:59], v[172:175], v[64:67], v[56:59]
  ds_read_b128 v[140:143], v7 offset:21504
  v_exp_f32 v159, v159
  v_mfma_f32_16x16x32_bf16 v[160:163], v[100:103], v[64:67], v[160:163]
  ds_read_b128 v[144:147], v7 offset:22528
  v_exp_f32 v36, v36
  v_mfma_f32_16x16x32_bf16 v[52:55], v[100:103], v[60:63], v[52:55]
  ds_read_b128 v[148:151], v7 offset:23552
  v_exp_f32 v37, v37
  v_mfma_f32_16x16x32_bf16 v[48:51], v[104:107], v[92:95], v[48:51]
  v_exp_f32 v38, v38
  v_mfma_f32_16x16x32_bf16 v[56:59], v[104:107], v[96:99], v[56:59]
  v_exp_f32 v39, v39
  v_cvt_pk_bf16_f32 v80, v156, v157
  v_mfma_f32_16x16x32_bf16 v[160:163], v[108:111], v[96:99], v[160:163]
  v_cvt_pk_bf16_f32 v81, v158, v159
  v_cvt_pk_bf16_f32 v82, v36, v37
  v_mfma_f32_16x16x32_bf16 v[52:55], v[108:111], v[92:95], v[52:55]
  v_cvt_pk_bf16_f32 v83, v38, v39
  v_exp_f32 v40, v40
  v_mfma_f32_16x16x32_bf16 v[48:51], v[112:115], v[124:127], v[48:51]
  v_exp_f32 v41, v41
  v_mfma_f32_16x16x32_bf16 v[56:59], v[112:115], v[128:131], v[56:59]
  v_exp_f32 v42, v42
  v_mfma_f32_16x16x32_bf16 v[160:163], v[116:119], v[128:131], v[160:163]
  v_exp_f32 v43, v43
  v_mfma_f32_16x16x32_bf16 v[52:55], v[116:119], v[124:127], v[52:55]
  v_exp_f32 v44, v44
  v_exp_f32 v45, v45
  v_mfma_f32_16x16x32_bf16 v[184:187], v[72:75], v[80:83], v[184:187]
  ds_read_b128 v[88:91], v6 offset:0
  s_waitcnt lgkmcnt(1)
  v_mfma_f32_16x16x32_bf16 a[0:3], v[120:123], v[80:83], a[0:3]
  ds_read_b128 v[168:171], v6 offset:1024
  v_exp_f32 v46, v46
  v_mfma_f32_16x16x32_bf16 a[8:11], v[176:179], v[80:83], a[8:11]
  ds_read_b128 v[172:175], v6 offset:2048
  v_exp_f32 v47, v47
  v_mfma_f32_16x16x32_bf16 a[16:19], v[180:183], v[80:83], a[16:19]
  ds_read_b128 v[100:103], v6 offset:3072
  v_cvt_pk_bf16_f32 v84, v40, v41
  v_cvt_pk_bf16_f32 v85, v42, v43
  v_mfma_f32_16x16x32_bf16 a[24:27], v[132:135], v[80:83], a[24:27]
  ds_read_b128 v[104:107], v6 offset:4096
  v_cvt_pk_bf16_f32 v86, v44, v45
  v_mfma_f32_16x16x32_bf16 a[32:35], v[136:139], v[80:83], a[32:35]
  ds_read_b128 v[108:111], v6 offset:5120
  v_cvt_pk_bf16_f32 v87, v46, v47
  v_max3_f32 v21, v48, v49, v50
  v_mfma_f32_16x16x32_bf16 a[40:43], v[140:143], v[80:83], a[40:43]
  ds_read_b128 v[112:115], v6 offset:6144
  v_max3_f32 v21, v21, v51, v52
  v_mfma_f32_16x16x32_bf16 a[48:51], v[144:147], v[80:83], a[48:51]
  ds_read_b128 v[116:119], v6 offset:7168
  v_max3_f32 v21, v21, v53, v54
  v_max3_f32 v21, v21, v55, v56
  v_mfma_f32_16x16x32_bf16 a[56:59], v[148:151], v[80:83], a[56:59]
  v_max3_f32 v21, v21, v57, v58
  v_max3_f32 v21, v21, v59, v160
  v_mfma_f32_16x16x32_bf16 v[188:191], v[72:75], v[84:87], v[188:191]
  v_max3_f32 v21, v21, v161, v162
  v_max_f32 v21, v21, v163
  v_cmp_ge_f32 s[48:49], v21, v12
  v_mfma_f32_16x16x32_bf16 a[4:7], v[120:123], v[84:87], a[4:7]
  ds_read_b32 v20, v19
  s_add_u32 s31, s31, 1
  v_mfma_f32_16x16x32_bf16 a[12:15], v[176:179], v[84:87], a[12:15]
  v_mfma_f32_16x16x32_bf16 a[20:23], v[180:183], v[84:87], a[20:23]
  v_mfma_f32_16x16x32_bf16 a[28:31], v[132:135], v[84:87], a[28:31]
  v_mfma_f32_16x16x32_bf16 a[36:39], v[136:139], v[84:87], a[36:39]
  s_waitcnt vmcnt(0) lgkmcnt(0)
  v_add_u32 v13, 1, v13
  v_cmp_gt_i32 vcc, s31, v20
  v_mfma_f32_16x16x32_bf16 a[44:47], v[140:143], v[84:87], a[44:47]
  ds_write_b32 v17, v13
  v_mfma_f32_16x16x32_bf16 a[52:55], v[144:147], v[84:87], a[52:55]
  v_mfma_f32_16x16x32_bf16 a[60:63], v[148:151], v[84:87], a[60:63]
  s_or_b64 vcc, vcc, s[48:49]
  s_cbranch_vccnz L_attn_hnd_56
L_attn_spun_55:
L_attn_N3:
  s_cmp_eq_u32 s31, s32
  s_cbranch_scc1 L_attn_M3
  v_mfma_f32_16x16x32_bf16 v[156:159], v[88:91], v[28:31], v[164:167]
  ds_read_b128 v[120:123], v7 offset:24576
  v_mfma_f32_16x16x32_bf16 v[40:43], v[88:91], v[32:35], v[68:71]
  ds_read_b128 v[176:179], v7 offset:25600
  v_exp_f32 v48, v48
  v_mfma_f32_16x16x32_bf16 v[44:47], v[168:171], v[32:35], v[68:71]
  ds_read_b128 v[180:183], v7 offset:26624
  v_exp_f32 v49, v49
  v_mfma_f32_16x16x32_bf16 v[36:39], v[168:171], v[28:31], v[164:167]
  ds_read_b128 v[132:135], v7 offset:27648
  v_exp_f32 v50, v50
  v_mfma_f32_16x16x32_bf16 v[156:159], v[172:175], v[60:63], v[156:159]
  ds_read_b128 v[136:139], v7 offset:28672
  v_mfma_f32_16x16x32_bf16 v[40:43], v[172:175], v[64:67], v[40:43]
  ds_read_b128 v[140:143], v7 offset:29696
  v_exp_f32 v51, v51
  v_mfma_f32_16x16x32_bf16 v[44:47], v[100:103], v[64:67], v[44:47]
  ds_read_b128 v[144:147], v7 offset:30720
  v_exp_f32 v52, v52
  v_mfma_f32_16x16x32_bf16 v[36:39], v[100:103], v[60:63], v[36:39]
  ds_read_b128 v[148:151], v7 offset:31744
  v_exp_f32 v53, v53
  v_mfma_f32_16x16x32_bf16 v[156:159], v[104:107], v[92:95], v[156:159]
  v_exp_f32 v54, v54
  v_mfma_f32_16x16x32_bf16 v[40:43], v[104:107], v[96:99], v[40:43]
  v_exp_f32 v55, v55
  v_cvt_pk_bf16_f32 v80, v48, v49
  v_mfma_f32_16x16x32_bf16 v[44:47], v[108:111], v[96:99], v[44:47]
  v_cvt_pk_bf16_f32 v81, v50, v51
  v_cvt_pk_bf16_f32 v82, v52, v53
  v_mfma_f32_16x16x32_bf16 v[36:39], v[108:111], v[92:95], v[36:39]
  v_cvt_pk_bf16_f32 v83, v54, v55
  v_exp_f32 v56, v56
  v_mfma_f32_16x16x32_bf16 v[156:159], v[112:115], v[124:127], v[156:159]
  v_exp_f32 v57, v57
  v_mfma_f32_16x16x32_bf16 v[40:43], v[112:115], v[128:131], v[40:43]
  v_exp_f32 v58, v58
  v_mfma_f32_16x16x32_bf16 v[44:47], v[116:119], v[128:131], v[44:47]
  v_exp_f32 v59, v59
  v_mfma_f32_16x16x32_bf16 v[36:39], v[116:119], v[124:127], v[36:39]
  v_exp_f32 v160, v160
  v_exp_f32 v161, v161
  v_xor_b32 v7, 0x20000, v7
  v_mfma_f32_16x16x32_bf16 v[184:187], v[72:75], v[80:83], v[184:187]
  ds_read_b128 v[88:91], v6 offset:8192
  s_waitcnt lgkmcnt(1)
  v_mfma_f32_16x16x32_bf16 a[0:3], v[120:123], v[80:83], a[0:3]
  ds_read_b128 v[168:171], v6 offset:9216
  v_exp_f32 v162, v162
  v_mfma_f32_16x16x32_bf16 a[8:11], v[176:179], v[80:83], a[8:11]
  ds_read_b128 v[172:175], v6 offset:10240
  v_exp_f32 v163, v163
  v_mfma_f32_16x16x32_bf16 a[16:19], v[180:183], v[80:83], a[16:19]
  ds_read_b128 v[100:103], v6 offset:11264
  v_cvt_pk_bf16_f32 v84, v56, v57
  v_cvt_pk_bf16_f32 v85, v58, v59
  v_mfma_f32_16x16x32_bf16 a[24:27], v[132:135], v[80:83], a[24:27]
  ds_read_b128 v[104:107], v6 offset:12288
  v_cvt_pk_bf16_f32 v86, v160, v161
  v_mfma_f32_16x16x32_bf16 a[32:35], v[136:139], v[80:83], a[32:35]
  ds_read_b128 v[108:111], v6 offset:13312
  v_cvt_pk_bf16_f32 v87, v162, v163
  v_max3_f32 v21, v156, v157, v158
  v_mfma_f32_16x16x32_bf16 a[40:43], v[140:143], v[80:83], a[40:43]
  ds_read_b128 v[112:115], v6 offset:14336
  v_max3_f32 v21, v21, v159, v36
  v_mfma_f32_16x16x32_bf16 a[48:51], v[144:147], v[80:83], a[48:51]
  ds_read_b128 v[116:119], v6 offset:15360
  v_max3_f32 v21, v21, v37, v38
  v_max3_f32 v21, v21, v39, v40
  v_mfma_f32_16x16x32_bf16 a[56:59], v[148:151], v[80:83], a[56:59]
  v_max3_f32 v21, v21, v41, v42
  v_max3_f32 v21, v21, v43, v44
  v_mfma_f32_16x16x32_bf16 v[188:191], v[72:75], v[84:87], v[188:191]
  v_max3_f32 v21, v21, v45, v46
  v_max_f32 v21, v21, v47
  v_cmp_ge_f32 s[48:49], v21, v12
  v_mfma_f32_16x16x32_bf16 a[4:7], v[120:123], v[84:87], a[4:7]
  ds_read_b32 v20, v19
  s_add_u32 s31, s31, 1
  v_mfma_f32_16x16x32_bf16 a[12:15], v[176:179], v[84:87], a[12:15]
  v_mfma_f32_16x16x32_bf16 a[20:23], v[180:183], v[84:87], a[20:23]
  v_mfma_f32_16x16x32_bf16 a[28:31], v[132:135], v[84:87], a[28:31]
  v_mfma_f32_16x16x32_bf16 a[36:39], v[136:139], v[84:87], a[36:39]
  s_waitcnt vmcnt(0) lgkmcnt(0)
  v_add_u32 v13, 1, v13
  v_cmp_gt_i32 vcc, s31, v20
  v_mfma_f32_16x16x32_bf16 a[44:47], v[140:143], v[84:87], a[44:47]
  ds_write_b32 v17, v13
  v_mfma_f32_16x16x32_bf16 a[52:55], v[144:147], v[84:87], a[52:55]
  v_mfma_f32_16x16x32_bf16 a[60:63], v[148:151], v[84:87], a[60:63]
  s_or_b64 vcc, vcc, s[48:49]
  s_cbranch_vccnz L_attn_hnd_60
L_attn_spun_59:
  s_branch L_attn_N0
L_attn_T0:
  v_mfma_f32_16x16x32_bf16 v[48:51], v[88:91], v[28:31], v[164:167]
  ds_read_b128 v[120:123], v7 offset:0
  v_mfma_f32_16x16x32_bf16 v[56:59], v[88:91], v[32:35], v[68:71]
  ds_read_b128 v[176:179], v7 offset:1024
  v_exp_f32 v156, v156
  v_mfma_f32_16x16x32_bf16 v[160:163], v[168:171], v[32:35], v[68:71]
  ds_read_b128 v[180:183], v7 offset:2048
  v_exp_f32 v157, v157
  v_mfma_f32_16x16x32_bf16 v[52:55], v[168:171], v[28:31], v[164:167]
  ds_read_b128 v[132:135], v7 offset:3072
  v_exp_f32 v158, v158
  v_mfma_f32_16x16x32_bf16 v[48:51], v[172:175], v[60:63], v[48:51]
  ds_read_b128 v[136:139], v7 offset:4096
  v_mfma_f32_16x16x32_bf16 v[56:59], v[172:175], v[64:67], v[56:59]
  ds_read_b128 v[140:143], v7 offset:5120
  v_exp_f32 v159, v159
  v_mfma_f32_16x16x32_bf16 v[160:163], v[100:103], v[64:67], v[160:163]
  ds_read_b128 v[144:147], v7 offset:6144
  v_exp_f32 v36, v36
  v_mfma_f32_16x16x32_bf16 v[52:55], v[100:103], v[60:63], v[52:55]
  ds_read_b128 v[148:151], v7 offset:7168
  v_exp_f32 v37, v37
  v_mfma_f32_16x16x32_bf16 v[48:51], v[104:107], v[92:95], v[48:51]
  v_exp_f32 v38, v38
  v_mfma_f32_16x16x32_bf16 v[56:59], v[104:107], v[96:99], v[56:59]
  v_exp_f32 v39, v39
  v_cvt_pk_bf16_f32 v80, v156, v157
  v_mfma_f32_16x16x32_bf16 v[160:163], v[108:111], v[96:99], v[160:163]
  v_cvt_pk_bf16_f32 v81, v158, v159
  v_cvt_pk_bf16_f32 v82, v36, v37
  v_mfma_f32_16x16x32_bf16 v[52:55], v[108:111], v[92:95], v[52:55]
  v_cvt_pk_bf16_f32 v83, v38, v39
  v_exp_f32 v40, v40
  v_mfma_f32_16x16x32_bf16 v[48:51], v[112:115], v[124:127], v[48:51]
  v_exp_f32 v41, v41
  v_mfma_f32_16x16x32_bf16 v[56:59], v[112:115], v[128:131], v[56:59]
  v_exp_f32 v42, v42
  v_mfma_f32_16x16x32_bf16 v[160:163], v[116:119], v[128:131], v[160:163]
  v_exp_f32 v43, v43
  v_mfma_f32_16x16x32_bf16 v[52:55], v[116:119], v[124:127], v[52:55]
  v_exp_f32 v44, v44
  v_exp_f32 v45, v45
  v_mfma_f32_16x16x32_bf16 v[184:187], v[72:75], v[80:83], v[184:187]
  ds_read_b128 v[88:91], v6 offset:16384
  s_waitcnt lgkmcnt(1)
  v_mfma_f32_16x16x32_bf16 a[0:3], v[120:123], v[80:83], a[0:3]
  ds_read_b128 v[168:171], v6 offset:17408
  v_exp_f32 v46, v46
  v_mfma_f32_16x16x32_bf16 a[8:11], v[176:179], v[80:83], a[8:11]
  ds_read_b128 v[172:175], v6 offset:18432
  v_exp_f32 v47, v47
  v_mfma_f32_16x16x32_bf16 a[16:19], v[180:183], v[80:83], a[16:19]
  ds_read_b128 v[100:103], v6 offset:19456
  v_cvt_pk_bf16_f32 v84, v40, v41
  v_cvt_pk_bf16_f32 v85, v42, v43
  v_mfma_f32_16x16x32_bf16 a[24:27], v[132:135], v[80:83], a[24:27]
  ds_read_b128 v[104:107], v6 offset:20480
  v_cvt_pk_bf16_f32 v86, v44, v45
  v_mfma_f32_16x16x32_bf16 a[32:35], v[136:139], v[80:83], a[32:35]
  ds_read_b128 v[108:111], v6 offset:21504
  v_cvt_pk_bf16_f32 v87, v46, v47
  v_max3_f32 v21, v48, v49, v50
  v_mfma_f32_16x16x32_bf16 a[40:43], v[140:143], v[80:83], a[40:43]
  ds_read_b128 v[112:115], v6 offset:22528
  v_max3_f32 v21, v21, v51, v52
  v_mfma_f32_16x16x32_bf16 a[48:51], v[144:147], v[80:83], a[48:51]
  ds_read_b128 v[116:119], v6 offset:23552
  v_max3_f32 v21, v21, v53, v54
  v_max3_f32 v21, v21, v55, v56
  v_mfma_f32_16x16x32_bf16 a[56:59], v[148:151], v[80:83], a[56:59]
  v_max3_f32 v21, v21, v57, v58
  v_max3_f32 v21, v21, v59, v160
  v_mfma_f32_16x16x32_bf16 v[188:191], v[72:75], v[84:87], v[188:191]
  v_max3_f32 v21, v21, v161, v162
  v_max_f32 v21, v21, v163
  v_cmp_ge_f32 s[48:49], v21, v12
  v_mfma_f32_16x16x32_bf16 a[4:7], v[120:123], v[84:87], a[4:7]
  ds_read_b32 v20, v19
  s_add_u32 s31, s31, 1
  v_mfma_f32_16x16x32_bf16 a[12:15], v[176:179], v[84:87], a[12:15]
  v_mfma_f32_16x16x32_bf16 a[20:23], v[180:183], v[84:87], a[20:23]
  v_mfma_f32_16x16x32_bf16 a[28:31], v[132:135], v[84:87], a[28:31]
  v_mfma_f32_16x16x32_bf16 a[36:39], v[136:139], v[84:87], a[36:39]
  s_waitcnt vmcnt(4) lgkmcnt(0)
  v_add_u32 v13, 1, v13
  v_cmp_gt_i32 vcc, s31, v20
  v_mfma_f32_16x16x32_bf16 a[44:47], v[140:143], v[84:87], a[44:47]
  ds_write_b32 v17, v13
  v_mfma_f32_16x16x32_bf16 a[52:55], v[144:147], v[84:87], a[52:55]
  v_mfma_f32_16x16x32_bf16 a[60:63], v[148:151], v[84:87], a[60:63]
  s_or_b64 vcc, vcc, s[48:49]
  s_cbranch_vccnz L_attn_hnd_64
L_attn_spun_63:
  v_mfma_f32_16x16x32_bf16 v[156:159], v[88:91], v[28:31], v[164:167]
  ds_read_b128 v[120:123], v7 offset:8192
  v_mfma_f32_16x16x32_bf16 v[40:43], v[88:91], v[32:35], v[68:71]
  ds_read_b128 v[176:179], v7 offset:9216
  v_exp_f32 v48, v48
  v_mfma_f32_16x16x32_bf16 v[44:47], v[168:171], v[32:35], v[68:71]
  ds_read_b128 v[180:183], v7 offset:10240
  v_exp_f32 v49, v49
  v_mfma_f32_16x16x32_bf16 v[36:39], v[168:171], v[28:31], v[164:167]
  ds_read_b128 v[132:135], v7 offset:11264
  v_exp_f32 v50, v50
  v_mfma_f32_16x16x32_bf16 v[156:159], v[172:175], v[60:63], v[156:159]
  ds_read_b128 v[136:139], v7 offset:12288
  v_mfma_f32_16x16x32_bf16 v[40:43], v[172:175], v[64:67], v[40:43]
  ds_read_b128 v[140:143], v7 offset:13312
  v_exp_f32 v51, v51
  v_mfma_f32_16x16x32_bf16 v[44:47], v[100:103], v[64:67], v[44:47]
  ds_read_b128 v[144:147], v7 offset:14336
  v_exp_f32 v52, v52
  v_mfma_f32_16x16x32_bf16 v[36:39], v[100:103], v[60:63], v[36:39]
  ds_read_b128 v[148:151], v7 offset:15360
  v_exp_f32 v53, v53
  v_mfma_f32_16x16x32_bf16 v[156:159], v[104:107], v[92:95], v[156:159]
  v_exp_f32 v54, v54
  v_mfma_f32_16x16x32_bf16 v[40:43], v[104:107], v[96:99], v[40:43]
  v_exp_f32 v55, v55
  v_cvt_pk_bf16_f32 v80, v48, v49
  v_mfma_f32_16x16x32_bf16 v[44:47], v[108:111], v[96:99], v[44:47]
  v_cvt_pk_bf16_f32 v81, v50, v51
  v_cvt_pk_bf16_f32 v82, v52, v53
  v_mfma_f32_16x16x32_bf16 v[36:39], v[108:111], v[92:95], v[36:39]
  v_cvt_pk_bf16_f32 v83, v54, v55
  v_exp_f32 v56, v56
  v_mfma_f32_16x16x32_bf16 v[156:159], v[112:115], v[124:127], v[156:159]
  v_exp_f32 v57, v57
  v_mfma_f32_16x16x32_bf16 v[40:43], v[112:115], v[128:131], v[40:43]
  v_exp_f32 v58, v58
  v_mfma_f32_16x16x32_bf16 v[44:47], v[116:119], v[128:131], v[44:47]
  v_exp_f32 v59, v59
  v_mfma_f32_16x16x32_bf16 v[36:39], v[116:119], v[124:127], v[36:39]
  v_exp_f32 v160, v160
  v_exp_f32 v161, v161
  v_mfma_f32_16x16x32_bf16 v[184:187], v[72:75], v[80:83], v[184:187]
  ds_read_b128 v[88:91], v6 offset:24576
  s_waitcnt lgkmcnt(1)
  v_mfma_f32_16x16x32_bf16 a[0:3], v[120:123], v[80:83], a[0:3]
  ds_read_b128 v[168:171], v6 offset:25600
  v_exp_f32 v162, v162
  v_mfma_f32_16x16x32_bf16 a[8:11], v[176:179], v[80:83], a[8:11]
  ds_read_b128 v[172:175], v6 offset:26624
  v_exp_f32 v163, v163
  v_mfma_f32_16x16x32_bf16 a[16:19], v[180:183], v[80:83], a[16:19]
  ds_read_b128 v[100:103], v6 offset:27648
  v_cvt_pk_bf16_f32 v84, v56, v57
  v_cvt_pk_bf16_f32 v85, v58, v59
  v_mfma_f32_16x16x32_bf16 a[24:27], v[132:135], v[80:83], a[24:27]
  ds_read_b128 v[104:107], v6 offset:28672
  v_cvt_pk_bf16_f32 v86, v160, v161
  v_mfma_f32_16x16x32_bf16 a[32:35], v[136:139], v[80:83], a[32:35]
  ds_read_b128 v[108:111], v6 offset:29696
  v_cvt_pk_bf16_f32 v87, v162, v163
  v_max3_f32 v21, v156, v157, v158
  v_mfma_f32_16x16x32_bf16 a[40:43], v[140:143], v[80:83], a[40:43]
  ds_read_b128 v[112:115], v6 offset:30720
  v_max3_f32 v21, v21, v159, v36
  v_mfma_f32_16x16x32_bf16 a[48:51], v[144:147], v[80:83], a[48:51]
  ds_read_b128 v[116:119], v6 offset:31744
  v_max3_f32 v21, v21, v37, v38
  v_max3_f32 v21, v21, v39, v40
  v_mfma_f32_16x16x32_bf16 a[56:59], v[148:151], v[80:83], a[56:59]
  v_max3_f32 v21, v21, v41, v42
  v_max3_f32 v21, v21, v43, v44
  v_mfma_f32_16x16x32_bf16 v[188:191], v[72:75], v[84:87], v[188:191]
  v_max3_f32 v21, v21, v45, v46
  v_max_f32 v21, v21, v47
  v_cmp_ge_f32 s[48:49], v21, v12
  v_mfma_f32_16x16x32_bf16 a[4:7], v[120:123], v[84:87], a[4:7]
  ds_read_b32 v20, v19
  s_add_u32 s31, s31, 1
  v_mfma_f32_16x16x32_bf16 a[12:15], v[176:179], v[84:87], a[12:15]
  v_mfma_f32_16x16x32_bf16 a[20:23], v[180:183], v[84:87], a[20:23]
  v_mfma_f32_16x16x32_bf16 a[28:31], v[132:135], v[84:87], a[28:31]
  v_mfma_f32_16x16x32_bf16 a[36:39], v[136:139], v[84:87], a[36:39]
  s_waitcnt vmcnt(0) lgkmcnt(0)
  v_add_u32 v13, 1, v13
  v_cmp_gt_i32 vcc, s31, v20
  v_mfma_f32_16x16x32_bf16 a[44:47], v[140:143], v[84:87], a[44:47]
  ds_write_b32 v17, v13
  v_mfma_f32_16x16x32_bf16 a[52:55], v[144:147], v[84:87], a[52:55]
  v_mfma_f32_16x16x32_bf16 a[60:63], v[148:151], v[84:87], a[60:63]
  s_or_b64 vcc, vcc, s[48:49]
  v_xor_b32 v6, 0x8000, v6
  s_cbranch_vccnz L_attn_hnd_68
L_attn_spun_67:
  s_branch L_attn_N2
L_attn_M0:
  v_mfma_f32_16x16x32_bf16 v[48:51], v[88:91], v[28:31], v[164:167]
  ds_read_b128 v[120:123], v7 offset:0
  v_mfma_f32_16x16x32_bf16 v[56:59], v[88:91], v[32:35], v[68:71]
  ds_read_b128 v[176:179], v7 offset:1024
  v_exp_f32 v156, v156
  v_mfma_f32_16x16x32_bf16 v[160:163], v[168:171], v[32:35], v[68:71]
  ds_read_b128 v[180:183], v7 offset:2048
  v_exp_f32 v157, v157
  v_mfma_f32_16x16x32_bf16 v[52:55], v[168:171], v[28:31], v[164:167]
  ds_read_b128 v[132:135], v7 offset:3072
  v_exp_f32 v158, v158
  v_mfma_f32_16x16x32_bf16 v[48:51], v[172:175], v[60:63], v[48:51]
  ds_read_b128 v[136:139], v7 offset:4096
  v_mfma_f32_16x16x32_bf16 v[56:59], v[172:175], v[64:67], v[56:59]
  ds_read_b128 v[140:143], v7 offset:5120
  v_exp_f32 v159, v159
  v_mfma_f32_16x16x32_bf16 v[160:163], v[100:103], v[64:67], v[160:163]
  ds_read_b128 v[144:147], v7 offset:6144
  v_exp_f32 v36, v36
  v_mfma_f32_16x16x32_bf16 v[52:55], v[100:103], v[60:63], v[52:55]
  ds_read_b128 v[148:151], v7 offset:7168
  v_exp_f32 v37, v37
  v_mfma_f32_16x16x32_bf16 v[48:51], v[104:107], v[92:95], v[48:51]
  v_exp_f32 v38, v38
  v_mfma_f32_16x16x32_bf16 v[56:59], v[104:107], v[96:99], v[56:59]
  v_exp_f32 v39, v39
  v_cvt_pk_bf16_f32 v80, v156, v157
  v_mfma_f32_16x16x32_bf16 v[160:163], v[108:111], v[96:99], v[160:163]
  v_cvt_pk_bf16_f32 v81, v158, v159
  v_cvt_pk_bf16_f32 v82, v36, v37
  v_mfma_f32_16x16x32_bf16 v[52:55], v[108:111], v[92:95], v[52:55]
  v_cvt_pk_bf16_f32 v83, v38, v39
  v_exp_f32 v40, v40
  v_mfma_f32_16x16x32_bf16 v[48:51], v[112:115], v[124:127], v[48:51]
  v_exp_f32 v41, v41
  v_mfma_f32_16x16x32_bf16 v[56:59], v[112:115], v[128:131], v[56:59]
  v_exp_f32 v42, v42
  v_mfma_f32_16x16x32_bf16 v[160:163], v[116:119], v[128:131], v[160:163]
  v_exp_f32 v43, v43
  v_mfma_f32_16x16x32_bf16 v[52:55], v[116:119], v[124:127], v[52:55]
  v_exp_f32 v44, v44
  v_exp_f32 v45, v45
  v_mfma_f32_16x16x32_bf16 v[184:187], v[72:75], v[80:83], v[184:187]
  v_exp_f32 v46, v46
  s_waitcnt lgkmcnt(0)
  v_mfma_f32_16x16x32_bf16 a[0:3], v[120:123], v[80:83], a[0:3]
  v_exp_f32 v47, v47
  v_cvt_pk_bf16_f32 v84, v40, v41
  v_mfma_f32_16x16x32_bf16 a[8:11], v[176:179], v[80:83], a[8:11]
  v_cvt_pk_bf16_f32 v85, v42, v43
  v_cvt_pk_bf16_f32 v86, v44, v45
  v_mfma_f32_16x16x32_bf16 a[16:19], v[180:183], v[80:83], a[16:19]
  v_cvt_pk_bf16_f32 v87, v46, v47
  v_cmp_ge_i32 s[48:49], v14, 0
  v_cmp_ge_i32 s[50:51], v14, 1
  v_mfma_f32_16x16x32_bf16 a[24:27], v[132:135], v[80:83], a[24:27]
  v_cmp_ge_i32 s[52:53], v14, 2
  v_cmp_ge_i32 s[54:55], v14, 3
  v_mfma_f32_16x16x32_bf16 a[32:35], v[136:139], v[80:83], a[32:35]
  v_mov_b32 v52, v16
  v_mov_b32 v53, v16
  v_mov_b32 v54, v16
  v_mfma_f32_16x16x32_bf16 a[40:43], v[140:143], v[80:83], a[40:43]
  v_mov_b32 v55, v16
  v_cndmask_b32 v48, v16, v48, s[48:49]
  v_mfma_f32_16x16x32_bf16 a[48:51], v[144:147], v[80:83], a[48:51]
  v_cndmask_b32 v49, v16, v49, s[50:51]
  v_cndmask_b32 v50, v16, v50, s[52:53]
  v_cndmask_b32 v51, v16, v51, s[54:55]
  v_mfma_f32_16x16x32_bf16 a[56:59], v[148:151], v[80:83], a[56:59]
  v_cndmask_b32 v160, v16, v160, s[48:49]
  v_cndmask_b32 v161, v16, v161, s[50:51]
  v_mfma_f32_16x16x32_bf16 v[188:191], v[72:75], v[84:87], v[188:191]
  v_cndmask_b32 v162, v16, v162, s[52:53]
  v_cndmask_b32 v163, v16, v163, s[54:55]
  v_max3_f32 v21, v48, v49, v50
  v_mfma_f32_16x16x32_bf16 a[4:7], v[120:123], v[84:87], a[4:7]
  ds_read_b32 v20, v19
  s_add_u32 s31, s31, 1
  v_mfma_f32_16x16x32_bf16 a[12:15], v[176:179], v[84:87], a[12:15]
  v_max3_f32 v21, v21, v51, v52
  v_max3_f32 v21, v21, v53, v54
  v_max3_f32 v21, v21, v55, v56
  v_mfma_f32_16x16x32_bf16 a[20:23], v[180:183], v[84:87], a[20:23]
  v_max3_f32 v21, v21, v57, v58
  v_max3_f32 v21, v21, v59, v160
  v_mfma_f32_16x16x32_bf16 a[28:31], v[132:135], v[84:87], a[28:31]
  v_max3_f32 v21, v21, v161, v162
  v_max_f32 v21, v21, v163
  v_cmp_ge_f32 s[48:49], v21, v12
  v_mfma_f32_16x16x32_bf16 a[36:39], v[136:139], v[84:87], a[36:39]
  s_waitcnt vmcnt(0) lgkmcnt(0)
  v_add_u32 v13, 1, v13
  v_cmp_gt_i32 vcc, s31, v20
  v_mfma_f32_16x16x32_bf16 a[44:47], v[140:143], v[84:87], a[44:47]
  ds_write_b32 v17, v13
  v_mfma_f32_16x16x32_bf16 a[52:55], v[144:147], v[84:87], a[52:55]
  v_mfma_f32_16x16x32_bf16 a[60:63], v[148:151], v[84:87], a[60:63]
  s_or_b64 vcc, vcc, s[48:49]
  s_cbranch_vccnz L_attn_hnd_72
L_attn_spun_71:
L_attn_L1:
  ds_read_b128 v[120:123], v7 offset:8192
  ds_read_b128 v[180:183], v7 offset:10240
  ds_read_b128 v[136:139], v7 offset:12288
  ds_read_b128 v[144:147], v7 offset:14336
  ds_read_b128 v[176:179], v7 offset:9216
  ds_read_b128 v[132:135], v7 offset:11264
  ds_read_b128 v[140:143], v7 offset:13312
  ds_read_b128 v[148:151], v7 offset:15360
  v_exp_f32 v48, v48
  v_exp_f32 v49, v49
  v_exp_f32 v50, v50
  v_exp_f32 v51, v51
  v_exp_f32 v52, v52
  v_exp_f32 v53, v53
  v_exp_f32 v54, v54
  v_exp_f32 v55, v55
  v_cvt_pk_bf16_f32 v80, v48, v49
  v_cvt_pk_bf16_f32 v81, v50, v51
  v_cvt_pk_bf16_f32 v82, v52, v53
  v_cvt_pk_bf16_f32 v83, v54, v55
  v_mov_b32 v2, s44
  s_waitcnt lgkmcnt(0)
  ds_write_b32 v17, v2
  v_mfma_f32_16x16x32_bf16 v[184:187], v[72:75], v[80:83], v[184:187]
  v_exp_f32 v56, v56
  v_mfma_f32_16x16x32_bf16 a[0:3], v[120:123], v[80:83], a[0:3]
  v_exp_f32 v57, v57
  v_mfma_f32_16x16x32_bf16 a[8:11], v[176:179], v[80:83], a[8:11]
  v_exp_f32 v58, v58
  v_mfma_f32_16x16x32_bf16 a[16:19], v[180:183], v[80:83], a[16:19]
  v_exp_f32 v59, v59
  v_exp_f32 v160, v160
  v_mfma_f32_16x16x32_bf16 a[24:27], v[132:135], v[80:83], a[24:27]
  v_exp_f32 v161, v161
  v_mfma_f32_16x16x32_bf16 a[32:35], v[136:139], v[80:83], a[32:35]
  v_exp_f32 v162, v162
  v_mfma_f32_16x16x32_bf16 a[40:43], v[140:143], v[80:83], a[40:43]
  v_exp_f32 v163, v163
  v_cvt_pk_bf16_f32 v84, v56, v57
  v_mfma_f32_16x16x32_bf16 a[48:51], v[144:147], v[80:83], a[48:51]
  v_cvt_pk_bf16_f32 v85, v58, v59
  v_cvt_pk_bf16_f32 v86, v160, v161
  v_cvt_pk_bf16_f32 v87, v162, v163
  v_mfma_f32_16x16x32_bf16 a[56:59], v[148:151], v[80:83], a[56:59]
  s_nop 1
  v_mfma_f32_16x16x32_bf16 v[188:191], v[72:75], v[84:87], v[188:191]
  v_mfma_f32_16x16x32_bf16 a[4:7], v[120:123], v[84:87], a[4:7]
  v_mfma_f32_16x16x32_bf16 a[12:15], v[176:179], v[84:87], a[12:15]
  v_mfma_f32_16x16x32_bf16 a[20:23], v[180:183], v[84:87], a[20:23]
  v_mfma_f32_16x16x32_bf16 a[28:31], v[132:135], v[84:87], a[28:31]
  v_mfma_f32_16x16x32_bf16 a[36:39], v[136:139], v[84:87], a[36:39]
  v_mfma_f32_16x16x32_bf16 a[44:47], v[140:143], v[84:87], a[44:47]
  v_mfma_f32_16x16x32_bf16 a[52:55], v[144:147], v[84:87], a[52:55]
  v_mfma_f32_16x16x32_bf16 a[60:63], v[148:151], v[84:87], a[60:63]
  s_branch L_attn_epi
L_attn_M1:
  v_mfma_f32_16x16x32_bf16 v[156:159], v[88:91], v[28:31], v[164:167]
  ds_read_b128 v[120:123], v7 offset:8192
  v_mfma_f32_16x16x32_bf16 v[40:43], v[88:91], v[32:35], v[68:71]
  ds_read_b128 v[176:179], v7 offset:9216
  v_exp_f32 v48, v48
  v_mfma_f32_16x16x32_bf16 v[44:47], v[168:171], v[32:35], v[68:71]
  ds_read_b128 v[180:183], v7 offset:10240
  v_exp_f32 v49, v49
  v_mfma_f32_16x16x32_bf16 v[36:39], v[168:171], v[28:31], v[164:167]
  ds_read_b128 v[132:135], v7 offset:11264
  v_exp_f32 v50, v50
  v_mfma_f32_16x16x32_bf16 v[156:159], v[172:175], v[60:63], v[156:159]
  ds_read_b128 v[136:139], v7 offset:12288
  v_mfma_f32_16x16x32_bf16 v[40:43], v[172:175], v[64:67], v[40:43]
  ds_read_b128 v[140:143], v7 offset:13312
  v_exp_f32 v51, v51
  v_mfma_f32_16x16x32_bf16 v[44:47], v[100:103], v[64:67], v[44:47]
  ds_read_b128 v[144:147], v7 offset:14336
  v_exp_f32 v52, v52
  v_mfma_f32_16x16x32_bf16 v[36:39], v[100:103], v[60:63], v[36:39]
  ds_read_b128 v[148:151], v7 offset:15360
  v_exp_f32 v53, v53
  v_mfma_f32_16x16x32_bf16 v[156:159], v[104:107], v[92:95], v[156:159]
  v_exp_f32 v54, v54
  v_mfma_f32_16x16x32_bf16 v[40:43], v[104:107], v[96:99], v[40:43]
  v_exp_f32 v55, v55
  v_cvt_pk_bf16_f32 v80, v48, v49
  v_mfma_f32_16x16x32_bf16 v[44:47], v[108:111], v[96:99], v[44:47]
  v_cvt_pk_bf16_f32 v81, v50, v51
  v_cvt_pk_bf16_f32 v82, v52, v53
  v_mfma_f32_16x16x32_bf16 v[36:39], v[108:111], v[92:95], v[36:39]
  v_cvt_pk_bf16_f32 v83, v54, v55
  v_exp_f32 v56, v56
  v_mfma_f32_16x16x32_bf16 v[156:159], v[112:115], v[124:127], v[156:159]
  v_exp_f32 v57, v57
  v_mfma_f32_16x16x32_bf16 v[40:43], v[112:115], v[128:131], v[40:43]
  v_exp_f32 v58, v58
  v_mfma_f32_16x16x32_bf16 v[44:47], v[116:119], v[128:131], v[44:47]
  v_exp_f32 v59, v59
  v_mfma_f32_16x16x32_bf16 v[36:39], v[116:119], v[124:127], v[36:39]
  v_exp_f32 v160, v160
  v_exp_f32 v161, v161
  v_mfma_f32_16x16x32_bf16 v[184:187], v[72:75], v[80:83], v[184:187]
  v_exp_f32 v162, v162
  s_waitcnt lgkmcnt(0)
  v_mfma_f32_16x16x32_bf16 a[0:3], v[120:123], v[80:83], a[0:3]
  v_exp_f32 v163, v163
  v_cvt_pk_bf16_f32 v84, v56, v57
  v_mfma_f32_16x16x32_bf16 a[8:11], v[176:179], v[80:83], a[8:11]
  v_cvt_pk_bf16_f32 v85, v58, v59
  v_cvt_pk_bf16_f32 v86, v160, v161
  v_mfma_f32_16x16x32_bf16 a[16:19], v[180:183], v[80:83], a[16:19]
  v_cvt_pk_bf16_f32 v87, v162, v163
  v_cmp_ge_i32 s[48:49], v14, 0
  v_cmp_ge_i32 s[50:51], v14, 1
  v_mfma_f32_16x16x32_bf16 a[24:27], v[132:135], v[80:83], a[24:27]
  v_cmp_ge_i32 s[52:53], v14, 2
  v_cmp_ge_i32 s[54:55], v14, 3
  v_mfma_f32_16x16x32_bf16 a[32:35], v[136:139], v[80:83], a[32:35]
  v_mov_b32 v36, v16
  v_mov_b32 v37, v16
  v_mov_b32 v38, v16
  v_mfma_f32_16x16x32_bf16 a[40:43], v[140:143], v[80:83], a[40:43]
  v_mov_b32 v39, v16
  v_cndmask_b32 v156, v16, v156, s[48:49]
  v_mfma_f32_16x16x32_bf16 a[48:51], v[144:147], v[80:83], a[48:51]
  v_cndmask_b32 v157, v16, v157, s[50:51]
  v_cndmask_b32 v158, v16, v158, s[52:53]
  v_cndmask_b32 v159, v16, v159, s[54:55]
  v_mfma_f32_16x16x32_bf16 a[56:59], v[148:151], v[80:83], a[56:59]
  v_cndmask_b32 v44, v16, v44, s[48:49]
  v_cndmask_b32 v45, v16, v45, s[50:51]
  v_mfma_f32_16x16x32_bf16 v[188:191], v[72:75], v[84:87], v[188:191]
  v_cndmask_b32 v46, v16, v46, s[52:53]
  v_cndmask_b32 v47, v16, v47, s[54:55]
  v_max3_f32 v21, v156, v157, v158
  v_mfma_f32_16x16x32_bf16 a[4:7], v[120:123], v[84:87], a[4:7]
  ds_read_b32 v20, v19
  s_add_u32 s31, s31, 1
  v_mfma_f32_16x16x32_bf16 a[12:15], v[176:179], v[84:87], a[12:15]
  v_max3_f32 v21, v21, v159, v36
  v_max3_f32 v21, v21, v37, v38
  v_max3_f32 v21, v21, v39, v40
  v_mfma_f32_16x16x32_bf16 a[20:23], v[180:183], v[84:87], a[20:23]
  v_max3_f32 v21, v21, v41, v42
  v_max3_f32 v21, v21, v43, v44
  v_mfma_f32_16x16x32_bf16 a[28:31], v[132:135], v[84:87], a[28:31]
  v_max3_f32 v21, v21, v45, v46
  v_max_f32 v21, v21, v47
  v_cmp_ge_f32 s[48:49], v21, v12
  v_mfma_f32_16x16x32_bf16 a[36:39], v[136:139], v[84:87], a[36:39]
  s_waitcnt vmcnt(0) lgkmcnt(0)
  v_add_u32 v13, 1, v13
  v_cmp_gt_i32 vcc, s31, v20
  v_mfma_f32_16x16x32_bf16 a[44:47], v[140:143], v[84:87], a[44:47]
  ds_write_b32 v17, v13
  v_mfma_f32_16x16x32_bf16 a[52:55], v[144:147], v[84:87], a[52:55]
  v_mfma_f32_16x16x32_bf16 a[60:63], v[148:151], v[84:87], a[60:63]
  s_or_b64 vcc, vcc, s[48:49]
  v_xor_b32 v6, 0x8000, v6
  s_cbranch_vccnz L_attn_hnd_76
L_attn_spun_75:
L_attn_L2:
  ds_read_b128 v[120:123], v7 offset:16384
  ds_read_b128 v[180:183], v7 offset:18432
  ds_read_b128 v[136:139], v7 offset:20480
  ds_read_b128 v[144:147], v7 offset:22528
  ds_read_b128 v[176:179], v7 offset:17408
  ds_read_b128 v[132:135], v7 offset:19456
  ds_read_b128 v[140:143], v7 offset:21504
  ds_read_b128 v[148:151], v7 offset:23552
  v_exp_f32 v156, v156
  v_exp_f32 v157, v157
  v_exp_f32 v158, v158
  v_exp_f32 v159, v159
  v_exp_f32 v36, v36
  v_exp_f32 v37, v37
  v_exp_f32 v38, v38
  v_exp_f32 v39, v39
  v_cvt_pk_bf16_f32 v80, v156, v157
  v_cvt_pk_bf16_f32 v81, v158, v159
  v_cvt_pk_bf16_f32 v82, v36, v37
  v_cvt_pk_bf16_f32 v83, v38, v39
  v_mov_b32 v2, s44
  s_waitcnt lgkmcnt(0)
  ds_write_b32 v17, v2
  v_mfma_f32_16x16x32_bf16 v[184:187], v[72:75], v[80:83], v[184:187]
  v_exp_f32 v40, v40
  v_mfma_f32_16x16x32_bf16 a[0:3], v[120:123], v[80:83], a[0:3]
  v_exp_f32 v41, v41
  v_mfma_f32_16x16x32_bf16 a[8:11], v[176:179], v[80:83], a[8:11]
  v_exp_f32 v42, v42
  v_mfma_f32_16x16x32_bf16 a[16:19], v[180:183], v[80:83], a[16:19]
  v_exp_f32 v43, v43
  v_exp_f32 v44, v44
  v_mfma_f32_16x16x32_bf16 a[24:27], v[132:135], v[80:83], a[24:27]
  v_exp_f32 v45, v45
  v_mfma_f32_16x16x32_bf16 a[32:35], v[136:139], v[80:83], a[32:35]
  v_exp_f32 v46, v46
  v_mfma_f32_16x16x32_bf16 a[40:43], v[140:143], v[80:83], a[40:43]
  v_exp_f32 v47, v47
  v_cvt_pk_bf16_f32 v84, v40, v41
  v_mfma_f32_16x16x32_bf16 a[48:51], v[144:147], v[80:83], a[48:51]
  v_cvt_pk_bf16_f32 v85, v42, v43
  v_cvt_pk_bf16_f32 v86, v44, v45
  v_cvt_pk_bf16_f32 v87, v46, v47
  v_mfma_f32_16x16x32_bf16 a[56:59], v[148:151], v[80:83], a[56:59]
  s_nop 1
  v_mfma_f32_16x16x32_bf16 v[188:191], v[72:75], v[84:87], v[188:191]
  v_mfma_f32_16x16x32_bf16 a[4:7], v[120:123], v[84:87], a[4:7]
  v_mfma_f32_16x16x32_bf16 a[12:15], v[176:179], v[84:87], a[12:15]
  v_mfma_f32_16x16x32_bf16 a[20:23], v[180:183], v[84:87], a[20:23]
  v_mfma_f32_16x16x32_bf16 a[28:31], v[132:135], v[84:87], a[28:31]
  v_mfma_f32_16x16x32_bf16 a[36:39], v[136:139], v[84:87], a[36:39]
  v_mfma_f32_16x16x32_bf16 a[44:47], v[140:143], v[84:87], a[44:47]
  v_mfma_f32_16x16x32_bf16 a[52:55], v[144:147], v[84:87], a[52:55]
  v_mfma_f32_16x16x32_bf16 a[60:63], v[148:151], v[84:87], a[60:63]
  s_branch L_attn_epi
L_attn_M2:
  v_mfma_f32_16x16x32_bf16 v[48:51], v[88:91], v[28:31], v[164:167]
  ds_read_b128 v[120:123], v7 offset:16384
  v_mfma_f32_16x16x32_bf16 v[56:59], v[88:91], v[32:35], v[68:71]
  ds_read_b128 v[176:179], v7 offset:17408
  v_exp_f32 v156, v156
  v_mfma_f32_16x16x32_bf16 v[160:163], v[168:171], v[32:35], v[68:71]
  ds_read_b128 v[180:183], v7 offset:18432
  v_exp_f32 v157, v157
  v_mfma_f32_16x16x32_bf16 v[52:55], v[168:171], v[28:31], v[164:167]
  ds_read_b128 v[132:135], v7 offset:19456
  v_exp_f32 v158, v158
  v_mfma_f32_16x16x32_bf16 v[48:51], v[172:175], v[60:63], v[48:51]
  ds_read_b128 v[136:139], v7 offset:20480
  v_mfma_f32_16x16x32_bf16 v[56:59], v[172:175], v[64:67], v[56:59]
  ds_read_b128 v[140:143], v7 offset:21504
  v_exp_f32 v159, v159
  v_mfma_f32_16x16x32_bf16 v[160:163], v[100:103], v[64:67], v[160:163]
  ds_read_b128 v[144:147], v7 offset:22528
  v_exp_f32 v36, v36
  v_mfma_f32_16x16x32_bf16 v[52:55], v[100:103], v[60:63], v[52:55]
  ds_read_b128 v[148:151], v7 offset:23552
  v_exp_f32 v37, v37
  v_mfma_f32_16x16x32_bf16 v[48:51], v[104:107], v[92:95], v[48:51]
  v_exp_f32 v38, v38
  v_mfma_f32_16x16x32_bf16 v[56:59], v[104:107], v[96:99], v[56:59]
  v_exp_f32 v39, v39
  v_cvt_pk_bf16_f32 v80, v156, v157
  v_mfma_f32_16x16x32_bf16 v[160:163], v[108:111], v[96:99], v[160:163]
  v_cvt_pk_bf16_f32 v81, v158, v159
  v_cvt_pk_bf16_f32 v82, v36, v37
  v_mfma_f32_16x16x32_bf16 v[52:55], v[108:111], v[92:95], v[52:55]
  v_cvt_pk_bf16_f32 v83, v38, v39
  v_exp_f32 v40, v40
  v_mfma_f32_16x16x32_bf16 v[48:51], v[112:115], v[124:127], v[48:51]
  v_exp_f32 v41, v41
  v_mfma_f32_16x16x32_bf16 v[56:59], v[112:115], v[128:131], v[56:59]
  v_exp_f32 v42, v42
  v_mfma_f32_16x16x32_bf16 v[160:163], v[116:119], v[128:131], v[160:163]
  v_exp_f32 v43, v43
  v_mfma_f32_16x16x32_bf16 v[52:55], v[116:119], v[124:127], v[52:55]
  v_exp_f32 v44, v44
  v_exp_f32 v45, v45
  v_mfma_f32_16x16x32_bf16 v[184:187], v[72:75], v[80:83], v[184:187]
  v_exp_f32 v46, v46
  s_waitcnt lgkmcnt(0)
  v_mfma_f32_16x16x32_bf16 a[0:3], v[120:123], v[80:83], a[0:3]
  v_exp_f32 v47, v47
  v_cvt_pk_bf16_f32 v84, v40, v41
  v_mfma_f32_16x16x32_bf16 a[8:11], v[176:179], v[80:83], a[8:11]
  v_cvt_pk_bf16_f32 v85, v42, v43
  v_cvt_pk_bf16_f32 v86, v44, v45
  v_mfma_f32_16x16x32_bf16 a[16:19], v[180:183], v[80:83], a[16:19]
  v_cvt_pk_bf16_f32 v87, v46, v47
  v_cmp_ge_i32 s[48:49], v14, 0
  v_cmp_ge_i32 s[50:51], v14, 1
  v_mfma_f32_16x16x32_bf16 a[24:27], v[132:135], v[80:83], a[24:27]
  v_cmp_ge_i32 s[52:53], v14, 2
  v_cmp_ge_i32 s[54:55], v14, 3
  v_mfma_f32_16x16x32_bf16 a[32:35], v[136:139], v[80:83], a[32:35]
  v_mov_b32 v52, v16
  v_mov_b32 v53, v16
  v_mov_b32 v54, v16
  v_mfma_f32_16x16x32_bf16 a[40:43], v[140:143], v[80:83], a[40:43]
  v_mov_b32 v55, v16
  v_cndmask_b32 v48, v16, v48, s[48:49]
  v_mfma_f32_16x16x32_bf16 a[48:51], v[144:147], v[80:83], a[48:51]
  v_cndmask_b32 v49, v16, v49, s[50:51]
  v_cndmask_b32 v50, v16, v50, s[52:53]
  v_cndmask_b32 v51, v16, v51, s[54:55]
  v_mfma_f32_16x16x32_bf16 a[56:59], v[148:151], v[80:83], a[56:59]
  v_cndmask_b32 v160, v16, v160, s[48:49]
  v_cndmask_b32 v161, v16, v161, s[50:51]
  v_mfma_f32_16x16x32_bf16 v[188:191], v[72:75], v[84:87], v[188:191]
  v_cndmask_b32 v162, v16, v162, s[52:53]
  v_cndmask_b32 v163, v16, v163, s[54:55]
  v_max3_f32 v21, v48, v49, v50
  v_mfma_f32_16x16x32_bf16 a[4:7], v[120:123], v[84:87], a[4:7]
  ds_read_b32 v20, v19
  s_add_u32 s31, s31, 1
  v_mfma_f32_16x16x32_bf16 a[12:15], v[176:179], v[84:87], a[12:15]
  v_max3_f32 v21, v21, v51, v52
  v_max3_f32 v21, v21, v53, v54
  v_max3_f32 v21, v21, v55, v56
  v_mfma_f32_16x16x32_bf16 a[20:23], v[180:183], v[84:87], a[20:23]
  v_max3_f32 v21, v21, v57, v58
  v_max3_f32 v21, v21, v59, v160
  v_mfma_f32_16x16x32_bf16 a[28:31], v[132:135], v[84:87], a[28:31]
  v_max3_f32 v21, v21, v161, v162
  v_max_f32 v21, v21, v163
  v_cmp_ge_f32 s[48:49], v21, v12
  v_mfma_f32_16x16x32_bf16 a[36:39], v[136:139], v[84:87], a[36:39]
  s_waitcnt vmcnt(0) lgkmcnt(0)
  v_add_u32 v13, 1, v13
  v_cmp_gt_i32 vcc, s31, v20
  v_mfma_f32_16x16x32_bf16 a[44:47], v[140:143], v[84:87], a[44:47]
  ds_write_b32 v17, v13
  v_mfma_f32_16x16x32_bf16 a[52:55], v[144:147], v[84:87], a[52:55]
  v_mfma_f32_16x16x32_bf16 a[60:63], v[148:151], v[84:87], a[60:63]
  s_or_b64 vcc, vcc, s[48:49]
  s_cbranch_vccnz L_attn_hnd_80
L_attn_spun_79:
L_attn_L3:
  ds_read_b128 v[120:123], v7 offset:24576
  ds_read_b128 v[180:183], v7 offset:26624
  ds_read_b128 v[136:139], v7 offset:28672
  ds_read_b128 v[144:147], v7 offset:30720
  ds_read_b128 v[176:179], v7 offset:25600
  ds_read_b128 v[132:135], v7 offset:27648
  ds_read_b128 v[140:143], v7 offset:29696
  ds_read_b128 v[148:151], v7 offset:31744
  v_exp_f32 v48, v48
  v_exp_f32 v49, v49
  v_exp_f32 v50, v50
  v_exp_f32 v51, v51
  v_exp_f32 v52, v52
  v_exp_f32 v53, v53
  v_exp_f32 v54, v54
  v_exp_f32 v55, v55
  v_cvt_pk_bf16_f32 v80, v48, v49
  v_cvt_pk_bf16_f32 v81, v50, v51
  v_cvt_pk_bf16_f32 v82, v52, v53
  v_cvt_pk_bf16_f32 v83, v54, v55
  v_mov_b32 v2, s44
  s_waitcnt lgkmcnt(0)
  ds_write_b32 v17, v2
  v_mfma_f32_16x16x32_bf16 v[184:187], v[72:75], v[80:83], v[184:187]
  v_exp_f32 v56, v56
  v_mfma_f32_16x16x32_bf16 a[0:3], v[120:123], v[80:83], a[0:3]
  v_exp_f32 v57, v57
  v_mfma_f32_16x16x32_bf16 a[8:11], v[176:179], v[80:83], a[8:11]
  v_exp_f32 v58, v58
  v_mfma_f32_16x16x32_bf16 a[16:19], v[180:183], v[80:83], a[16:19]
  v_exp_f32 v59, v59
  v_exp_f32 v160, v160
  v_mfma_f32_16x16x32_bf16 a[24:27], v[132:135], v[80:83], a[24:27]
  v_exp_f32 v161, v161
  v_mfma_f32_16x16x32_bf16 a[32:35], v[136:139], v[80:83], a[32:35]
  v_exp_f32 v162, v162
  v_mfma_f32_16x16x32_bf16 a[40:43], v[140:143], v[80:83], a[40:43]
  v_exp_f32 v163, v163
  v_cvt_pk_bf16_f32 v84, v56, v57
  v_mfma_f32_16x16x32_bf16 a[48:51], v[144:147], v[80:83], a[48:51]
  v_cvt_pk_bf16_f32 v85, v58, v59
  v_cvt_pk_bf16_f32 v86, v160, v161
  v_cvt_pk_bf16_f32 v87, v162, v163
  v_mfma_f32_16x16x32_bf16 a[56:59], v[148:151], v[80:83], a[56:59]
  s_nop 1
  v_mfma_f32_16x16x32_bf16 v[188:191], v[72:75], v[84:87], v[188:191]
  v_mfma_f32_16x16x32_bf16 a[4:7], v[120:123], v[84:87], a[4:7]
  v_mfma_f32_16x16x32_bf16 a[12:15], v[176:179], v[84:87], a[12:15]
  v_mfma_f32_16x16x32_bf16 a[20:23], v[180:183], v[84:87], a[20:23]
  v_mfma_f32_16x16x32_bf16 a[28:31], v[132:135], v[84:87], a[28:31]
  v_mfma_f32_16x16x32_bf16 a[36:39], v[136:139], v[84:87], a[36:39]
  v_mfma_f32_16x16x32_bf16 a[44:47], v[140:143], v[84:87], a[44:47]
  v_mfma_f32_16x16x32_bf16 a[52:55], v[144:147], v[84:87], a[52:55]
  v_mfma_f32_16x16x32_bf16 a[60:63], v[148:151], v[84:87], a[60:63]
  s_branch L_attn_epi
L_attn_M3:
  v_mfma_f32_16x16x32_bf16 v[156:159], v[88:91], v[28:31], v[164:167]
  ds_read_b128 v[120:123], v7 offset:24576
  v_mfma_f32_16x16x32_bf16 v[40:43], v[88:91], v[32:35], v[68:71]
  ds_read_b128 v[176:179], v7 offset:25600
  v_exp_f32 v48, v48
  v_mfma_f32_16x16x32_bf16 v[44:47], v[168:171], v[32:35], v[68:71]
  ds_read_b128 v[180:183], v7 offset:26624
  v_exp_f32 v49, v49
  v_mfma_f32_16x16x32_bf16 v[36:39], v[168:171], v[28:31], v[164:167]
  ds_read_b128 v[132:135], v7 offset:27648
  v_exp_f32 v50, v50
  v_mfma_f32_16x16x32_bf16 v[156:159], v[172:175], v[60:63], v[156:159]
  ds_read_b128 v[136:139], v7 offset:28672
  v_mfma_f32_16x16x32_bf16 v[40:43], v[172:175], v[64:67], v[40:43]
  ds_read_b128 v[140:143], v7 offset:29696
  v_exp_f32 v51, v51
  v_mfma_f32_16x16x32_bf16 v[44:47], v[100:103], v[64:67], v[44:47]
  ds_read_b128 v[144:147], v7 offset:30720
  v_exp_f32 v52, v52
  v_mfma_f32_16x16x32_bf16 v[36:39], v[100:103], v[60:63], v[36:39]
  ds_read_b128 v[148:151], v7 offset:31744
  v_exp_f32 v53, v53
  v_mfma_f32_16x16x32_bf16 v[156:159], v[104:107], v[92:95], v[156:159]
  v_exp_f32 v54, v54
  v_mfma_f32_16x16x32_bf16 v[40:43], v[104:107], v[96:99], v[40:43]
  v_exp_f32 v55, v55
  v_cvt_pk_bf16_f32 v80, v48, v49
  v_mfma_f32_16x16x32_bf16 v[44:47], v[108:111], v[96:99], v[44:47]
  v_cvt_pk_bf16_f32 v81, v50, v51
  v_cvt_pk_bf16_f32 v82, v52, v53
  v_mfma_f32_16x16x32_bf16 v[36:39], v[108:111], v[92:95], v[36:39]
  v_cvt_pk_bf16_f32 v83, v54, v55
  v_exp_f32 v56, v56
  v_mfma_f32_16x16x32_bf16 v[156:159], v[112:115], v[124:127], v[156:159]
  v_exp_f32 v57, v57
  v_mfma_f32_16x16x32_bf16 v[40:43], v[112:115], v[128:131], v[40:43]
  v_exp_f32 v58, v58
  v_mfma_f32_16x16x32_bf16 v[44:47], v[116:119], v[128:131], v[44:47]
  v_exp_f32 v59, v59
  v_mfma_f32_16x16x32_bf16 v[36:39], v[116:119], v[124:127], v[36:39]
  v_exp_f32 v160, v160
  v_exp_f32 v161, v161
  v_xor_b32 v7, 0x20000, v7
  v_mfma_f32_16x16x32_bf16 v[184:187], v[72:75], v[80:83], v[184:187]
  v_exp_f32 v162, v162
  s_waitcnt lgkmcnt(0)
  v_mfma_f32_16x16x32_bf16 a[0:3], v[120:123], v[80:83], a[0:3]
  v_exp_f32 v163, v163
  v_cvt_pk_bf16_f32 v84, v56, v57
  v_mfma_f32_16x16x32_bf16 a[8:11], v[176:179], v[80:83], a[8:11]
  v_cvt_pk_bf16_f32 v85, v58, v59
  v_cvt_pk_bf16_f32 v86, v160, v161
  v_mfma_f32_16x16x32_bf16 a[16:19], v[180:183], v[80:83], a[16:19]
  v_cvt_pk_bf16_f32 v87, v162, v163
  v_cmp_ge_i32 s[48:49], v14, 0
  v_cmp_ge_i32 s[50:51], v14, 1
  v_mfma_f32_16x16x32_bf16 a[24:27], v[132:135], v[80:83], a[24:27]
  v_cmp_ge_i32 s[52:53], v14, 2
  v_cmp_ge_i32 s[54:55], v14, 3
  v_mfma_f32_16x16x32_bf16 a[32:35], v[136:139], v[80:83], a[32:35]
  v_mov_b32 v36, v16
  v_mov_b32 v37, v16
  v_mov_b32 v38, v16
  v_mfma_f32_16x16x32_bf16 a[40:43], v[140:143], v[80:83], a[40:43]
  v_mov_b32 v39, v16
  v_cndmask_b32 v156, v16, v156, s[48:49]
  v_mfma_f32_16x16x32_bf16 a[48:51], v[144:147], v[80:83], a[48:51]
  v_cndmask_b32 v157, v16, v157, s[50:51]
  v_cndmask_b32 v158, v16, v158, s[52:53]
  v_cndmask_b32 v159, v16, v159, s[54:55]
  v_mfma_f32_16x16x32_bf16 a[56:59], v[148:151], v[80:83], a[56:59]
  v_cndmask_b32 v44, v16, v44, s[48:49]
  v_cndmask_b32 v45, v16, v45, s[50:51]
  v_mfma_f32_16x16x32_bf16 v[188:191], v[72:75], v[84:87], v[188:191]
  v_cndmask_b32 v46, v16, v46, s[52:53]
  v_cndmask_b32 v47, v16, v47, s[54:55]
  v_max3_f32 v21, v156, v157, v158
  v_mfma_f32_16x16x32_bf16 a[4:7], v[120:123], v[84:87], a[4:7]
  ds_read_b32 v20, v19
  s_add_u32 s31, s31, 1
  v_mfma_f32_16x16x32_bf16 a[12:15], v[176:179], v[84:87], a[12:15]
  v_max3_f32 v21, v21, v159, v36
  v_max3_f32 v21, v21, v37, v38
  v_max3_f32 v21, v21, v39, v40
  v_mfma_f32_16x16x32_bf16 a[20:23], v[180:183], v[84:87], a[20:23]
  v_max3_f32 v21, v21, v41, v42
  v_max3_f32 v21, v21, v43, v44
  v_mfma_f32_16x16x32_bf16 a[28:31], v[132:135], v[84:87], a[28:31]
  v_max3_f32 v21, v21, v45, v46
  v_max_f32 v21, v21, v47
  v_cmp_ge_f32 s[48:49], v21, v12
  v_mfma_f32_16x16x32_bf16 a[36:39], v[136:139], v[84:87], a[36:39]
  s_waitcnt vmcnt(0) lgkmcnt(0)
  v_add_u32 v13, 1, v13
  v_cmp_gt_i32 vcc, s31, v20
  v_mfma_f32_16x16x32_bf16 a[44:47], v[140:143], v[84:87], a[44:47]
  ds_write_b32 v17, v13
  v_mfma_f32_16x16x32_bf16 a[52:55], v[144:147], v[84:87], a[52:55]
  v_mfma_f32_16x16x32_bf16 a[60:63], v[148:151], v[84:87], a[60:63]
  s_or_b64 vcc, vcc, s[48:49]
  s_cbranch_vccnz L_attn_hnd_84
L_attn_spun_83:
L_attn_L0:
  ds_read_b128 v[120:123], v7 offset:0
  ds_read_b128 v[180:183], v7 offset:2048
  ds_read_b128 v[136:139], v7 offset:4096
  ds_read_b128 v[144:147], v7 offset:6144
  ds_read_b128 v[176:179], v7 offset:1024
  ds_read_b128 v[132:135], v7 offset:3072
  ds_read_b128 v[140:143], v7 offset:5120
  ds_read_b128 v[148:151], v7 offset:7168
  v_exp_f32 v156, v156
  v_exp_f32 v157, v157
  v_exp_f32 v158, v158
  v_exp_f32 v159, v159
  v_exp_f32 v36, v36
  v_exp_f32 v37, v37
  v_exp_f32 v38, v38
  v_exp_f32 v39, v39
  v_cvt_pk_bf16_f32 v80, v156, v157
  v_cvt_pk_bf16_f32 v81, v158, v159
  v_cvt_pk_bf16_f32 v82, v36, v37
  v_cvt_pk_bf16_f32 v83, v38, v39
  v_mov_b32 v2, s44
  s_waitcnt lgkmcnt(0)
  ds_write_b32 v17, v2
  v_mfma_f32_16x16x32_bf16 v[184:187], v[72:75], v[80:83], v[184:187]
  v_exp_f32 v40, v40
  v_mfma_f32_16x16x32_bf16 a[0:3], v[120:123], v[80:83], a[0:3]
  v_exp_f32 v41, v41
  v_mfma_f32_16x16x32_bf16 a[8:11], v[176:179], v[80:83], a[8:11]
  v_exp_f32 v42, v42
  v_mfma_f32_16x16x32_bf16 a[16:19], v[180:183], v[80:83], a[16:19]
  v_exp_f32 v43, v43
  v_exp_f32 v44, v44
  v_mfma_f32_16x16x32_bf16 a[24:27], v[132:135], v[80:83], a[24:27]
  v_exp_f32 v45, v45
  v_mfma_f32_16x16x32_bf16 a[32:35], v[136:139], v[80:83], a[32:35]
  v_exp_f32 v46, v46
  v_mfma_f32_16x16x32_bf16 a[40:43], v[140:143], v[80:83], a[40:43]
  v_exp_f32 v47, v47
  v_cvt_pk_bf16_f32 v84, v40, v41
  v_mfma_f32_16x16x32_bf16 a[48:51], v[144:147], v[80:83], a[48:51]
  v_cvt_pk_bf16_f32 v85, v42, v43
  v_cvt_pk_bf16_f32 v86, v44, v45
  v_cvt_pk_bf16_f32 v87, v46, v47
  v_mfma_f32_16x16x32_bf16 a[56:59], v[148:151], v[80:83], a[56:59]
  s_nop 1
  v_mfma_f32_16x16x32_bf16 v[188:191], v[72:75], v[84:87], v[188:191]
  v_mfma_f32_16x16x32_bf16 a[4:7], v[120:123], v[84:87], a[4:7]
  v_mfma_f32_16x16x32_bf16 a[12:15], v[176:179], v[84:87], a[12:15]
  v_mfma_f32_16x16x32_bf16 a[20:23], v[180:183], v[84:87], a[20:23]
  v_mfma_f32_16x16x32_bf16 a[28:31], v[132:135], v[84:87], a[28:31]
  v_mfma_f32_16x16x32_bf16 a[36:39], v[136:139], v[84:87], a[36:39]
  v_mfma_f32_16x16x32_bf16 a[44:47], v[140:143], v[84:87], a[44:47]
  v_mfma_f32_16x16x32_bf16 a[52:55], v[144:147], v[84:87], a[52:55]
  v_mfma_f32_16x16x32_bf16 a[60:63], v[148:151], v[84:87], a[60:63]
L_attn_epi:
  v_rcp_f32 v21, v184
  v_rcp_f32 v10, v188
  s_nop 3
  s_mov_b32 s37, 0
  s_mov_b32 s38, 4096
  s_nop 1
  v_accvgpr_read_b32 v22, a0
  v_mul_f32 v22, v22, v21
  v_accvgpr_read_b32 v23, a1
  v_mul_f32 v23, v23, v21
  v_cvt_pk_bf16_f32 v88, v22, v23
  v_accvgpr_read_b32 v24, a2
  v_mul_f32 v24, v24, v21
  v_accvgpr_read_b32 v25, a3
  v_mul_f32 v25, v25, v21
  v_cvt_pk_bf16_f32 v89, v24, v25
  v_accvgpr_read_b32 v22, a4
  v_mul_f32 v22, v22, v10
  v_accvgpr_read_b32 v23, a5
  v_mul_f32 v23, v23, v10
  v_cvt_pk_bf16_f32 v90, v22, v23
  v_accvgpr_read_b32 v24, a6
  v_mul_f32 v24, v24, v10
  v_accvgpr_read_b32 v25, a7
  v_mul_f32 v25, v25, v10
  v_cvt_pk_bf16_f32 v91, v24, v25
  v_accvgpr_read_b32 v22, a8
  v_mul_f32 v22, v22, v21
  v_accvgpr_read_b32 v23, a9
  v_mul_f32 v23, v23, v21
  v_cvt_pk_bf16_f32 v168, v22, v23
  v_accvgpr_read_b32 v24, a10
  v_mul_f32 v24, v24, v21
  v_accvgpr_read_b32 v25, a11
  v_mul_f32 v25, v25, v21
  v_cvt_pk_bf16_f32 v169, v24, v25
  v_accvgpr_read_b32 v22, a12
  v_mul_f32 v22, v22, v10
  v_accvgpr_read_b32 v23, a13
  v_mul_f32 v23, v23, v10
  v_cvt_pk_bf16_f32 v170, v22, v23
  v_accvgpr_read_b32 v24, a14
  v_mul_f32 v24, v24, v10
  v_accvgpr_read_b32 v25, a15
  v_mul_f32 v25, v25, v10
  v_cvt_pk_bf16_f32 v171, v24, v25
  s_nop 1
  v_permlane16_swap_b32 v88, v90
  v_permlane16_swap_b32 v89, v91
  v_permlane16_swap_b32 v168, v170
  v_permlane16_swap_b32 v169, v171
  buffer_store_dwordx4 v[88:91], v18, s[20:23], s37 offen offset:0 sc1
  buffer_store_dwordx4 v[168:171], v18, s[20:23], s37 offen offset:1024 sc1
  v_accvgpr_read_b32 v22, a16
  v_mul_f32 v22, v22, v21
  v_accvgpr_read_b32 v23, a17
  v_mul_f32 v23, v23, v21
  v_cvt_pk_bf16_f32 v172, v22, v23
  v_accvgpr_read_b32 v24, a18
  v_mul_f32 v24, v24, v21
  v_accvgpr_read_b32 v25, a19
  v_mul_f32 v25, v25, v21
  v_cvt_pk_bf16_f32 v173, v24, v25
  v_accvgpr_read_b32 v22, a20
  v_mul_f32 v22, v22, v10
  v_accvgpr_read_b32 v23, a21
  v_mul_f32 v23, v23, v10
  v_cvt_pk_bf16_f32 v174, v22, v23
  v_accvgpr_read_b32 v24, a22
  v_mul_f32 v24, v24, v10
  v_accvgpr_read_b32 v25, a23
  v_mul_f32 v25, v25, v10
  v_cvt_pk_bf16_f32 v175, v24, v25
  v_accvgpr_read_b32 v22, a24
  v_mul_f32 v22, v22, v21
  v_accvgpr_read_b32 v23, a25
  v_mul_f32 v23, v23, v21
  v_cvt_pk_bf16_f32 v100, v22, v23
  v_accvgpr_read_b32 v24, a26
  v_mul_f32 v24, v24, v21
  v_accvgpr_read_b32 v25, a27
  v_mul_f32 v25, v25, v21
  v_cvt_pk_bf16_f32 v101, v24, v25
  v_accvgpr_read_b32 v22, a28
  v_mul_f32 v22, v22, v10
  v_accvgpr_read_b32 v23, a29
  v_mul_f32 v23, v23, v10
  v_cvt_pk_bf16_f32 v102, v22, v23
  v_accvgpr_read_b32 v24, a30
  v_mul_f32 v24, v24, v10
  v_accvgpr_read_b32 v25, a31
  v_mul_f32 v25, v25, v10
  v_cvt_pk_bf16_f32 v103, v24, v25
  s_nop 1
  v_permlane16_swap_b32 v172, v174
  v_permlane16_swap_b32 v173, v175
  v_permlane16_swap_b32 v100, v102
  v_permlane16_swap_b32 v101, v103
  buffer_store_dwordx4 v[172:175], v18, s[20:23], s37 offen offset:2048 sc1
  buffer_store_dwordx4 v[100:103], v18, s[20:23], s37 offen offset:3072 sc1
  v_accvgpr_read_b32 v22, a32
  v_mul_f32 v22, v22, v21
  v_accvgpr_read_b32 v23, a33
  v_mul_f32 v23, v23, v21
  v_cvt_pk_bf16_f32 v104, v22, v23
  v_accvgpr_read_b32 v24, a34
  v_mul_f32 v24, v24, v21
  v_accvgpr_read_b32 v25, a35
  v_mul_f32 v25, v25, v21
  v_cvt_pk_bf16_f32 v105, v24, v25
  v_accvgpr_read_b32 v22, a36
  v_mul_f32 v22, v22, v10
  v_accvgpr_read_b32 v23, a37
  v_mul_f32 v23, v23, v10
  v_cvt_pk_bf16_f32 v106, v22, v23
  v_accvgpr_read_b32 v24, a38
  v_mul_f32 v24, v24, v10
  v_accvgpr_read_b32 v25, a39
  v_mul_f32 v25, v25, v10
  v_cvt_pk_bf16_f32 v107, v24, v25
  v_accvgpr_read_b32 v22, a40
  v_mul_f32 v22, v22, v21
  v_accvgpr_read_b32 v23, a41
  v_mul_f32 v23, v23, v21
  v_cvt_pk_bf16_f32 v108, v22, v23
  v_accvgpr_read_b32 v24, a42
  v_mul_f32 v24, v24, v21
  v_accvgpr_read_b32 v25, a43
  v_mul_f32 v25, v25, v21
  v_cvt_pk_bf16_f32 v109, v24, v25
  v_accvgpr_read_b32 v22, a44
  v_mul_f32 v22, v22, v10
  v_accvgpr_read_b32 v23, a45
  v_mul_f32 v23, v23, v10
  v_cvt_pk_bf16_f32 v110, v22, v23
  v_accvgpr_read_b32 v24, a46
  v_mul_f32 v24, v24, v10
  v_accvgpr_read_b32 v25, a47
  v_mul_f32 v25, v25, v10
  v_cvt_pk_bf16_f32 v111, v24, v25
  s_nop 1
  v_permlane16_swap_b32 v104, v106
  v_permlane16_swap_b32 v105, v107
  v_permlane16_swap_b32 v108, v110
  v_permlane16_swap_b32 v109, v111
  buffer_store_dwordx4 v[104:107], v18, s[20:23], s38 offen offset:0 sc1
  buffer_store_dwordx4 v[108:111], v18, s[20:23], s38 offen offset:1024 sc1
  v_accvgpr_read_b32 v22, a48
  v_mul_f32 v22, v22, v21
  v_accvgpr_read_b32 v23, a49
  v_mul_f32 v23, v23, v21
  v_cvt_pk_bf16_f32 v112, v22, v23
  v_accvgpr_read_b32 v24, a50
  v_mul_f32 v24, v24, v21
  v_accvgpr_read_b32 v25, a51
  v_mul_f32 v25, v25, v21
  v_cvt_pk_bf16_f32 v113, v24, v25
  v_accvgpr_read_b32 v22, a52
  v_mul_f32 v22, v22, v10
  v_accvgpr_read_b32 v23, a53
  v_mul_f32 v23, v23, v10
  v_cvt_pk_bf16_f32 v114, v22, v23
  v_accvgpr_read_b32 v24, a54
  v_mul_f32 v24, v24, v10
  v_accvgpr_read_b32 v25, a55
  v_mul_f32 v25, v25, v10
  v_cvt_pk_bf16_f32 v115, v24, v25
  v_accvgpr_read_b32 v22, a56
  v_mul_f32 v22, v22, v21
  v_accvgpr_read_b32 v23, a57
  v_mul_f32 v23, v23, v21
  v_cvt_pk_bf16_f32 v116, v22, v23
  v_accvgpr_read_b32 v24, a58
  v_mul_f32 v24, v24, v21
  v_accvgpr_read_b32 v25, a59
  v_mul_f32 v25, v25, v21
  v_cvt_pk_bf16_f32 v117, v24, v25
  v_accvgpr_read_b32 v22, a60
  v_mul_f32 v22, v22, v10
  v_accvgpr_read_b32 v23, a61
  v_mul_f32 v23, v23, v10
  v_cvt_pk_bf16_f32 v118, v22, v23
  v_accvgpr_read_b32 v24, a62
  v_mul_f32 v24, v24, v10
  v_accvgpr_read_b32 v25, a63
  v_mul_f32 v25, v25, v10
  v_cvt_pk_bf16_f32 v119, v24, v25
  s_nop 1
  v_permlane16_swap_b32 v112, v114
  v_permlane16_swap_b32 v113, v115
  v_permlane16_swap_b32 v116, v118
  v_permlane16_swap_b32 v117, v119
  buffer_store_dwordx4 v[112:115], v18, s[20:23], s38 offen offset:2048 sc1
  buffer_store_dwordx4 v[116:119], v18, s[20:23], s38 offen offset:3072 sc1
  s_cmp_eq_u32 s45, 0
  s_cbranch_scc1 L_attn_nold_86
  s_bfe_u32 s28, s2, 0x30003
  s_lshl_b32 s28, s28, 2
  s_add_u32 s31, s28, 2
  s_sub_u32 s46, 56, s28
  s_add_u32 s30, s28, 9
  s_lshl_b32 s30, s30, 13
L_attn_ldl_87:
  s_mov_b32 s39, 0x100000
L_attn_lds_88:
  ds_read_b32 v20, v19
  s_add_u32 s37, s31, 5
  s_and_b32 s37, s37, 7
  s_lshl_b32 s37, s37, 13
  s_add_u32 s34, s37, 0x10000
  s_add_u32 s37, s31, 7
  s_and_b32 s38, s37, 3
  s_lshl_b32 s38, s38, 13
  s_bitcmp1_b32 s37, 2
  s_cselect_b32 s37, 0, 0x20000
  s_add_u32 s40, s37, s38
  s_add_u32 s35, s30, 4096
  s_waitcnt lgkmcnt(0)
  v_cmp_gt_i32 vcc, s31, v20
  s_cbranch_vccz L_attn_ldg_89
  s_sleep 1
  s_sub_u32 s39, s39, 1
  s_cbranch_scc0 L_attn_lds_88
L_attn_ldg_89:
  s_add_u32 m0, s40, 0
  s_nop 0
  buffer_load_dwordx4 v9, s[12:15], s30 offen offset:0 lds
  buffer_load_dwordx4 v9, s[12:15], s30 offen offset:1024 lds
  buffer_load_dwordx4 v9, s[12:15], s30 offen offset:2048 lds
  buffer_load_dwordx4 v9, s[12:15], s30 offen offset:3072 lds
  s_add_u32 m0, s40, 4096
  s_nop 0
  buffer_load_dwordx4 v9, s[12:15], s35 offen offset:0 lds
  buffer_load_dwordx4 v9, s[12:15], s35 offen offset:1024 lds
  buffer_load_dwordx4 v9, s[12:15], s35 offen offset:2048 lds
  buffer_load_dwordx4 v9, s[12:15], s35 offen offset:3072 lds
  s_add_u32 s37, s31, 2
  s_cmp_gt_i32 s37, s46
  s_cbranch_scc1 L_attn_ldv_90
  s_add_u32 m0, s34, 0
  s_nop 0
  buffer_load_dwordx4 v9, s[8:11], s30 offen offset:0 lds
  buffer_load_dwordx4 v9, s[8:11], s30 offen offset:1024 lds
  buffer_load_dwordx4 v9, s[8:11], s30 offen offset:2048 lds
  buffer_load_dwordx4 v9, s[8:11], s30 offen offset:3072 lds
  s_add_u32 m0, s34, 4096
  s_nop 0
  buffer_load_dwordx4 v9, s[8:11], s35 offen offset:0 lds
  buffer_load_dwordx4 v9, s[8:11], s35 offen offset:1024 lds
  buffer_load_dwordx4 v9, s[8:11], s35 offen offset:2048 lds
  buffer_load_dwordx4 v9, s[8:11], s35 offen offset:3072 lds
  s_waitcnt vmcnt(32)
  s_branch L_attn_ldp_91
L_attn_ldv_90:
  s_waitcnt vmcnt(16)
L_attn_ldp_91:
  s_add_u32 s37, s31, 3
  s_max_i32 s37, s37, s44
  v_mov_b32 v13, s37
  ds_write_b32 v17, v13
  s_add_u32 s30, s30, 8192
  s_add_u32 s31, s31, 1
  s_cmp_le_i32 s31, s46
  s_cbranch_scc1 L_attn_ldl_87
  v_mov_b32 v13, 0x7fffffff
  s_waitcnt vmcnt(0)
  ds_write_b32 v17, v13
  v_accvgpr_write_b32 a0, 0
  v_accvgpr_write_b32 a1, 0
  v_accvgpr_write_b32 a2, 0
  v_accvgpr_write_b32 a3, 0
  v_accvgpr_write_b32 a4, 0
  v_accvgpr_write_b32 a5, 0
  v_accvgpr_write_b32 a6, 0
  v_accvgpr_write_b32 a7, 0
  v_accvgpr_write_b32 a8, 0
  v_accvgpr_write_b32 a9, 0
  v_accvgpr_write_b32 a10, 0
  v_accvgpr_write_b32 a11, 0
  v_accvgpr_write_b32 a12, 0
  v_accvgpr_write_b32 a13, 0
  v_accvgpr_write_b32 a14, 0
  v_accvgpr_write_b32 a15, 0
  v_accvgpr_write_b32 a16, 0
  v_accvgpr_write_b32 a17, 0
  v_accvgpr_write_b32 a18, 0
  v_accvgpr_write_b32 a19, 0
  v_accvgpr_write_b32 a20, 0
  v_accvgpr_write_b32 a21, 0
  v_accvgpr_write_b32 a22, 0
  v_accvgpr_write_b32 a23, 0
  v_accvgpr_write_b32 a24, 0
  v_accvgpr_write_b32 a25, 0
  v_accvgpr_write_b32 a26, 0
  v_accvgpr_write_b32 a27, 0
  v_accvgpr_write_b32 a28, 0
  v_accvgpr_write_b32 a29, 0
  v_accvgpr_write_b32 a30, 0
  v_accvgpr_write_b32 a31, 0
  v_accvgpr_write_b32 a32, 0
  v_accvgpr_write_b32 a33, 0
  v_accvgpr_write_b32 a34, 0
  v_accvgpr_write_b32 a35, 0
  v_accvgpr_write_b32 a36, 0
  v_accvgpr_write_b32 a37, 0
  v_accvgpr_write_b32 a38, 0
  v_accvgpr_write_b32 a39, 0
  v_accvgpr_write_b32 a40, 0
  v_accvgpr_write_b32 a41, 0
  v_accvgpr_write_b32 a42, 0
  v_accvgpr_write_b32 a43, 0
  v_accvgpr_write_b32 a44, 0
  v_accvgpr_write_b32 a45, 0
  v_accvgpr_write_b32 a46, 0
  v_accvgpr_write_b32 a47, 0
  v_accvgpr_write_b32 a48, 0
  v_accvgpr_write_b32 a49, 0
  v_accvgpr_write_b32 a50, 0
  v_accvgpr_write_b32 a51, 0
  v_accvgpr_write_b32 a52, 0
  v_accvgpr_write_b32 a53, 0
  v_accvgpr_write_b32 a54, 0
  v_accvgpr_write_b32 a55, 0
  v_accvgpr_write_b32 a56, 0
  v_accvgpr_write_b32 a57, 0
  v_accvgpr_write_b32 a58, 0
  v_accvgpr_write_b32 a59, 0
  v_accvgpr_write_b32 a60, 0
  v_accvgpr_write_b32 a61, 0
  v_accvgpr_write_b32 a62, 0
  v_accvgpr_write_b32 a63, 0
L_attn_nold_86:
  s_setprio 0
  s_bfe_u32 s63, s2, 0x30003
  s_sub_u32 s28, 15, s63
  s_cmp_eq_u32 s26, 0
  s_cselect_b32 s28, s28, s63
  s_and_b32 s72, s2, 7
  s_lshr_b32 s73, s2, 3
  s_lshl_b32 s74, s72, 2
  s_lshr_b32 s74, 0x6153724, s74
  s_and_b32 s74, s74, 7
  s_lshl_b32 s70, s74, 2
  s_and_b32 s74, s73, 3
  s_add_u32 s70, s70, s74
  s_lshr_b32 s71, s73, 2
  s_lshl_b32 s73, s28, 3
  s_add_u32 s73, s73, s72
  s_lshl_b32 s73, s73, 8
  s_add_u32 s69, s73, 0x3002000
  s_lshr_b32 s73, s70, 1
  s_lshl_b32 s73, s73, 3
  s_add_u32 s73, s73, s24
  s_lshl_b32 s73, s73, 8
  s_add_u32 s68, s73, 0x3002000
  s_and_b32 s74, s24, 3
  s_lshl_b32 s74, s74, 3
  s_mov_b32 s72, 0x563a1d00
  s_mov_b32 s47, 0x1c1d1d
  s_cmp_lg_u32 s43, 0
  s_cselect_b32 s72, s72, 0x3a230f00
  s_cselect_b32 s47, s47, 0x1c17140f
  s_lshr_b32 s72, s72, s74
  s_and_b32 s72, s72, 0xff
  s_lshr_b32 s47, s47, s74
  s_and_b32 s47, s47, 0xff
  s_mul_i32 s73, s70, 172
  s_add_u32 s73, s73, s72
  s_lshl_b32 s64, s73, 10
  s_mul_i32 s73, s71, 342
  s_add_u32 s74, s73, s72
  s_add_u32 s74, s74, 256
  s_lshl_b32 s74, s74, 11
  s_add_u32 s65, s74, 0x2000000
  s_lshl_b32 s72, s24, 5
  s_add_u32 s73, s73, s72
  s_lshl_b32 s73, s73, 11
  s_add_u32 s67, s73, 0x2000000
  s_lshl_b32 s73, s70, 9
  s_add_u32 s73, s73, s72
  s_lshl_b32 s73, s73, 10
  s_add_u32 s66, s73, 0x1000000
  s_nop 1
  s_load_dwordx2 s[50:51], s[0:1], 0
  s_load_dwordx2 s[56:57], s[0:1], 72
  s_load_dwordx2 s[40:41], s[0:1], 40
  v_mov_b32 v3, 0
  v_mov_b32 v13, 34816
  buffer_load_dword v5, v3, s[20:23], s68 offen sc1
  ds_read_b32 v15, v13
  s_lshl_b32 s28, s70, 6
  s_lshr_b32 s29, s24, 2
  s_lshl_b32 s29, s29, 5
  s_add_u32 s28, s28, s29
  s_lshl_b32 s28, s28, 10
  s_lshl_b32 s29, s71, 7
  s_add_u32 s28, s28, s29
  s_bfe_u32 s29, s24, 0x10001
  s_lshl_b32 s29, s29, 6
  s_add_u32 s28, s28, s29
  s_and_b32 s29, s24, 1
  s_lshl_b32 s29, s29, 5
  s_add_u32 s28, s28, s29
  v_and_b32 v2, 31, v1
  v_lshlrev_b32 v10, 10, v2
  v_lshrrev_b32 v2, 5, v1
  v_lshl_add_u32 v10, v2, 3, v10
  v_add_u32 v10, s28, v10
  s_lshl_b32 s28, s24, 11
  v_add_u32 v11, s28, v9
  v_add_u32 v12, 0x10000, v11
  v_add_u32 v6, 0x20000, v11
  s_mov_b32 s35, s24
  s_lshl_b32 s28, s35, 14
  s_add_u32 s29, s28, 0x8000
  s_cmp_lt_u32 s35, 2
  s_cselect_b32 s28, s28, s29
  v_add_u32 v4, s28, v9
  s_mul_i32 s29, s24, 6144
  s_add_u32 s29, s29, 12288
  s_cmp_eq_u32 s26, 0
  s_cselect_b32 s33, s28, s29
  v_add_u32 v7, s33, v9
  v_mov_b32 v2, 1
  s_mov_b32 s30, 0xbfb8aa3b
  s_mov_b32 s34, 0x7fffffff
  s_waitcnt vmcnt(1) lgkmcnt(0)
  s_mov_b64 exec, 1
  buffer_atomic_add v2, v3, s[20:23], s69 offen
  s_mov_b64 exec, -1
  s_mov_b32 s8, s50
  s_mov_b32 s9, s51
  s_mov_b32 s10, 0x200000
  s_mov_b32 s11, 0x00020000
  s_mov_b32 s12, s56
  s_mov_b32 s13, s57
  s_mov_b32 s14, 0x200000
  s_mov_b32 s15, 0x00020000
  s_bfe_u32 s28, s2, 0x30003
  s_cmp_gt_u32 s28, 3
  s_cbranch_scc1 L_attn_now_92
  s_sub_u32 s29, s24, 4
  s_cmp_gt_u32 s29, 2
  s_cbranch_scc1 L_attn_now_92
  s_mov_b32 s42, 0x400000
  s_mov_b32 s43, 0x00020000
  s_lshl_b32 s46, s29, 13
  s_add_u32 s46, s46, 36864
  s_and_b32 s44, s2, 7
  s_lshl_b32 s44, s44, 4
  s_lshr_b32 s45, s2, 6
  s_lshl_b32 s45, s45, 2
  s_add_u32 s44, s44, s45
  s_add_u32 s44, s44, s28
  s_lshl_b32 s44, s44, 2
  s_sub_u32 s45, 3, s29
  v_lshrrev_b32 v53, 5, v1
  v_and_b32 v52, 31, v1
  v_lshlrev_b32 v52, 4, v52
  v_lshl_add_u32 v52, v53, 10, v52
  v_lshlrev_b32 v53, 3, v53
  v_bfe_u32 v54, v1, 2, 2
  v_add_u32 v53, v53, v54
  v_lshlrev_b32 v53, 9, v53
  v_bfe_u32 v54, v1, 4, 1
  v_lshl_add_u32 v53, v54, 5, v53
  v_and_b32 v54, 3, v1
  v_lshl_add_u32 v53, v54, 3, v53
  v_add_u32 v53, s46, v53
L_attn_wl_93:
  s_add_u32 s28, s44, s45
  s_lshr_b32 s36, s28, 1
  s_and_b32 s28, s28, 1
  s_lshl_b32 s29, s36, 14
  s_lshl_b32 s37, s28, 9
  s_add_u32 s29, s29, s37
  s_add_u32 m0, s46, 0
  s_nop 0
  buffer_load_dwordx4 v52, s[40:43], s29 offen offset:0 lds
  s_add_u32 m0, s46, 4294966272
  s_nop 0
  buffer_load_dwordx4 v52, s[40:43], s29 offen offset:2048 lds
  s_add_u32 m0, s46, 2048
  s_add_u32 s29, s29, 4096
  buffer_load_dwordx4 v52, s[40:43], s29 offen offset:0 lds
  s_add_u32 m0, s46, 1024
  s_nop 0
  buffer_load_dwordx4 v52, s[40:43], s29 offen offset:2048 lds
  s_add_u32 m0, s46, 4096
  s_add_u32 s29, s29, 4096
  buffer_load_dwordx4 v52, s[40:43], s29 offen offset:0 lds
  s_add_u32 m0, s46, 3072
  s_nop 0
  buffer_load_dwordx4 v52, s[40:43], s29 offen offset:2048 lds
  s_add_u32 m0, s46, 6144
  s_add_u32 s29, s29, 4096
  buffer_load_dwordx4 v52, s[40:43], s29 offen offset:0 lds
  s_add_u32 m0, s46, 5120
  s_nop 0
  buffer_load_dwordx4 v52, s[40:43], s29 offen offset:2048 lds
  s_mul_i32 s37, s28, 1368
  s_add_u32 s37, s37, s36
  s_lshl_b32 s37, s37, 11
  s_add_u32 s37, s37, 0x2000000
  s_waitcnt vmcnt(0)
  ds_read_b64_tr_b16 v[20:21], v53 offset:0
  ds_read_b64_tr_b16 v[22:23], v53 offset:2048
  ds_read_b64_tr_b16 v[24:25], v53 offset:64
  ds_read_b64_tr_b16 v[26:27], v53 offset:2112
  ds_read_b64_tr_b16 v[28:29], v53 offset:128
  ds_read_b64_tr_b16 v[30:31], v53 offset:2176
  ds_read_b64_tr_b16 v[32:33], v53 offset:192
  ds_read_b64_tr_b16 v[34:35], v53 offset:2240
  ds_read_b64_tr_b16 v[36:37], v53 offset:256
  ds_read_b64_tr_b16 v[38:39], v53 offset:2304
  ds_read_b64_tr_b16 v[40:41], v53 offset:320
  ds_read_b64_tr_b16 v[42:43], v53 offset:2368
  ds_read_b64_tr_b16 v[44:45], v53 offset:384
  ds_read_b64_tr_b16 v[46:47], v53 offset:2432
  ds_read_b64_tr_b16 v[48:49], v53 offset:448
  ds_read_b64_tr_b16 v[50:51], v53 offset:2496
  s_waitcnt lgkmcnt(14)
  buffer_store_dwordx4 v[20:23], v9, s[20:23], s37 offen offset:0 sc1
  s_waitcnt lgkmcnt(12)
  buffer_store_dwordx4 v[24:27], v9, s[20:23], s37 offen offset:1024 sc1
  s_add_u32 s37, s37, 700416
  s_waitcnt lgkmcnt(10)
  buffer_store_dwordx4 v[28:31], v9, s[20:23], s37 offen offset:0 sc1
  s_waitcnt lgkmcnt(8)
  buffer_store_dwordx4 v[32:35], v9, s[20:23], s37 offen offset:1024 sc1
  s_add_u32 s37, s37, 700416
  s_waitcnt lgkmcnt(6)
  buffer_store_dwordx4 v[36:39], v9, s[20:23], s37 offen offset:0 sc1
  s_waitcnt lgkmcnt(4)
  buffer_store_dwordx4 v[40:43], v9, s[20:23], s37 offen offset:1024 sc1
  s_add_u32 s37, s37, 700416
  s_waitcnt lgkmcnt(2)
  buffer_store_dwordx4 v[44:47], v9, s[20:23], s37 offen offset:0 sc1
  s_waitcnt lgkmcnt(0)
  buffer_store_dwordx4 v[48:51], v9, s[20:23], s37 offen offset:1024 sc1
  s_sub_u32 s45, s45, 1
  s_cmp_eq_u32 s45, 0
  s_cbranch_scc1 L_attn_wl_93
  s_and_b32 s28, s2, 7
  s_lshl_b32 s28, s28, 8
  s_add_u32 s28, s28, 0x3001800
  s_waitcnt vmcnt(0)
  s_mov_b64 exec, 1
  buffer_atomic_add v2, v3, s[20:23], s28 offen
  s_mov_b64 exec, -1
L_attn_now_92:
  v_cmp_ne_u32 vcc, 1, v15
  s_cbranch_vccz L_attn_qdg_96
  s_mov_b32 s32, 0x40000
  s_mov_b32 s28, 0x3001000
  v_lshlrev_b32 v14, 8, v1
  s_mov_b64 exec, 0xff
L_attn_qdp_94:
  buffer_load_dword v15, v14, s[20:23], s28 offen sc1
  s_waitcnt vmcnt(0)
  v_cmp_ne_u32 vcc, 32, v15
  s_cbranch_vccz L_attn_qdpr_95
  s_sleep 8
  s_sub_u32 s32, s32, 1
  s_cbranch_scc0 L_attn_qdp_94
L_attn_qdpr_95:
  s_mov_b64 exec, -1
  ds_write_b32 v13, v2
L_attn_qdg_96:
  s_cmp_eq_u32 s26, 0
  s_cbranch_scc1 L_attn_tlong_97
  s_mov_b32 s16, s64
  s_add_u32 s17, s64, 88064
  s_mov_b32 s18, s65
  s_cmp_eq_u32 s47, 28
  s_cbranch_scc1 L_attn_g28_100
  s_cmp_eq_u32 s47, 23
  s_cbranch_scc1 L_attn_g23_101
  s_cmp_eq_u32 s47, 20
  s_cbranch_scc1 L_attn_g20_102
  s_cmp_eq_u32 s47, 15
  s_cbranch_scc1 L_attn_g15_103
  s_cmp_eq_u32 s47, 0
  s_cbranch_scc1 L_attn_gend_98
L_attn_g29_99:
  buffer_load_dwordx4 v[28:31], v9, s[20:23], s18 offen offset:0 sc1
  buffer_load_dwordx4 v[32:35], v9, s[20:23], s18 offen offset:1024 sc1
  buffer_load_dwordx4 v[20:23], v9, s[20:23], s16 offen offset:0 sc1
  buffer_load_dwordx4 v[24:27], v9, s[20:23], s17 offen offset:0 sc1
  buffer_load_dwordx4 v[44:47], v9, s[20:23], s18 offen offset:2048 sc1
  buffer_load_dwordx4 v[48:51], v9, s[20:23], s18 offen offset:3072 sc1
  buffer_load_dwordx4 v[36:39], v9, s[20:23], s16 offen offset:1024 sc1
  buffer_load_dwordx4 v[40:43], v9, s[20:23], s17 offen offset:1024 sc1
  s_add_u32 s18, s18, 4096
  buffer_load_dwordx4 v[60:63], v9, s[20:23], s18 offen offset:0 sc1
  buffer_load_dwordx4 v[64:67], v9, s[20:23], s18 offen offset:1024 sc1
  buffer_load_dwordx4 v[52:55], v9, s[20:23], s16 offen offset:2048 sc1
  buffer_load_dwordx4 v[56:59], v9, s[20:23], s17 offen offset:2048 sc1
  buffer_load_dwordx4 v[76:79], v9, s[20:23], s18 offen offset:2048 sc1
  buffer_load_dwordx4 v[80:83], v9, s[20:23], s18 offen offset:3072 sc1
  buffer_load_dwordx4 v[68:71], v9, s[20:23], s16 offen offset:3072 sc1
  buffer_load_dwordx4 v[72:75], v9, s[20:23], s17 offen offset:3072 sc1
  s_add_u32 s18, s18, 4096
  buffer_load_dwordx4 v[92:95], v9, s[20:23], s18 offen offset:0 sc1
  buffer_load_dwordx4 v[96:99], v9, s[20:23], s18 offen offset:1024 sc1
  s_add_u32 s16, s16, 4096
  s_add_u32 s17, s17, 4096
  buffer_load_dwordx4 v[84:87], v9, s[20:23], s16 offen offset:0 sc1
  buffer_load_dwordx4 v[88:91], v9, s[20:23], s17 offen offset:0 sc1
  buffer_load_dwordx4 v[108:111], v9, s[20:23], s18 offen offset:2048 sc1
  buffer_load_dwordx4 v[112:115], v9, s[20:23], s18 offen offset:3072 sc1
  buffer_load_dwordx4 v[100:103], v9, s[20:23], s16 offen offset:1024 sc1
  buffer_load_dwordx4 v[104:107], v9, s[20:23], s17 offen offset:1024 sc1
  s_add_u32 s18, s18, 4096
  buffer_load_dwordx4 v[124:127], v9, s[20:23], s18 offen offset:0 sc1
  buffer_load_dwordx4 v[128:131], v9, s[20:23], s18 offen offset:1024 sc1
  buffer_load_dwordx4 v[116:119], v9, s[20:23], s16 offen offset:2048 sc1
  buffer_load_dwordx4 v[120:123], v9, s[20:23], s17 offen offset:2048 sc1
  buffer_load_dwordx4 v[140:143], v9, s[20:23], s18 offen offset:2048 sc1
  buffer_load_dwordx4 v[144:147], v9, s[20:23], s18 offen offset:3072 sc1
  buffer_load_dwordx4 v[132:135], v9, s[20:23], s16 offen offset:3072 sc1
  buffer_load_dwordx4 v[136:139], v9, s[20:23], s17 offen offset:3072 sc1
  s_waitcnt vmcnt(28)
  v_mfma_f32_32x32x16_bf16 a[0:15], v[28:31], v[20:23], 0
  v_mfma_f32_32x32x16_bf16 a[16:31], v[32:35], v[20:23], 0
  v_mfma_f32_32x32x16_bf16 a[32:47], v[28:31], v[24:27], 0
  v_mfma_f32_32x32x16_bf16 a[48:63], v[32:35], v[24:27], 0
  s_add_u32 s18, s18, 4096
  buffer_load_dwordx4 v[28:31], v9, s[20:23], s18 offen offset:0 sc1
  buffer_load_dwordx4 v[32:35], v9, s[20:23], s18 offen offset:1024 sc1
  s_add_u32 s16, s16, 4096
  s_add_u32 s17, s17, 4096
  buffer_load_dwordx4 v[20:23], v9, s[20:23], s16 offen offset:0 sc1
  buffer_load_dwordx4 v[24:27], v9, s[20:23], s17 offen offset:0 sc1
  s_waitcnt vmcnt(28)
  v_mfma_f32_32x32x16_bf16 a[0:15], v[44:47], v[36:39], a[0:15]
  v_mfma_f32_32x32x16_bf16 a[16:31], v[48:51], v[36:39], a[16:31]
  v_mfma_f32_32x32x16_bf16 a[32:47], v[44:47], v[40:43], a[32:47]
  v_mfma_f32_32x32x16_bf16 a[48:63], v[48:51], v[40:43], a[48:63]
  buffer_load_dwordx4 v[44:47], v9, s[20:23], s18 offen offset:2048 sc1
  buffer_load_dwordx4 v[48:51], v9, s[20:23], s18 offen offset:3072 sc1
  buffer_load_dwordx4 v[36:39], v9, s[20:23], s16 offen offset:1024 sc1
  buffer_load_dwordx4 v[40:43], v9, s[20:23], s17 offen offset:1024 sc1
  s_waitcnt vmcnt(28)
  v_mfma_f32_32x32x16_bf16 a[0:15], v[60:63], v[52:55], a[0:15]
  v_mfma_f32_32x32x16_bf16 a[16:31], v[64:67], v[52:55], a[16:31]
  v_mfma_f32_32x32x16_bf16 a[32:47], v[60:63], v[56:59], a[32:47]
  v_mfma_f32_32x32x16_bf16 a[48:63], v[64:67], v[56:59], a[48:63]
  s_add_u32 s18, s18, 4096
  buffer_load_dwordx4 v[60:63], v9, s[20:23], s18 offen offset:0 sc1
  buffer_load_dwordx4 v[64:67], v9, s[20:23], s18 offen offset:1024 sc1
  buffer_load_dwordx4 v[52:55], v9, s[20:23], s16 offen offset:2048 sc1
  buffer_load_dwordx4 v[56:59], v9, s[20:23], s17 offen offset:2048 sc1
  s_waitcnt vmcnt(28)
  v_mfma_f32_32x32x16_bf16 a[0:15], v[76:79], v[68:71], a[0:15]
  v_mfma_f32_32x32x16_bf16 a[16:31], v[80:83], v[68:71], a[16:31]
  v_mfma_f32_32x32x16_bf16 a[32:47], v[76:79], v[72:75], a[32:47]
  v_mfma_f32_32x32x16_bf16 a[48:63], v[80:83], v[72:75], a[48:63]
  buffer_load_dwordx4 v[76:79], v9, s[20:23], s18 offen offset:2048 sc1
  buffer_load_dwordx4 v[80:83], v9, s[20:23], s18 offen offset:3072 sc1
  buffer_load_dwordx4 v[68:71], v9, s[20:23], s16 offen offset:3072 sc1
  buffer_load_dwordx4 v[72:75], v9, s[20:23], s17 offen offset:3072 sc1
  s_waitcnt vmcnt(28)
  v_mfma_f32_32x32x16_bf16 a[0:15], v[92:95], v[84:87], a[0:15]
  v_mfma_f32_32x32x16_bf16 a[16:31], v[96:99], v[84:87], a[16:31]
  v_mfma_f32_32x32x16_bf16 a[32:47], v[92:95], v[88:91], a[32:47]
  v_mfma_f32_32x32x16_bf16 a[48:63], v[96:99], v[88:91], a[48:63]
  s_add_u32 s18, s18, 4096
  buffer_load_dwordx4 v[92:95], v9, s[20:23], s18 offen offset:0 sc1
  buffer_load_dwordx4 v[96:99], v9, s[20:23], s18 offen offset:1024 sc1
  s_add_u32 s16, s16, 4096
  s_add_u32 s17, s17, 4096
  buffer_load_dwordx4 v[84:87], v9, s[20:23], s16 offen offset:0 sc1
  buffer_load_dwordx4 v[88:91], v9, s[20:23], s17 offen offset:0 sc1
  s_waitcnt vmcnt(28)
  v_mfma_f32_32x32x16_bf16 a[0:15], v[108:111], v[100:103], a[0:15]
  v_mfma_f32_32x32x16_bf16 a[16:31], v[112:115], v[100:103], a[16:31]
  v_mfma_f32_32x32x16_bf16 a[32:47], v[108:111], v[104:107], a[32:47]
  v_mfma_f32_32x32x16_bf16 a[48:63], v[112:115], v[104:107], a[48:63]
  buffer_load_dwordx4 v[108:111], v9, s[20:23], s18 offen offset:2048 sc1
  buffer_load_dwordx4 v[112:115], v9, s[20:23], s18 offen offset:3072 sc1
  buffer_load_dwordx4 v[100:103], v9, s[20:23], s16 offen offset:1024 sc1
  buffer_load_dwordx4 v[104:107], v9, s[20:23], s17 offen offset:1024 sc1
  s_waitcnt vmcnt(28)
  v_mfma_f32_32x32x16_bf16 a[0:15], v[124:127], v[116:119], a[0:15]
  v_mfma_f32_32x32x16_bf16 a[16:31], v[128:131], v[116:119], a[16:31]
  v_mfma_f32_32x32x16_bf16 a[32:47], v[124:127], v[120:123], a[32:47]
  v_mfma_f32_32x32x16_bf16 a[48:63], v[128:131], v[120:123], a[48:63]
  s_add_u32 s18, s18, 4096
  buffer_load_dwordx4 v[124:127], v9, s[20:23], s18 offen offset:0 sc1
  buffer_load_dwordx4 v[128:131], v9, s[20:23], s18 offen offset:1024 sc1
  buffer_load_dwordx4 v[116:119], v9, s[20:23], s16 offen offset:2048 sc1
  buffer_load_dwordx4 v[120:123], v9, s[20:23], s17 offen offset:2048 sc1
  s_waitcnt vmcnt(28)
  v_mfma_f32_32x32x16_bf16 a[0:15], v[140:143], v[132:135], a[0:15]
  v_mfma_f32_32x32x16_bf16 a[16:31], v[144:147], v[132:135], a[16:31]
  v_mfma_f32_32x32x16_bf16 a[32:47], v[140:143], v[136:139], a[32:47]
  v_mfma_f32_32x32x16_bf16 a[48:63], v[144:147], v[136:139], a[48:63]
  buffer_load_dwordx4 v[140:143], v9, s[20:23], s18 offen offset:2048 sc1
  buffer_load_dwordx4 v[144:147], v9, s[20:23], s18 offen offset:3072 sc1
  buffer_load_dwordx4 v[132:135], v9, s[20:23], s16 offen offset:3072 sc1
  buffer_load_dwordx4 v[136:139], v9, s[20:23], s17 offen offset:3072 sc1
  s_waitcnt vmcnt(28)
  v_mfma_f32_32x32x16_bf16 a[0:15], v[28:31], v[20:23], a[0:15]
  v_mfma_f32_32x32x16_bf16 a[16:31], v[32:35], v[20:23], a[16:31]
  v_mfma_f32_32x32x16_bf16 a[32:47], v[28:31], v[24:27], a[32:47]
  v_mfma_f32_32x32x16_bf16 a[48:63], v[32:35], v[24:27], a[48:63]
  s_add_u32 s18, s18, 4096
  buffer_load_dwordx4 v[28:31], v9, s[20:23], s18 offen offset:0 sc1
  buffer_load_dwordx4 v[32:35], v9, s[20:23], s18 offen offset:1024 sc1
  s_add_u32 s16, s16, 4096
  s_add_u32 s17, s17, 4096
  buffer_load_dwordx4 v[20:23], v9, s[20:23], s16 offen offset:0 sc1
  buffer_load_dwordx4 v[24:27], v9, s[20:23], s17 offen offset:0 sc1
  s_waitcnt vmcnt(28)
  v_mfma_f32_32x32x16_bf16 a[0:15], v[44:47], v[36:39], a[0:15]
  v_mfma_f32_32x32x16_bf16 a[16:31], v[48:51], v[36:39], a[16:31]
  v_mfma_f32_32x32x16_bf16 a[32:47], v[44:47], v[40:43], a[32:47]
  v_mfma_f32_32x32x16_bf16 a[48:63], v[48:51], v[40:43], a[48:63]
  buffer_load_dwordx4 v[44:47], v9, s[20:23], s18 offen offset:2048 sc1
  buffer_load_dwordx4 v[48:51], v9, s[20:23], s18 offen offset:3072 sc1
  buffer_load_dwordx4 v[36:39], v9, s[20:23], s16 offen offset:1024 sc1
  buffer_load_dwordx4 v[40:43], v9, s[20:23], s17 offen offset:1024 sc1
  s_waitcnt vmcnt(28)
  v_mfma_f32_32x32x16_bf16 a[0:15], v[60:63], v[52:55], a[0:15]
  v_mfma_f32_32x32x16_bf16 a[16:31], v[64:67], v[52:55], a[16:31]
  v_mfma_f32_32x32x16_bf16 a[32:47], v[60:63], v[56:59], a[32:47]
  v_mfma_f32_32x32x16_bf16 a[48:63], v[64:67], v[56:59], a[48:63]
  s_add_u32 s18, s18, 4096
  buffer_load_dwordx4 v[60:63], v9, s[20:23], s18 offen offset:0 sc1
  buffer_load_dwordx4 v[64:67], v9, s[20:23], s18 offen offset:1024 sc1
  buffer_load_dwordx4 v[52:55], v9, s[20:23], s16 offen offset:2048 sc1
  buffer_load_dwordx4 v[56:59], v9, s[20:23], s17 offen offset:2048 sc1
  s_waitcnt vmcnt(28)
  v_mfma_f32_32x32x16_bf16 a[0:15], v[76:79], v[68:71], a[0:15]
  v_mfma_f32_32x32x16_bf16 a[16:31], v[80:83], v[68:71], a[16:31]
  v_mfma_f32_32x32x16_bf16 a[32:47], v[76:79], v[72:75], a[32:47]
  v_mfma_f32_32x32x16_bf16 a[48:63], v[80:83], v[72:75], a[48:63]
  buffer_load_dwordx4 v[76:79], v9, s[20:23], s18 offen offset:2048 sc1
  buffer_load_dwordx4 v[80:83], v9, s[20:23], s18 offen offset:3072 sc1
  buffer_load_dwordx4 v[68:71], v9, s[20:23], s16 offen offset:3072 sc1
  buffer_load_dwordx4 v[72:75], v9, s[20:23], s17 offen offset:3072 sc1
  s_waitcnt vmcnt(28)
  v_mfma_f32_32x32x16_bf16 a[0:15], v[92:95], v[84:87], a[0:15]
  v_mfma_f32_32x32x16_bf16 a[16:31], v[96:99], v[84:87], a[16:31]
  v_mfma_f32_32x32x16_bf16 a[32:47], v[92:95], v[88:91], a[32:47]
  v_mfma_f32_32x32x16_bf16 a[48:63], v[96:99], v[88:91], a[48:63]
  s_add_u32 s18, s18, 4096
  buffer_load_dwordx4 v[92:95], v9, s[20:23], s18 offen offset:0 sc1
  buffer_load_dwordx4 v[96:99], v9, s[20:23], s18 offen offset:1024 sc1
  s_add_u32 s16, s16, 4096
  s_add_u32 s17, s17, 4096
  buffer_load_dwordx4 v[84:87], v9, s[20:23], s16 offen offset:0 sc1
  buffer_load_dwordx4 v[88:91], v9, s[20:23], s17 offen offset:0 sc1
  s_waitcnt vmcnt(28)
  v_mfma_f32_32x32x16_bf16 a[0:15], v[108:111], v[100:103], a[0:15]
  v_mfma_f32_32x32x16_bf16 a[16:31], v[112:115], v[100:103], a[16:31]
  v_mfma_f32_32x32x16_bf16 a[32:47], v[108:111], v[104:107], a[32:47]
  v_mfma_f32_32x32x16_bf16 a[48:63], v[112:115], v[104:107], a[48:63]
  buffer_load_dwordx4 v[108:111], v9, s[20:23], s18 offen offset:2048 sc1
  buffer_load_dwordx4 v[112:115], v9, s[20:23], s18 offen offset:3072 sc1
  buffer_load_dwordx4 v[100:103], v9, s[20:23], s16 offen offset:1024 sc1
  buffer_load_dwordx4 v[104:107], v9, s[20:23], s17 offen offset:1024 sc1
  s_waitcnt vmcnt(28)
  v_mfma_f32_32x32x16_bf16 a[0:15], v[124:127], v[116:119], a[0:15]
  v_mfma_f32_32x32x16_bf16 a[16:31], v[128:131], v[116:119], a[16:31]
  v_mfma_f32_32x32x16_bf16 a[32:47], v[124:127], v[120:123], a[32:47]
  v_mfma_f32_32x32x16_bf16 a[48:63], v[128:131], v[120:123], a[48:63]
  s_add_u32 s18, s18, 4096
  buffer_load_dwordx4 v[124:127], v9, s[20:23], s18 offen offset:0 sc1
  buffer_load_dwordx4 v[128:131], v9, s[20:23], s18 offen offset:1024 sc1
  buffer_load_dwordx4 v[116:119], v9, s[20:23], s16 offen offset:2048 sc1
  buffer_load_dwordx4 v[120:123], v9, s[20:23], s17 offen offset:2048 sc1
  s_waitcnt vmcnt(28)
  v_mfma_f32_32x32x16_bf16 a[0:15], v[140:143], v[132:135], a[0:15]
  v_mfma_f32_32x32x16_bf16 a[16:31], v[144:147], v[132:135], a[16:31]
  v_mfma_f32_32x32x16_bf16 a[32:47], v[140:143], v[136:139], a[32:47]
  v_mfma_f32_32x32x16_bf16 a[48:63], v[144:147], v[136:139], a[48:63]
  buffer_load_dwordx4 v[140:143], v9, s[20:23], s18 offen offset:2048 sc1
  buffer_load_dwordx4 v[144:147], v9, s[20:23], s18 offen offset:3072 sc1
  buffer_load_dwordx4 v[132:135], v9, s[20:23], s16 offen offset:3072 sc1
  buffer_load_dwordx4 v[136:139], v9, s[20:23], s17 offen offset:3072 sc1
  s_waitcnt vmcnt(28)
  v_mfma_f32_32x32x16_bf16 a[0:15], v[28:31], v[20:23], a[0:15]
  v_mfma_f32_32x32x16_bf16 a[16:31], v[32:35], v[20:23], a[16:31]
  v_mfma_f32_32x32x16_bf16 a[32:47], v[28:31], v[24:27], a[32:47]
  v_mfma_f32_32x32x16_bf16 a[48:63], v[32:35], v[24:27], a[48:63]
  s_add_u32 s18, s18, 4096
  buffer_load_dwordx4 v[28:31], v9, s[20:23], s18 offen offset:0 sc1
  buffer_load_dwordx4 v[32:35], v9, s[20:23], s18 offen offset:1024 sc1
  s_add_u32 s16, s16, 4096
  s_add_u32 s17, s17, 4096
  buffer_load_dwordx4 v[20:23], v9, s[20:23], s16 offen offset:0 sc1
  buffer_load_dwordx4 v[24:27], v9, s[20:23], s17 offen offset:0 sc1
  s_waitcnt vmcnt(28)
  v_mfma_f32_32x32x16_bf16 a[0:15], v[44:47], v[36:39], a[0:15]
  v_mfma_f32_32x32x16_bf16 a[16:31], v[48:51], v[36:39], a[16:31]
  v_mfma_f32_32x32x16_bf16 a[32:47], v[44:47], v[40:43], a[32:47]
  v_mfma_f32_32x32x16_bf16 a[48:63], v[48:51], v[40:43], a[48:63]
  buffer_load_dwordx4 v[44:47], v9, s[20:23], s18 offen offset:2048 sc1
  buffer_load_dwordx4 v[48:51], v9, s[20:23], s18 offen offset:3072 sc1
  buffer_load_dwordx4 v[36:39], v9, s[20:23], s16 offen offset:1024 sc1
  buffer_load_dwordx4 v[40:43], v9, s[20:23], s17 offen offset:1024 sc1
  s_waitcnt vmcnt(28)
  v_mfma_f32_32x32x16_bf16 a[0:15], v[60:63], v[52:55], a[0:15]
  v_mfma_f32_32x32x16_bf16 a[16:31], v[64:67], v[52:55], a[16:31]
  v_mfma_f32_32x32x16_bf16 a[32:47], v[60:63], v[56:59], a[32:47]
  v_mfma_f32_32x32x16_bf16 a[48:63], v[64:67], v[56:59], a[48:63]
  s_add_u32 s18, s18, 4096
  buffer_load_dwordx4 v[60:63], v9, s[20:23], s18 offen offset:0 sc1
  buffer_load_dwordx4 v[64:67], v9, s[20:23], s18 offen offset:1024 sc1
  buffer_load_dwordx4 v[52:55], v9, s[20:23], s16 offen offset:2048 sc1
  buffer_load_dwordx4 v[56:59], v9, s[20:23], s17 offen offset:2048 sc1
  s_waitcnt vmcnt(28)
  v_mfma_f32_32x32x16_bf16 a[0:15], v[76:79], v[68:71], a[0:15]
  v_mfma_f32_32x32x16_bf16 a[16:31], v[80:83], v[68:71], a[16:31]
  v_mfma_f32_32x32x16_bf16 a[32:47], v[76:79], v[72:75], a[32:47]
  v_mfma_f32_32x32x16_bf16 a[48:63], v[80:83], v[72:75], a[48:63]
  buffer_load_dwordx4 v[76:79], v9, s[20:23], s18 offen offset:2048 sc1
  buffer_load_dwordx4 v[80:83], v9, s[20:23], s18 offen offset:3072 sc1
  buffer_load_dwordx4 v[68:71], v9, s[20:23], s16 offen offset:3072 sc1
  buffer_load_dwordx4 v[72:75], v9, s[20:23], s17 offen offset:3072 sc1
  s_waitcnt vmcnt(28)
  v_mfma_f32_32x32x16_bf16 a[0:15], v[92:95], v[84:87], a[0:15]
  v_mfma_f32_32x32x16_bf16 a[16:31], v[96:99], v[84:87], a[16:31]
  v_mfma_f32_32x32x16_bf16 a[32:47], v[92:95], v[88:91], a[32:47]
  v_mfma_f32_32x32x16_bf16 a[48:63], v[96:99], v[88:91], a[48:63]
  s_add_u32 s18, s18, 4096
  buffer_load_dwordx4 v[92:95], v9, s[20:23], s18 offen offset:0 sc1
  buffer_load_dwordx4 v[96:99], v9, s[20:23], s18 offen offset:1024 sc1
  s_add_u32 s16, s16, 4096
  s_add_u32 s17, s17, 4096
  buffer_load_dwordx4 v[84:87], v9, s[20:23], s16 offen offset:0 sc1
  buffer_load_dwordx4 v[88:91], v9, s[20:23], s17 offen offset:0 sc1
  buffer_load_dword v5, v3, s[20:23], s68 offen sc1
  s_waitcnt vmcnt(29)
  v_mfma_f32_32x32x16_bf16 a[0:15], v[108:111], v[100:103], a[0:15]
  v_mfma_f32_32x32x16_bf16 a[16:31], v[112:115], v[100:103], a[16:31]
  v_mfma_f32_32x32x16_bf16 a[32:47], v[108:111], v[104:107], a[32:47]
  v_mfma_f32_32x32x16_bf16 a[48:63], v[112:115], v[104:107], a[48:63]
  s_waitcnt vmcnt(25)
  v_mfma_f32_32x32x16_bf16 a[0:15], v[124:127], v[116:119], a[0:15]
  v_mfma_f32_32x32x16_bf16 a[16:31], v[128:131], v[116:119], a[16:31]
  v_mfma_f32_32x32x16_bf16 a[32:47], v[124:127], v[120:123], a[32:47]
  v_mfma_f32_32x32x16_bf16 a[48:63], v[128:131], v[120:123], a[48:63]
  s_waitcnt vmcnt(21)
  v_mfma_f32_32x32x16_bf16 a[0:15], v[140:143], v[132:135], a[0:15]
  v_mfma_f32_32x32x16_bf16 a[16:31], v[144:147], v[132:135], a[16:31]
  v_mfma_f32_32x32x16_bf16 a[32:47], v[140:143], v[136:139], a[32:47]
  v_mfma_f32_32x32x16_bf16 a[48:63], v[144:147], v[136:139], a[48:63]
  s_waitcnt vmcnt(17)
  v_mfma_f32_32x32x16_bf16 a[0:15], v[28:31], v[20:23], a[0:15]
  v_mfma_f32_32x32x16_bf16 a[16:31], v[32:35], v[20:23], a[16:31]
  v_mfma_f32_32x32x16_bf16 a[32:47], v[28:31], v[24:27], a[32:47]
  v_mfma_f32_32x32x16_bf16 a[48:63], v[32:35], v[24:27], a[48:63]
  s_waitcnt vmcnt(13)
  v_mfma_f32_32x32x16_bf16 a[0:15], v[44:47], v[36:39], a[0:15]
  v_mfma_f32_32x32x16_bf16 a[16:31], v[48:51], v[36:39], a[16:31]
  v_mfma_f32_32x32x16_bf16 a[32:47], v[44:47], v[40:43], a[32:47]
  v_mfma_f32_32x32x16_bf16 a[48:63], v[48:51], v[40:43], a[48:63]
  s_waitcnt vmcnt(9)
  v_mfma_f32_32x32x16_bf16 a[0:15], v[60:63], v[52:55], a[0:15]
  v_mfma_f32_32x32x16_bf16 a[16:31], v[64:67], v[52:55], a[16:31]
  v_mfma_f32_32x32x16_bf16 a[32:47], v[60:63], v[56:59], a[32:47]
  v_mfma_f32_32x32x16_bf16 a[48:63], v[64:67], v[56:59], a[48:63]
  s_waitcnt vmcnt(5)
  v_mfma_f32_32x32x16_bf16 a[0:15], v[76:79], v[68:71], a[0:15]
  v_mfma_f32_32x32x16_bf16 a[16:31], v[80:83], v[68:71], a[16:31]
  v_mfma_f32_32x32x16_bf16 a[32:47], v[76:79], v[72:75], a[32:47]
  v_mfma_f32_32x32x16_bf16 a[48:63], v[80:83], v[72:75], a[48:63]
  s_waitcnt vmcnt(1)
  v_mfma_f32_32x32x16_bf16 a[0:15], v[92:95], v[84:87], a[0:15]
  v_mfma_f32_32x32x16_bf16 a[16:31], v[96:99], v[84:87], a[16:31]
  v_mfma_f32_32x32x16_bf16 a[32:47], v[92:95], v[88:91], a[32:47]
  v_mfma_f32_32x32x16_bf16 a[48:63], v[96:99], v[88:91], a[48:63]
  s_branch L_attn_gend_98
L_attn_g28_100:
  buffer_load_dwordx4 v[28:31], v9, s[20:23], s18 offen offset:0 sc1
  buffer_load_dwordx4 v[32:35], v9, s[20:23], s18 offen offset:1024 sc1
  buffer_load_dwordx4 v[20:23], v9, s[20:23], s16 offen offset:0 sc1
  buffer_load_dwordx4 v[24:27], v9, s[20:23], s17 offen offset:0 sc1
  buffer_load_dwordx4 v[44:47], v9, s[20:23], s18 offen offset:2048 sc1
  buffer_load_dwordx4 v[48:51], v9, s[20:23], s18 offen offset:3072 sc1
  buffer_load_dwordx4 v[36:39], v9, s[20:23], s16 offen offset:1024 sc1
  buffer_load_dwordx4 v[40:43], v9, s[20:23], s17 offen offset:1024 sc1
  s_add_u32 s18, s18, 4096
  buffer_load_dwordx4 v[60:63], v9, s[20:23], s18 offen offset:0 sc1
  buffer_load_dwordx4 v[64:67], v9, s[20:23], s18 offen offset:1024 sc1
  buffer_load_dwordx4 v[52:55], v9, s[20:23], s16 offen offset:2048 sc1
  buffer_load_dwordx4 v[56:59], v9, s[20:23], s17 offen offset:2048 sc1
  buffer_load_dwordx4 v[76:79], v9, s[20:23], s18 offen offset:2048 sc1
  buffer_load_dwordx4 v[80:83], v9, s[20:23], s18 offen offset:3072 sc1
  buffer_load_dwordx4 v[68:71], v9, s[20:23], s16 offen offset:3072 sc1
  buffer_load_dwordx4 v[72:75], v9, s[20:23], s17 offen offset:3072 sc1
  s_add_u32 s18, s18, 4096
  buffer_load_dwordx4 v[92:95], v9, s[20:23], s18 offen offset:0 sc1
  buffer_load_dwordx4 v[96:99], v9, s[20:23], s18 offen offset:1024 sc1
  s_add_u32 s16, s16, 4096
  s_add_u32 s17, s17, 4096
  buffer_load_dwordx4 v[84:87], v9, s[20:23], s16 offen offset:0 sc1
  buffer_load_dwordx4 v[88:91], v9, s[20:23], s17 offen offset:0 sc1
  buffer_load_dwordx4 v[108:111], v9, s[20:23], s18 offen offset:2048 sc1
  buffer_load_dwordx4 v[112:115], v9, s[20:23], s18 offen offset:3072 sc1
  buffer_load_dwordx4 v[100:103], v9, s[20:23], s16 offen offset:1024 sc1
  buffer_load_dwordx4 v[104:107], v9, s[20:23], s17 offen offset:1024 sc1
  s_add_u32 s18, s18, 4096
  buffer_load_dwordx4 v[124:127], v9, s[20:23], s18 offen offset:0 sc1
  buffer_load_dwordx4 v[128:131], v9, s[20:23], s18 offen offset:1024 sc1
  buffer_load_dwordx4 v[116:119], v9, s[20:23], s16 offen offset:2048 sc1
  buffer_load_dwordx4 v[120:123], v9, s[20:23], s17 offen offset:2048 sc1
  buffer_load_dwordx4 v[140:143], v9, s[20:23], s18 offen offset:2048 sc1
  buffer_load_dwordx4 v[144:147], v9, s[20:23], s18 offen offset:3072 sc1
  buffer_load_dwordx4 v[132:135], v9, s[20:23], s16 offen offset:3072 sc1
  buffer_load_dwordx4 v[136:139], v9, s[20:23], s17 offen offset:3072 sc1
  s_waitcnt vmcnt(28)
  v_mfma_f32_32x32x16_bf16 a[0:15], v[28:31], v[20:23], 0
  v_mfma_f32_32x32x16_bf16 a[16:31], v[32:35], v[20:23], 0
  v_mfma_f32_32x32x16_bf16 a[32:47], v[28:31], v[24:27], 0
  v_mfma_f32_32x32x16_bf16 a[48:63], v[32:35], v[24:27], 0
  s_add_u32 s18, s18, 4096
  buffer_load_dwordx4 v[28:31], v9, s[20:23], s18 offen offset:0 sc1
  buffer_load_dwordx4 v[32:35], v9, s[20:23], s18 offen offset:1024 sc1
  s_add_u32 s16, s16, 4096
  s_add_u32 s17, s17, 4096
  buffer_load_dwordx4 v[20:23], v9, s[20:23], s16 offen offset:0 sc1
  buffer_load_dwordx4 v[24:27], v9, s[20:23], s17 offen offset:0 sc1
  s_waitcnt vmcnt(28)
  v_mfma_f32_32x32x16_bf16 a[0:15], v[44:47], v[36:39], a[0:15]
  v_mfma_f32_32x32x16_bf16 a[16:31], v[48:51], v[36:39], a[16:31]
  v_mfma_f32_32x32x16_bf16 a[32:47], v[44:47], v[40:43], a[32:47]
  v_mfma_f32_32x32x16_bf16 a[48:63], v[48:51], v[40:43], a[48:63]
  buffer_load_dwordx4 v[44:47], v9, s[20:23], s18 offen offset:2048 sc1
  buffer_load_dwordx4 v[48:51], v9, s[20:23], s18 offen offset:3072 sc1
  buffer_load_dwordx4 v[36:39], v9, s[20:23], s16 offen offset:1024 sc1
  buffer_load_dwordx4 v[40:43], v9, s[20:23], s17 offen offset:1024 sc1
  s_waitcnt vmcnt(28)
  v_mfma_f32_32x32x16_bf16 a[0:15], v[60:63], v[52:55], a[0:15]
  v_mfma_f32_32x32x16_bf16 a[16:31], v[64:67], v[52:55], a[16:31]
  v_mfma_f32_32x32x16_bf16 a[32:47], v[60:63], v[56:59], a[32:47]
  v_mfma_f32_32x32x16_bf16 a[48:63], v[64:67], v[56:59], a[48:63]
  s_add_u32 s18, s18, 4096
  buffer_load_dwordx4 v[60:63], v9, s[20:23], s18 offen offset:0 sc1
  buffer_load_dwordx4 v[64:67], v9, s[20:23], s18 offen offset:1024 sc1
  buffer_load_dwordx4 v[52:55], v9, s[20:23], s16 offen offset:2048 sc1
  buffer_load_dwordx4 v[56:59], v9, s[20:23], s17 offen offset:2048 sc1
  s_waitcnt vmcnt(28)
  v_mfma_f32_32x32x16_bf16 a[0:15], v[76:79], v[68:71], a[0:15]
  v_mfma_f32_32x32x16_bf16 a[16:31], v[80:83], v[68:71], a[16:31]
  v_mfma_f32_32x32x16_bf16 a[32:47], v[76:79], v[72:75], a[32:47]
  v_mfma_f32_32x32x16_bf16 a[48:63], v[80:83], v[72:75], a[48:63]
  buffer_load_dwordx4 v[76:79], v9, s[20:23], s18 offen offset:2048 sc1
  buffer_load_dwordx4 v[80:83], v9, s[20:23], s18 offen offset:3072 sc1
  buffer_load_dwordx4 v[68:71], v9, s[20:23], s16 offen offset:3072 sc1
  buffer_load_dwordx4 v[72:75], v9, s[20:23], s17 offen offset:3072 sc1
  s_waitcnt vmcnt(28)
  v_mfma_f32_32x32x16_bf16 a[0:15], v[92:95], v[84:87], a[0:15]
  v_mfma_f32_32x32x16_bf16 a[16:31], v[96:99], v[84:87], a[16:31]
  v_mfma_f32_32x32x16_bf16 a[32:47], v[92:95], v[88:91], a[32:47]
  v_mfma_f32_32x32x16_bf16 a[48:63], v[96:99], v[88:91], a[48:63]
  s_add_u32 s18, s18, 4096
  buffer_load_dwordx4 v[92:95], v9, s[20:23], s18 offen offset:0 sc1
  buffer_load_dwordx4 v[96:99], v9, s[20:23], s18 offen offset:1024 sc1
  s_add_u32 s16, s16, 4096
  s_add_u32 s17, s17, 4096
  buffer_load_dwordx4 v[84:87], v9, s[20:23], s16 offen offset:0 sc1
  buffer_load_dwordx4 v[88:91], v9, s[20:23], s17 offen offset:0 sc1
  s_waitcnt vmcnt(28)
  v_mfma_f32_32x32x16_bf16 a[0:15], v[108:111], v[100:103], a[0:15]
  v_mfma_f32_32x32x16_bf16 a[16:31], v[112:115], v[100:103], a[16:31]
  v_mfma_f32_32x32x16_bf16 a[32:47], v[108:111], v[104:107], a[32:47]
  v_mfma_f32_32x32x16_bf16 a[48:63], v[112:115], v[104:107], a[48:63]
  buffer_load_dwordx4 v[108:111], v9, s[20:23], s18 offen offset:2048 sc1
  buffer_load_dwordx4 v[112:115], v9, s[20:23], s18 offen offset:3072 sc1
  buffer_load_dwordx4 v[100:103], v9, s[20:23], s16 offen offset:1024 sc1
  buffer_load_dwordx4 v[104:107], v9, s[20:23], s17 offen offset:1024 sc1
  s_waitcnt vmcnt(28)
  v_mfma_f32_32x32x16_bf16 a[0:15], v[124:127], v[116:119], a[0:15]
  v_mfma_f32_32x32x16_bf16 a[16:31], v[128:131], v[116:119], a[16:31]
  v_mfma_f32_32x32x16_bf16 a[32:47], v[124:127], v[120:123], a[32:47]
  v_mfma_f32_32x32x16_bf16 a[48:63], v[128:131], v[120:123], a[48:63]
  s_add_u32 s18, s18, 4096
  buffer_load_dwordx4 v[124:127], v9, s[20:23], s18 offen offset:0 sc1
  buffer_load_dwordx4 v[128:131], v9, s[20:23], s18 offen offset:1024 sc1
  buffer_load_dwordx4 v[116:119], v9, s[20:23], s16 offen offset:2048 sc1
  buffer_load_dwordx4 v[120:123], v9, s[20:23], s17 offen offset:2048 sc1
  s_waitcnt vmcnt(28)
  v_mfma_f32_32x32x16_bf16 a[0:15], v[140:143], v[132:135], a[0:15]
  v_mfma_f32_32x32x16_bf16 a[16:31], v[144:147], v[132:135], a[16:31]
  v_mfma_f32_32x32x16_bf16 a[32:47], v[140:143], v[136:139], a[32:47]
  v_mfma_f32_32x32x16_bf16 a[48:63], v[144:147], v[136:139], a[48:63]
  buffer_load_dwordx4 v[140:143], v9, s[20:23], s18 offen offset:2048 sc1
  buffer_load_dwordx4 v[144:147], v9, s[20:23], s18 offen offset:3072 sc1
  buffer_load_dwordx4 v[132:135], v9, s[20:23], s16 offen offset:3072 sc1
  buffer_load_dwordx4 v[136:139], v9, s[20:23], s17 offen offset:3072 sc1
  s_waitcnt vmcnt(28)
  v_mfma_f32_32x32x16_bf16 a[0:15], v[28:31], v[20:23], a[0:15]
  v_mfma_f32_32x32x16_bf16 a[16:31], v[32:35], v[20:23], a[16:31]
  v_mfma_f32_32x32x16_bf16 a[32:47], v[28:31], v[24:27], a[32:47]
  v_mfma_f32_32x32x16_bf16 a[48:63], v[32:35], v[24:27], a[48:63]
  s_add_u32 s18, s18, 4096
  buffer_load_dwordx4 v[28:31], v9, s[20:23], s18 offen offset:0 sc1
  buffer_load_dwordx4 v[32:35], v9, s[20:23], s18 offen offset:1024 sc1
  s_add_u32 s16, s16, 4096
  s_add_u32 s17, s17, 4096
  buffer_load_dwordx4 v[20:23], v9, s[20:23], s16 offen offset:0 sc1
  buffer_load_dwordx4 v[24:27], v9, s[20:23], s17 offen offset:0 sc1
  s_waitcnt vmcnt(28)
  v_mfma_f32_32x32x16_bf16 a[0:15], v[44:47], v[36:39], a[0:15]
  v_mfma_f32_32x32x16_bf16 a[16:31], v[48:51], v[36:39], a[16:31]
  v_mfma_f32_32x32x16_bf16 a[32:47], v[44:47], v[40:43], a[32:47]
  v_mfma_f32_32x32x16_bf16 a[48:63], v[48:51], v[40:43], a[48:63]
  buffer_load_dwordx4 v[44:47], v9, s[20:23], s18 offen offset:2048 sc1
  buffer_load_dwordx4 v[48:51], v9, s[20:23], s18 offen offset:3072 sc1
  buffer_load_dwordx4 v[36:39], v9, s[20:23], s16 offen offset:1024 sc1
  buffer_load_dwordx4 v[40:43], v9, s[20:23], s17 offen offset:1024 sc1
  s_waitcnt vmcnt(28)
  v_mfma_f32_32x32x16_bf16 a[0:15], v[60:63], v[52:55], a[0:15]
  v_mfma_f32_32x32x16_bf16 a[16:31], v[64:67], v[52:55], a[16:31]
  v_mfma_f32_32x32x16_bf16 a[32:47], v[60:63], v[56:59], a[32:47]
  v_mfma_f32_32x32x16_bf16 a[48:63], v[64:67], v[56:59], a[48:63]
  s_add_u32 s18, s18, 4096
  buffer_load_dwordx4 v[60:63], v9, s[20:23], s18 offen offset:0 sc1
  buffer_load_dwordx4 v[64:67], v9, s[20:23], s18 offen offset:1024 sc1
  buffer_load_dwordx4 v[52:55], v9, s[20:23], s16 offen offset:2048 sc1
  buffer_load_dwordx4 v[56:59], v9, s[20:23], s17 offen offset:2048 sc1
  s_waitcnt vmcnt(28)
  v_mfma_f32_32x32x16_bf16 a[0:15], v[76:79], v[68:71], a[0:15]
  v_mfma_f32_32x32x16_bf16 a[16:31], v[80:83], v[68:71], a[16:31]
  v_mfma_f32_32x32x16_bf16 a[32:47], v[76:79], v[72:75], a[32:47]
  v_mfma_f32_32x32x16_bf16 a[48:63], v[80:83], v[72:75], a[48:63]
  buffer_load_dwordx4 v[76:79], v9, s[20:23], s18 offen offset:2048 sc1
  buffer_load_dwordx4 v[80:83], v9, s[20:23], s18 offen offset:3072 sc1
  buffer_load_dwordx4 v[68:71], v9, s[20:23], s16 offen offset:3072 sc1
  buffer_load_dwordx4 v[72:75], v9, s[20:23], s17 offen offset:3072 sc1
  s_waitcnt vmcnt(28)
  v_mfma_f32_32x32x16_bf16 a[0:15], v[92:95], v[84:87], a[0:15]
  v_mfma_f32_32x32x16_bf16 a[16:31], v[96:99], v[84:87], a[16:31]
  v_mfma_f32_32x32x16_bf16 a[32:47], v[92:95], v[88:91], a[32:47]
  v_mfma_f32_32x32x16_bf16 a[48:63], v[96:99], v[88:91], a[48:63]
  s_add_u32 s18, s18, 4096
  buffer_load_dwordx4 v[92:95], v9, s[20:23], s18 offen offset:0 sc1
  buffer_load_dwordx4 v[96:99], v9, s[20:23], s18 offen offset:1024 sc1
  s_add_u32 s16, s16, 4096
  s_add_u32 s17, s17, 4096
  buffer_load_dwordx4 v[84:87], v9, s[20:23], s16 offen offset:0 sc1
  buffer_load_dwordx4 v[88:91], v9, s[20:23], s17 offen offset:0 sc1
  s_waitcnt vmcnt(28)
  v_mfma_f32_32x32x16_bf16 a[0:15], v[108:111], v[100:103], a[0:15]
  v_mfma_f32_32x32x16_bf16 a[16:31], v[112:115], v[100:103], a[16:31]
  v_mfma_f32_32x32x16_bf16 a[32:47], v[108:111], v[104:107], a[32:47]
  v_mfma_f32_32x32x16_bf16 a[48:63], v[112:115], v[104:107], a[48:63]
  buffer_load_dwordx4 v[108:111], v9, s[20:23], s18 offen offset:2048 sc1
  buffer_load_dwordx4 v[112:115], v9, s[20:23], s18 offen offset:3072 sc1
  buffer_load_dwordx4 v[100:103], v9, s[20:23], s16 offen offset:1024 sc1
  buffer_load_dwordx4 v[104:107], v9, s[20:23], s17 offen offset:1024 sc1
  s_waitcnt vmcnt(28)
  v_mfma_f32_32x32x16_bf16 a[0:15], v[124:127], v[116:119], a[0:15]
  v_mfma_f32_32x32x16_bf16 a[16:31], v[128:131], v[116:119], a[16:31]
  v_mfma_f32_32x32x16_bf16 a[32:47], v[124:127], v[120:123], a[32:47]
  v_mfma_f32_32x32x16_bf16 a[48:63], v[128:131], v[120:123], a[48:63]
  s_add_u32 s18, s18, 4096
  buffer_load_dwordx4 v[124:127], v9, s[20:23], s18 offen offset:0 sc1
  buffer_load_dwordx4 v[128:131], v9, s[20:23], s18 offen offset:1024 sc1
  buffer_load_dwordx4 v[116:119], v9, s[20:23], s16 offen offset:2048 sc1
  buffer_load_dwordx4 v[120:123], v9, s[20:23], s17 offen offset:2048 sc1
  s_waitcnt vmcnt(28)
  v_mfma_f32_32x32x16_bf16 a[0:15], v[140:143], v[132:135], a[0:15]
  v_mfma_f32_32x32x16_bf16 a[16:31], v[144:147], v[132:135], a[16:31]
  v_mfma_f32_32x32x16_bf16 a[32:47], v[140:143], v[136:139], a[32:47]
  v_mfma_f32_32x32x16_bf16 a[48:63], v[144:147], v[136:139], a[48:63]
  buffer_load_dwordx4 v[140:143], v9, s[20:23], s18 offen offset:2048 sc1
  buffer_load_dwordx4 v[144:147], v9, s[20:23], s18 offen offset:3072 sc1
  buffer_load_dwordx4 v[132:135], v9, s[20:23], s16 offen offset:3072 sc1
  buffer_load_dwordx4 v[136:139], v9, s[20:23], s17 offen offset:3072 sc1
  s_waitcnt vmcnt(28)
  v_mfma_f32_32x32x16_bf16 a[0:15], v[28:31], v[20:23], a[0:15]
  v_mfma_f32_32x32x16_bf16 a[16:31], v[32:35], v[20:23], a[16:31]
  v_mfma_f32_32x32x16_bf16 a[32:47], v[28:31], v[24:27], a[32:47]
  v_mfma_f32_32x32x16_bf16 a[48:63], v[32:35], v[24:27], a[48:63]
  s_add_u32 s18, s18, 4096
  buffer_load_dwordx4 v[28:31], v9, s[20:23], s18 offen offset:0 sc1
  buffer_load_dwordx4 v[32:35], v9, s[20:23], s18 offen offset:1024 sc1
  s_add_u32 s16, s16, 4096
  s_add_u32 s17, s17, 4096
  buffer_load_dwordx4 v[20:23], v9, s[20:23], s16 offen offset:0 sc1
  buffer_load_dwordx4 v[24:27], v9, s[20:23], s17 offen offset:0 sc1
  s_waitcnt vmcnt(28)
  v_mfma_f32_32x32x16_bf16 a[0:15], v[44:47], v[36:39], a[0:15]
  v_mfma_f32_32x32x16_bf16 a[16:31], v[48:51], v[36:39], a[16:31]
  v_mfma_f32_32x32x16_bf16 a[32:47], v[44:47], v[40:43], a[32:47]
  v_mfma_f32_32x32x16_bf16 a[48:63], v[48:51], v[40:43], a[48:63]
  buffer_load_dwordx4 v[44:47], v9, s[20:23], s18 offen offset:2048 sc1
  buffer_load_dwordx4 v[48:51], v9, s[20:23], s18 offen offset:3072 sc1
  buffer_load_dwordx4 v[36:39], v9, s[20:23], s16 offen offset:1024 sc1
  buffer_load_dwordx4 v[40:43], v9, s[20:23], s17 offen offset:1024 sc1
  s_waitcnt vmcnt(28)
  v_mfma_f32_32x32x16_bf16 a[0:15], v[60:63], v[52:55], a[0:15]
  v_mfma_f32_32x32x16_bf16 a[16:31], v[64:67], v[52:55], a[16:31]
  v_mfma_f32_32x32x16_bf16 a[32:47], v[60:63], v[56:59], a[32:47]
  v_mfma_f32_32x32x16_bf16 a[48:63], v[64:67], v[56:59], a[48:63]
  s_add_u32 s18, s18, 4096
  buffer_load_dwordx4 v[60:63], v9, s[20:23], s18 offen offset:0 sc1
  buffer_load_dwordx4 v[64:67], v9, s[20:23], s18 offen offset:1024 sc1
  buffer_load_dwordx4 v[52:55], v9, s[20:23], s16 offen offset:2048 sc1
  buffer_load_dwordx4 v[56:59], v9, s[20:23], s17 offen offset:2048 sc1
  s_waitcnt vmcnt(28)
  v_mfma_f32_32x32x16_bf16 a[0:15], v[76:79], v[68:71], a[0:15]
  v_mfma_f32_32x32x16_bf16 a[16:31], v[80:83], v[68:71], a[16:31]
  v_mfma_f32_32x32x16_bf16 a[32:47], v[76:79], v[72:75], a[32:47]
  v_mfma_f32_32x32x16_bf16 a[48:63], v[80:83], v[72:75], a[48:63]
  buffer_load_dwordx4 v[76:79], v9, s[20:23], s18 offen offset:2048 sc1
  buffer_load_dwordx4 v[80:83], v9, s[20:23], s18 offen offset:3072 sc1
  buffer_load_dwordx4 v[68:71], v9, s[20:23], s16 offen offset:3072 sc1
  buffer_load_dwordx4 v[72:75], v9, s[20:23], s17 offen offset:3072 sc1
  buffer_load_dword v5, v3, s[20:23], s68 offen sc1
  s_waitcnt vmcnt(29)
  v_mfma_f32_32x32x16_bf16 a[0:15], v[92:95], v[84:87], a[0:15]
  v_mfma_f32_32x32x16_bf16 a[16:31], v[96:99], v[84:87], a[16:31]
  v_mfma_f32_32x32x16_bf16 a[32:47], v[92:95], v[88:91], a[32:47]
  v_mfma_f32_32x32x16_bf16 a[48:63], v[96:99], v[88:91], a[48:63]
  s_waitcnt vmcnt(25)
  v_mfma_f32_32x32x16_bf16 a[0:15], v[108:111], v[100:103], a[0:15]
  v_mfma_f32_32x32x16_bf16 a[16:31], v[112:115], v[100:103], a[16:31]
  v_mfma_f32_32x32x16_bf16 a[32:47], v[108:111], v[104:107], a[32:47]
  v_mfma_f32_32x32x16_bf16 a[48:63], v[112:115], v[104:107], a[48:63]
  s_waitcnt vmcnt(21)
  v_mfma_f32_32x32x16_bf16 a[0:15], v[124:127], v[116:119], a[0:15]
  v_mfma_f32_32x32x16_bf16 a[16:31], v[128:131], v[116:119], a[16:31]
  v_mfma_f32_32x32x16_bf16 a[32:47], v[124:127], v[120:123], a[32:47]
  v_mfma_f32_32x32x16_bf16 a[48:63], v[128:131], v[120:123], a[48:63]
  s_waitcnt vmcnt(17)
  v_mfma_f32_32x32x16_bf16 a[0:15], v[140:143], v[132:135], a[0:15]
  v_mfma_f32_32x32x16_bf16 a[16:31], v[144:147], v[132:135], a[16:31]
  v_mfma_f32_32x32x16_bf16 a[32:47], v[140:143], v[136:139], a[32:47]
  v_mfma_f32_32x32x16_bf16 a[48:63], v[144:147], v[136:139], a[48:63]
  s_waitcnt vmcnt(13)
  v_mfma_f32_32x32x16_bf16 a[0:15], v[28:31], v[20:23], a[0:15]
  v_mfma_f32_32x32x16_bf16 a[16:31], v[32:35], v[20:23], a[16:31]
  v_mfma_f32_32x32x16_bf16 a[32:47], v[28:31], v[24:27], a[32:47]
  v_mfma_f32_32x32x16_bf16 a[48:63], v[32:35], v[24:27], a[48:63]
  s_waitcnt vmcnt(9)
  v_mfma_f32_32x32x16_bf16 a[0:15], v[44:47], v[36:39], a[0:15]
  v_mfma_f32_32x32x16_bf16 a[16:31], v[48:51], v[36:39], a[16:31]
  v_mfma_f32_32x32x16_bf16 a[32:47], v[44:47], v[40:43], a[32:47]
  v_mfma_f32_32x32x16_bf16 a[48:63], v[48:51], v[40:43], a[48:63]
  s_waitcnt vmcnt(5)
  v_mfma_f32_32x32x16_bf16 a[0:15], v[60:63], v[52:55], a[0:15]
  v_mfma_f32_32x32x16_bf16 a[16:31], v[64:67], v[52:55], a[16:31]
  v_mfma_f32_32x32x16_bf16 a[32:47], v[60:63], v[56:59], a[32:47]
  v_mfma_f32_32x32x16_bf16 a[48:63], v[64:67], v[56:59], a[48:63]
  s_waitcnt vmcnt(1)
  v_mfma_f32_32x32x16_bf16 a[0:15], v[76:79], v[68:71], a[0:15]
  v_mfma_f32_32x32x16_bf16 a[16:31], v[80:83], v[68:71], a[16:31]
  v_mfma_f32_32x32x16_bf16 a[32:47], v[76:79], v[72:75], a[32:47]
  v_mfma_f32_32x32x16_bf16 a[48:63], v[80:83], v[72:75], a[48:63]
  s_branch L_attn_gend_98
L_attn_g23_101:
  buffer_load_dwordx4 v[28:31], v9, s[20:23], s18 offen offset:0 sc1
  buffer_load_dwordx4 v[32:35], v9, s[20:23], s18 offen offset:1024 sc1
  buffer_load_dwordx4 v[20:23], v9, s[20:23], s16 offen offset:0 sc1
  buffer_load_dwordx4 v[24:27], v9, s[20:23], s17 offen offset:0 sc1
  buffer_load_dwordx4 v[44:47], v9, s[20:23], s18 offen offset:2048 sc1
  buffer_load_dwordx4 v[48:51], v9, s[20:23], s18 offen offset:3072 sc1
  buffer_load_dwordx4 v[36:39], v9, s[20:23], s16 offen offset:1024 sc1
  buffer_load_dwordx4 v[40:43], v9, s[20:23], s17 offen offset:1024 sc1
  s_add_u32 s18, s18, 4096
  buffer_load_dwordx4 v[60:63], v9, s[20:23], s18 offen offset:0 sc1
  buffer_load_dwordx4 v[64:67], v9, s[20:23], s18 offen offset:1024 sc1
  buffer_load_dwordx4 v[52:55], v9, s[20:23], s16 offen offset:2048 sc1
  buffer_load_dwordx4 v[56:59], v9, s[20:23], s17 offen offset:2048 sc1
  buffer_load_dwordx4 v[76:79], v9, s[20:23], s18 offen offset:2048 sc1
  buffer_load_dwordx4 v[80:83], v9, s[20:23], s18 offen offset:3072 sc1
  buffer_load_dwordx4 v[68:71], v9, s[20:23], s16 offen offset:3072 sc1
  buffer_load_dwordx4 v[72:75], v9, s[20:23], s17 offen offset:3072 sc1
  s_add_u32 s18, s18, 4096
  buffer_load_dwordx4 v[92:95], v9, s[20:23], s18 offen offset:0 sc1
  buffer_load_dwordx4 v[96:99], v9, s[20:23], s18 offen offset:1024 sc1
  s_add_u32 s16, s16, 4096
  s_add_u32 s17, s17, 4096
  buffer_load_dwordx4 v[84:87], v9, s[20:23], s16 offen offset:0 sc1
  buffer_load_dwordx4 v[88:91], v9, s[20:23], s17 offen offset:0 sc1
  buffer_load_dwordx4 v[108:111], v9, s[20:23], s18 offen offset:2048 sc1
  buffer_load_dwordx4 v[112:115], v9, s[20:23], s18 offen offset:3072 sc1
  buffer_load_dwordx4 v[100:103], v9, s[20:23], s16 offen offset:1024 sc1
  buffer_load_dwordx4 v[104:107], v9, s[20:23], s17 offen offset:1024 sc1
  s_add_u32 s18, s18, 4096
  buffer_load_dwordx4 v[124:127], v9, s[20:23], s18 offen offset:0 sc1
  buffer_load_dwordx4 v[128:131], v9, s[20:23], s18 offen offset:1024 sc1
  buffer_load_dwordx4 v[116:119], v9, s[20:23], s16 offen offset:2048 sc1
  buffer_load_dwordx4 v[120:123], v9, s[20:23], s17 offen offset:2048 sc1
  buffer_load_dwordx4 v[140:143], v9, s[20:23], s18 offen offset:2048 sc1
  buffer_load_dwordx4 v[144:147], v9, s[20:23], s18 offen offset:3072 sc1
  buffer_load_dwordx4 v[132:135], v9, s[20:23], s16 offen offset:3072 sc1
  buffer_load_dwordx4 v[136:139], v9, s[20:23], s17 offen offset:3072 sc1
  s_waitcnt vmcnt(28)
  v_mfma_f32_32x32x16_bf16 a[0:15], v[28:31], v[20:23], 0
  v_mfma_f32_32x32x16_bf16 a[16:31], v[32:35], v[20:23], 0
  v_mfma_f32_32x32x16_bf16 a[32:47], v[28:31], v[24:27], 0
  v_mfma_f32_32x32x16_bf16 a[48:63], v[32:35], v[24:27], 0
  s_add_u32 s18, s18, 4096
  buffer_load_dwordx4 v[28:31], v9, s[20:23], s18 offen offset:0 sc1
  buffer_load_dwordx4 v[32:35], v9, s[20:23], s18 offen offset:1024 sc1
  s_add_u32 s16, s16, 4096
  s_add_u32 s17, s17, 4096
  buffer_load_dwordx4 v[20:23], v9, s[20:23], s16 offen offset:0 sc1
  buffer_load_dwordx4 v[24:27], v9, s[20:23], s17 offen offset:0 sc1
  s_waitcnt vmcnt(28)
  v_mfma_f32_32x32x16_bf16 a[0:15], v[44:47], v[36:39], a[0:15]
  v_mfma_f32_32x32x16_bf16 a[16:31], v[48:51], v[36:39], a[16:31]
  v_mfma_f32_32x32x16_bf16 a[32:47], v[44:47], v[40:43], a[32:47]
  v_mfma_f32_32x32x16_bf16 a[48:63], v[48:51], v[40:43], a[48:63]
  buffer_load_dwordx4 v[44:47], v9, s[20:23], s18 offen offset:2048 sc1
  buffer_load_dwordx4 v[48:51], v9, s[20:23], s18 offen offset:3072 sc1
  buffer_load_dwordx4 v[36:39], v9, s[20:23], s16 offen offset:1024 sc1
  buffer_load_dwordx4 v[40:43], v9, s[20:23], s17 offen offset:1024 sc1
  s_waitcnt vmcnt(28)
  v_mfma_f32_32x32x16_bf16 a[0:15], v[60:63], v[52:55], a[0:15]
  v_mfma_f32_32x32x16_bf16 a[16:31], v[64:67], v[52:55], a[16:31]
  v_mfma_f32_32x32x16_bf16 a[32:47], v[60:63], v[56:59], a[32:47]
  v_mfma_f32_32x32x16_bf16 a[48:63], v[64:67], v[56:59], a[48:63]
  s_add_u32 s18, s18, 4096
  buffer_load_dwordx4 v[60:63], v9, s[20:23], s18 offen offset:0 sc1
  buffer_load_dwordx4 v[64:67], v9, s[20:23], s18 offen offset:1024 sc1
  buffer_load_dwordx4 v[52:55], v9, s[20:23], s16 offen offset:2048 sc1
  buffer_load_dwordx4 v[56:59], v9, s[20:23], s17 offen offset:2048 sc1
  s_waitcnt vmcnt(28)
  v_mfma_f32_32x32x16_bf16 a[0:15], v[76:79], v[68:71], a[0:15]
  v_mfma_f32_32x32x16_bf16 a[16:31], v[80:83], v[68:71], a[16:31]
  v_mfma_f32_32x32x16_bf16 a[32:47], v[76:79], v[72:75], a[32:47]
  v_mfma_f32_32x32x16_bf16 a[48:63], v[80:83], v[72:75], a[48:63]
  buffer_load_dwordx4 v[76:79], v9, s[20:23], s18 offen offset:2048 sc1
  buffer_load_dwordx4 v[80:83], v9, s[20:23], s18 offen offset:3072 sc1
  buffer_load_dwordx4 v[68:71], v9, s[20:23], s16 offen offset:3072 sc1
  buffer_load_dwordx4 v[72:75], v9, s[20:23], s17 offen offset:3072 sc1
  s_waitcnt vmcnt(28)
  v_mfma_f32_32x32x16_bf16 a[0:15], v[92:95], v[84:87], a[0:15]
  v_mfma_f32_32x32x16_bf16 a[16:31], v[96:99], v[84:87], a[16:31]
  v_mfma_f32_32x32x16_bf16 a[32:47], v[92:95], v[88:91], a[32:47]
  v_mfma_f32_32x32x16_bf16 a[48:63], v[96:99], v[88:91], a[48:63]
  s_add_u32 s18, s18, 4096
  buffer_load_dwordx4 v[92:95], v9, s[20:23], s18 offen offset:0 sc1
  buffer_load_dwordx4 v[96:99], v9, s[20:23], s18 offen offset:1024 sc1
  s_add_u32 s16, s16, 4096
  s_add_u32 s17, s17, 4096
  buffer_load_dwordx4 v[84:87], v9, s[20:23], s16 offen offset:0 sc1
  buffer_load_dwordx4 v[88:91], v9, s[20:23], s17 offen offset:0 sc1
  s_waitcnt vmcnt(28)
  v_mfma_f32_32x32x16_bf16 a[0:15], v[108:111], v[100:103], a[0:15]
  v_mfma_f32_32x32x16_bf16 a[16:31], v[112:115], v[100:103], a[16:31]
  v_mfma_f32_32x32x16_bf16 a[32:47], v[108:111], v[104:107], a[32:47]
  v_mfma_f32_32x32x16_bf16 a[48:63], v[112:115], v[104:107], a[48:63]
  buffer_load_dwordx4 v[108:111], v9, s[20:23], s18 offen offset:2048 sc1
  buffer_load_dwordx4 v[112:115], v9, s[20:23], s18 offen offset:3072 sc1
  buffer_load_dwordx4 v[100:103], v9, s[20:23], s16 offen offset:1024 sc1
  buffer_load_dwordx4 v[104:107], v9, s[20:23], s17 offen offset:1024 sc1
  s_waitcnt vmcnt(28)
  v_mfma_f32_32x32x16_bf16 a[0:15], v[124:127], v[116:119], a[0:15]
  v_mfma_f32_32x32x16_bf16 a[16:31], v[128:131], v[116:119], a[16:31]
  v_mfma_f32_32x32x16_bf16 a[32:47], v[124:127], v[120:123], a[32:47]
  v_mfma_f32_32x32x16_bf16 a[48:63], v[128:131], v[120:123], a[48:63]
  s_add_u32 s18, s18, 4096
  buffer_load_dwordx4 v[124:127], v9, s[20:23], s18 offen offset:0 sc1
  buffer_load_dwordx4 v[128:131], v9, s[20:23], s18 offen offset:1024 sc1
  buffer_load_dwordx4 v[116:119], v9, s[20:23], s16 offen offset:2048 sc1
  buffer_load_dwordx4 v[120:123], v9, s[20:23], s17 offen offset:2048 sc1
  s_waitcnt vmcnt(28)
  v_mfma_f32_32x32x16_bf16 a[0:15], v[140:143], v[132:135], a[0:15]
  v_mfma_f32_32x32x16_bf16 a[16:31], v[144:147], v[132:135], a[16:31]
  v_mfma_f32_32x32x16_bf16 a[32:47], v[140:143], v[136:139], a[32:47]
  v_mfma_f32_32x32x16_bf16 a[48:63], v[144:147], v[136:139], a[48:63]
  buffer_load_dwordx4 v[140:143], v9, s[20:23], s18 offen offset:2048 sc1
  buffer_load_dwordx4 v[144:147], v9, s[20:23], s18 offen offset:3072 sc1
  buffer_load_dwordx4 v[132:135], v9, s[20:23], s16 offen offset:3072 sc1
  buffer_load_dwordx4 v[136:139], v9, s[20:23], s17 offen offset:3072 sc1
  s_waitcnt vmcnt(28)
  v_mfma_f32_32x32x16_bf16 a[0:15], v[28:31], v[20:23], a[0:15]
  v_mfma_f32_32x32x16_bf16 a[16:31], v[32:35], v[20:23], a[16:31]
  v_mfma_f32_32x32x16_bf16 a[32:47], v[28:31], v[24:27], a[32:47]
  v_mfma_f32_32x32x16_bf16 a[48:63], v[32:35], v[24:27], a[48:63]
  s_add_u32 s18, s18, 4096
  buffer_load_dwordx4 v[28:31], v9, s[20:23], s18 offen offset:0 sc1
  buffer_load_dwordx4 v[32:35], v9, s[20:23], s18 offen offset:1024 sc1
  s_add_u32 s16, s16, 4096
  s_add_u32 s17, s17, 4096
  buffer_load_dwordx4 v[20:23], v9, s[20:23], s16 offen offset:0 sc1
  buffer_load_dwordx4 v[24:27], v9, s[20:23], s17 offen offset:0 sc1
  s_waitcnt vmcnt(28)
  v_mfma_f32_32x32x16_bf16 a[0:15], v[44:47], v[36:39], a[0:15]
  v_mfma_f32_32x32x16_bf16 a[16:31], v[48:51], v[36:39], a[16:31]
  v_mfma_f32_32x32x16_bf16 a[32:47], v[44:47], v[40:43], a[32:47]
  v_mfma_f32_32x32x16_bf16 a[48:63], v[48:51], v[40:43], a[48:63]
  buffer_load_dwordx4 v[44:47], v9, s[20:23], s18 offen offset:2048 sc1
  buffer_load_dwordx4 v[48:51], v9, s[20:23], s18 offen offset:3072 sc1
  buffer_load_dwordx4 v[36:39], v9, s[20:23], s16 offen offset:1024 sc1
  buffer_load_dwordx4 v[40:43], v9, s[20:23], s17 offen offset:1024 sc1
  s_waitcnt vmcnt(28)
  v_mfma_f32_32x32x16_bf16 a[0:15], v[60:63], v[52:55], a[0:15]
  v_mfma_f32_32x32x16_bf16 a[16:31], v[64:67], v[52:55], a[16:31]
  v_mfma_f32_32x32x16_bf16 a[32:47], v[60:63], v[56:59], a[32:47]
  v_mfma_f32_32x32x16_bf16 a[48:63], v[64:67], v[56:59], a[48:63]
  s_add_u32 s18, s18, 4096
  buffer_load_dwordx4 v[60:63], v9, s[20:23], s18 offen offset:0 sc1
  buffer_load_dwordx4 v[64:67], v9, s[20:23], s18 offen offset:1024 sc1
  buffer_load_dwordx4 v[52:55], v9, s[20:23], s16 offen offset:2048 sc1
  buffer_load_dwordx4 v[56:59], v9, s[20:23], s17 offen offset:2048 sc1
  s_waitcnt vmcnt(28)
  v_mfma_f32_32x32x16_bf16 a[0:15], v[76:79], v[68:71], a[0:15]
  v_mfma_f32_32x32x16_bf16 a[16:31], v[80:83], v[68:71], a[16:31]
  v_mfma_f32_32x32x16_bf16 a[32:47], v[76:79], v[72:75], a[32:47]
  v_mfma_f32_32x32x16_bf16 a[48:63], v[80:83], v[72:75], a[48:63]
  buffer_load_dwordx4 v[76:79], v9, s[20:23], s18 offen offset:2048 sc1
  buffer_load_dwordx4 v[80:83], v9, s[20:23], s18 offen offset:3072 sc1
  buffer_load_dwordx4 v[68:71], v9, s[20:23], s16 offen offset:3072 sc1
  buffer_load_dwordx4 v[72:75], v9, s[20:23], s17 offen offset:3072 sc1
  s_waitcnt vmcnt(28)
  v_mfma_f32_32x32x16_bf16 a[0:15], v[92:95], v[84:87], a[0:15]
  v_mfma_f32_32x32x16_bf16 a[16:31], v[96:99], v[84:87], a[16:31]
  v_mfma_f32_32x32x16_bf16 a[32:47], v[92:95], v[88:91], a[32:47]
  v_mfma_f32_32x32x16_bf16 a[48:63], v[96:99], v[88:91], a[48:63]
  s_add_u32 s18, s18, 4096
  buffer_load_dwordx4 v[92:95], v9, s[20:23], s18 offen offset:0 sc1
  buffer_load_dwordx4 v[96:99], v9, s[20:23], s18 offen offset:1024 sc1
  s_add_u32 s16, s16, 4096
  s_add_u32 s17, s17, 4096
  buffer_load_dwordx4 v[84:87], v9, s[20:23], s16 offen offset:0 sc1
  buffer_load_dwordx4 v[88:91], v9, s[20:23], s17 offen offset:0 sc1
  s_waitcnt vmcnt(28)
  v_mfma_f32_32x32x16_bf16 a[0:15], v[108:111], v[100:103], a[0:15]
  v_mfma_f32_32x32x16_bf16 a[16:31], v[112:115], v[100:103], a[16:31]
  v_mfma_f32_32x32x16_bf16 a[32:47], v[108:111], v[104:107], a[32:47]
  v_mfma_f32_32x32x16_bf16 a[48:63], v[112:115], v[104:107], a[48:63]
  buffer_load_dwordx4 v[108:111], v9, s[20:23], s18 offen offset:2048 sc1
  buffer_load_dwordx4 v[112:115], v9, s[20:23], s18 offen offset:3072 sc1
  buffer_load_dwordx4 v[100:103], v9, s[20:23], s16 offen offset:1024 sc1
  buffer_load_dwordx4 v[104:107], v9, s[20:23], s17 offen offset:1024 sc1
  s_waitcnt vmcnt(28)
  v_mfma_f32_32x32x16_bf16 a[0:15], v[124:127], v[116:119], a[0:15]
  v_mfma_f32_32x32x16_bf16 a[16:31], v[128:131], v[116:119], a[16:31]
  v_mfma_f32_32x32x16_bf16 a[32:47], v[124:127], v[120:123], a[32:47]
  v_mfma_f32_32x32x16_bf16 a[48:63], v[128:131], v[120:123], a[48:63]
  s_add_u32 s18, s18, 4096
  buffer_load_dwordx4 v[124:127], v9, s[20:23], s18 offen offset:0 sc1
  buffer_load_dwordx4 v[128:131], v9, s[20:23], s18 offen offset:1024 sc1
  buffer_load_dwordx4 v[116:119], v9, s[20:23], s16 offen offset:2048 sc1
  buffer_load_dwordx4 v[120:123], v9, s[20:23], s17 offen offset:2048 sc1
  buffer_load_dword v5, v3, s[20:23], s68 offen sc1
  s_waitcnt vmcnt(29)
  v_mfma_f32_32x32x16_bf16 a[0:15], v[140:143], v[132:135], a[0:15]
  v_mfma_f32_32x32x16_bf16 a[16:31], v[144:147], v[132:135], a[16:31]
  v_mfma_f32_32x32x16_bf16 a[32:47], v[140:143], v[136:139], a[32:47]
  v_mfma_f32_32x32x16_bf16 a[48:63], v[144:147], v[136:139], a[48:63]
  s_waitcnt vmcnt(25)
  v_mfma_f32_32x32x16_bf16 a[0:15], v[28:31], v[20:23], a[0:15]
  v_mfma_f32_32x32x16_bf16 a[16:31], v[32:35], v[20:23], a[16:31]
  v_mfma_f32_32x32x16_bf16 a[32:47], v[28:31], v[24:27], a[32:47]
  v_mfma_f32_32x32x16_bf16 a[48:63], v[32:35], v[24:27], a[48:63]
  s_waitcnt vmcnt(21)
  v_mfma_f32_32x32x16_bf16 a[0:15], v[44:47], v[36:39], a[0:15]
  v_mfma_f32_32x32x16_bf16 a[16:31], v[48:51], v[36:39], a[16:31]
  v_mfma_f32_32x32x16_bf16 a[32:47], v[44:47], v[40:43], a[32:47]
  v_mfma_f32_32x32x16_bf16 a[48:63], v[48:51], v[40:43], a[48:63]
  s_waitcnt vmcnt(17)
  v_mfma_f32_32x32x16_bf16 a[0:15], v[60:63], v[52:55], a[0:15]
  v_mfma_f32_32x32x16_bf16 a[16:31], v[64:67], v[52:55], a[16:31]
  v_mfma_f32_32x32x16_bf16 a[32:47], v[60:63], v[56:59], a[32:47]
  v_mfma_f32_32x32x16_bf16 a[48:63], v[64:67], v[56:59], a[48:63]
  s_waitcnt vmcnt(13)
  v_mfma_f32_32x32x16_bf16 a[0:15], v[76:79], v[68:71], a[0:15]
  v_mfma_f32_32x32x16_bf16 a[16:31], v[80:83], v[68:71], a[16:31]
  v_mfma_f32_32x32x16_bf16 a[32:47], v[76:79], v[72:75], a[32:47]
  v_mfma_f32_32x32x16_bf16 a[48:63], v[80:83], v[72:75], a[48:63]
  s_waitcnt vmcnt(9)
  v_mfma_f32_32x32x16_bf16 a[0:15], v[92:95], v[84:87], a[0:15]
  v_mfma_f32_32x32x16_bf16 a[16:31], v[96:99], v[84:87], a[16:31]
  v_mfma_f32_32x32x16_bf16 a[32:47], v[92:95], v[88:91], a[32:47]
  v_mfma_f32_32x32x16_bf16 a[48:63], v[96:99], v[88:91], a[48:63]
  s_waitcnt vmcnt(5)
  v_mfma_f32_32x32x16_bf16 a[0:15], v[108:111], v[100:103], a[0:15]
  v_mfma_f32_32x32x16_bf16 a[16:31], v[112:115], v[100:103], a[16:31]
  v_mfma_f32_32x32x16_bf16 a[32:47], v[108:111], v[104:107], a[32:47]
  v_mfma_f32_32x32x16_bf16 a[48:63], v[112:115], v[104:107], a[48:63]
  s_waitcnt vmcnt(1)
  v_mfma_f32_32x32x16_bf16 a[0:15], v[124:127], v[116:119], a[0:15]
  v_mfma_f32_32x32x16_bf16 a[16:31], v[128:131], v[116:119], a[16:31]
  v_mfma_f32_32x32x16_bf16 a[32:47], v[124:127], v[120:123], a[32:47]
  v_mfma_f32_32x32x16_bf16 a[48:63], v[128:131], v[120:123], a[48:63]
  s_branch L_attn_gend_98
L_attn_g20_102:
  buffer_load_dwordx4 v[28:31], v9, s[20:23], s18 offen offset:0 sc1
  buffer_load_dwordx4 v[32:35], v9, s[20:23], s18 offen offset:1024 sc1
  buffer_load_dwordx4 v[20:23], v9, s[20:23], s16 offen offset:0 sc1
  buffer_load_dwordx4 v[24:27], v9, s[20:23], s17 offen offset:0 sc1
  buffer_load_dwordx4 v[44:47], v9, s[20:23], s18 offen offset:2048 sc1
  buffer_load_dwordx4 v[48:51], v9, s[20:23], s18 offen offset:3072 sc1
  buffer_load_dwordx4 v[36:39], v9, s[20:23], s16 offen offset:1024 sc1
  buffer_load_dwordx4 v[40:43], v9, s[20:23], s17 offen offset:1024 sc1
  s_add_u32 s18, s18, 4096
  buffer_load_dwordx4 v[60:63], v9, s[20:23], s18 offen offset:0 sc1
  buffer_load_dwordx4 v[64:67], v9, s[20:23], s18 offen offset:1024 sc1
  buffer_load_dwordx4 v[52:55], v9, s[20:23], s16 offen offset:2048 sc1
  buffer_load_dwordx4 v[56:59], v9, s[20:23], s17 offen offset:2048 sc1
  buffer_load_dwordx4 v[76:79], v9, s[20:23], s18 offen offset:2048 sc1
  buffer_load_dwordx4 v[80:83], v9, s[20:23], s18 offen offset:3072 sc1
  buffer_load_dwordx4 v[68:71], v9, s[20:23], s16 offen offset:3072 sc1
  buffer_load_dwordx4 v[72:75], v9, s[20:23], s17 offen offset:3072 sc1
  s_add_u32 s18, s18, 4096
  buffer_load_dwordx4 v[92:95], v9, s[20:23], s18 offen offset:0 sc1
  buffer_load_dwordx4 v[96:99], v9, s[20:23], s18 offen offset:1024 sc1
  s_add_u32 s16, s16, 4096
  s_add_u32 s17, s17, 4096
  buffer_load_dwordx4 v[84:87], v9, s[20:23], s16 offen offset:0 sc1
  buffer_load_dwordx4 v[88:91], v9, s[20:23], s17 offen offset:0 sc1
  buffer_load_dwordx4 v[108:111], v9, s[20:23], s18 offen offset:2048 sc1
  buffer_load_dwordx4 v[112:115], v9, s[20:23], s18 offen offset:3072 sc1
  buffer_load_dwordx4 v[100:103], v9, s[20:23], s16 offen offset:1024 sc1
  buffer_load_dwordx4 v[104:107], v9, s[20:23], s17 offen offset:1024 sc1
  s_add_u32 s18, s18, 4096
  buffer_load_dwordx4 v[124:127], v9, s[20:23], s18 offen offset:0 sc1
  buffer_load_dwordx4 v[128:131], v9, s[20:23], s18 offen offset:1024 sc1
  buffer_load_dwordx4 v[116:119], v9, s[20:23], s16 offen offset:2048 sc1
  buffer_load_dwordx4 v[120:123], v9, s[20:23], s17 offen offset:2048 sc1
  buffer_load_dwordx4 v[140:143], v9, s[20:23], s18 offen offset:2048 sc1
  buffer_load_dwordx4 v[144:147], v9, s[20:23], s18 offen offset:3072 sc1
  buffer_load_dwordx4 v[132:135], v9, s[20:23], s16 offen offset:3072 sc1
  buffer_load_dwordx4 v[136:139], v9, s[20:23], s17 offen offset:3072 sc1
  s_waitcnt vmcnt(28)
  v_mfma_f32_32x32x16_bf16 a[0:15], v[28:31], v[20:23], 0
  v_mfma_f32_32x32x16_bf16 a[16:31], v[32:35], v[20:23], 0
  v_mfma_f32_32x32x16_bf16 a[32:47], v[28:31], v[24:27], 0
  v_mfma_f32_32x32x16_bf16 a[48:63], v[32:35], v[24:27], 0
  s_add_u32 s18, s18, 4096
  buffer_load_dwordx4 v[28:31], v9, s[20:23], s18 offen offset:0 sc1
  buffer_load_dwordx4 v[32:35], v9, s[20:23], s18 offen offset:1024 sc1
  s_add_u32 s16, s16, 4096
  s_add_u32 s17, s17, 4096
  buffer_load_dwordx4 v[20:23], v9, s[20:23], s16 offen offset:0 sc1
  buffer_load_dwordx4 v[24:27], v9, s[20:23], s17 offen offset:0 sc1
  s_waitcnt vmcnt(28)
  v_mfma_f32_32x32x16_bf16 a[0:15], v[44:47], v[36:39], a[0:15]
  v_mfma_f32_32x32x16_bf16 a[16:31], v[48:51], v[36:39], a[16:31]
  v_mfma_f32_32x32x16_bf16 a[32:47], v[44:47], v[40:43], a[32:47]
  v_mfma_f32_32x32x16_bf16 a[48:63], v[48:51], v[40:43], a[48:63]
  buffer_load_dwordx4 v[44:47], v9, s[20:23], s18 offen offset:2048 sc1
  buffer_load_dwordx4 v[48:51], v9, s[20:23], s18 offen offset:3072 sc1
  buffer_load_dwordx4 v[36:39], v9, s[20:23], s16 offen offset:1024 sc1
  buffer_load_dwordx4 v[40:43], v9, s[20:23], s17 offen offset:1024 sc1
  s_waitcnt vmcnt(28)
  v_mfma_f32_32x32x16_bf16 a[0:15], v[60:63], v[52:55], a[0:15]
  v_mfma_f32_32x32x16_bf16 a[16:31], v[64:67], v[52:55], a[16:31]
  v_mfma_f32_32x32x16_bf16 a[32:47], v[60:63], v[56:59], a[32:47]
  v_mfma_f32_32x32x16_bf16 a[48:63], v[64:67], v[56:59], a[48:63]
  s_add_u32 s18, s18, 4096
  buffer_load_dwordx4 v[60:63], v9, s[20:23], s18 offen offset:0 sc1
  buffer_load_dwordx4 v[64:67], v9, s[20:23], s18 offen offset:1024 sc1
  buffer_load_dwordx4 v[52:55], v9, s[20:23], s16 offen offset:2048 sc1
  buffer_load_dwordx4 v[56:59], v9, s[20:23], s17 offen offset:2048 sc1
  s_waitcnt vmcnt(28)
  v_mfma_f32_32x32x16_bf16 a[0:15], v[76:79], v[68:71], a[0:15]
  v_mfma_f32_32x32x16_bf16 a[16:31], v[80:83], v[68:71], a[16:31]
  v_mfma_f32_32x32x16_bf16 a[32:47], v[76:79], v[72:75], a[32:47]
  v_mfma_f32_32x32x16_bf16 a[48:63], v[80:83], v[72:75], a[48:63]
  buffer_load_dwordx4 v[76:79], v9, s[20:23], s18 offen offset:2048 sc1
  buffer_load_dwordx4 v[80:83], v9, s[20:23], s18 offen offset:3072 sc1
  buffer_load_dwordx4 v[68:71], v9, s[20:23], s16 offen offset:3072 sc1
  buffer_load_dwordx4 v[72:75], v9, s[20:23], s17 offen offset:3072 sc1
  s_waitcnt vmcnt(28)
  v_mfma_f32_32x32x16_bf16 a[0:15], v[92:95], v[84:87], a[0:15]
  v_mfma_f32_32x32x16_bf16 a[16:31], v[96:99], v[84:87], a[16:31]
  v_mfma_f32_32x32x16_bf16 a[32:47], v[92:95], v[88:91], a[32:47]
  v_mfma_f32_32x32x16_bf16 a[48:63], v[96:99], v[88:91], a[48:63]
  s_add_u32 s18, s18, 4096
  buffer_load_dwordx4 v[92:95], v9, s[20:23], s18 offen offset:0 sc1
  buffer_load_dwordx4 v[96:99], v9, s[20:23], s18 offen offset:1024 sc1
  s_add_u32 s16, s16, 4096
  s_add_u32 s17, s17, 4096
  buffer_load_dwordx4 v[84:87], v9, s[20:23], s16 offen offset:0 sc1
  buffer_load_dwordx4 v[88:91], v9, s[20:23], s17 offen offset:0 sc1
  s_waitcnt vmcnt(28)
  v_mfma_f32_32x32x16_bf16 a[0:15], v[108:111], v[100:103], a[0:15]
  v_mfma_f32_32x32x16_bf16 a[16:31], v[112:115], v[100:103], a[16:31]
  v_mfma_f32_32x32x16_bf16 a[32:47], v[108:111], v[104:107], a[32:47]
  v_mfma_f32_32x32x16_bf16 a[48:63], v[112:115], v[104:107], a[48:63]
  buffer_load_dwordx4 v[108:111], v9, s[20:23], s18 offen offset:2048 sc1
  buffer_load_dwordx4 v[112:115], v9, s[20:23], s18 offen offset:3072 sc1
  buffer_load_dwordx4 v[100:103], v9, s[20:23], s16 offen offset:1024 sc1
  buffer_load_dwordx4 v[104:107], v9, s[20:23], s17 offen offset:1024 sc1
  s_waitcnt vmcnt(28)
  v_mfma_f32_32x32x16_bf16 a[0:15], v[124:127], v[116:119], a[0:15]
  v_mfma_f32_32x32x16_bf16 a[16:31], v[128:131], v[116:119], a[16:31]
  v_mfma_f32_32x32x16_bf16 a[32:47], v[124:127], v[120:123], a[32:47]
  v_mfma_f32_32x32x16_bf16 a[48:63], v[128:131], v[120:123], a[48:63]
  s_add_u32 s18, s18, 4096
  buffer_load_dwordx4 v[124:127], v9, s[20:23], s18 offen offset:0 sc1
  buffer_load_dwordx4 v[128:131], v9, s[20:23], s18 offen offset:1024 sc1
  buffer_load_dwordx4 v[116:119], v9, s[20:23], s16 offen offset:2048 sc1
  buffer_load_dwordx4 v[120:123], v9, s[20:23], s17 offen offset:2048 sc1
  s_waitcnt vmcnt(28)
  v_mfma_f32_32x32x16_bf16 a[0:15], v[140:143], v[132:135], a[0:15]
  v_mfma_f32_32x32x16_bf16 a[16:31], v[144:147], v[132:135], a[16:31]
  v_mfma_f32_32x32x16_bf16 a[32:47], v[140:143], v[136:139], a[32:47]
  v_mfma_f32_32x32x16_bf16 a[48:63], v[144:147], v[136:139], a[48:63]
  buffer_load_dwordx4 v[140:143], v9, s[20:23], s18 offen offset:2048 sc1
  buffer_load_dwordx4 v[144:147], v9, s[20:23], s18 offen offset:3072 sc1
  buffer_load_dwordx4 v[132:135], v9, s[20:23], s16 offen offset:3072 sc1
  buffer_load_dwordx4 v[136:139], v9, s[20:23], s17 offen offset:3072 sc1
  s_waitcnt vmcnt(28)
  v_mfma_f32_32x32x16_bf16 a[0:15], v[28:31], v[20:23], a[0:15]
  v_mfma_f32_32x32x16_bf16 a[16:31], v[32:35], v[20:23], a[16:31]
  v_mfma_f32_32x32x16_bf16 a[32:47], v[28:31], v[24:27], a[32:47]
  v_mfma_f32_32x32x16_bf16 a[48:63], v[32:35], v[24:27], a[48:63]
  s_add_u32 s18, s18, 4096
  buffer_load_dwordx4 v[28:31], v9, s[20:23], s18 offen offset:0 sc1
  buffer_load_dwordx4 v[32:35], v9, s[20:23], s18 offen offset:1024 sc1
  s_add_u32 s16, s16, 4096
  s_add_u32 s17, s17, 4096
  buffer_load_dwordx4 v[20:23], v9, s[20:23], s16 offen offset:0 sc1
  buffer_load_dwordx4 v[24:27], v9, s[20:23], s17 offen offset:0 sc1
  s_waitcnt vmcnt(28)
  v_mfma_f32_32x32x16_bf16 a[0:15], v[44:47], v[36:39], a[0:15]
  v_mfma_f32_32x32x16_bf16 a[16:31], v[48:51], v[36:39], a[16:31]
  v_mfma_f32_32x32x16_bf16 a[32:47], v[44:47], v[40:43], a[32:47]
  v_mfma_f32_32x32x16_bf16 a[48:63], v[48:51], v[40:43], a[48:63]
  buffer_load_dwordx4 v[44:47], v9, s[20:23], s18 offen offset:2048 sc1
  buffer_load_dwordx4 v[48:51], v9, s[20:23], s18 offen offset:3072 sc1
  buffer_load_dwordx4 v[36:39], v9, s[20:23], s16 offen offset:1024 sc1
  buffer_load_dwordx4 v[40:43], v9, s[20:23], s17 offen offset:1024 sc1
  s_waitcnt vmcnt(28)
  v_mfma_f32_32x32x16_bf16 a[0:15], v[60:63], v[52:55], a[0:15]
  v_mfma_f32_32x32x16_bf16 a[16:31], v[64:67], v[52:55], a[16:31]
  v_mfma_f32_32x32x16_bf16 a[32:47], v[60:63], v[56:59], a[32:47]
  v_mfma_f32_32x32x16_bf16 a[48:63], v[64:67], v[56:59], a[48:63]
  s_add_u32 s18, s18, 4096
  buffer_load_dwordx4 v[60:63], v9, s[20:23], s18 offen offset:0 sc1
  buffer_load_dwordx4 v[64:67], v9, s[20:23], s18 offen offset:1024 sc1
  buffer_load_dwordx4 v[52:55], v9, s[20:23], s16 offen offset:2048 sc1
  buffer_load_dwordx4 v[56:59], v9, s[20:23], s17 offen offset:2048 sc1
  s_waitcnt vmcnt(28)
  v_mfma_f32_32x32x16_bf16 a[0:15], v[76:79], v[68:71], a[0:15]
  v_mfma_f32_32x32x16_bf16 a[16:31], v[80:83], v[68:71], a[16:31]
  v_mfma_f32_32x32x16_bf16 a[32:47], v[76:79], v[72:75], a[32:47]
  v_mfma_f32_32x32x16_bf16 a[48:63], v[80:83], v[72:75], a[48:63]
  buffer_load_dwordx4 v[76:79], v9, s[20:23], s18 offen offset:2048 sc1
  buffer_load_dwordx4 v[80:83], v9, s[20:23], s18 offen offset:3072 sc1
  buffer_load_dwordx4 v[68:71], v9, s[20:23], s16 offen offset:3072 sc1
  buffer_load_dwordx4 v[72:75], v9, s[20:23], s17 offen offset:3072 sc1
  buffer_load_dword v5, v3, s[20:23], s68 offen sc1
  s_waitcnt vmcnt(29)
  v_mfma_f32_32x32x16_bf16 a[0:15], v[92:95], v[84:87], a[0:15]
  v_mfma_f32_32x32x16_bf16 a[16:31], v[96:99], v[84:87], a[16:31]
  v_mfma_f32_32x32x16_bf16 a[32:47], v[92:95], v[88:91], a[32:47]
  v_mfma_f32_32x32x16_bf16 a[48:63], v[96:99], v[88:91], a[48:63]
  s_waitcnt vmcnt(25)
  v_mfma_f32_32x32x16_bf16 a[0:15], v[108:111], v[100:103], a[0:15]
  v_mfma_f32_32x32x16_bf16 a[16:31], v[112:115], v[100:103], a[16:31]
  v_mfma_f32_32x32x16_bf16 a[32:47], v[108:111], v[104:107], a[32:47]
  v_mfma_f32_32x32x16_bf16 a[48:63], v[112:115], v[104:107], a[48:63]
  s_waitcnt vmcnt(21)
  v_mfma_f32_32x32x16_bf16 a[0:15], v[124:127], v[116:119], a[0:15]
  v_mfma_f32_32x32x16_bf16 a[16:31], v[128:131], v[116:119], a[16:31]
  v_mfma_f32_32x32x16_bf16 a[32:47], v[124:127], v[120:123], a[32:47]
  v_mfma_f32_32x32x16_bf16 a[48:63], v[128:131], v[120:123], a[48:63]
  s_waitcnt vmcnt(17)
  v_mfma_f32_32x32x16_bf16 a[0:15], v[140:143], v[132:135], a[0:15]
  v_mfma_f32_32x32x16_bf16 a[16:31], v[144:147], v[132:135], a[16:31]
  v_mfma_f32_32x32x16_bf16 a[32:47], v[140:143], v[136:139], a[32:47]
  v_mfma_f32_32x32x16_bf16 a[48:63], v[144:147], v[136:139], a[48:63]
  s_waitcnt vmcnt(13)
  v_mfma_f32_32x32x16_bf16 a[0:15], v[28:31], v[20:23], a[0:15]
  v_mfma_f32_32x32x16_bf16 a[16:31], v[32:35], v[20:23], a[16:31]
  v_mfma_f32_32x32x16_bf16 a[32:47], v[28:31], v[24:27], a[32:47]
  v_mfma_f32_32x32x16_bf16 a[48:63], v[32:35], v[24:27], a[48:63]
  s_waitcnt vmcnt(9)
  v_mfma_f32_32x32x16_bf16 a[0:15], v[44:47], v[36:39], a[0:15]
  v_mfma_f32_32x32x16_bf16 a[16:31], v[48:51], v[36:39], a[16:31]
  v_mfma_f32_32x32x16_bf16 a[32:47], v[44:47], v[40:43], a[32:47]
  v_mfma_f32_32x32x16_bf16 a[48:63], v[48:51], v[40:43], a[48:63]
  s_waitcnt vmcnt(5)
  v_mfma_f32_32x32x16_bf16 a[0:15], v[60:63], v[52:55], a[0:15]
  v_mfma_f32_32x32x16_bf16 a[16:31], v[64:67], v[52:55], a[16:31]
  v_mfma_f32_32x32x16_bf16 a[32:47], v[60:63], v[56:59], a[32:47]
  v_mfma_f32_32x32x16_bf16 a[48:63], v[64:67], v[56:59], a[48:63]
  s_waitcnt vmcnt(1)
  v_mfma_f32_32x32x16_bf16 a[0:15], v[76:79], v[68:71], a[0:15]
  v_mfma_f32_32x32x16_bf16 a[16:31], v[80:83], v[68:71], a[16:31]
  v_mfma_f32_32x32x16_bf16 a[32:47], v[76:79], v[72:75], a[32:47]
  v_mfma_f32_32x32x16_bf16 a[48:63], v[80:83], v[72:75], a[48:63]
  s_branch L_attn_gend_98
L_attn_g15_103:
  buffer_load_dwordx4 v[28:31], v9, s[20:23], s18 offen offset:0 sc1
  buffer_load_dwordx4 v[32:35], v9, s[20:23], s18 offen offset:1024 sc1
  buffer_load_dwordx4 v[20:23], v9, s[20:23], s16 offen offset:0 sc1
  buffer_load_dwordx4 v[24:27], v9, s[20:23], s17 offen offset:0 sc1
  buffer_load_dwordx4 v[44:47], v9, s[20:23], s18 offen offset:2048 sc1
  buffer_load_dwordx4 v[48:51], v9, s[20:23], s18 offen offset:3072 sc1
  buffer_load_dwordx4 v[36:39], v9, s[20:23], s16 offen offset:1024 sc1
  buffer_load_dwordx4 v[40:43], v9, s[20:23], s17 offen offset:1024 sc1
  s_add_u32 s18, s18, 4096
  buffer_load_dwordx4 v[60:63], v9, s[20:23], s18 offen offset:0 sc1
  buffer_load_dwordx4 v[64:67], v9, s[20:23], s18 offen offset:1024 sc1
  buffer_load_dwordx4 v[52:55], v9, s[20:23], s16 offen offset:2048 sc1
  buffer_load_dwordx4 v[56:59], v9, s[20:23], s17 offen offset:2048 sc1
  buffer_load_dwordx4 v[76:79], v9, s[20:23], s18 offen offset:2048 sc1
  buffer_load_dwordx4 v[80:83], v9, s[20:23], s18 offen offset:3072 sc1
  buffer_load_dwordx4 v[68:71], v9, s[20:23], s16 offen offset:3072 sc1
  buffer_load_dwordx4 v[72:75], v9, s[20:23], s17 offen offset:3072 sc1
  s_add_u32 s18, s18, 4096
  buffer_load_dwordx4 v[92:95], v9, s[20:23], s18 offen offset:0 sc1
  buffer_load_dwordx4 v[96:99], v9, s[20:23], s18 offen offset:1024 sc1
  s_add_u32 s16, s16, 4096
  s_add_u32 s17, s17, 4096
  buffer_load_dwordx4 v[84:87], v9, s[20:23], s16 offen offset:0 sc1
  buffer_load_dwordx4 v[88:91], v9, s[20:23], s17 offen offset:0 sc1
  buffer_load_dwordx4 v[108:111], v9, s[20:23], s18 offen offset:2048 sc1
  buffer_load_dwordx4 v[112:115], v9, s[20:23], s18 offen offset:3072 sc1
  buffer_load_dwordx4 v[100:103], v9, s[20:23], s16 offen offset:1024 sc1
  buffer_load_dwordx4 v[104:107], v9, s[20:23], s17 offen offset:1024 sc1
  s_add_u32 s18, s18, 4096
  buffer_load_dwordx4 v[124:127], v9, s[20:23], s18 offen offset:0 sc1
  buffer_load_dwordx4 v[128:131], v9, s[20:23], s18 offen offset:1024 sc1
  buffer_load_dwordx4 v[116:119], v9, s[20:23], s16 offen offset:2048 sc1
  buffer_load_dwordx4 v[120:123], v9, s[20:23], s17 offen offset:2048 sc1
  buffer_load_dwordx4 v[140:143], v9, s[20:23], s18 offen offset:2048 sc1
  buffer_load_dwordx4 v[144:147], v9, s[20:23], s18 offen offset:3072 sc1
  buffer_load_dwordx4 v[132:135], v9, s[20:23], s16 offen offset:3072 sc1
  buffer_load_dwordx4 v[136:139], v9, s[20:23], s17 offen offset:3072 sc1
  s_waitcnt vmcnt(28)
  v_mfma_f32_32x32x16_bf16 a[0:15], v[28:31], v[20:23], 0
  v_mfma_f32_32x32x16_bf16 a[16:31], v[32:35], v[20:23], 0
  v_mfma_f32_32x32x16_bf16 a[32:47], v[28:31], v[24:27], 0
  v_mfma_f32_32x32x16_bf16 a[48:63], v[32:35], v[24:27], 0
  s_add_u32 s18, s18, 4096
  buffer_load_dwordx4 v[28:31], v9, s[20:23], s18 offen offset:0 sc1
  buffer_load_dwordx4 v[32:35], v9, s[20:23], s18 offen offset:1024 sc1
  s_add_u32 s16, s16, 4096
  s_add_u32 s17, s17, 4096
  buffer_load_dwordx4 v[20:23], v9, s[20:23], s16 offen offset:0 sc1
  buffer_load_dwordx4 v[24:27], v9, s[20:23], s17 offen offset:0 sc1
  s_waitcnt vmcnt(28)
  v_mfma_f32_32x32x16_bf16 a[0:15], v[44:47], v[36:39], a[0:15]
  v_mfma_f32_32x32x16_bf16 a[16:31], v[48:51], v[36:39], a[16:31]
  v_mfma_f32_32x32x16_bf16 a[32:47], v[44:47], v[40:43], a[32:47]
  v_mfma_f32_32x32x16_bf16 a[48:63], v[48:51], v[40:43], a[48:63]
  buffer_load_dwordx4 v[44:47], v9, s[20:23], s18 offen offset:2048 sc1
  buffer_load_dwordx4 v[48:51], v9, s[20:23], s18 offen offset:3072 sc1
  buffer_load_dwordx4 v[36:39], v9, s[20:23], s16 offen offset:1024 sc1
  buffer_load_dwordx4 v[40:43], v9, s[20:23], s17 offen offset:1024 sc1
  s_waitcnt vmcnt(28)
  v_mfma_f32_32x32x16_bf16 a[0:15], v[60:63], v[52:55], a[0:15]
  v_mfma_f32_32x32x16_bf16 a[16:31], v[64:67], v[52:55], a[16:31]
  v_mfma_f32_32x32x16_bf16 a[32:47], v[60:63], v[56:59], a[32:47]
  v_mfma_f32_32x32x16_bf16 a[48:63], v[64:67], v[56:59], a[48:63]
  s_add_u32 s18, s18, 4096
  buffer_load_dwordx4 v[60:63], v9, s[20:23], s18 offen offset:0 sc1
  buffer_load_dwordx4 v[64:67], v9, s[20:23], s18 offen offset:1024 sc1
  buffer_load_dwordx4 v[52:55], v9, s[20:23], s16 offen offset:2048 sc1
  buffer_load_dwordx4 v[56:59], v9, s[20:23], s17 offen offset:2048 sc1
  s_waitcnt vmcnt(28)
  v_mfma_f32_32x32x16_bf16 a[0:15], v[76:79], v[68:71], a[0:15]
  v_mfma_f32_32x32x16_bf16 a[16:31], v[80:83], v[68:71], a[16:31]
  v_mfma_f32_32x32x16_bf16 a[32:47], v[76:79], v[72:75], a[32:47]
  v_mfma_f32_32x32x16_bf16 a[48:63], v[80:83], v[72:75], a[48:63]
  buffer_load_dwordx4 v[76:79], v9, s[20:23], s18 offen offset:2048 sc1
  buffer_load_dwordx4 v[80:83], v9, s[20:23], s18 offen offset:3072 sc1
  buffer_load_dwordx4 v[68:71], v9, s[20:23], s16 offen offset:3072 sc1
  buffer_load_dwordx4 v[72:75], v9, s[20:23], s17 offen offset:3072 sc1
  s_waitcnt vmcnt(28)
  v_mfma_f32_32x32x16_bf16 a[0:15], v[92:95], v[84:87], a[0:15]
  v_mfma_f32_32x32x16_bf16 a[16:31], v[96:99], v[84:87], a[16:31]
  v_mfma_f32_32x32x16_bf16 a[32:47], v[92:95], v[88:91], a[32:47]
  v_mfma_f32_32x32x16_bf16 a[48:63], v[96:99], v[88:91], a[48:63]
  s_add_u32 s18, s18, 4096
  buffer_load_dwordx4 v[92:95], v9, s[20:23], s18 offen offset:0 sc1
  buffer_load_dwordx4 v[96:99], v9, s[20:23], s18 offen offset:1024 sc1
  s_add_u32 s16, s16, 4096
  s_add_u32 s17, s17, 4096
  buffer_load_dwordx4 v[84:87], v9, s[20:23], s16 offen offset:0 sc1
  buffer_load_dwordx4 v[88:91], v9, s[20:23], s17 offen offset:0 sc1
  s_waitcnt vmcnt(28)
  v_mfma_f32_32x32x16_bf16 a[0:15], v[108:111], v[100:103], a[0:15]
  v_mfma_f32_32x32x16_bf16 a[16:31], v[112:115], v[100:103], a[16:31]
  v_mfma_f32_32x32x16_bf16 a[32:47], v[108:111], v[104:107], a[32:47]
  v_mfma_f32_32x32x16_bf16 a[48:63], v[112:115], v[104:107], a[48:63]
  buffer_load_dwordx4 v[108:111], v9, s[20:23], s18 offen offset:2048 sc1
  buffer_load_dwordx4 v[112:115], v9, s[20:23], s18 offen offset:3072 sc1
  buffer_load_dwordx4 v[100:103], v9, s[20:23], s16 offen offset:1024 sc1
  buffer_load_dwordx4 v[104:107], v9, s[20:23], s17 offen offset:1024 sc1
  s_waitcnt vmcnt(28)
  v_mfma_f32_32x32x16_bf16 a[0:15], v[124:127], v[116:119], a[0:15]
  v_mfma_f32_32x32x16_bf16 a[16:31], v[128:131], v[116:119], a[16:31]
  v_mfma_f32_32x32x16_bf16 a[32:47], v[124:127], v[120:123], a[32:47]
  v_mfma_f32_32x32x16_bf16 a[48:63], v[128:131], v[120:123], a[48:63]
  s_add_u32 s18, s18, 4096
  buffer_load_dwordx4 v[124:127], v9, s[20:23], s18 offen offset:0 sc1
  buffer_load_dwordx4 v[128:131], v9, s[20:23], s18 offen offset:1024 sc1
  buffer_load_dwordx4 v[116:119], v9, s[20:23], s16 offen offset:2048 sc1
  buffer_load_dwordx4 v[120:123], v9, s[20:23], s17 offen offset:2048 sc1
  buffer_load_dword v5, v3, s[20:23], s68 offen sc1
  s_waitcnt vmcnt(29)
  v_mfma_f32_32x32x16_bf16 a[0:15], v[140:143], v[132:135], a[0:15]
  v_mfma_f32_32x32x16_bf16 a[16:31], v[144:147], v[132:135], a[16:31]
  v_mfma_f32_32x32x16_bf16 a[32:47], v[140:143], v[136:139], a[32:47]
  v_mfma_f32_32x32x16_bf16 a[48:63], v[144:147], v[136:139], a[48:63]
  s_waitcnt vmcnt(25)
  v_mfma_f32_32x32x16_bf16 a[0:15], v[28:31], v[20:23], a[0:15]
  v_mfma_f32_32x32x16_bf16 a[16:31], v[32:35], v[20:23], a[16:31]
  v_mfma_f32_32x32x16_bf16 a[32:47], v[28:31], v[24:27], a[32:47]
  v_mfma_f32_32x32x16_bf16 a[48:63], v[32:35], v[24:27], a[48:63]
  s_waitcnt vmcnt(21)
  v_mfma_f32_32x32x16_bf16 a[0:15], v[44:47], v[36:39], a[0:15]
  v_mfma_f32_32x32x16_bf16 a[16:31], v[48:51], v[36:39], a[16:31]
  v_mfma_f32_32x32x16_bf16 a[32:47], v[44:47], v[40:43], a[32:47]
  v_mfma_f32_32x32x16_bf16 a[48:63], v[48:51], v[40:43], a[48:63]
  s_waitcnt vmcnt(17)
  v_mfma_f32_32x32x16_bf16 a[0:15], v[60:63], v[52:55], a[0:15]
  v_mfma_f32_32x32x16_bf16 a[16:31], v[64:67], v[52:55], a[16:31]
  v_mfma_f32_32x32x16_bf16 a[32:47], v[60:63], v[56:59], a[32:47]
  v_mfma_f32_32x32x16_bf16 a[48:63], v[64:67], v[56:59], a[48:63]
  s_waitcnt vmcnt(13)
  v_mfma_f32_32x32x16_bf16 a[0:15], v[76:79], v[68:71], a[0:15]
  v_mfma_f32_32x32x16_bf16 a[16:31], v[80:83], v[68:71], a[16:31]
  v_mfma_f32_32x32x16_bf16 a[32:47], v[76:79], v[72:75], a[32:47]
  v_mfma_f32_32x32x16_bf16 a[48:63], v[80:83], v[72:75], a[48:63]
  s_waitcnt vmcnt(9)
  v_mfma_f32_32x32x16_bf16 a[0:15], v[92:95], v[84:87], a[0:15]
  v_mfma_f32_32x32x16_bf16 a[16:31], v[96:99], v[84:87], a[16:31]
  v_mfma_f32_32x32x16_bf16 a[32:47], v[92:95], v[88:91], a[32:47]
  v_mfma_f32_32x32x16_bf16 a[48:63], v[96:99], v[88:91], a[48:63]
  s_waitcnt vmcnt(5)
  v_mfma_f32_32x32x16_bf16 a[0:15], v[108:111], v[100:103], a[0:15]
  v_mfma_f32_32x32x16_bf16 a[16:31], v[112:115], v[100:103], a[16:31]
  v_mfma_f32_32x32x16_bf16 a[32:47], v[108:111], v[104:107], a[32:47]
  v_mfma_f32_32x32x16_bf16 a[48:63], v[112:115], v[104:107], a[48:63]
  s_waitcnt vmcnt(1)
  v_mfma_f32_32x32x16_bf16 a[0:15], v[124:127], v[116:119], a[0:15]
  v_mfma_f32_32x32x16_bf16 a[16:31], v[128:131], v[116:119], a[16:31]
  v_mfma_f32_32x32x16_bf16 a[32:47], v[124:127], v[120:123], a[32:47]
  v_mfma_f32_32x32x16_bf16 a[48:63], v[128:131], v[120:123], a[48:63]
L_attn_gend_98:
  ds_read_b32 v15, v13 offset:4
  s_waitcnt lgkmcnt(0)
  v_cmp_ne_u32 vcc, 1, v15
  s_cbranch_vccz L_attn_q2g_106
  s_mov_b32 s32, 0x40000
  s_mov_b32 s28, 0x3001800
  v_lshlrev_b32 v14, 8, v1
  s_mov_b64 exec, 255
L_attn_q2p_104:
  buffer_load_dword v15, v14, s[20:23], s28 offen sc1
  s_waitcnt vmcnt(0)
  v_cmp_ne_u32 vcc, 48, v15
  s_cbranch_vccz L_attn_q2pr_105
  s_sleep 8
  s_sub_u32 s32, s32, 1
  s_cbranch_scc0 L_attn_q2p_104
L_attn_q2pr_105:
  s_mov_b64 exec, -1
  ds_write_b32 v13, v2 offset:4
L_attn_q2g_106:
  s_add_u32 s28, s67, 59392
  s_add_u32 m0, s33, 0
  s_nop 0
  buffer_load_dwordx4 v9, s[20:23], s28 offen offset:0 sc1 lds
  buffer_load_dwordx4 v9, s[20:23], s28 offen offset:1024 sc1 lds
  buffer_load_dwordx4 v9, s[20:23], s28 offen offset:2048 sc1 lds
  buffer_load_dwordx4 v9, s[20:23], s28 offen offset:3072 sc1 lds
  s_add_u32 m0, s33, 4096
  s_add_u32 s28, s28, 4096
  buffer_load_dwordx4 v9, s[20:23], s28 offen offset:0 sc1 lds
  buffer_load_dwordx4 v9, s[20:23], s28 offen offset:1024 sc1 lds
  s_branch L_attn_tshort_107
L_attn_tlong_97:
  ds_read_b32 v15, v13 offset:4
  s_waitcnt lgkmcnt(0)
  v_cmp_ne_u32 vcc, 1, v15
  s_cbranch_vccz L_attn_q2g_110
  s_mov_b32 s32, 0x40000
  s_mov_b32 s28, 0x3001800
  v_lshlrev_b32 v14, 8, v1
  s_mov_b64 exec, 255
L_attn_q2p_108:
  buffer_load_dword v15, v14, s[20:23], s28 offen sc1
  s_waitcnt vmcnt(0)
  v_cmp_ne_u32 vcc, 48, v15
  s_cbranch_vccz L_attn_q2pr_109
  s_sleep 8
  s_sub_u32 s32, s32, 1
  s_cbranch_scc0 L_attn_q2p_108
L_attn_q2pr_109:
  s_mov_b64 exec, -1
  ds_write_b32 v13, v2 offset:4
L_attn_q2g_110:
L_attn_tshort_107:
  s_mov_b32 s16, s66
  s_add_u32 s17, s66, 262144
  s_mov_b32 s18, s67
  buffer_load_dwordx4 v[28:31], v9, s[20:23], s18 offen offset:0 sc1
  buffer_load_dwordx4 v[32:35], v9, s[20:23], s18 offen offset:1024 sc1
  buffer_load_dwordx4 v[44:47], v9, s[20:23], s18 offen offset:2048 sc1
  buffer_load_dwordx4 v[48:51], v9, s[20:23], s18 offen offset:3072 sc1
  s_add_u32 s18, s18, 4096
  buffer_load_dwordx4 v[60:63], v9, s[20:23], s18 offen offset:0 sc1
  buffer_load_dwordx4 v[64:67], v9, s[20:23], s18 offen offset:1024 sc1
  buffer_load_dwordx4 v[76:79], v9, s[20:23], s18 offen offset:2048 sc1
  buffer_load_dwordx4 v[80:83], v9, s[20:23], s18 offen offset:3072 sc1
  s_add_u32 s18, s18, 4096
  buffer_load_dwordx4 v[92:95], v9, s[20:23], s18 offen offset:0 sc1
  buffer_load_dwordx4 v[96:99], v9, s[20:23], s18 offen offset:1024 sc1
  buffer_load_dwordx4 v[108:111], v9, s[20:23], s18 offen offset:2048 sc1
  buffer_load_dwordx4 v[112:115], v9, s[20:23], s18 offen offset:3072 sc1
  s_add_u32 s18, s18, 4096
  buffer_load_dwordx4 v[124:127], v9, s[20:23], s18 offen offset:0 sc1
  buffer_load_dwordx4 v[128:131], v9, s[20:23], s18 offen offset:1024 sc1
  buffer_load_dwordx4 v[140:143], v9, s[20:23], s18 offen offset:2048 sc1
  buffer_load_dwordx4 v[144:147], v9, s[20:23], s18 offen offset:3072 sc1
  s_waitcnt vmcnt(16)
  v_readfirstlane_b32 s31, v5
  s_cmp_lt_u32 s31, 16
  s_cbranch_scc1 L_attn_late_111
  buffer_load_dwordx4 v[20:23], v9, s[20:23], s16 offen offset:0 sc1
  buffer_load_dwordx4 v[24:27], v9, s[20:23], s17 offen offset:0 sc1
  buffer_load_dwordx4 v[36:39], v9, s[20:23], s16 offen offset:1024 sc1
  buffer_load_dwordx4 v[40:43], v9, s[20:23], s17 offen offset:1024 sc1
  buffer_load_dwordx4 v[52:55], v9, s[20:23], s16 offen offset:2048 sc1
  buffer_load_dwordx4 v[56:59], v9, s[20:23], s17 offen offset:2048 sc1
  buffer_load_dwordx4 v[68:71], v9, s[20:23], s16 offen offset:3072 sc1
  buffer_load_dwordx4 v[72:75], v9, s[20:23], s17 offen offset:3072 sc1
  s_add_u32 s16, s16, 4096
  s_add_u32 s17, s17, 4096
  buffer_load_dwordx4 v[84:87], v9, s[20:23], s16 offen offset:0 sc1
  buffer_load_dwordx4 v[88:91], v9, s[20:23], s17 offen offset:0 sc1
  buffer_load_dwordx4 v[100:103], v9, s[20:23], s16 offen offset:1024 sc1
  buffer_load_dwordx4 v[104:107], v9, s[20:23], s17 offen offset:1024 sc1
  buffer_load_dwordx4 v[116:119], v9, s[20:23], s16 offen offset:2048 sc1
  buffer_load_dwordx4 v[120:123], v9, s[20:23], s17 offen offset:2048 sc1
  buffer_load_dwordx4 v[132:135], v9, s[20:23], s16 offen offset:3072 sc1
  buffer_load_dwordx4 v[136:139], v9, s[20:23], s17 offen offset:3072 sc1
L_attn_late_111:
  s_barrier
  s_cmp_lg_u32 s26, 0
  s_cbranch_scc1 L_attn_gw_112
  s_add_u32 s28, s67, 59392
  s_add_u32 m0, s33, 0
  s_nop 0
  buffer_load_dwordx4 v9, s[20:23], s28 offen offset:0 sc1 lds
  buffer_load_dwordx4 v9, s[20:23], s28 offen offset:1024 sc1 lds
  buffer_load_dwordx4 v9, s[20:23], s28 offen offset:2048 sc1 lds
  buffer_load_dwordx4 v9, s[20:23], s28 offen offset:3072 sc1 lds
  s_add_u32 m0, s33, 4096
  s_add_u32 s28, s28, 4096
  buffer_load_dwordx4 v9, s[20:23], s28 offen offset:0 sc1 lds
  buffer_load_dwordx4 v9, s[20:23], s28 offen offset:1024 sc1 lds
  s_branch L_attn_gwe_113
L_attn_gw_112:
  ds_write_b128 v4, a[0:3] offset:0
  ds_write_b128 v4, a[4:7] offset:1024
  ds_write_b128 v4, a[8:11] offset:2048
  ds_write_b128 v4, a[12:15] offset:3072
  ds_write_b128 v4, a[16:19] offset:4096
  ds_write_b128 v4, a[20:23] offset:5120
  ds_write_b128 v4, a[24:27] offset:6144
  ds_write_b128 v4, a[28:31] offset:7168
  ds_write_b128 v4, a[32:35] offset:8192
  ds_write_b128 v4, a[36:39] offset:9216
  ds_write_b128 v4, a[40:43] offset:10240
  ds_write_b128 v4, a[44:47] offset:11264
  ds_write_b128 v4, a[48:51] offset:12288
  ds_write_b128 v4, a[52:55] offset:13312
  ds_write_b128 v4, a[56:59] offset:14336
  ds_write_b128 v4, a[60:63] offset:15360
L_attn_gwe_113:
  s_waitcnt lgkmcnt(0)
  s_barrier
  ds_read_b128 v[148:151], v12 offset:32768
  ds_read_b128 v[152:155], v12 offset:33792
  ds_read_b128 v[156:159], v12 offset:49152
  ds_read_b128 v[160:163], v12 offset:50176
  ds_read_b128 v[164:167], v6 offset:0
  ds_read_b128 v[168:171], v6 offset:1024
  ds_read_b128 v[172:175], v6 offset:16384
  ds_read_b128 v[176:179], v6 offset:17408
  s_waitcnt lgkmcnt(0)
  s_barrier
  v_add_f32 v180, v148, v156
  v_add_f32 v181, v149, v157
  v_add_f32 v182, v150, v158
  v_add_f32 v183, v151, v159
  v_add_f32 v184, v152, v160
  v_add_f32 v185, v153, v161
  v_add_f32 v186, v154, v162
  v_add_f32 v187, v155, v163
  v_add_f32 v180, v180, v164
  v_add_f32 v181, v181, v165
  v_add_f32 v182, v182, v166
  v_add_f32 v183, v183, v167
  v_add_f32 v184, v184, v168
  v_add_f32 v185, v185, v169
  v_add_f32 v186, v186, v170
  v_add_f32 v187, v187, v171
  v_add_f32 v180, v180, v172
  v_add_f32 v181, v181, v173
  v_add_f32 v182, v182, v174
  v_add_f32 v183, v183, v175
  v_add_f32 v184, v184, v176
  v_add_f32 v185, v185, v177
  v_add_f32 v186, v186, v178
  v_add_f32 v187, v187, v179
  v_cvt_pk_bf16_f32 v180, v180, v180
  v_and_b32 v180, 0xffff0000, v180
  v_cvt_pk_bf16_f32 v181, v181, v181
  v_and_b32 v181, 0xffff0000, v181
  v_cvt_pk_bf16_f32 v182, v182, v182
  v_and_b32 v182, 0xffff0000, v182
  v_cvt_pk_bf16_f32 v183, v183, v183
  v_and_b32 v183, 0xffff0000, v183
  v_cvt_pk_bf16_f32 v184, v184, v184
  v_and_b32 v184, 0xffff0000, v184
  v_cvt_pk_bf16_f32 v185, v185, v185
  v_and_b32 v185, 0xffff0000, v185
  v_cvt_pk_bf16_f32 v186, v186, v186
  v_and_b32 v186, 0xffff0000, v186
  v_cvt_pk_bf16_f32 v187, v187, v187
  v_and_b32 v187, 0xffff0000, v187
  v_mul_f32 v148, s30, v180
  v_mul_f32 v149, s30, v181
  v_mul_f32 v150, s30, v182
  v_mul_f32 v151, s30, v183
  v_mul_f32 v152, s30, v184
  v_mul_f32 v153, s30, v185
  v_mul_f32 v154, s30, v186
  v_mul_f32 v155, s30, v187
  v_exp_f32 v148, v148
  v_exp_f32 v149, v149
  v_exp_f32 v150, v150
  v_exp_f32 v151, v151
  v_exp_f32 v152, v152
  v_exp_f32 v153, v153
  v_exp_f32 v154, v154
  v_exp_f32 v155, v155
  s_nop 0
  v_add_f32 v148, 1.0, v148
  v_add_f32 v149, 1.0, v149
  v_add_f32 v150, 1.0, v150
  v_add_f32 v151, 1.0, v151
  v_add_f32 v152, 1.0, v152
  v_add_f32 v153, 1.0, v153
  v_add_f32 v154, 1.0, v154
  v_add_f32 v155, 1.0, v155
  v_rcp_f32 v148, v148
  v_rcp_f32 v149, v149
  v_rcp_f32 v150, v150
  v_rcp_f32 v151, v151
  v_rcp_f32 v152, v152
  v_rcp_f32 v153, v153
  v_rcp_f32 v154, v154
  v_rcp_f32 v155, v155
  s_nop 0
  v_mul_f32 v180, v180, v148
  v_mul_f32 v181, v181, v149
  v_mul_f32 v182, v182, v150
  v_mul_f32 v183, v183, v151
  v_mul_f32 v184, v184, v152
  v_mul_f32 v185, v185, v153
  v_mul_f32 v186, v186, v154
  v_mul_f32 v187, v187, v155
  v_cvt_pk_bf16_f32 v180, v180, v180
  v_and_b32 v180, 0xffff0000, v180
  v_cvt_pk_bf16_f32 v181, v181, v181
  v_and_b32 v181, 0xffff0000, v181
  v_cvt_pk_bf16_f32 v182, v182, v182
  v_and_b32 v182, 0xffff0000, v182
  v_cvt_pk_bf16_f32 v183, v183, v183
  v_and_b32 v183, 0xffff0000, v183
  v_cvt_pk_bf16_f32 v184, v184, v184
  v_and_b32 v184, 0xffff0000, v184
  v_cvt_pk_bf16_f32 v185, v185, v185
  v_and_b32 v185, 0xffff0000, v185
  v_cvt_pk_bf16_f32 v186, v186, v186
  v_and_b32 v186, 0xffff0000, v186
  v_cvt_pk_bf16_f32 v187, v187, v187
  v_and_b32 v187, 0xffff0000, v187
  s_cmp_ge_u32 s31, 16
  s_cbranch_scc1 L_attn_go_114
  s_mov_b32 s32, 0x40000
L_attn_csp_115:
  buffer_load_dword v5, v3, s[20:23], s68 offen sc1
  s_waitcnt vmcnt(0)
  v_readfirstlane_b32 s31, v5
  s_cmp_ge_u32 s31, 16
  s_cbranch_scc1 L_attn_cok_116
  s_sleep 2
  s_sub_u32 s32, s32, 1
  s_cbranch_scc0 L_attn_csp_115
L_attn_cok_116:
  buffer_load_dwordx4 v[20:23], v9, s[20:23], s16 offen offset:0 sc1
  buffer_load_dwordx4 v[24:27], v9, s[20:23], s17 offen offset:0 sc1
  buffer_load_dwordx4 v[36:39], v9, s[20:23], s16 offen offset:1024 sc1
  buffer_load_dwordx4 v[40:43], v9, s[20:23], s17 offen offset:1024 sc1
  buffer_load_dwordx4 v[52:55], v9, s[20:23], s16 offen offset:2048 sc1
  buffer_load_dwordx4 v[56:59], v9, s[20:23], s17 offen offset:2048 sc1
  buffer_load_dwordx4 v[68:71], v9, s[20:23], s16 offen offset:3072 sc1
  buffer_load_dwordx4 v[72:75], v9, s[20:23], s17 offen offset:3072 sc1
  s_add_u32 s16, s16, 4096
  s_add_u32 s17, s17, 4096
  buffer_load_dwordx4 v[84:87], v9, s[20:23], s16 offen offset:0 sc1
  buffer_load_dwordx4 v[88:91], v9, s[20:23], s17 offen offset:0 sc1
  buffer_load_dwordx4 v[100:103], v9, s[20:23], s16 offen offset:1024 sc1
  buffer_load_dwordx4 v[104:107], v9, s[20:23], s17 offen offset:1024 sc1
  buffer_load_dwordx4 v[116:119], v9, s[20:23], s16 offen offset:2048 sc1
  buffer_load_dwordx4 v[120:123], v9, s[20:23], s17 offen offset:2048 sc1
  buffer_load_dwordx4 v[132:135], v9, s[20:23], s16 offen offset:3072 sc1
  buffer_load_dwordx4 v[136:139], v9, s[20:23], s17 offen offset:3072 sc1
L_attn_go_114:
  s_waitcnt vmcnt(14)
  v_mfma_f32_32x32x16_bf16 a[0:15], v[28:31], v[20:23], 0
  v_mfma_f32_32x32x16_bf16 a[16:31], v[32:35], v[20:23], 0
  v_mfma_f32_32x32x16_bf16 a[32:47], v[28:31], v[24:27], 0
  v_mfma_f32_32x32x16_bf16 a[48:63], v[32:35], v[24:27], 0
  s_add_u32 s18, s18, 4096
  buffer_load_dwordx4 v[28:31], v9, s[20:23], s18 offen offset:0 sc1
  buffer_load_dwordx4 v[32:35], v9, s[20:23], s18 offen offset:1024 sc1
  s_add_u32 s16, s16, 4096
  s_add_u32 s17, s17, 4096
  buffer_load_dwordx4 v[20:23], v9, s[20:23], s16 offen offset:0 sc1
  buffer_load_dwordx4 v[24:27], v9, s[20:23], s17 offen offset:0 sc1
  s_waitcnt vmcnt(16)
  v_mfma_f32_32x32x16_bf16 a[0:15], v[44:47], v[36:39], a[0:15]
  v_mfma_f32_32x32x16_bf16 a[16:31], v[48:51], v[36:39], a[16:31]
  v_mfma_f32_32x32x16_bf16 a[32:47], v[44:47], v[40:43], a[32:47]
  v_mfma_f32_32x32x16_bf16 a[48:63], v[48:51], v[40:43], a[48:63]
  buffer_load_dwordx4 v[44:47], v9, s[20:23], s18 offen offset:2048 sc1
  buffer_load_dwordx4 v[48:51], v9, s[20:23], s18 offen offset:3072 sc1
  buffer_load_dwordx4 v[36:39], v9, s[20:23], s16 offen offset:1024 sc1
  buffer_load_dwordx4 v[40:43], v9, s[20:23], s17 offen offset:1024 sc1
  s_waitcnt vmcnt(18)
  v_mfma_f32_32x32x16_bf16 a[0:15], v[60:63], v[52:55], a[0:15]
  v_mfma_f32_32x32x16_bf16 a[16:31], v[64:67], v[52:55], a[16:31]
  v_mfma_f32_32x32x16_bf16 a[32:47], v[60:63], v[56:59], a[32:47]
  v_mfma_f32_32x32x16_bf16 a[48:63], v[64:67], v[56:59], a[48:63]
  s_add_u32 s18, s18, 4096
  buffer_load_dwordx4 v[60:63], v9, s[20:23], s18 offen offset:0 sc1
  buffer_load_dwordx4 v[64:67], v9, s[20:23], s18 offen offset:1024 sc1
  buffer_load_dwordx4 v[52:55], v9, s[20:23], s16 offen offset:2048 sc1
  buffer_load_dwordx4 v[56:59], v9, s[20:23], s17 offen offset:2048 sc1
  s_waitcnt vmcnt(20)
  v_mfma_f32_32x32x16_bf16 a[0:15], v[76:79], v[68:71], a[0:15]
  v_mfma_f32_32x32x16_bf16 a[16:31], v[80:83], v[68:71], a[16:31]
  v_mfma_f32_32x32x16_bf16 a[32:47], v[76:79], v[72:75], a[32:47]
  v_mfma_f32_32x32x16_bf16 a[48:63], v[80:83], v[72:75], a[48:63]
  buffer_load_dwordx4 v[76:79], v9, s[20:23], s18 offen offset:2048 sc1
  buffer_load_dwordx4 v[80:83], v9, s[20:23], s18 offen offset:3072 sc1
  buffer_load_dwordx4 v[68:71], v9, s[20:23], s16 offen offset:3072 sc1
  buffer_load_dwordx4 v[72:75], v9, s[20:23], s17 offen offset:3072 sc1
  s_waitcnt vmcnt(22)
  v_mfma_f32_32x32x16_bf16 a[0:15], v[92:95], v[84:87], a[0:15]
  v_mfma_f32_32x32x16_bf16 a[16:31], v[96:99], v[84:87], a[16:31]
  v_mfma_f32_32x32x16_bf16 a[32:47], v[92:95], v[88:91], a[32:47]
  v_mfma_f32_32x32x16_bf16 a[48:63], v[96:99], v[88:91], a[48:63]
  s_add_u32 s18, s18, 4096
  buffer_load_dwordx4 v[92:95], v9, s[20:23], s18 offen offset:0 sc1
  buffer_load_dwordx4 v[96:99], v9, s[20:23], s18 offen offset:1024 sc1
  s_add_u32 s16, s16, 4096
  s_add_u32 s17, s17, 4096
  buffer_load_dwordx4 v[84:87], v9, s[20:23], s16 offen offset:0 sc1
  buffer_load_dwordx4 v[88:91], v9, s[20:23], s17 offen offset:0 sc1
  s_waitcnt vmcnt(24)
  v_mfma_f32_32x32x16_bf16 a[0:15], v[108:111], v[100:103], a[0:15]
  v_mfma_f32_32x32x16_bf16 a[16:31], v[112:115], v[100:103], a[16:31]
  v_mfma_f32_32x32x16_bf16 a[32:47], v[108:111], v[104:107], a[32:47]
  v_mfma_f32_32x32x16_bf16 a[48:63], v[112:115], v[104:107], a[48:63]
  buffer_load_dwordx4 v[108:111], v9, s[20:23], s18 offen offset:2048 sc1
  buffer_load_dwordx4 v[112:115], v9, s[20:23], s18 offen offset:3072 sc1
  buffer_load_dwordx4 v[100:103], v9, s[20:23], s16 offen offset:1024 sc1
  buffer_load_dwordx4 v[104:107], v9, s[20:23], s17 offen offset:1024 sc1
  s_waitcnt vmcnt(26)
  v_mfma_f32_32x32x16_bf16 a[0:15], v[124:127], v[116:119], a[0:15]
  v_mfma_f32_32x32x16_bf16 a[16:31], v[128:131], v[116:119], a[16:31]
  v_mfma_f32_32x32x16_bf16 a[32:47], v[124:127], v[120:123], a[32:47]
  v_mfma_f32_32x32x16_bf16 a[48:63], v[128:131], v[120:123], a[48:63]
  s_add_u32 s18, s18, 4096
  buffer_load_dwordx4 v[124:127], v9, s[20:23], s18 offen offset:0 sc1
  buffer_load_dwordx4 v[128:131], v9, s[20:23], s18 offen offset:1024 sc1
  buffer_load_dwordx4 v[116:119], v9, s[20:23], s16 offen offset:2048 sc1
  buffer_load_dwordx4 v[120:123], v9, s[20:23], s17 offen offset:2048 sc1
  s_waitcnt vmcnt(28)
  v_mfma_f32_32x32x16_bf16 a[0:15], v[140:143], v[132:135], a[0:15]
  v_mfma_f32_32x32x16_bf16 a[16:31], v[144:147], v[132:135], a[16:31]
  v_mfma_f32_32x32x16_bf16 a[32:47], v[140:143], v[136:139], a[32:47]
  v_mfma_f32_32x32x16_bf16 a[48:63], v[144:147], v[136:139], a[48:63]
  buffer_load_dwordx4 v[140:143], v9, s[20:23], s18 offen offset:2048 sc1
  buffer_load_dwordx4 v[144:147], v9, s[20:23], s18 offen offset:3072 sc1
  buffer_load_dwordx4 v[132:135], v9, s[20:23], s16 offen offset:3072 sc1
  buffer_load_dwordx4 v[136:139], v9, s[20:23], s17 offen offset:3072 sc1
  s_waitcnt vmcnt(28)
  v_mfma_f32_32x32x16_bf16 a[0:15], v[28:31], v[20:23], a[0:15]
  v_mfma_f32_32x32x16_bf16 a[16:31], v[32:35], v[20:23], a[16:31]
  v_mfma_f32_32x32x16_bf16 a[32:47], v[28:31], v[24:27], a[32:47]
  v_mfma_f32_32x32x16_bf16 a[48:63], v[32:35], v[24:27], a[48:63]
  s_add_u32 s18, s18, 4096
  buffer_load_dwordx4 v[28:31], v9, s[20:23], s18 offen offset:0 sc1
  buffer_load_dwordx4 v[32:35], v9, s[20:23], s18 offen offset:1024 sc1
  s_add_u32 s16, s16, 4096
  s_add_u32 s17, s17, 4096
  buffer_load_dwordx4 v[20:23], v9, s[20:23], s16 offen offset:0 sc1
  buffer_load_dwordx4 v[24:27], v9, s[20:23], s17 offen offset:0 sc1
  s_waitcnt vmcnt(28)
  v_mfma_f32_32x32x16_bf16 a[0:15], v[44:47], v[36:39], a[0:15]
  v_mfma_f32_32x32x16_bf16 a[16:31], v[48:51], v[36:39], a[16:31]
  v_mfma_f32_32x32x16_bf16 a[32:47], v[44:47], v[40:43], a[32:47]
  v_mfma_f32_32x32x16_bf16 a[48:63], v[48:51], v[40:43], a[48:63]
  buffer_load_dwordx4 v[44:47], v9, s[20:23], s18 offen offset:2048 sc1
  buffer_load_dwordx4 v[48:51], v9, s[20:23], s18 offen offset:3072 sc1
  buffer_load_dwordx4 v[36:39], v9, s[20:23], s16 offen offset:1024 sc1
  buffer_load_dwordx4 v[40:43], v9, s[20:23], s17 offen offset:1024 sc1
  s_waitcnt vmcnt(28)
  v_mfma_f32_32x32x16_bf16 a[0:15], v[60:63], v[52:55], a[0:15]
  v_mfma_f32_32x32x16_bf16 a[16:31], v[64:67], v[52:55], a[16:31]
  v_mfma_f32_32x32x16_bf16 a[32:47], v[60:63], v[56:59], a[32:47]
  v_mfma_f32_32x32x16_bf16 a[48:63], v[64:67], v[56:59], a[48:63]
  s_add_u32 s18, s18, 4096
  buffer_load_dwordx4 v[60:63], v9, s[20:23], s18 offen offset:0 sc1
  buffer_load_dwordx4 v[64:67], v9, s[20:23], s18 offen offset:1024 sc1
  buffer_load_dwordx4 v[52:55], v9, s[20:23], s16 offen offset:2048 sc1
  buffer_load_dwordx4 v[56:59], v9, s[20:23], s17 offen offset:2048 sc1
  s_waitcnt vmcnt(28)
  v_mfma_f32_32x32x16_bf16 a[0:15], v[76:79], v[68:71], a[0:15]
  v_mfma_f32_32x32x16_bf16 a[16:31], v[80:83], v[68:71], a[16:31]
  v_mfma_f32_32x32x16_bf16 a[32:47], v[76:79], v[72:75], a[32:47]
  v_mfma_f32_32x32x16_bf16 a[48:63], v[80:83], v[72:75], a[48:63]
  buffer_load_dwordx4 v[76:79], v9, s[20:23], s18 offen offset:2048 sc1
  buffer_load_dwordx4 v[80:83], v9, s[20:23], s18 offen offset:3072 sc1
  buffer_load_dwordx4 v[68:71], v9, s[20:23], s16 offen offset:3072 sc1
  buffer_load_dwordx4 v[72:75], v9, s[20:23], s17 offen offset:3072 sc1
  s_waitcnt vmcnt(28)
  v_mfma_f32_32x32x16_bf16 a[0:15], v[92:95], v[84:87], a[0:15]
  v_mfma_f32_32x32x16_bf16 a[16:31], v[96:99], v[84:87], a[16:31]
  v_mfma_f32_32x32x16_bf16 a[32:47], v[92:95], v[88:91], a[32:47]
  v_mfma_f32_32x32x16_bf16 a[48:63], v[96:99], v[88:91], a[48:63]
  s_add_u32 s18, s18, 4096
  buffer_load_dwordx4 v[92:95], v9, s[20:23], s18 offen offset:0 sc1
  buffer_load_dwordx4 v[96:99], v9, s[20:23], s18 offen offset:1024 sc1
  s_add_u32 s16, s16, 4096
  s_add_u32 s17, s17, 4096
  buffer_load_dwordx4 v[84:87], v9, s[20:23], s16 offen offset:0 sc1
  buffer_load_dwordx4 v[88:91], v9, s[20:23], s17 offen offset:0 sc1
  s_waitcnt vmcnt(28)
  v_mfma_f32_32x32x16_bf16 a[0:15], v[108:111], v[100:103], a[0:15]
  v_mfma_f32_32x32x16_bf16 a[16:31], v[112:115], v[100:103], a[16:31]
  v_mfma_f32_32x32x16_bf16 a[32:47], v[108:111], v[104:107], a[32:47]
  v_mfma_f32_32x32x16_bf16 a[48:63], v[112:115], v[104:107], a[48:63]
  buffer_load_dwordx4 v[108:111], v9, s[20:23], s18 offen offset:2048 sc1
  buffer_load_dwordx4 v[112:115], v9, s[20:23], s18 offen offset:3072 sc1
  buffer_load_dwordx4 v[100:103], v9, s[20:23], s16 offen offset:1024 sc1
  buffer_load_dwordx4 v[104:107], v9, s[20:23], s17 offen offset:1024 sc1
  s_waitcnt vmcnt(28)
  v_mfma_f32_32x32x16_bf16 a[0:15], v[124:127], v[116:119], a[0:15]
  v_mfma_f32_32x32x16_bf16 a[16:31], v[128:131], v[116:119], a[16:31]
  v_mfma_f32_32x32x16_bf16 a[32:47], v[124:127], v[120:123], a[32:47]
  v_mfma_f32_32x32x16_bf16 a[48:63], v[128:131], v[120:123], a[48:63]
  s_add_u32 s18, s18, 4096
  buffer_load_dwordx4 v[124:127], v9, s[20:23], s18 offen offset:0 sc1
  buffer_load_dwordx4 v[128:131], v9, s[20:23], s18 offen offset:1024 sc1
  buffer_load_dwordx4 v[116:119], v9, s[20:23], s16 offen offset:2048 sc1
  buffer_load_dwordx4 v[120:123], v9, s[20:23], s17 offen offset:2048 sc1
  s_waitcnt vmcnt(28)
  v_mfma_f32_32x32x16_bf16 a[0:15], v[140:143], v[132:135], a[0:15]
  v_mfma_f32_32x32x16_bf16 a[16:31], v[144:147], v[132:135], a[16:31]
  v_mfma_f32_32x32x16_bf16 a[32:47], v[140:143], v[136:139], a[32:47]
  v_mfma_f32_32x32x16_bf16 a[48:63], v[144:147], v[136:139], a[48:63]
  buffer_load_dwordx4 v[140:143], v9, s[20:23], s18 offen offset:2048 sc1
  buffer_load_dwordx4 v[144:147], v9, s[20:23], s18 offen offset:3072 sc1
  buffer_load_dwordx4 v[132:135], v9, s[20:23], s16 offen offset:3072 sc1
  buffer_load_dwordx4 v[136:139], v9, s[20:23], s17 offen offset:3072 sc1
  s_waitcnt vmcnt(28)
  v_mfma_f32_32x32x16_bf16 a[0:15], v[28:31], v[20:23], a[0:15]
  v_mfma_f32_32x32x16_bf16 a[16:31], v[32:35], v[20:23], a[16:31]
  v_mfma_f32_32x32x16_bf16 a[32:47], v[28:31], v[24:27], a[32:47]
  v_mfma_f32_32x32x16_bf16 a[48:63], v[32:35], v[24:27], a[48:63]
  s_add_u32 s18, s18, 4096
  buffer_load_dwordx4 v[28:31], v9, s[20:23], s18 offen offset:0 sc1
  buffer_load_dwordx4 v[32:35], v9, s[20:23], s18 offen offset:1024 sc1
  s_add_u32 s16, s16, 4096
  s_add_u32 s17, s17, 4096
  buffer_load_dwordx4 v[20:23], v9, s[20:23], s16 offen offset:0 sc1
  buffer_load_dwordx4 v[24:27], v9, s[20:23], s17 offen offset:0 sc1
  s_waitcnt vmcnt(28)
  v_mfma_f32_32x32x16_bf16 a[0:15], v[44:47], v[36:39], a[0:15]
  v_mfma_f32_32x32x16_bf16 a[16:31], v[48:51], v[36:39], a[16:31]
  v_mfma_f32_32x32x16_bf16 a[32:47], v[44:47], v[40:43], a[32:47]
  v_mfma_f32_32x32x16_bf16 a[48:63], v[48:51], v[40:43], a[48:63]
  buffer_load_dwordx4 v[44:47], v9, s[20:23], s18 offen offset:2048 sc1
  buffer_load_dwordx4 v[48:51], v9, s[20:23], s18 offen offset:3072 sc1
  buffer_load_dwordx4 v[36:39], v9, s[20:23], s16 offen offset:1024 sc1
  buffer_load_dwordx4 v[40:43], v9, s[20:23], s17 offen offset:1024 sc1
  s_waitcnt vmcnt(28)
  v_mfma_f32_32x32x16_bf16 a[0:15], v[60:63], v[52:55], a[0:15]
  v_mfma_f32_32x32x16_bf16 a[16:31], v[64:67], v[52:55], a[16:31]
  v_mfma_f32_32x32x16_bf16 a[32:47], v[60:63], v[56:59], a[32:47]
  v_mfma_f32_32x32x16_bf16 a[48:63], v[64:67], v[56:59], a[48:63]
  s_add_u32 s18, s18, 4096
  buffer_load_dwordx4 v[60:63], v9, s[20:23], s18 offen offset:0 sc1
  buffer_load_dwordx4 v[64:67], v9, s[20:23], s18 offen offset:1024 sc1
  buffer_load_dwordx4 v[52:55], v9, s[20:23], s16 offen offset:2048 sc1
  buffer_load_dwordx4 v[56:59], v9, s[20:23], s17 offen offset:2048 sc1
  s_waitcnt vmcnt(28)
  v_mfma_f32_32x32x16_bf16 a[0:15], v[76:79], v[68:71], a[0:15]
  v_mfma_f32_32x32x16_bf16 a[16:31], v[80:83], v[68:71], a[16:31]
  v_mfma_f32_32x32x16_bf16 a[32:47], v[76:79], v[72:75], a[32:47]
  v_mfma_f32_32x32x16_bf16 a[48:63], v[80:83], v[72:75], a[48:63]
  buffer_load_dwordx4 v[76:79], v9, s[20:23], s18 offen offset:2048 sc1
  buffer_load_dwordx4 v[80:83], v9, s[20:23], s18 offen offset:3072 sc1
  buffer_load_dwordx4 v[68:71], v9, s[20:23], s16 offen offset:3072 sc1
  buffer_load_dwordx4 v[72:75], v9, s[20:23], s17 offen offset:3072 sc1
  s_waitcnt vmcnt(28)
  v_mfma_f32_32x32x16_bf16 a[0:15], v[92:95], v[84:87], a[0:15]
  v_mfma_f32_32x32x16_bf16 a[16:31], v[96:99], v[84:87], a[16:31]
  v_mfma_f32_32x32x16_bf16 a[32:47], v[92:95], v[88:91], a[32:47]
  v_mfma_f32_32x32x16_bf16 a[48:63], v[96:99], v[88:91], a[48:63]
  s_add_u32 s18, s18, 4096
  buffer_load_dwordx4 v[92:95], v9, s[20:23], s18 offen offset:0 sc1
  buffer_load_dwordx4 v[96:99], v9, s[20:23], s18 offen offset:1024 sc1
  s_add_u32 s16, s16, 4096
  s_add_u32 s17, s17, 4096
  buffer_load_dwordx4 v[84:87], v9, s[20:23], s16 offen offset:0 sc1
  buffer_load_dwordx4 v[88:91], v9, s[20:23], s17 offen offset:0 sc1
  s_waitcnt vmcnt(28)
  v_mfma_f32_32x32x16_bf16 a[0:15], v[108:111], v[100:103], a[0:15]
  v_mfma_f32_32x32x16_bf16 a[16:31], v[112:115], v[100:103], a[16:31]
  v_mfma_f32_32x32x16_bf16 a[32:47], v[108:111], v[104:107], a[32:47]
  v_mfma_f32_32x32x16_bf16 a[48:63], v[112:115], v[104:107], a[48:63]
  ds_read_b128 v[108:111], v7 offset:0
  ds_read_b128 v[112:115], v7 offset:1024
  buffer_load_dwordx4 v[100:103], v9, s[20:23], s16 offen offset:1024 sc1
  buffer_load_dwordx4 v[104:107], v9, s[20:23], s17 offen offset:1024 sc1
  s_waitcnt vmcnt(26)
  v_mfma_f32_32x32x16_bf16 a[0:15], v[124:127], v[116:119], a[0:15]
  v_mfma_f32_32x32x16_bf16 a[16:31], v[128:131], v[116:119], a[16:31]
  v_mfma_f32_32x32x16_bf16 a[32:47], v[124:127], v[120:123], a[32:47]
  v_mfma_f32_32x32x16_bf16 a[48:63], v[128:131], v[120:123], a[48:63]
  ds_read_b128 v[124:127], v7 offset:2048
  ds_read_b128 v[128:131], v7 offset:3072
  buffer_load_dwordx4 v[116:119], v9, s[20:23], s16 offen offset:2048 sc1
  buffer_load_dwordx4 v[120:123], v9, s[20:23], s17 offen offset:2048 sc1
  s_waitcnt vmcnt(24)
  v_mfma_f32_32x32x16_bf16 a[0:15], v[140:143], v[132:135], a[0:15]
  v_mfma_f32_32x32x16_bf16 a[16:31], v[144:147], v[132:135], a[16:31]
  v_mfma_f32_32x32x16_bf16 a[32:47], v[140:143], v[136:139], a[32:47]
  v_mfma_f32_32x32x16_bf16 a[48:63], v[144:147], v[136:139], a[48:63]
  ds_read_b128 v[140:143], v7 offset:4096
  ds_read_b128 v[144:147], v7 offset:5120
  buffer_load_dwordx4 v[132:135], v9, s[20:23], s16 offen offset:3072 sc1
  buffer_load_dwordx4 v[136:139], v9, s[20:23], s17 offen offset:3072 sc1
  buffer_load_dwordx2 v[14:15], v10, s[8:11], 0 offen
  buffer_load_dwordx2 v[16:17], v10, s[8:11], 0 offen offset:16
  s_waitcnt vmcnt(24)
  v_mfma_f32_32x32x16_bf16 a[0:15], v[28:31], v[20:23], a[0:15]
  v_mfma_f32_32x32x16_bf16 a[16:31], v[32:35], v[20:23], a[16:31]
  v_mfma_f32_32x32x16_bf16 a[32:47], v[28:31], v[24:27], a[32:47]
  v_mfma_f32_32x32x16_bf16 a[48:63], v[32:35], v[24:27], a[48:63]
  s_waitcnt vmcnt(20)
  v_mfma_f32_32x32x16_bf16 a[0:15], v[44:47], v[36:39], a[0:15]
  v_mfma_f32_32x32x16_bf16 a[16:31], v[48:51], v[36:39], a[16:31]
  v_mfma_f32_32x32x16_bf16 a[32:47], v[44:47], v[40:43], a[32:47]
  v_mfma_f32_32x32x16_bf16 a[48:63], v[48:51], v[40:43], a[48:63]
  s_waitcnt vmcnt(16)
  v_mfma_f32_32x32x16_bf16 a[0:15], v[60:63], v[52:55], a[0:15]
  v_mfma_f32_32x32x16_bf16 a[16:31], v[64:67], v[52:55], a[16:31]
  v_mfma_f32_32x32x16_bf16 a[32:47], v[60:63], v[56:59], a[32:47]
  v_mfma_f32_32x32x16_bf16 a[48:63], v[64:67], v[56:59], a[48:63]
  s_waitcnt vmcnt(12)
  v_mfma_f32_32x32x16_bf16 a[0:15], v[76:79], v[68:71], a[0:15]
  v_mfma_f32_32x32x16_bf16 a[16:31], v[80:83], v[68:71], a[16:31]
  v_mfma_f32_32x32x16_bf16 a[32:47], v[76:79], v[72:75], a[32:47]
  v_mfma_f32_32x32x16_bf16 a[48:63], v[80:83], v[72:75], a[48:63]
  s_waitcnt vmcnt(8)
  v_mfma_f32_32x32x16_bf16 a[0:15], v[92:95], v[84:87], a[0:15]
  v_mfma_f32_32x32x16_bf16 a[16:31], v[96:99], v[84:87], a[16:31]
  v_mfma_f32_32x32x16_bf16 a[32:47], v[92:95], v[88:91], a[32:47]
  v_mfma_f32_32x32x16_bf16 a[48:63], v[96:99], v[88:91], a[48:63]
  s_waitcnt vmcnt(6) lgkmcnt(4)
  v_mfma_f32_32x32x16_bf16 a[0:15], v[108:111], v[100:103], a[0:15]
  v_mfma_f32_32x32x16_bf16 a[16:31], v[112:115], v[100:103], a[16:31]
  v_mfma_f32_32x32x16_bf16 a[32:47], v[108:111], v[104:107], a[32:47]
  v_mfma_f32_32x32x16_bf16 a[48:63], v[112:115], v[104:107], a[48:63]
  s_waitcnt vmcnt(4) lgkmcnt(2)
  v_mfma_f32_32x32x16_bf16 a[0:15], v[124:127], v[116:119], a[0:15]
  v_mfma_f32_32x32x16_bf16 a[16:31], v[128:131], v[116:119], a[16:31]
  v_mfma_f32_32x32x16_bf16 a[32:47], v[124:127], v[120:123], a[32:47]
  v_mfma_f32_32x32x16_bf16 a[48:63], v[128:131], v[120:123], a[48:63]
  s_waitcnt vmcnt(2) lgkmcnt(0)
  v_mfma_f32_32x32x16_bf16 a[0:15], v[140:143], v[132:135], a[0:15]
  v_mfma_f32_32x32x16_bf16 a[16:31], v[144:147], v[132:135], a[16:31]
  v_mfma_f32_32x32x16_bf16 a[32:47], v[140:143], v[136:139], a[32:47]
  v_mfma_f32_32x32x16_bf16 a[48:63], v[144:147], v[136:139], a[48:63]
  s_nop 15
  ds_write_b128 v4, a[0:3] offset:0
  ds_write_b128 v4, a[4:7] offset:1024
  ds_write_b128 v4, a[8:11] offset:2048
  ds_write_b128 v4, a[12:15] offset:3072
  ds_write_b128 v4, a[16:19] offset:4096
  ds_write_b128 v4, a[20:23] offset:5120
  ds_write_b128 v4, a[24:27] offset:6144
  ds_write_b128 v4, a[28:31] offset:7168
  ds_write_b128 v4, a[32:35] offset:8192
  ds_write_b128 v4, a[36:39] offset:9216
  ds_write_b128 v4, a[40:43] offset:10240
  ds_write_b128 v4, a[44:47] offset:11264
  ds_write_b128 v4, a[48:51] offset:12288
  ds_write_b128 v4, a[52:55] offset:13312
  ds_write_b128 v4, a[56:59] offset:14336
  ds_write_b128 v4, a[60:63] offset:15360
  s_waitcnt lgkmcnt(0)
  s_barrier
  ds_read_b128 v[20:23], v11 offset:0
  ds_read_b128 v[24:27], v11 offset:1024
  ds_read_b128 v[28:31], v11 offset:16384
  ds_read_b128 v[32:35], v11 offset:17408
  ds_read_b128 v[36:39], v12 offset:0
  ds_read_b128 v[40:43], v12 offset:1024
  ds_read_b128 v[44:47], v12 offset:16384
  ds_read_b128 v[48:51], v12 offset:17408
  ds_read_b128 v[52:55], v12 offset:32768
  ds_read_b128 v[56:59], v12 offset:33792
  ds_read_b128 v[60:63], v12 offset:49152
  ds_read_b128 v[64:67], v12 offset:50176
  ds_read_b128 v[68:71], v6 offset:0
  ds_read_b128 v[72:75], v6 offset:1024
  ds_read_b128 v[76:79], v6 offset:16384
  ds_read_b128 v[80:83], v6 offset:17408
  s_waitcnt lgkmcnt(12)
  v_add_f32 v20, v20, v28
  v_add_f32 v21, v21, v29
  v_add_f32 v22, v22, v30
  v_add_f32 v23, v23, v31
  v_add_f32 v24, v24, v32
  v_add_f32 v25, v25, v33
  v_add_f32 v26, v26, v34
  v_add_f32 v27, v27, v35
  s_waitcnt lgkmcnt(10)
  v_add_f32 v20, v20, v36
  v_add_f32 v21, v21, v37
  v_add_f32 v22, v22, v38
  v_add_f32 v23, v23, v39
  v_add_f32 v24, v24, v40
  v_add_f32 v25, v25, v41
  v_add_f32 v26, v26, v42
  v_add_f32 v27, v27, v43
  s_waitcnt lgkmcnt(8)
  v_add_f32 v20, v20, v44
  v_add_f32 v21, v21, v45
  v_add_f32 v22, v22, v46
  v_add_f32 v23, v23, v47
  v_add_f32 v24, v24, v48
  v_add_f32 v25, v25, v49
  v_add_f32 v26, v26, v50
  v_add_f32 v27, v27, v51
  s_waitcnt lgkmcnt(6)
  v_add_f32 v20, v20, v52
  v_add_f32 v21, v21, v53
  v_add_f32 v22, v22, v54
  v_add_f32 v23, v23, v55
  v_add_f32 v24, v24, v56
  v_add_f32 v25, v25, v57
  v_add_f32 v26, v26, v58
  v_add_f32 v27, v27, v59
  s_waitcnt lgkmcnt(4)
  v_add_f32 v20, v20, v60
  v_add_f32 v21, v21, v61
  v_add_f32 v22, v22, v62
  v_add_f32 v23, v23, v63
  v_add_f32 v24, v24, v64
  v_add_f32 v25, v25, v65
  v_add_f32 v26, v26, v66
  v_add_f32 v27, v27, v67
  s_waitcnt lgkmcnt(2)
  v_add_f32 v20, v20, v68
  v_add_f32 v21, v21, v69
  v_add_f32 v22, v22, v70
  v_add_f32 v23, v23, v71
  v_add_f32 v24, v24, v72
  v_add_f32 v25, v25, v73
  v_add_f32 v26, v26, v74
  v_add_f32 v27, v27, v75
  s_waitcnt lgkmcnt(0)
  v_add_f32 v20, v20, v76
  v_add_f32 v21, v21, v77
  v_add_f32 v22, v22, v78
  v_add_f32 v23, v23, v79
  v_add_f32 v24, v24, v80
  v_add_f32 v25, v25, v81
  v_add_f32 v26, v26, v82
  v_add_f32 v27, v27, v83
  v_cvt_pk_bf16_f32 v20, v20, v20
  v_and_b32 v20, 0xffff0000, v20
  v_cvt_pk_bf16_f32 v21, v21, v21
  v_and_b32 v21, 0xffff0000, v21
  v_cvt_pk_bf16_f32 v22, v22, v22
  v_and_b32 v22, 0xffff0000, v22
  v_cvt_pk_bf16_f32 v23, v23, v23
  v_and_b32 v23, 0xffff0000, v23
  v_cvt_pk_bf16_f32 v24, v24, v24
  v_and_b32 v24, 0xffff0000, v24
  v_cvt_pk_bf16_f32 v25, v25, v25
  v_and_b32 v25, 0xffff0000, v25
  v_cvt_pk_bf16_f32 v26, v26, v26
  v_and_b32 v26, 0xffff0000, v26
  v_cvt_pk_bf16_f32 v27, v27, v27
  v_and_b32 v27, 0xffff0000, v27
  v_mul_f32 v20, v20, v180
  v_mul_f32 v21, v21, v181
  v_mul_f32 v22, v22, v182
  v_mul_f32 v23, v23, v183
  v_mul_f32 v24, v24, v184
  v_mul_f32 v25, v25, v185
  v_mul_f32 v26, v26, v186
  v_mul_f32 v27, v27, v187
  v_cvt_pk_bf16_f32 v20, v20, v20
  v_and_b32 v20, 0xffff0000, v20
  v_cvt_pk_bf16_f32 v21, v21, v21
  v_and_b32 v21, 0xffff0000, v21
  v_cvt_pk_bf16_f32 v22, v22, v22
  v_and_b32 v22, 0xffff0000, v22
  v_cvt_pk_bf16_f32 v23, v23, v23
  v_and_b32 v23, 0xffff0000, v23
  v_cvt_pk_bf16_f32 v24, v24, v24
  v_and_b32 v24, 0xffff0000, v24
  v_cvt_pk_bf16_f32 v25, v25, v25
  v_and_b32 v25, 0xffff0000, v25
  v_cvt_pk_bf16_f32 v26, v26, v26
  v_and_b32 v26, 0xffff0000, v26
  v_cvt_pk_bf16_f32 v27, v27, v27
  v_and_b32 v27, 0xffff0000, v27
  s_waitcnt vmcnt(0)
  v_lshlrev_b32 v36, 16, v14
  v_and_b32 v37, 0xffff0000, v14
  v_lshlrev_b32 v38, 16, v15
  v_and_b32 v39, 0xffff0000, v15
  v_lshlrev_b32 v40, 16, v16
  v_and_b32 v41, 0xffff0000, v16
  v_lshlrev_b32 v42, 16, v17
  v_and_b32 v43, 0xffff0000, v17
  v_add_f32 v20, v36, v20
  v_add_f32 v21, v37, v21
  v_add_f32 v22, v38, v22
  v_add_f32 v23, v39, v23
  v_add_f32 v24, v40, v24
  v_add_f32 v25, v41, v25
  v_add_f32 v26, v42, v26
  v_add_f32 v27, v43, v27
  v_cvt_pk_bf16_f32 v14, v20, v21
  v_cvt_pk_bf16_f32 v15, v22, v23
  v_cvt_pk_bf16_f32 v16, v24, v25
  v_cvt_pk_bf16_f32 v17, v26, v27
  buffer_store_dwordx2 v[14:15], v10, s[12:15], 0 offen
  buffer_store_dwordx2 v[16:17], v10, s[12:15], 0 offen offset:16
L_attn_done:
  s_endpgm
L_attn_qdsig:
  s_and_b32 s73, s2, 7
  s_lshl_b32 s73, s73, 8
  s_add_u32 s73, s73, 0x3001000
  s_mov_b64 exec, 1
  v_mov_b32 v2, 0
  v_mov_b32 v3, 1
  buffer_atomic_add v3, v2, s[20:23], s73 offen
  s_mov_b64 exec, -1
  s_branch L_attn_qdback
L_attn_slow_21:
  s_mov_b32 s36, 0
  s_branch L_attn_resc0
L_attn_slow_29:
  s_mov_b32 s36, 1
  s_branch L_attn_resc0
L_attn_slow_37:
  s_mov_b32 s36, 2
  s_branch L_attn_resc0
L_attn_slow_45:
  s_mov_b32 s36, 3
  s_branch L_attn_resc0
L_attn_slow_53:
  s_mov_b32 s36, 4
  s_branch L_attn_resc0
L_attn_slow_61:
  s_mov_b32 s36, 5
  s_branch L_attn_resc0
L_attn_slow_69:
  s_mov_b32 s36, 6
  s_branch L_attn_resc0
L_attn_slow_77:
  s_mov_b32 s36, 7
  s_branch L_attn_resc0
L_attn_slow_85:
  s_mov_b32 s36, 8
  s_branch L_attn_resc0
L_attn_resc0:
  s_nop 11
  v_max3_f32 v21, v156, v157, v158
  v_max3_f32 v21, v21, v159, v36
  v_max3_f32 v21, v21, v37, v38
  v_max_f32 v21, v21, v39
  v_max3_f32 v10, v40, v41, v42
  v_max3_f32 v10, v10, v43, v44
  v_max3_f32 v10, v10, v45, v46
  v_max_f32 v10, v10, v47
  v_mov_b32 v2, v21
  v_mov_b32 v3, v10
  s_nop 1
  v_permlane16_swap_b32 v2, v21
  v_permlane16_swap_b32 v3, v10
  v_max_f32 v21, v21, v2
  v_max_f32 v10, v10, v3
  v_mov_b32 v2, v21
  v_mov_b32 v3, v10
  s_nop 1
  v_permlane32_swap_b32 v2, v21
  v_permlane32_swap_b32 v3, v10
  v_max_f32 v21, v21, v2
  v_max_f32 v10, v10, v3
  v_max_f32 v21, 0, v21
  v_max_f32 v10, 0, v10
  v_sub_f32 v156, v156, v21
  v_sub_f32 v157, v157, v21
  v_sub_f32 v158, v158, v21
  v_sub_f32 v159, v159, v21
  v_sub_f32 v36, v36, v21
  v_sub_f32 v37, v37, v21
  v_sub_f32 v38, v38, v21
  v_sub_f32 v39, v39, v21
  v_sub_f32 v40, v40, v10
  v_sub_f32 v41, v41, v10
  v_sub_f32 v42, v42, v10
  v_sub_f32 v43, v43, v10
  v_sub_f32 v44, v44, v10
  v_sub_f32 v45, v45, v10
  v_sub_f32 v46, v46, v10
  v_sub_f32 v47, v47, v10
  v_exp_f32 v2, -v21
  v_exp_f32 v3, -v10
  v_sub_f32 v164, v164, v21
  v_sub_f32 v165, v165, v21
  v_sub_f32 v166, v166, v21
  v_sub_f32 v167, v167, v21
  v_sub_f32 v68, v68, v10
  v_sub_f32 v69, v69, v10
  v_sub_f32 v70, v70, v10
  v_sub_f32 v71, v71, v10
  v_mul_f32 v184, v184, v2
  v_mul_f32 v185, v185, v2
  v_mul_f32 v188, v188, v3
  v_mul_f32 v189, v189, v3
  v_accvgpr_read_b32 v22, a0
  v_mul_f32 v22, v22, v2
  v_accvgpr_write_b32 a0, v22
  v_accvgpr_read_b32 v23, a1
  v_mul_f32 v23, v23, v2
  v_accvgpr_write_b32 a1, v23
  v_accvgpr_read_b32 v24, a2
  v_mul_f32 v24, v24, v2
  v_accvgpr_write_b32 a2, v24
  v_accvgpr_read_b32 v25, a3
  v_mul_f32 v25, v25, v2
  v_accvgpr_write_b32 a3, v25
  v_accvgpr_read_b32 v26, a4
  v_mul_f32 v26, v26, v3
  v_accvgpr_write_b32 a4, v26
  v_accvgpr_read_b32 v27, a5
  v_mul_f32 v27, v27, v3
  v_accvgpr_write_b32 a5, v27
  v_accvgpr_read_b32 v152, a6
  v_mul_f32 v152, v152, v3
  v_accvgpr_write_b32 a6, v152
  v_accvgpr_read_b32 v153, a7
  v_mul_f32 v153, v153, v3
  v_accvgpr_write_b32 a7, v153
  v_accvgpr_read_b32 v22, a8
  v_mul_f32 v22, v22, v2
  v_accvgpr_write_b32 a8, v22
  v_accvgpr_read_b32 v23, a9
  v_mul_f32 v23, v23, v2
  v_accvgpr_write_b32 a9, v23
  v_accvgpr_read_b32 v24, a10
  v_mul_f32 v24, v24, v2
  v_accvgpr_write_b32 a10, v24
  v_accvgpr_read_b32 v25, a11
  v_mul_f32 v25, v25, v2
  v_accvgpr_write_b32 a11, v25
  v_accvgpr_read_b32 v26, a12
  v_mul_f32 v26, v26, v3
  v_accvgpr_write_b32 a12, v26
  v_accvgpr_read_b32 v27, a13
  v_mul_f32 v27, v27, v3
  v_accvgpr_write_b32 a13, v27
  v_accvgpr_read_b32 v152, a14
  v_mul_f32 v152, v152, v3
  v_accvgpr_write_b32 a14, v152
  v_accvgpr_read_b32 v153, a15
  v_mul_f32 v153, v153, v3
  v_accvgpr_write_b32 a15, v153
  v_accvgpr_read_b32 v22, a16
  v_mul_f32 v22, v22, v2
  v_accvgpr_write_b32 a16, v22
  v_accvgpr_read_b32 v23, a17
  v_mul_f32 v23, v23, v2
  v_accvgpr_write_b32 a17, v23
  v_accvgpr_read_b32 v24, a18
  v_mul_f32 v24, v24, v2
  v_accvgpr_write_b32 a18, v24
  v_accvgpr_read_b32 v25, a19
  v_mul_f32 v25, v25, v2
  v_accvgpr_write_b32 a19, v25
  v_accvgpr_read_b32 v26, a20
  v_mul_f32 v26, v26, v3
  v_accvgpr_write_b32 a20, v26
  v_accvgpr_read_b32 v27, a21
  v_mul_f32 v27, v27, v3
  v_accvgpr_write_b32 a21, v27
  v_accvgpr_read_b32 v152, a22
  v_mul_f32 v152, v152, v3
  v_accvgpr_write_b32 a22, v152
  v_accvgpr_read_b32 v153, a23
  v_mul_f32 v153, v153, v3
  v_accvgpr_write_b32 a23, v153
  v_accvgpr_read_b32 v22, a24
  v_mul_f32 v22, v22, v2
  v_accvgpr_write_b32 a24, v22
  v_accvgpr_read_b32 v23, a25
  v_mul_f32 v23, v23, v2
  v_accvgpr_write_b32 a25, v23
  v_accvgpr_read_b32 v24, a26
  v_mul_f32 v24, v24, v2
  v_accvgpr_write_b32 a26, v24
  v_accvgpr_read_b32 v25, a27
  v_mul_f32 v25, v25, v2
  v_accvgpr_write_b32 a27, v25
  v_accvgpr_read_b32 v26, a28
  v_mul_f32 v26, v26, v3
  v_accvgpr_write_b32 a28, v26
  v_accvgpr_read_b32 v27, a29
  v_mul_f32 v27, v27, v3
  v_accvgpr_write_b32 a29, v27
  v_accvgpr_read_b32 v152, a30
  v_mul_f32 v152, v152, v3
  v_accvgpr_write_b32 a30, v152
  v_accvgpr_read_b32 v153, a31
  v_mul_f32 v153, v153, v3
  v_accvgpr_write_b32 a31, v153
  v_accvgpr_read_b32 v22, a32
  v_mul_f32 v22, v22, v2
  v_accvgpr_write_b32 a32, v22
  v_accvgpr_read_b32 v23, a33
  v_mul_f32 v23, v23, v2
  v_accvgpr_write_b32 a33, v23
  v_accvgpr_read_b32 v24, a34
  v_mul_f32 v24, v24, v2
  v_accvgpr_write_b32 a34, v24
  v_accvgpr_read_b32 v25, a35
  v_mul_f32 v25, v25, v2
  v_accvgpr_write_b32 a35, v25
  v_accvgpr_read_b32 v26, a36
  v_mul_f32 v26, v26, v3
  v_accvgpr_write_b32 a36, v26
  v_accvgpr_read_b32 v27, a37
  v_mul_f32 v27, v27, v3
  v_accvgpr_write_b32 a37, v27
  v_accvgpr_read_b32 v152, a38
  v_mul_f32 v152, v152, v3
  v_accvgpr_write_b32 a38, v152
  v_accvgpr_read_b32 v153, a39
  v_mul_f32 v153, v153, v3
  v_accvgpr_write_b32 a39, v153
  v_accvgpr_read_b32 v22, a40
  v_mul_f32 v22, v22, v2
  v_accvgpr_write_b32 a40, v22
  v_accvgpr_read_b32 v23, a41
  v_mul_f32 v23, v23, v2
  v_accvgpr_write_b32 a41, v23
  v_accvgpr_read_b32 v24, a42
  v_mul_f32 v24, v24, v2
  v_accvgpr_write_b32 a42, v24
  v_accvgpr_read_b32 v25, a43
  v_mul_f32 v25, v25, v2
  v_accvgpr_write_b32 a43, v25
  v_accvgpr_read_b32 v26, a44
  v_mul_f32 v26, v26, v3
  v_accvgpr_write_b32 a44, v26
  v_accvgpr_read_b32 v27, a45
  v_mul_f32 v27, v27, v3
  v_accvgpr_write_b32 a45, v27
  v_accvgpr_read_b32 v152, a46
  v_mul_f32 v152, v152, v3
  v_accvgpr_write_b32 a46, v152
  v_accvgpr_read_b32 v153, a47
  v_mul_f32 v153, v153, v3
  v_accvgpr_write_b32 a47, v153
  v_accvgpr_read_b32 v22, a48
  v_mul_f32 v22, v22, v2
  v_accvgpr_write_b32 a48, v22
  v_accvgpr_read_b32 v23, a49
  v_mul_f32 v23, v23, v2
  v_accvgpr_write_b32 a49, v23
  v_accvgpr_read_b32 v24, a50
  v_mul_f32 v24, v24, v2
  v_accvgpr_write_b32 a50, v24
  v_accvgpr_read_b32 v25, a51
  v_mul_f32 v25, v25, v2
  v_accvgpr_write_b32 a51, v25
  v_accvgpr_read_b32 v26, a52
  v_mul_f32 v26, v26, v3
  v_accvgpr_write_b32 a52, v26
  v_accvgpr_read_b32 v27, a53
  v_mul_f32 v27, v27, v3
  v_accvgpr_write_b32 a53, v27
  v_accvgpr_read_b32 v152, a54
  v_mul_f32 v152, v152, v3
  v_accvgpr_write_b32 a54, v152
  v_accvgpr_read_b32 v153, a55
  v_mul_f32 v153, v153, v3
  v_accvgpr_write_b32 a55, v153
  v_accvgpr_read_b32 v22, a56
  v_mul_f32 v22, v22, v2
  v_accvgpr_write_b32 a56, v22
  v_accvgpr_read_b32 v23, a57
  v_mul_f32 v23, v23, v2
  v_accvgpr_write_b32 a57, v23
  v_accvgpr_read_b32 v24, a58
  v_mul_f32 v24, v24, v2
  v_accvgpr_write_b32 a58, v24
  v_accvgpr_read_b32 v25, a59
  v_mul_f32 v25, v25, v2
  v_accvgpr_write_b32 a59, v25
  v_accvgpr_read_b32 v26, a60
  v_mul_f32 v26, v26, v3
  v_accvgpr_write_b32 a60, v26
  v_accvgpr_read_b32 v27, a61
  v_mul_f32 v27, v27, v3
  v_accvgpr_write_b32 a61, v27
  v_accvgpr_read_b32 v152, a62
  v_mul_f32 v152, v152, v3
  v_accvgpr_write_b32 a62, v152
  v_accvgpr_read_b32 v153, a63
  v_mul_f32 v153, v153, v3
  v_accvgpr_write_b32 a63, v153
  s_nop 1
  s_cmp_eq_u32 s36, 0
  s_cbranch_scc1 L_attn_spun_19
  s_cmp_eq_u32 s36, 1
  s_cbranch_scc1 L_attn_spun_27
  s_cmp_eq_u32 s36, 2
  s_cbranch_scc1 L_attn_spun_35
  s_cmp_eq_u32 s36, 3
  s_cbranch_scc1 L_attn_spun_43
  s_cmp_eq_u32 s36, 4
  s_cbranch_scc1 L_attn_spun_51
  s_cmp_eq_u32 s36, 5
  s_cbranch_scc1 L_attn_spun_59
  s_cmp_eq_u32 s36, 6
  s_cbranch_scc1 L_attn_spun_67
  s_cmp_eq_u32 s36, 7
  s_cbranch_scc1 L_attn_spun_75
  s_branch L_attn_spun_83
L_attn_slow_17:
  s_mov_b32 s36, 0
  s_branch L_attn_resc1
L_attn_slow_25:
  s_mov_b32 s36, 1
  s_branch L_attn_resc1
L_attn_slow_33:
  s_mov_b32 s36, 2
  s_branch L_attn_resc1
L_attn_slow_41:
  s_mov_b32 s36, 3
  s_branch L_attn_resc1
L_attn_slow_49:
  s_mov_b32 s36, 4
  s_branch L_attn_resc1
L_attn_slow_57:
  s_mov_b32 s36, 5
  s_branch L_attn_resc1
L_attn_slow_65:
  s_mov_b32 s36, 6
  s_branch L_attn_resc1
L_attn_slow_73:
  s_mov_b32 s36, 7
  s_branch L_attn_resc1
L_attn_slow_81:
  s_mov_b32 s36, 8
  s_branch L_attn_resc1
L_attn_resc1:
  s_nop 11
  v_max3_f32 v21, v48, v49, v50
  v_max3_f32 v21, v21, v51, v52
  v_max3_f32 v21, v21, v53, v54
  v_max_f32 v21, v21, v55
  v_max3_f32 v10, v56, v57, v58
  v_max3_f32 v10, v10, v59, v160
  v_max3_f32 v10, v10, v161, v162
  v_max_f32 v10, v10, v163
  v_mov_b32 v2, v21
  v_mov_b32 v3, v10
  s_nop 1
  v_permlane16_swap_b32 v2, v21
  v_permlane16_swap_b32 v3, v10
  v_max_f32 v21, v21, v2
  v_max_f32 v10, v10, v3
  v_mov_b32 v2, v21
  v_mov_b32 v3, v10
  s_nop 1
  v_permlane32_swap_b32 v2, v21
  v_permlane32_swap_b32 v3, v10
  v_max_f32 v21, v21, v2
  v_max_f32 v10, v10, v3
  v_max_f32 v21, 0, v21
  v_max_f32 v10, 0, v10
  v_sub_f32 v48, v48, v21
  v_sub_f32 v49, v49, v21
  v_sub_f32 v50, v50, v21
  v_sub_f32 v51, v51, v21
  v_sub_f32 v52, v52, v21
  v_sub_f32 v53, v53, v21
  v_sub_f32 v54, v54, v21
  v_sub_f32 v55, v55, v21
  v_sub_f32 v56, v56, v10
  v_sub_f32 v57, v57, v10
  v_sub_f32 v58, v58, v10
  v_sub_f32 v59, v59, v10
  v_sub_f32 v160, v160, v10
  v_sub_f32 v161, v161, v10
  v_sub_f32 v162, v162, v10
  v_sub_f32 v163, v163, v10
  v_exp_f32 v2, -v21
  v_exp_f32 v3, -v10
  v_sub_f32 v164, v164, v21
  v_sub_f32 v165, v165, v21
  v_sub_f32 v166, v166, v21
  v_sub_f32 v167, v167, v21
  v_sub_f32 v68, v68, v10
  v_sub_f32 v69, v69, v10
  v_sub_f32 v70, v70, v10
  v_sub_f32 v71, v71, v10
  v_mul_f32 v184, v184, v2
  v_mul_f32 v185, v185, v2
  v_mul_f32 v188, v188, v3
  v_mul_f32 v189, v189, v3
  v_accvgpr_read_b32 v22, a0
  v_mul_f32 v22, v22, v2
  v_accvgpr_write_b32 a0, v22
  v_accvgpr_read_b32 v23, a1
  v_mul_f32 v23, v23, v2
  v_accvgpr_write_b32 a1, v23
  v_accvgpr_read_b32 v24, a2
  v_mul_f32 v24, v24, v2
  v_accvgpr_write_b32 a2, v24
  v_accvgpr_read_b32 v25, a3
  v_mul_f32 v25, v25, v2
  v_accvgpr_write_b32 a3, v25
  v_accvgpr_read_b32 v26, a4
  v_mul_f32 v26, v26, v3
  v_accvgpr_write_b32 a4, v26
  v_accvgpr_read_b32 v27, a5
  v_mul_f32 v27, v27, v3
  v_accvgpr_write_b32 a5, v27
  v_accvgpr_read_b32 v152, a6
  v_mul_f32 v152, v152, v3
  v_accvgpr_write_b32 a6, v152
  v_accvgpr_read_b32 v153, a7
  v_mul_f32 v153, v153, v3
  v_accvgpr_write_b32 a7, v153
  v_accvgpr_read_b32 v22, a8
  v_mul_f32 v22, v22, v2
  v_accvgpr_write_b32 a8, v22
  v_accvgpr_read_b32 v23, a9
  v_mul_f32 v23, v23, v2
  v_accvgpr_write_b32 a9, v23
  v_accvgpr_read_b32 v24, a10
  v_mul_f32 v24, v24, v2
  v_accvgpr_write_b32 a10, v24
  v_accvgpr_read_b32 v25, a11
  v_mul_f32 v25, v25, v2
  v_accvgpr_write_b32 a11, v25
  v_accvgpr_read_b32 v26, a12
  v_mul_f32 v26, v26, v3
  v_accvgpr_write_b32 a12, v26
  v_accvgpr_read_b32 v27, a13
  v_mul_f32 v27, v27, v3
  v_accvgpr_write_b32 a13, v27
  v_accvgpr_read_b32 v152, a14
  v_mul_f32 v152, v152, v3
  v_accvgpr_write_b32 a14, v152
  v_accvgpr_read_b32 v153, a15
  v_mul_f32 v153, v153, v3
  v_accvgpr_write_b32 a15, v153
  v_accvgpr_read_b32 v22, a16
  v_mul_f32 v22, v22, v2
  v_accvgpr_write_b32 a16, v22
  v_accvgpr_read_b32 v23, a17
  v_mul_f32 v23, v23, v2
  v_accvgpr_write_b32 a17, v23
  v_accvgpr_read_b32 v24, a18
  v_mul_f32 v24, v24, v2
  v_accvgpr_write_b32 a18, v24
  v_accvgpr_read_b32 v25, a19
  v_mul_f32 v25, v25, v2
  v_accvgpr_write_b32 a19, v25
  v_accvgpr_read_b32 v26, a20
  v_mul_f32 v26, v26, v3
  v_accvgpr_write_b32 a20, v26
  v_accvgpr_read_b32 v27, a21
  v_mul_f32 v27, v27, v3
  v_accvgpr_write_b32 a21, v27
  v_accvgpr_read_b32 v152, a22
  v_mul_f32 v152, v152, v3
  v_accvgpr_write_b32 a22, v152
  v_accvgpr_read_b32 v153, a23
  v_mul_f32 v153, v153, v3
  v_accvgpr_write_b32 a23, v153
  v_accvgpr_read_b32 v22, a24
  v_mul_f32 v22, v22, v2
  v_accvgpr_write_b32 a24, v22
  v_accvgpr_read_b32 v23, a25
  v_mul_f32 v23, v23, v2
  v_accvgpr_write_b32 a25, v23
  v_accvgpr_read_b32 v24, a26
  v_mul_f32 v24, v24, v2
  v_accvgpr_write_b32 a26, v24
  v_accvgpr_read_b32 v25, a27
  v_mul_f32 v25, v25, v2
  v_accvgpr_write_b32 a27, v25
  v_accvgpr_read_b32 v26, a28
  v_mul_f32 v26, v26, v3
  v_accvgpr_write_b32 a28, v26
  v_accvgpr_read_b32 v27, a29
  v_mul_f32 v27, v27, v3
  v_accvgpr_write_b32 a29, v27
  v_accvgpr_read_b32 v152, a30
  v_mul_f32 v152, v152, v3
  v_accvgpr_write_b32 a30, v152
  v_accvgpr_read_b32 v153, a31
  v_mul_f32 v153, v153, v3
  v_accvgpr_write_b32 a31, v153
  v_accvgpr_read_b32 v22, a32
  v_mul_f32 v22, v22, v2
  v_accvgpr_write_b32 a32, v22
  v_accvgpr_read_b32 v23, a33
  v_mul_f32 v23, v23, v2
  v_accvgpr_write_b32 a33, v23
  v_accvgpr_read_b32 v24, a34
  v_mul_f32 v24, v24, v2
  v_accvgpr_write_b32 a34, v24
  v_accvgpr_read_b32 v25, a35
  v_mul_f32 v25, v25, v2
  v_accvgpr_write_b32 a35, v25
  v_accvgpr_read_b32 v26, a36
  v_mul_f32 v26, v26, v3
  v_accvgpr_write_b32 a36, v26
  v_accvgpr_read_b32 v27, a37
  v_mul_f32 v27, v27, v3
  v_accvgpr_write_b32 a37, v27
  v_accvgpr_read_b32 v152, a38
  v_mul_f32 v152, v152, v3
  v_accvgpr_write_b32 a38, v152
  v_accvgpr_read_b32 v153, a39
  v_mul_f32 v153, v153, v3
  v_accvgpr_write_b32 a39, v153
  v_accvgpr_read_b32 v22, a40
  v_mul_f32 v22, v22, v2
  v_accvgpr_write_b32 a40, v22
  v_accvgpr_read_b32 v23, a41
  v_mul_f32 v23, v23, v2
  v_accvgpr_write_b32 a41, v23
  v_accvgpr_read_b32 v24, a42
  v_mul_f32 v24, v24, v2
  v_accvgpr_write_b32 a42, v24
  v_accvgpr_read_b32 v25, a43
  v_mul_f32 v25, v25, v2
  v_accvgpr_write_b32 a43, v25
  v_accvgpr_read_b32 v26, a44
  v_mul_f32 v26, v26, v3
  v_accvgpr_write_b32 a44, v26
  v_accvgpr_read_b32 v27, a45
  v_mul_f32 v27, v27, v3
  v_accvgpr_write_b32 a45, v27
  v_accvgpr_read_b32 v152, a46
  v_mul_f32 v152, v152, v3
  v_accvgpr_write_b32 a46, v152
  v_accvgpr_read_b32 v153, a47
  v_mul_f32 v153, v153, v3
  v_accvgpr_write_b32 a47, v153
  v_accvgpr_read_b32 v22, a48
  v_mul_f32 v22, v22, v2
  v_accvgpr_write_b32 a48, v22
  v_accvgpr_read_b32 v23, a49
  v_mul_f32 v23, v23, v2
  v_accvgpr_write_b32 a49, v23
  v_accvgpr_read_b32 v24, a50
  v_mul_f32 v24, v24, v2
  v_accvgpr_write_b32 a50, v24
  v_accvgpr_read_b32 v25, a51
  v_mul_f32 v25, v25, v2
  v_accvgpr_write_b32 a51, v25
  v_accvgpr_read_b32 v26, a52
  v_mul_f32 v26, v26, v3
  v_accvgpr_write_b32 a52, v26
  v_accvgpr_read_b32 v27, a53
  v_mul_f32 v27, v27, v3
  v_accvgpr_write_b32 a53, v27
  v_accvgpr_read_b32 v152, a54
  v_mul_f32 v152, v152, v3
  v_accvgpr_write_b32 a54, v152
  v_accvgpr_read_b32 v153, a55
  v_mul_f32 v153, v153, v3
  v_accvgpr_write_b32 a55, v153
  v_accvgpr_read_b32 v22, a56
  v_mul_f32 v22, v22, v2
  v_accvgpr_write_b32 a56, v22
  v_accvgpr_read_b32 v23, a57
  v_mul_f32 v23, v23, v2
  v_accvgpr_write_b32 a57, v23
  v_accvgpr_read_b32 v24, a58
  v_mul_f32 v24, v24, v2
  v_accvgpr_write_b32 a58, v24
  v_accvgpr_read_b32 v25, a59
  v_mul_f32 v25, v25, v2
  v_accvgpr_write_b32 a59, v25
  v_accvgpr_read_b32 v26, a60
  v_mul_f32 v26, v26, v3
  v_accvgpr_write_b32 a60, v26
  v_accvgpr_read_b32 v27, a61
  v_mul_f32 v27, v27, v3
  v_accvgpr_write_b32 a61, v27
  v_accvgpr_read_b32 v152, a62
  v_mul_f32 v152, v152, v3
  v_accvgpr_write_b32 a62, v152
  v_accvgpr_read_b32 v153, a63
  v_mul_f32 v153, v153, v3
  v_accvgpr_write_b32 a63, v153
  s_nop 1
  s_cmp_eq_u32 s36, 0
  s_cbranch_scc1 L_attn_spun_15
  s_cmp_eq_u32 s36, 1
  s_cbranch_scc1 L_attn_spun_23
  s_cmp_eq_u32 s36, 2
  s_cbranch_scc1 L_attn_spun_31
  s_cmp_eq_u32 s36, 3
  s_cbranch_scc1 L_attn_spun_39
  s_cmp_eq_u32 s36, 4
  s_cbranch_scc1 L_attn_spun_47
  s_cmp_eq_u32 s36, 5
  s_cbranch_scc1 L_attn_spun_55
  s_cmp_eq_u32 s36, 6
  s_cbranch_scc1 L_attn_spun_63
  s_cmp_eq_u32 s36, 7
  s_cbranch_scc1 L_attn_spun_71
  s_branch L_attn_spun_79
L_attn_hnd_16_x:
  s_cmp_eq_u64 s[48:49], 0
  s_cbranch_scc1 L_attn_spun_15
  s_branch L_attn_slow_17
L_attn_hnd_20_x:
  s_cmp_eq_u64 s[48:49], 0
  s_cbranch_scc1 L_attn_spun_19
  s_branch L_attn_slow_21
L_attn_hnd_24_x:
  s_cmp_eq_u64 s[48:49], 0
  s_cbranch_scc1 L_attn_spun_23
  s_branch L_attn_slow_25
L_attn_hnd_28_x:
  s_cmp_eq_u64 s[48:49], 0
  s_cbranch_scc1 L_attn_spun_27
  s_branch L_attn_slow_29
L_attn_hnd_32_x:
  s_cmp_eq_u64 s[48:49], 0
  s_cbranch_scc1 L_attn_spun_31
  s_branch L_attn_slow_33
L_attn_hnd_36_x:
  s_cmp_eq_u64 s[48:49], 0
  s_cbranch_scc1 L_attn_spun_35
  s_branch L_attn_slow_37
L_attn_hnd_40_x:
  s_cmp_eq_u64 s[48:49], 0
  s_cbranch_scc1 L_attn_spun_39
  s_branch L_attn_slow_41
L_attn_hnd_44_x:
  s_cmp_eq_u64 s[48:49], 0
  s_cbranch_scc1 L_attn_spun_43
  s_branch L_attn_slow_45
L_attn_hnd_48_x:
  s_cmp_eq_u64 s[48:49], 0
  s_cbranch_scc1 L_attn_spun_47
  s_branch L_attn_slow_49
L_attn_hnd_52_x:
  s_cmp_eq_u64 s[48:49], 0
  s_cbranch_scc1 L_attn_spun_51
  s_branch L_attn_slow_53
L_attn_hnd_56_x:
  s_cmp_eq_u64 s[48:49], 0
  s_cbranch_scc1 L_attn_spun_55
  s_branch L_attn_slow_57
L_attn_hnd_60_x:
  s_cmp_eq_u64 s[48:49], 0
  s_cbranch_scc1 L_attn_spun_59
  s_branch L_attn_slow_61
L_attn_hnd_64_x:
  s_cmp_eq_u64 s[48:49], 0
  s_cbranch_scc1 L_attn_spun_63
  s_branch L_attn_slow_65
L_attn_hnd_68_x:
  s_cmp_eq_u64 s[48:49], 0
  s_cbranch_scc1 L_attn_spun_67
  s_branch L_attn_slow_69
L_attn_hnd_72_x:
  s_cmp_eq_u64 s[48:49], 0
  s_cbranch_scc1 L_attn_spun_71
  s_branch L_attn_slow_73
L_attn_hnd_76_x:
  s_cmp_eq_u64 s[48:49], 0
  s_cbranch_scc1 L_attn_spun_75
  s_branch L_attn_slow_77
L_attn_hnd_80_x:
  s_cmp_eq_u64 s[48:49], 0
  s_cbranch_scc1 L_attn_spun_79
  s_branch L_attn_slow_81
L_attn_hnd_84_x:
  s_cmp_eq_u64 s[48:49], 0
  s_cbranch_scc1 L_attn_spun_83
  s_branch L_attn_slow_85
L_attn_spin_12:
  s_mov_b32 s39, 0x100000
L_attn_spin_12_l:
  ds_read_b32 v20, v19
  s_waitcnt lgkmcnt(0)
  v_cmp_gt_i32 vcc, s31, v20
  s_cbranch_vccz L_attn_spun_13
  s_sleep 1
  s_sub_u32 s39, s39, 1
  s_cbranch_scc0 L_attn_spin_12_l
  s_branch L_attn_spun_13
L_attn_hnd_16:
  s_mov_b32 s39, 0x100000
L_attn_hnd_16_l:
  ds_read_b32 v20, v19
  s_waitcnt lgkmcnt(0)
  v_cmp_gt_i32 vcc, s31, v20
  s_cbranch_vccz L_attn_hnd_16_x
  s_sleep 1
  s_sub_u32 s39, s39, 1
  s_cbranch_scc0 L_attn_hnd_16_l
  s_branch L_attn_hnd_16_x
L_attn_hnd_20:
  s_mov_b32 s39, 0x100000
L_attn_hnd_20_l:
  ds_read_b32 v20, v19
  s_waitcnt lgkmcnt(0)
  v_cmp_gt_i32 vcc, s31, v20
  s_cbranch_vccz L_attn_hnd_20_x
  s_sleep 1
  s_sub_u32 s39, s39, 1
  s_cbranch_scc0 L_attn_hnd_20_l
  s_branch L_attn_hnd_20_x
L_attn_hnd_24:
  s_mov_b32 s39, 0x100000
L_attn_hnd_24_l:
  ds_read_b32 v20, v19
  s_waitcnt lgkmcnt(0)
  v_cmp_gt_i32 vcc, s31, v20
  s_cbranch_vccz L_attn_hnd_24_x
  s_sleep 1
  s_sub_u32 s39, s39, 1
  s_cbranch_scc0 L_attn_hnd_24_l
  s_branch L_attn_hnd_24_x
L_attn_hnd_28:
  s_mov_b32 s39, 0x100000
L_attn_hnd_28_l:
  ds_read_b32 v20, v19
  s_waitcnt lgkmcnt(0)
  v_cmp_gt_i32 vcc, s31, v20
  s_cbranch_vccz L_attn_hnd_28_x
  s_sleep 1
  s_sub_u32 s39, s39, 1
  s_cbranch_scc0 L_attn_hnd_28_l
  s_branch L_attn_hnd_28_x
L_attn_hnd_32:
  s_mov_b32 s39, 0x100000
L_attn_hnd_32_l:
  ds_read_b32 v20, v19
  s_waitcnt lgkmcnt(0)
  v_cmp_gt_i32 vcc, s31, v20
  s_cbranch_vccz L_attn_hnd_32_x
  s_sleep 1
  s_sub_u32 s39, s39, 1
  s_cbranch_scc0 L_attn_hnd_32_l
  s_branch L_attn_hnd_32_x
L_attn_hnd_36:
  s_mov_b32 s39, 0x100000
L_attn_hnd_36_l:
  ds_read_b32 v20, v19
  s_waitcnt lgkmcnt(0)
  v_cmp_gt_i32 vcc, s31, v20
  s_cbranch_vccz L_attn_hnd_36_x
  s_sleep 1
  s_sub_u32 s39, s39, 1
  s_cbranch_scc0 L_attn_hnd_36_l
  s_branch L_attn_hnd_36_x
L_attn_hnd_40:
  s_mov_b32 s39, 0x100000
L_attn_hnd_40_l:
  ds_read_b32 v20, v19
  s_waitcnt lgkmcnt(0)
  v_cmp_gt_i32 vcc, s31, v20
  s_cbranch_vccz L_attn_hnd_40_x
  s_sleep 1
  s_sub_u32 s39, s39, 1
  s_cbranch_scc0 L_attn_hnd_40_l
  s_branch L_attn_hnd_40_x
L_attn_hnd_44:
  s_mov_b32 s39, 0x100000
L_attn_hnd_44_l:
  ds_read_b32 v20, v19
  s_waitcnt lgkmcnt(0)
  v_cmp_gt_i32 vcc, s31, v20
  s_cbranch_vccz L_attn_hnd_44_x
  s_sleep 1
  s_sub_u32 s39, s39, 1
  s_cbranch_scc0 L_attn_hnd_44_l
  s_branch L_attn_hnd_44_x
L_attn_hnd_48:
  s_mov_b32 s39, 0x100000
L_attn_hnd_48_l:
  ds_read_b32 v20, v19
  s_waitcnt lgkmcnt(0)
  v_cmp_gt_i32 vcc, s31, v20
  s_cbranch_vccz L_attn_hnd_48_x
  s_sleep 1
  s_sub_u32 s39, s39, 1
  s_cbranch_scc0 L_attn_hnd_48_l
  s_branch L_attn_hnd_48_x
L_attn_hnd_52:
  s_mov_b32 s39, 0x100000
L_attn_hnd_52_l:
  ds_read_b32 v20, v19
  s_waitcnt lgkmcnt(0)
  v_cmp_gt_i32 vcc, s31, v20
  s_cbranch_vccz L_attn_hnd_52_x
  s_sleep 1
  s_sub_u32 s39, s39, 1
  s_cbranch_scc0 L_attn_hnd_52_l
  s_branch L_attn_hnd_52_x
L_attn_hnd_56:
  s_mov_b32 s39, 0x100000
L_attn_hnd_56_l:
  ds_read_b32 v20, v19
  s_waitcnt lgkmcnt(0)
  v_cmp_gt_i32 vcc, s31, v20
  s_cbranch_vccz L_attn_hnd_56_x
  s_sleep 1
  s_sub_u32 s39, s39, 1
  s_cbranch_scc0 L_attn_hnd_56_l
  s_branch L_attn_hnd_56_x
L_attn_hnd_60:
  s_mov_b32 s39, 0x100000
L_attn_hnd_60_l:
  ds_read_b32 v20, v19
  s_waitcnt lgkmcnt(0)
  v_cmp_gt_i32 vcc, s31, v20
  s_cbranch_vccz L_attn_hnd_60_x
  s_sleep 1
  s_sub_u32 s39, s39, 1
  s_cbranch_scc0 L_attn_hnd_60_l
  s_branch L_attn_hnd_60_x
L_attn_hnd_64:
  s_mov_b32 s39, 0x100000
L_attn_hnd_64_l:
  ds_read_b32 v20, v19
  s_waitcnt lgkmcnt(0)
  v_cmp_gt_i32 vcc, s31, v20
  s_cbranch_vccz L_attn_hnd_64_x
  s_sleep 1
  s_sub_u32 s39, s39, 1
  s_cbranch_scc0 L_attn_hnd_64_l
  s_branch L_attn_hnd_64_x
L_attn_hnd_68:
  s_mov_b32 s39, 0x100000
L_attn_hnd_68_l:
  ds_read_b32 v20, v19
  s_waitcnt lgkmcnt(0)
  v_cmp_gt_i32 vcc, s31, v20
  s_cbranch_vccz L_attn_hnd_68_x
  s_sleep 1
  s_sub_u32 s39, s39, 1
  s_cbranch_scc0 L_attn_hnd_68_l
  s_branch L_attn_hnd_68_x
L_attn_hnd_72:
  s_mov_b32 s39, 0x100000
L_attn_hnd_72_l:
  ds_read_b32 v20, v19
  s_waitcnt lgkmcnt(0)
  v_cmp_gt_i32 vcc, s31, v20
  s_cbranch_vccz L_attn_hnd_72_x
  s_sleep 1
  s_sub_u32 s39, s39, 1
  s_cbranch_scc0 L_attn_hnd_72_l
  s_branch L_attn_hnd_72_x
L_attn_hnd_76:
  s_mov_b32 s39, 0x100000
L_attn_hnd_76_l:
  ds_read_b32 v20, v19
  s_waitcnt lgkmcnt(0)
  v_cmp_gt_i32 vcc, s31, v20
  s_cbranch_vccz L_attn_hnd_76_x
  s_sleep 1
  s_sub_u32 s39, s39, 1
  s_cbranch_scc0 L_attn_hnd_76_l
  s_branch L_attn_hnd_76_x
L_attn_hnd_80:
  s_mov_b32 s39, 0x100000
L_attn_hnd_80_l:
  ds_read_b32 v20, v19
  s_waitcnt lgkmcnt(0)
  v_cmp_gt_i32 vcc, s31, v20
  s_cbranch_vccz L_attn_hnd_80_x
  s_sleep 1
  s_sub_u32 s39, s39, 1
  s_cbranch_scc0 L_attn_hnd_80_l
  s_branch L_attn_hnd_80_x
L_attn_hnd_84:
  s_mov_b32 s39, 0x100000
L_attn_hnd_84_l:
  ds_read_b32 v20, v19
  s_waitcnt lgkmcnt(0)
  v_cmp_gt_i32 vcc, s31, v20
  s_cbranch_vccz L_attn_hnd_84_x
  s_sleep 1
  s_sub_u32 s39, s39, 1
  s_cbranch_scc0 L_attn_hnd_84_l
  s_branch L_attn_hnd_84_x
.section .rodata,"a"
.p2align 6
.amdhsa_kernel qa_kernel
  .amdhsa_next_free_vgpr 256
  .amdhsa_next_free_sgpr 102
  .amdhsa_accum_offset 192
  .amdhsa_group_segment_fixed_size 0
  .amdhsa_kernarg_size 96
  .amdhsa_user_sgpr_count 2
  .amdhsa_user_sgpr_kernarg_segment_ptr 1
  .amdhsa_system_sgpr_workgroup_id_x 1
.end_amdhsa_kernel
```
